```python
import torch

def _softmax(x, axis=-1):
    return torch.softmax(x, dim=axis)

def _gelu(x):
    return torch.nn.functional.gelu(x, approximate='tanh')

def _silu(x):
    return torch.nn.functional.silu(x)

def _sigmoid(x):
    return torch.sigmoid(x)

def _layernorm(x, axis=-1, eps=1e-05):
    m = x.mean(dim=axis, keepdim=True)
    v = x.var(dim=axis, keepdim=True, unbiased=False)
    return (x - m) / torch.sqrt(v + eps)

def _scatter_add(tgt, idx, src, axis=0):
    return tgt.clone().index_add_(axis, idx, src)

def _segment_sum(src, seg, n):
    out = torch.zeros((n,) + src.shape[1:], dtype=src.dtype)
    return out.index_add_(0, seg, src)

def _pad(x, pw):
    flat = tuple((v for pair in reversed(pw) for v in pair))
    return torch.nn.functional.pad(x, flat)
kernel_name = 'concat_heads__linear_kernel_hedgehog__memory_aug_recurrent_mem_tr__prompt'

def setup_inputs():

    _w = lambda a: (lambda t: t.to(torch.bfloat16) if t.is_floating_point() else t)(torch.as_tensor(a))

    def _A_setup():
        B, S, D, H = (1, 2048, 640, 32)
        Dh = D // H
        return {'x': _w((lambda *s: torch.randn(*s, dtype=torch.bfloat16) * 0.8)(B, S, D)), 'wqkv': _w((lambda *s: torch.randn(*s, dtype=torch.bfloat16) * 0.8)(D, 3 * D)), 'w_phi': _w((lambda *s: torch.randn(*s, dtype=torch.bfloat16) * 0.8)(H, Dh, Dh) * Dh ** (-0.5)), 'wo': _w((lambda *s: torch.randn(*s, dtype=torch.bfloat16) * 0.05)(D, D))}
    _A_in = _A_setup()

    def _B_setup():
        B, S, Dm = (1, 2048, 640)
        H, Dh = (32, 128)
        M, seg = (8, 32)
        seg = min(seg, S)
        S = S // seg * seg
        return {'x': _w((lambda *s: torch.randn(*s, dtype=torch.bfloat16) * 0.05)(B, S, Dm)), 'mem0': _w((lambda *s: torch.randn(*s, dtype=torch.bfloat16) * 1.6)(B, M, Dm)), 'Wq': _w((lambda *s: torch.randn(*s, dtype=torch.bfloat16) * 0.8)(Dm, H, Dh) * Dm ** (-0.5)), 'Wk': _w((lambda *s: torch.randn(*s, dtype=torch.bfloat16) * 0.8)(Dm, H, Dh) * Dm ** (-0.5)), 'Wv': _w((lambda *s: torch.randn(*s, dtype=torch.bfloat16) * 1.6)(Dm, H, Dh) * Dm ** (-0.5)), 'Wo': _w((lambda *s: torch.randn(*s, dtype=torch.bfloat16) * 1.6)(H, Dh, Dm) * (H * Dh) ** (-0.5)), 'seg_len': seg}
    _B_in = _B_setup()
    return {'A_x': _A_in['x'], 'A_wqkv': _A_in['wqkv'], 'A_w_phi': _A_in['w_phi'], 'A_wo': _A_in['wo'], 'B_x': _B_in['x'], 'B_mem0': _B_in['mem0'], 'B_Wq': _B_in['Wq'], 'B_Wk': _B_in['Wk'], 'B_Wv': _B_in['Wv'], 'B_Wo': _B_in['Wo'], 'B_seg_len': _B_in['seg_len']}

def reference(A_x, A_wqkv, A_w_phi, A_wo, B_x, B_mem0, B_Wq, B_Wk, B_Wv, B_Wo, B_seg_len):

    def _A_ref(x, wqkv, w_phi, wo):
        B, S, D = x.shape
        H = 32
        Dh = D // H
        qkv = (lambda x, *d: x.permute(*d))((x @ wqkv).reshape(B, S, 3, H, Dh), 2, 0, 3, 1, 4)
        q, k, v = (qkv[0], qkv[1], qkv[2])
        pq = torch.einsum('bhsd,hdf->bhsf', q, w_phi)
        pk = torch.einsum('bhsd,hdf->bhsf', k, w_phi)
        phi_q = torch.concatenate([_softmax(pq, axis=-1), _softmax(-pq, axis=-1)], axis=-1)
        phi_k = torch.concatenate([_softmax(pk, axis=-1), _softmax(-pk, axis=-1)], axis=-1)
        kv = torch.einsum('bhsf,bhsd->bhfd', phi_k, v)
        z = torch.einsum('bhsf->bhf', phi_k)
        num = torch.einsum('bhqf,bhfd->bhqd', phi_q, kv)
        den = torch.einsum('bhqf,bhf->bhq', phi_q, z)[..., None] + 1e-06
        o = num / den
        return (lambda x, *d: x.permute(*d))(o, 0, 2, 1, 3).reshape(B, S, D) @ wo

    def _B_ref(x, mem0, Wq, Wk, Wv, Wo, seg_len):
        B, S, Dm = x.shape
        H, Dh = (Wq.shape[1], Wq.shape[2])
        M = mem0.shape[1]
        scale = Dh ** (-0.5)
        n_seg = S // seg_len
        L = M + seg_len
        idx = torch.arange(L)
        mask = (idx[:, None] < M) | (idx[:, None] >= idx[None, :])
        mem = mem0
        outs = []
        for s in range(n_seg):
            xs = x[:, s * seg_len:(s + 1) * seg_len, :].clone()
            h = torch.concatenate([mem, xs], axis=1)
            q = torch.einsum('btd,dhe->bhte', h, Wq)
            k = torch.einsum('btd,dhe->bhte', h, Wk)
            v = torch.einsum('btd,dhe->bhte', h, Wv)
            scores = torch.einsum('bhqe,bhke->bhqk', q, k) * scale
            scores = torch.where(mask[None, None], scores, -1000000000.0)
            p = _softmax(scores, axis=-1)
            o = torch.einsum('bhqk,bhke->bhqe', p, v)
            o = torch.einsum('bhte,hed->btd', o, Wo)
            mem = o[:, :M, :].clone()
            outs.append(o[:, M:, :])
        return torch.concatenate(outs, axis=1)
    a = _A_ref(A_x, A_wqkv, A_w_phi, A_wo)
    b = _B_ref(B_x, B_mem0, B_Wq, B_Wk, B_Wv, B_Wo, B_seg_len)
    return torch.concatenate([a, b], axis=-1)
```

```asm
; @launch grid=(256,1,1) block=(256,1,1) lds=163840
.amdgcn_target "amdgcn-amd-amdhsa--gfx950"
.text
.globl concat_heads__linear_kernel_hedgehog__memory_aug_recurrent_mem_tr__prompt_kernel
.p2align 8
.type concat_heads__linear_kernel_hedgehog__memory_aug_recurrent_mem_tr__prompt_kernel,@function
concat_heads__linear_kernel_hedgehog__memory_aug_recurrent_mem_tr__prompt_kernel:
    s_load_dwordx16 s[48:63], s[0:1], 0
    s_load_dwordx8 s[64:71], s[0:1], 64
    s_load_dwordx4 s[72:75], s[0:1], 96
    s_getreg_b32 s8, hwreg(HW_REG_XCC_ID, 0, 4)
    v_lshrrev_b32 v1, 6, v0
    v_and_b32 v79, 63, v0
    v_readfirstlane_b32 s9, v1
    s_waitcnt lgkmcnt(0)
    s_mov_b32 s12, s72
    s_mov_b32 s13, s73
    s_mov_b32 s14, 0x100
    s_mov_b32 s15, 0x20000
    s_mov_b32 s16, s74
    s_mov_b32 s17, s75
    s_mov_b32 s18, 0x10000000
    s_mov_b32 s19, 0x20000
    v_mov_b32 v3, 1
    s_lshl_b32 s24, s8, 2
    s_cmp_lt_u32 s8, 2
    s_cselect_b32 s25, 192, 0
    s_add_u32 s24, s24, s25
    v_mov_b32 v4, s24
    v_mov_b32 v5, 0
    s_cmp_lg_u32 s9, 0
    s_cbranch_scc1 L_notk
    s_mov_b64 exec, 1
    buffer_atomic_add v3, v4, s[12:15], 0 offen sc0
    s_mov_b64 exec, -1
    L_notk:
    s_cmp_lg_u32 s9, 0
    s_cbranch_scc1 L_noat
    s_waitcnt vmcnt(0)
    s_mov_b64 exec, 1
    ds_write_b32 v5, v3
    s_mov_b64 exec, -1
    s_waitcnt lgkmcnt(0)
L_noat:
    s_barrier
    ds_read_b32 v7, v5
    s_waitcnt lgkmcnt(0)
    v_readfirstlane_b32 s10, v7
    s_barrier
    s_cmp_ge_u32 s10, 32
    s_cbranch_scc1 L_end
    s_cmp_lt_u32 s8, 2
    s_cbranch_scc1 L_rec0
    s_cmp_lg_u32 s8, 2
    s_cbranch_scc1 L_cal
    s_cmp_lg_u32 s9, 0
    s_cbranch_scc1 L_cal
    v_mov_b32 v16, 0
    v_mov_b32 v17, -1
    s_mov_b64 exec, 1
    s_mov_b32 s30, -1
    s_lshl_b32 s24, s10, 12
    s_add_u32 s24, s24, 20971520
    s_memtime s[26:27]
    s_waitcnt lgkmcnt(0)
    buffer_store_dword v17, v16, s[16:19], s24 offen sc1
    s_waitcnt vmcnt(0)
    s_memtime s[28:29]
    s_waitcnt lgkmcnt(0)
    s_sub_u32 s25, s28, s26
    s_min_u32 s30, s30, s25
    s_memtime s[26:27]
    s_waitcnt lgkmcnt(0)
    buffer_store_dword v17, v16, s[16:19], s24 offen sc1
    s_waitcnt vmcnt(0)
    s_memtime s[28:29]
    s_waitcnt lgkmcnt(0)
    s_sub_u32 s25, s28, s26
    s_min_u32 s30, s30, s25
    s_memtime s[26:27]
    s_waitcnt lgkmcnt(0)
    buffer_store_dword v17, v16, s[16:19], s24 offen sc1
    s_waitcnt vmcnt(0)
    s_memtime s[28:29]
    s_waitcnt lgkmcnt(0)
    s_sub_u32 s25, s28, s26
    s_min_u32 s30, s30, s25
    s_memtime s[26:27]
    s_waitcnt lgkmcnt(0)
    buffer_store_dword v17, v16, s[16:19], s24 offen sc1
    s_waitcnt vmcnt(0)
    s_memtime s[28:29]
    s_waitcnt lgkmcnt(0)
    s_sub_u32 s25, s28, s26
    s_min_u32 s30, s30, s25
    s_lshl_b32 s24, s10, 2
    s_add_u32 s24, s24, 3170304
    v_mov_b32 v17, s30
    buffer_store_dword v17, v16, s[16:19], s24 offen sc1
    v_mov_b32 v17, 1
    v_mov_b32 v18, 76
    s_waitcnt vmcnt(0)
    buffer_atomic_add v17, v18, s[12:15], 0 offen
    s_mov_b64 exec, -1
    s_cmp_lg_u32 s10, 0
    s_cbranch_scc1 L_cal
    v_mov_b32 v18, 76
    s_mov_b32 s26, 200000
L_calw:
    buffer_load_dword v17, v18, s[12:15], 0 offen sc1
    s_waitcnt vmcnt(0)
    v_readfirstlane_b32 s24, v17
    s_sub_u32 s26, s26, 1
    s_cbranch_scc1 L_fail
    s_cmp_lt_u32 s24, 32
    s_cbranch_scc1 L_calw
    v_lshlrev_b32 v17, 2, v79
    v_and_b32 v17, 0x7c, v17
    s_mov_b32 s24, 3170304
    buffer_load_dword v16, v17, s[16:19], s24 offen sc1
    s_waitcnt vmcnt(0)
    v_mov_b32 v18, v16
    v_mov_b32 v19, v16
    s_nop 1
    v_min_u32_dpp v18, v18, v18 row_ror:1 row_mask:0xf bank_mask:0xf
    v_max_u32_dpp v19, v19, v19 row_ror:1 row_mask:0xf bank_mask:0xf
    s_nop 1
    v_min_u32_dpp v18, v18, v18 row_ror:2 row_mask:0xf bank_mask:0xf
    v_max_u32_dpp v19, v19, v19 row_ror:2 row_mask:0xf bank_mask:0xf
    s_nop 1
    v_min_u32_dpp v18, v18, v18 row_ror:4 row_mask:0xf bank_mask:0xf
    v_max_u32_dpp v19, v19, v19 row_ror:4 row_mask:0xf bank_mask:0xf
    s_nop 1
    v_min_u32_dpp v18, v18, v18 row_ror:8 row_mask:0xf bank_mask:0xf
    v_max_u32_dpp v19, v19, v19 row_ror:8 row_mask:0xf bank_mask:0xf
    s_nop 1
    v_readlane_b32 s24, v18, 0
    v_readlane_b32 s25, v18, 16
    v_readlane_b32 s26, v19, 0
    v_readlane_b32 s27, v19, 16
    s_min_u32 s24, s24, s25
    s_max_u32 s26, s26, s27
    s_min_u32 s26, s26, 0x10000
    s_add_u32 s24, s24, s26
    s_lshr_b32 s24, s24, 1
    v_cmp_ge_u32 vcc, s24, v16
    s_nop 4
    s_mov_b32 s24, vcc_lo
    s_bcnt1_i32_b32 s25, s24
    s_cmp_ge_u32 s25, 10
    s_cselect_b32 s24, s24, -1
    v_mov_b32 v17, s24
    v_mov_b32 v18, 72
    s_mov_b64 exec, 1
    buffer_store_dword v17, v18, s[12:15], 0 offen sc1
    s_mov_b64 exec, -1
L_cal:
    s_branch L_help
L_rec0:
    v_mov_b32 v15, v79
    v_and_b32 v70, 15, v79
    v_lshrrev_b32 v71, 4, v79
    v_bfe_u32 v72, v79, 2, 2
    v_and_b32 v73, 3, v79
    v_and_b32 v74, 1, v71
    v_lshlrev_b32 v74, 1, v74
    v_xor_b32 v74, v74, v70
    s_lshl_b32 s25, s10, 8
    s_lshl_b32 s24, s9, 1
    s_add_u32 s24, s24, 0
    s_and_b32 s24, s24, 3
    s_lshl_b32 s24, s24, 1
    v_and_b32 v75, 7, v79
    v_xor_b32 v75, s24, v75
    v_lshlrev_b32 v75, 4, v75
    v_lshrrev_b32 v76, 3, v79
    s_lshl_b32 s24, s10, 7
    s_lshl_b32 s26, s9, 5
    s_add_u32 s24, s24, s26
    v_add_u32 v76, s24, v76
    v_mul_u32_u24 v76, 1280, v76
    s_mul_i32 s24, s8, 640
    v_add3_u32 v75, v76, v75, s24
    v_add_u32 v20, 0, v75
    v_add_u32 v21, 9216, v75
    s_lshl_b32 s24, s9, 1
    s_add_u32 s24, s24, 1
    s_and_b32 s24, s24, 3
    s_lshl_b32 s24, s24, 1
    v_and_b32 v75, 7, v79
    v_xor_b32 v75, s24, v75
    v_lshlrev_b32 v75, 4, v75
    v_lshrrev_b32 v76, 3, v79
    s_lshl_b32 s24, s10, 7
    s_lshl_b32 s26, s9, 5
    s_add_u32 s24, s24, s26
    v_add_u32 v76, s24, v76
    v_mul_u32_u24 v76, 1280, v76
    s_mul_i32 s24, s8, 640
    v_add3_u32 v75, v76, v75, s24
    v_add_u32 v22, 18432, v75
    v_add_u32 v23, 27648, v75
    v_xor_b32 v75, 0, v74
    v_lshlrev_b32 v75, 4, v75
    s_lshl_b32 s24, s9, 4
    s_add_u32 s24, s24, 0
    v_add_u32 v76, s24, v71
    v_lshl_add_u32 v75, v76, 13, v75
    s_sub_u32 s24, s25, 0
    v_add_u32 v16, s24, v75
    v_xor_b32 v75, 4, v74
    v_lshlrev_b32 v75, 4, v75
    s_lshl_b32 s24, s9, 4
    s_add_u32 s24, s24, 4
    v_add_u32 v76, s24, v71
    v_lshl_add_u32 v75, v76, 13, v75
    s_sub_u32 s24, s25, 1024
    v_add_u32 v17, s24, v75
    v_xor_b32 v75, 8, v74
    v_lshlrev_b32 v75, 4, v75
    s_lshl_b32 s24, s9, 4
    s_add_u32 s24, s24, 8
    v_add_u32 v76, s24, v71
    v_lshl_add_u32 v75, v76, 13, v75
    s_sub_u32 s24, s25, 2048
    v_add_u32 v18, s24, v75
    v_xor_b32 v75, 12, v74
    v_lshlrev_b32 v75, 4, v75
    s_lshl_b32 s24, s9, 4
    s_add_u32 s24, s24, 12
    v_add_u32 v76, s24, v71
    v_lshl_add_u32 v75, v76, 13, v75
    s_sub_u32 s24, s25, 3072
    v_add_u32 v19, s24, v75
    v_xor_b32 v75, 0, v72
    v_and_b32 v75, 2, v75
    v_or_b32 v75, 0, v75
    v_lshl_add_u32 v40, v75, 19, v16
    v_xor_b32 v75, 1, v72
    v_and_b32 v75, 2, v75
    v_or_b32 v75, 0, v75
    v_lshl_add_u32 v41, v75, 19, v17
    v_xor_b32 v75, 2, v72
    v_and_b32 v75, 2, v75
    v_or_b32 v75, 0, v75
    v_lshl_add_u32 v42, v75, 19, v18
    v_xor_b32 v75, 3, v72
    v_and_b32 v75, 2, v75
    v_or_b32 v75, 0, v75
    v_lshl_add_u32 v43, v75, 19, v19
    v_xor_b32 v75, 1, v72
    v_and_b32 v75, 2, v75
    v_or_b32 v75, 1, v75
    v_lshl_add_u32 v44, v75, 19, v16
    v_xor_b32 v75, 0, v72
    v_and_b32 v75, 2, v75
    v_or_b32 v75, 1, v75
    v_lshl_add_u32 v45, v75, 19, v17
    v_xor_b32 v75, 3, v72
    v_and_b32 v75, 2, v75
    v_or_b32 v75, 1, v75
    v_lshl_add_u32 v46, v75, 19, v18
    v_xor_b32 v75, 2, v72
    v_and_b32 v75, 2, v75
    v_or_b32 v75, 1, v75
    v_lshl_add_u32 v47, v75, 19, v19
    v_xor_b32 v75, 2, v72
    v_and_b32 v75, 2, v75
    v_or_b32 v75, 0, v75
    v_lshl_add_u32 v48, v75, 19, v16
    v_xor_b32 v75, 3, v72
    v_and_b32 v75, 2, v75
    v_or_b32 v75, 0, v75
    v_lshl_add_u32 v49, v75, 19, v17
    v_xor_b32 v75, 0, v72
    v_and_b32 v75, 2, v75
    v_or_b32 v75, 0, v75
    v_lshl_add_u32 v50, v75, 19, v18
    v_xor_b32 v75, 1, v72
    v_and_b32 v75, 2, v75
    v_or_b32 v75, 0, v75
    v_lshl_add_u32 v51, v75, 19, v19
    v_xor_b32 v75, 3, v72
    v_and_b32 v75, 2, v75
    v_or_b32 v75, 1, v75
    v_lshl_add_u32 v52, v75, 19, v16
    v_xor_b32 v75, 2, v72
    v_and_b32 v75, 2, v75
    v_or_b32 v75, 1, v75
    v_lshl_add_u32 v53, v75, 19, v17
    v_xor_b32 v75, 1, v72
    v_and_b32 v75, 2, v75
    v_or_b32 v75, 1, v75
    v_lshl_add_u32 v54, v75, 19, v18
    v_xor_b32 v75, 0, v72
    v_and_b32 v75, 2, v75
    v_or_b32 v75, 1, v75
    v_lshl_add_u32 v55, v75, 19, v19
    s_lshl_b32 s29, s9, 12
    s_mul_i32 s30, s8, 2621440
    s_mul_i32 s31, s8, 4292345856
    s_mov_b32 s20, s60
    s_mov_b32 s21, s61
    s_mov_b32 s22, 0x500000
    s_mov_b32 s23, 0x20000
    s_add_u32 m0, s29, 98304
    s_add_u32 s28, s30, 0
    buffer_load_dwordx4 v40, s[20:23], s28 offen offset:0 lds
    buffer_load_dwordx4 v41, s[20:23], s28 offen offset:1024 lds
    buffer_load_dwordx4 v42, s[20:23], s28 offen offset:2048 lds
    buffer_load_dwordx4 v43, s[20:23], s28 offen offset:3072 lds
    s_add_u32 m0, s29, 114688
    s_add_u32 s28, s30, 0
    buffer_load_dwordx4 v44, s[20:23], s28 offen offset:0 lds
    buffer_load_dwordx4 v45, s[20:23], s28 offen offset:1024 lds
    buffer_load_dwordx4 v46, s[20:23], s28 offen offset:2048 lds
    buffer_load_dwordx4 v47, s[20:23], s28 offen offset:3072 lds
    s_add_u32 m0, s29, 131072
    s_add_u32 s28, s30, 0
    buffer_load_dwordx4 v48, s[20:23], s28 offen offset:0 lds
    buffer_load_dwordx4 v49, s[20:23], s28 offen offset:1024 lds
    buffer_load_dwordx4 v50, s[20:23], s28 offen offset:2048 lds
    buffer_load_dwordx4 v51, s[20:23], s28 offen offset:3072 lds
    s_add_u32 m0, s29, 147456
    s_add_u32 s28, s30, 0
    buffer_load_dwordx4 v52, s[20:23], s28 offen offset:0 lds
    buffer_load_dwordx4 v53, s[20:23], s28 offen offset:1024 lds
    buffer_load_dwordx4 v54, s[20:23], s28 offen offset:2048 lds
    buffer_load_dwordx4 v55, s[20:23], s28 offen offset:3072 lds
    s_add_u32 m0, s29, 0
    s_add_u32 s28, s30, 2097152
    buffer_load_dwordx4 v16, s[20:23], s28 offen offset:0 lds
    buffer_load_dwordx4 v17, s[20:23], s28 offen offset:1024 lds
    buffer_load_dwordx4 v18, s[20:23], s28 offen offset:2048 lds
    buffer_load_dwordx4 v19, s[20:23], s28 offen offset:3072 lds
    s_mov_b32 s20, s62
    s_mov_b32 s21, s63
    s_mov_b32 s22, 0x500000
    s_mov_b32 s23, 0x20000
    s_add_u32 m0, s29, 16384
    s_add_u32 s28, s30, 2097152
    buffer_load_dwordx4 v16, s[20:23], s28 offen offset:0 lds
    buffer_load_dwordx4 v17, s[20:23], s28 offen offset:1024 lds
    buffer_load_dwordx4 v18, s[20:23], s28 offen offset:2048 lds
    buffer_load_dwordx4 v19, s[20:23], s28 offen offset:3072 lds
    s_mov_b32 s20, s60
    s_mov_b32 s21, s61
    s_mov_b32 s22, 0x500000
    s_mov_b32 s23, 0x20000
    s_add_u32 m0, s29, 32768
    s_add_u32 s28, s31, 2621440
    buffer_load_dwordx4 v48, s[20:23], s28 offen offset:0 lds
    buffer_load_dwordx4 v49, s[20:23], s28 offen offset:1024 lds
    buffer_load_dwordx4 v50, s[20:23], s28 offen offset:2048 lds
    buffer_load_dwordx4 v51, s[20:23], s28 offen offset:3072 lds
    s_add_u32 m0, s29, 49152
    s_add_u32 s28, s31, 2621440
    buffer_load_dwordx4 v52, s[20:23], s28 offen offset:0 lds
    buffer_load_dwordx4 v53, s[20:23], s28 offen offset:1024 lds
    buffer_load_dwordx4 v54, s[20:23], s28 offen offset:2048 lds
    buffer_load_dwordx4 v55, s[20:23], s28 offen offset:3072 lds
    s_mov_b32 s20, s62
    s_mov_b32 s21, s63
    s_mov_b32 s22, 0x500000
    s_mov_b32 s23, 0x20000
    s_add_u32 m0, s29, 65536
    s_add_u32 s28, s30, 0
    buffer_load_dwordx4 v40, s[20:23], s28 offen offset:0 lds
    buffer_load_dwordx4 v41, s[20:23], s28 offen offset:1024 lds
    buffer_load_dwordx4 v42, s[20:23], s28 offen offset:2048 lds
    buffer_load_dwordx4 v43, s[20:23], s28 offen offset:3072 lds
    s_add_u32 m0, s29, 81920
    s_add_u32 s28, s30, 0
    buffer_load_dwordx4 v44, s[20:23], s28 offen offset:0 lds
    buffer_load_dwordx4 v45, s[20:23], s28 offen offset:1024 lds
    buffer_load_dwordx4 v46, s[20:23], s28 offen offset:2048 lds
    buffer_load_dwordx4 v47, s[20:23], s28 offen offset:3072 lds
    s_mov_b32 s11, -1
    s_cmp_eq_u32 s9, 0
    s_cselect_b32 s11, s10, s11
    s_add_u32 s24, s10, 32
    s_cmp_lt_u32 s10, 8
    s_cselect_b32 s24, s24, -1
    s_cmp_eq_u32 s9, 1
    s_cselect_b32 s11, s24, s11
    v_lshlrev_b32 v5, 4, v79
    s_lshl_b32 s24, s9, 12
    s_add_u32 s24, s24, 81920
    v_add_u32 v6, s24, v5
    v_add_u32 v5, 131072, v5
    v_mov_b32 v7, 0x4444
    v_mov_b32 v74, 0xeeee
    v_and_b32 v75, 2, v79
    v_cmp_ne_u32 vcc, 0, v75
    v_lshlrev_b32 v8, 2, v79
    v_lshlrev_b32 v14, 3, v71
    v_cndmask_b32 v7, v7, v74, vcc
    v_mul_u32_u24 v9, 576, v71
    v_lshl_add_u32 v9, v70, 2, v9
    s_lshl_b32 s24, s9, 6
    s_add_u32 s24, s24, 157696
    v_add_u32 v9, s24, v9
    v_and_b32 v74, 7, v70
    v_mul_u32_u24 v10, 288, v74
    v_lshl_add_u32 v10, v71, 4, v10
    v_add_u32 v10, 157696, v10
    v_lshrrev_b32 v74, 2, v70
    v_and_b32 v75, 1, v70
    v_lshl_add_u32 v74, v74, 1, v75
    v_mul_u32_u24 v11, 288, v74
    v_lshl_add_u32 v11, v71, 4, v11
    v_add_u32 v11, 160000, v11
    v_lshrrev_b32 v74, 2, v70
    v_and_b32 v75, 1, v70
    v_lshl_add_u32 v74, v74, 1, v75
    v_lshlrev_b32 v12, 5, v74
    v_lshl_add_u32 v12, v71, 8, v12
    v_bfe_u32 v75, v70, 1, 1
    v_lshl_add_u32 v12, v75, 4, v12
    v_add_u32 v12, 131072, v12
    v_and_b32 v76, 7, v70
    v_lshlrev_b32 v13, 5, v76
    v_lshl_add_u32 v13, v71, 8, v13
    v_lshrrev_b32 v76, 3, v70
    v_lshl_add_u32 v13, v76, 4, v13
    s_lshr_b32 s24, s9, 1
    s_lshl_b32 s24, s24, 10
    s_and_b32 s25, s9, 1
    s_lshl_b32 s25, s25, 3
    s_add_u32 s24, s24, s25
    s_add_u32 s24, s24, 131072
    v_add_u32 v13, s24, v13
    s_mov_b32 s88, 0x00ff00ff
    s_mov_b32 s89, 0x00ff00ff
    s_mov_b32 s90, 0xff00ff00
    s_mov_b32 s91, 0xff00ff00
    s_mov_b32 s92, 0x3030303
    s_mov_b32 s93, 0x3030303
    s_mov_b32 s94, 0xc0c0c0c
    s_mov_b32 s95, 0xc0c0c0c
    s_mov_b32 s96, 0x30303030
    s_mov_b32 s97, 0x30303030
    s_mov_b32 s98, 0xc0c0c0c0
    s_mov_b32 s99, 0xc0c0c0c0
    s_mov_b32 s80, 0x3e0293ee
    s_mul_i32 s25, s8, 1048576
    s_add_u32 s25, s25, 131072
    s_lshl_b32 s24, s11, 7
    s_add_u32 s100, s24, s25
    s_mul_i32 s24, s10, 5248
    s_add_u32 s79, s24, s25
    s_cmp_eq_u32 s9, 1
    s_cselect_b64 s[86:87], -1, 0
    s_lshl_b32 s83, s9, 10
    s_add_u32 s85, s83, 131072
    s_lshl_b32 s24, s9, 8
    s_add_u32 s84, s24, 135168
    s_add_u32 s81, s24, 4096
    v_lshrrev_b32 v0, 3, v15
    v_mul_u32_u24 v0, 5248, v0
    v_and_b32 v1, 7, v15
    v_lshl_add_u32 v0, v1, 4, v0
    v_bfe_u32 v2, v15, 4, 1
    v_lshrrev_b32 v3, 5, v15
    v_lshl_add_u32 v2, v2, 1, v3
    v_lshrrev_b32 v1, 1, v1
    v_and_b32 v4, 1, v15
    v_lshlrev_b32 v4, 4, v4
    v_lshl_add_u32 v3, v2, 2, v4
    v_lshl_add_u32 v3, v1, 10, v3
    v_lshl_add_u32 v2, v2, 5, v4
    v_lshl_add_u32 v2, v1, 2, v2
    v_cndmask_b32 v1, v3, v2, s[86:87]
    v_cndmask_b32 v1, v1, v8, s[86:87]
    v_add_u32 v4, 0xffff0000, v6
    s_mul_i32 s24, s8, 32768
    s_add_u32 s32, s24, 2621440
    v_mov_b32 v32, -1
    v_mov_b32 v33, -1
    v_mov_b32 v34, -1
    v_mov_b32 v35, -1
    s_lshl_b32 s24, s9, 18
    s_add_u32 s24, s24, s79
    s_sub_u32 s24, s24, 131072
    buffer_store_dwordx4 v[32:35], v5, s[16:19], s24 offen offset:0
    buffer_store_dwordx4 v[32:35], v5, s[16:19], s24 offen offset:1024
    buffer_store_dwordx4 v[32:35], v5, s[16:19], s24 offen offset:2048
    buffer_store_dwordx4 v[32:35], v5, s[16:19], s24 offen offset:3072
    s_add_u32 s24, s24, 4096
    buffer_store_dwordx4 v[32:35], v5, s[16:19], s24 offen
    s_lshl_b32 s24, s8, 5
    s_add_u32 s24, s24, s10
    s_lshl_b32 s24, s24, 2
    s_add_u32 s24, s24, s9
    s_lshl_b32 s24, s24, 9
    s_add_u32 s24, s24, 20971520
    v_lshlrev_b32 v36, 1, v8
    buffer_store_dwordx2 v[32:33], v36, s[16:19], s24 offen sc1
    s_lshl_b32 s24, s9, 5
    s_add_u32 s24, s24, s10
    s_cmp_lt_u32 s24, 4
    s_cselect_b32 s25, 0, 1073741824
    s_lshl_b32 s24, s24, 13
    s_add_u32 s24, s24, s32
    s_add_u32 s24, s24, s25
    s_sub_u32 s24, s24, 131072
    buffer_store_dwordx4 v[32:35], v5, s[16:19], s24 offen offset:0
    buffer_store_dwordx4 v[32:35], v5, s[16:19], s24 offen offset:1024
    buffer_store_dwordx4 v[32:35], v5, s[16:19], s24 offen offset:2048
    buffer_store_dwordx4 v[32:35], v5, s[16:19], s24 offen offset:3072
    s_add_u32 s24, s24, 4096
    buffer_store_dwordx4 v[32:35], v5, s[16:19], s24 offen
    s_lshl_b32 s24, s8, 5
    s_add_u32 s24, s24, s10
    s_lshl_b32 s24, s24, 8
    s_add_u32 s47, s24, 3178496
    s_cmp_eq_u32 s9, 3
    s_cselect_b32 s47, s47, 1073741824
    v_mov_b32 v36, 0
    buffer_store_dword v36, v8, s[16:19], s47 offen sc1
    s_lshl_b32 s24, s10, 8
    s_add_u32 s68, s32, s24
    s_cmp_lt_u32 s10, 20
    s_cselect_b32 s68, s68, 1073741824
    s_cmp_eq_u32 s9, 2
    s_cselect_b32 s68, s68, 1073741824
    s_cmp_ge_u32 s11, 32
    s_cselect_b32 s25, 7, 5
    s_lshl_b32 s24, s11, s25
    s_add_u32 s82, s32, s24
    s_and_b32 s33, s24, 0xfff
    s_add_u32 s33, s33, 20971520
    s_cmp_eq_u32 s11, -1
    s_cselect_b32 s33, 1073741824, s33
    v_lshrrev_b32 v74, 1, v71
    v_and_b32 v75, 1, v71
    v_lshrrev_b32 v76, 1, v72
    v_and_b32 v77, 1, v72
    v_lshrrev_b32 v26, 1, v73
    s_lshl_b32 s24, s9, 2
    v_add_u32 v26, s24, v26
    v_and_b32 v27, 1, v73
    v_mov_b32 v30, 0
    v_xor_b32 v31, 1, v76
    v_lshlrev_b32 v78, 4, v74
    v_lshl_add_u32 v78, v76, 3, v78
    v_lshl_add_u32 v78, v75, 2, v78
    v_lshl_add_u32 v78, v30, 1, v78
    v_add_u32 v78, v78, v77
    v_lshl_add_u32 v25, v75, 1, v77
    v_lshl_add_u32 v25, v76, 2, v25
    v_lshlrev_b32 v25, 1, v25
    v_xor_b32 v25, v25, v26
    v_lshlrev_b32 v25, 4, v25
    v_lshl_add_u32 v60, v78, 8, v25
    v_lshl_add_u32 v60, v27, 3, v60
    v_lshlrev_b32 v78, 4, v74
    v_lshl_add_u32 v78, v76, 3, v78
    v_lshl_add_u32 v78, v77, 2, v78
    v_lshl_add_u32 v78, v75, 1, v78
    v_add_u32 v78, v78, v30
    v_lshl_add_u32 v25, v77, 1, v30
    v_lshl_add_u32 v25, v76, 2, v25
    v_lshlrev_b32 v25, 1, v25
    v_xor_b32 v25, v25, v26
    v_lshlrev_b32 v25, 4, v25
    v_lshl_add_u32 v62, v78, 8, v25
    v_lshl_add_u32 v62, v27, 3, v62
    v_lshlrev_b32 v78, 5, v75
    v_lshl_add_u32 v78, v76, 4, v78
    v_lshl_add_u32 v78, v74, 2, v78
    v_add_u32 v78, v78, v77
    v_lshl_add_u32 v25, v75, 1, v76
    v_lshlrev_b32 v25, 1, v25
    v_lshrrev_b32 v26, 1, v73
    s_lshl_b32 s24, s9, 1
    v_add_u32 v26, s24, v26
    v_xor_b32 v25, v25, v26
    v_lshlrev_b32 v25, 4, v25
    v_lshl_add_u32 v24, v78, 7, v25
    v_lshl_add_u32 v24, v27, 3, v24
    v_add_u32 v63, 0xfffec000, v6
    s_and_b32 s24, s9, 1
    s_lshl_b32 s24, s24, 14
    v_add_u32 v61, s24, v60
    v_subrev_u32 v59, s24, v60
    s_waitcnt vmcnt(44)
    s_barrier
    v_add_u32 v28, 98304, v61
    v_xor_b32 v29, 32, v28
    ds_read_b64_tr_b16 v[160:161], v28 offset:0
    ds_read_b64_tr_b16 v[162:163], v28 offset:512
    ds_read_b64_tr_b16 v[164:165], v28 offset:8192
    ds_read_b64_tr_b16 v[166:167], v28 offset:8704
    ds_read_b64_tr_b16 v[168:169], v29 offset:0
    ds_read_b64_tr_b16 v[170:171], v29 offset:512
    ds_read_b64_tr_b16 v[172:173], v29 offset:8192
    ds_read_b64_tr_b16 v[174:175], v29 offset:8704
    s_waitcnt lgkmcnt(8)
    v_add_u32 v28, 114688, v59
    v_xor_b32 v29, 32, v28
    ds_read_b64_tr_b16 v[176:177], v28 offset:0
    ds_read_b64_tr_b16 v[178:179], v28 offset:512
    ds_read_b64_tr_b16 v[180:181], v28 offset:8192
    ds_read_b64_tr_b16 v[182:183], v28 offset:8704
    ds_read_b64_tr_b16 v[184:185], v29 offset:0
    ds_read_b64_tr_b16 v[186:187], v29 offset:512
    ds_read_b64_tr_b16 v[188:189], v29 offset:8192
    ds_read_b64_tr_b16 v[190:191], v29 offset:8704
    s_waitcnt lgkmcnt(0)
    s_barrier
    s_add_u32 m0, s29, 98304
    s_add_u32 s28, s30, 0
    buffer_load_dwordx4 v48, s[20:23], s28 offen offset:0 lds
    buffer_load_dwordx4 v49, s[20:23], s28 offen offset:1024 lds
    buffer_load_dwordx4 v50, s[20:23], s28 offen offset:2048 lds
    buffer_load_dwordx4 v51, s[20:23], s28 offen offset:3072 lds
    s_add_u32 m0, s29, 114688
    s_add_u32 s28, s30, 0
    buffer_load_dwordx4 v52, s[20:23], s28 offen offset:0 lds
    buffer_load_dwordx4 v53, s[20:23], s28 offen offset:1024 lds
    buffer_load_dwordx4 v54, s[20:23], s28 offen offset:2048 lds
    buffer_load_dwordx4 v55, s[20:23], s28 offen offset:3072 lds
    s_waitcnt lgkmcnt(0)
    s_waitcnt vmcnt(44)
    s_barrier
    v_add_u32 v28, 131072, v61
    v_xor_b32 v29, 32, v28
    ds_read_b64_tr_b16 v[192:193], v28 offset:0
    ds_read_b64_tr_b16 v[194:195], v28 offset:512
    ds_read_b64_tr_b16 v[196:197], v28 offset:8192
    ds_read_b64_tr_b16 v[198:199], v28 offset:8704
    ds_read_b64_tr_b16 v[200:201], v29 offset:0
    ds_read_b64_tr_b16 v[202:203], v29 offset:512
    ds_read_b64_tr_b16 v[204:205], v29 offset:8192
    ds_read_b64_tr_b16 v[206:207], v29 offset:8704
    s_waitcnt lgkmcnt(8)
    v_add_u32 v28, 147456, v59
    v_xor_b32 v29, 32, v28
    ds_read_b64_tr_b16 v[208:209], v28 offset:0
    ds_read_b64_tr_b16 v[210:211], v28 offset:512
    ds_read_b64_tr_b16 v[212:213], v28 offset:8192
    ds_read_b64_tr_b16 v[214:215], v28 offset:8704
    ds_read_b64_tr_b16 v[216:217], v29 offset:0
    ds_read_b64_tr_b16 v[218:219], v29 offset:512
    ds_read_b64_tr_b16 v[220:221], v29 offset:8192
    ds_read_b64_tr_b16 v[222:223], v29 offset:8704
    s_waitcnt lgkmcnt(0)
    s_barrier
    s_add_u32 m0, s29, 131072
    s_add_u32 s28, s31, 2621440
    buffer_load_dwordx4 v40, s[20:23], s28 offen offset:0 lds
    buffer_load_dwordx4 v41, s[20:23], s28 offen offset:1024 lds
    buffer_load_dwordx4 v42, s[20:23], s28 offen offset:2048 lds
    buffer_load_dwordx4 v43, s[20:23], s28 offen offset:3072 lds
    s_add_u32 m0, s29, 147456
    s_add_u32 s28, s31, 2621440
    buffer_load_dwordx4 v44, s[20:23], s28 offen offset:0 lds
    buffer_load_dwordx4 v45, s[20:23], s28 offen offset:1024 lds
    buffer_load_dwordx4 v46, s[20:23], s28 offen offset:2048 lds
    buffer_load_dwordx4 v47, s[20:23], s28 offen offset:3072 lds
    s_waitcnt lgkmcnt(0)
    s_waitcnt vmcnt(44)
    s_barrier
    v_add_u32 v28, 0, v62
    v_xor_b32 v29, 32, v28
    ds_read_b64_tr_b16 v[224:225], v28 offset:0
    ds_read_b64_tr_b16 v[226:227], v29 offset:256
    ds_read_b64_tr_b16 v[228:229], v28 offset:8192
    ds_read_b64_tr_b16 v[230:231], v29 offset:8448
    ds_read_b64_tr_b16 v[232:233], v29 offset:0
    ds_read_b64_tr_b16 v[234:235], v28 offset:256
    ds_read_b64_tr_b16 v[236:237], v29 offset:8192
    ds_read_b64_tr_b16 v[238:239], v28 offset:8448
    s_waitcnt lgkmcnt(8)
    v_add_u32 v28, 16384, v62
    v_xor_b32 v29, 32, v28
    ds_read_b64_tr_b16 a[96:97], v28 offset:0
    ds_read_b64_tr_b16 a[98:99], v29 offset:256
    ds_read_b64_tr_b16 a[100:101], v28 offset:8192
    ds_read_b64_tr_b16 a[102:103], v29 offset:8448
    ds_read_b64_tr_b16 a[104:105], v29 offset:0
    ds_read_b64_tr_b16 a[106:107], v28 offset:256
    ds_read_b64_tr_b16 a[108:109], v29 offset:8192
    ds_read_b64_tr_b16 a[110:111], v28 offset:8448
    s_waitcnt lgkmcnt(0)
    s_barrier
    s_add_u32 m0, s29, 0
    s_add_u32 s28, s31, 2621440
    buffer_load_dwordx4 v48, s[20:23], s28 offen offset:0 lds
    buffer_load_dwordx4 v49, s[20:23], s28 offen offset:1024 lds
    buffer_load_dwordx4 v50, s[20:23], s28 offen offset:2048 lds
    buffer_load_dwordx4 v51, s[20:23], s28 offen offset:3072 lds
    s_add_u32 m0, s29, 16384
    s_add_u32 s28, s31, 2621440
    buffer_load_dwordx4 v52, s[20:23], s28 offen offset:0 lds
    buffer_load_dwordx4 v53, s[20:23], s28 offen offset:1024 lds
    buffer_load_dwordx4 v54, s[20:23], s28 offen offset:2048 lds
    buffer_load_dwordx4 v55, s[20:23], s28 offen offset:3072 lds
    s_waitcnt lgkmcnt(0)
    s_waitcnt vmcnt(44)
    s_barrier
    v_add_u32 v28, 32768, v61
    v_xor_b32 v29, 32, v28
    ds_read_b64_tr_b16 v[240:241], v28 offset:0
    ds_read_b64_tr_b16 v[242:243], v28 offset:512
    ds_read_b64_tr_b16 v[244:245], v28 offset:8192
    ds_read_b64_tr_b16 v[246:247], v28 offset:8704
    ds_read_b64_tr_b16 v[248:249], v29 offset:0
    ds_read_b64_tr_b16 v[250:251], v29 offset:512
    ds_read_b64_tr_b16 v[252:253], v29 offset:8192
    ds_read_b64_tr_b16 v[254:255], v29 offset:8704
    s_waitcnt lgkmcnt(8)
    v_add_u32 v28, 49152, v59
    v_xor_b32 v29, 32, v28
    ds_read_b64_tr_b16 a[0:1], v28 offset:0
    ds_read_b64_tr_b16 a[2:3], v28 offset:512
    ds_read_b64_tr_b16 a[4:5], v28 offset:8192
    ds_read_b64_tr_b16 a[6:7], v28 offset:8704
    ds_read_b64_tr_b16 a[8:9], v29 offset:0
    ds_read_b64_tr_b16 a[10:11], v29 offset:512
    ds_read_b64_tr_b16 a[12:13], v29 offset:8192
    ds_read_b64_tr_b16 a[14:15], v29 offset:8704
    s_waitcnt lgkmcnt(0)
    s_barrier
    s_mov_b32 s20, s64
    s_mov_b32 s21, s65
    s_mov_b32 s22, 0x500000
    s_mov_b32 s23, 0x20000
    s_add_u32 m0, s29, 32768
    s_add_u32 s28, s31, 2621440
    buffer_load_dwordx4 v40, s[20:23], s28 offen offset:0 lds
    buffer_load_dwordx4 v41, s[20:23], s28 offen offset:1024 lds
    buffer_load_dwordx4 v42, s[20:23], s28 offen offset:2048 lds
    buffer_load_dwordx4 v43, s[20:23], s28 offen offset:3072 lds
    s_add_u32 m0, s29, 49152
    s_add_u32 s28, s31, 2621440
    buffer_load_dwordx4 v44, s[20:23], s28 offen offset:0 lds
    buffer_load_dwordx4 v45, s[20:23], s28 offen offset:1024 lds
    buffer_load_dwordx4 v46, s[20:23], s28 offen offset:2048 lds
    buffer_load_dwordx4 v47, s[20:23], s28 offen offset:3072 lds
    s_waitcnt lgkmcnt(0)
    s_waitcnt vmcnt(44)
    s_barrier
    v_add_u32 v28, 65536, v61
    v_xor_b32 v29, 32, v28
    ds_read_b64_tr_b16 a[32:33], v28 offset:0
    ds_read_b64_tr_b16 a[34:35], v28 offset:512
    ds_read_b64_tr_b16 a[36:37], v28 offset:8192
    ds_read_b64_tr_b16 a[38:39], v28 offset:8704
    ds_read_b64_tr_b16 a[40:41], v29 offset:0
    ds_read_b64_tr_b16 a[42:43], v29 offset:512
    ds_read_b64_tr_b16 a[44:45], v29 offset:8192
    ds_read_b64_tr_b16 a[46:47], v29 offset:8704
    s_waitcnt lgkmcnt(8)
    v_add_u32 v28, 81920, v59
    v_xor_b32 v29, 32, v28
    ds_read_b64_tr_b16 a[48:49], v28 offset:0
    ds_read_b64_tr_b16 a[50:51], v28 offset:512
    ds_read_b64_tr_b16 a[52:53], v28 offset:8192
    ds_read_b64_tr_b16 a[54:55], v28 offset:8704
    ds_read_b64_tr_b16 a[56:57], v29 offset:0
    ds_read_b64_tr_b16 a[58:59], v29 offset:512
    ds_read_b64_tr_b16 a[60:61], v29 offset:8192
    ds_read_b64_tr_b16 a[62:63], v29 offset:8704
    s_waitcnt lgkmcnt(0)
    s_barrier
    s_add_u32 m0, s29, 65536
    s_add_u32 s28, s31, 2621440
    buffer_load_dwordx4 v48, s[20:23], s28 offen offset:0 lds
    buffer_load_dwordx4 v49, s[20:23], s28 offen offset:1024 lds
    buffer_load_dwordx4 v50, s[20:23], s28 offen offset:2048 lds
    buffer_load_dwordx4 v51, s[20:23], s28 offen offset:3072 lds
    s_add_u32 m0, s29, 81920
    s_add_u32 s28, s31, 2621440
    buffer_load_dwordx4 v52, s[20:23], s28 offen offset:0 lds
    buffer_load_dwordx4 v53, s[20:23], s28 offen offset:1024 lds
    buffer_load_dwordx4 v54, s[20:23], s28 offen offset:2048 lds
    buffer_load_dwordx4 v55, s[20:23], s28 offen offset:3072 lds
    s_waitcnt lgkmcnt(0)
    s_waitcnt vmcnt(32)
    s_barrier
    s_cmp_lg_u32 s9, 0
    s_cbranch_scc1 L_arrd
    v_mov_b32 v36, 1
    v_mov_b32 v37, 64
    s_mov_b64 exec, 1
    buffer_atomic_add v36, v37, s[12:15], 0 offen
    s_mov_b64 exec, -1
L_arrd:
    v_add_u32 v28, 98304, v61
    v_xor_b32 v29, 32, v28
    ds_read_b64_tr_b16 a[64:65], v28 offset:0
    ds_read_b64_tr_b16 a[66:67], v28 offset:512
    ds_read_b64_tr_b16 a[68:69], v28 offset:8192
    ds_read_b64_tr_b16 a[70:71], v28 offset:8704
    ds_read_b64_tr_b16 a[72:73], v29 offset:0
    ds_read_b64_tr_b16 a[74:75], v29 offset:512
    ds_read_b64_tr_b16 a[76:77], v29 offset:8192
    ds_read_b64_tr_b16 a[78:79], v29 offset:8704
    s_waitcnt lgkmcnt(8)
    v_add_u32 v28, 114688, v59
    v_xor_b32 v29, 32, v28
    ds_read_b64_tr_b16 a[80:81], v28 offset:0
    ds_read_b64_tr_b16 a[82:83], v28 offset:512
    ds_read_b64_tr_b16 a[84:85], v28 offset:8192
    ds_read_b64_tr_b16 a[86:87], v28 offset:8704
    ds_read_b64_tr_b16 a[88:89], v29 offset:0
    ds_read_b64_tr_b16 a[90:91], v29 offset:512
    ds_read_b64_tr_b16 a[92:93], v29 offset:8192
    ds_read_b64_tr_b16 a[94:95], v29 offset:8704
    s_waitcnt lgkmcnt(0)
    s_barrier
    s_add_u32 m0, s29, 98304
    s_add_u32 s28, s31, 4718592
    buffer_load_dwordx4 v16, s[20:23], s28 offen offset:0 lds
    buffer_load_dwordx4 v17, s[20:23], s28 offen offset:1024 lds
    buffer_load_dwordx4 v18, s[20:23], s28 offen offset:2048 lds
    buffer_load_dwordx4 v19, s[20:23], s28 offen offset:3072 lds
    s_mov_b32 s20, s60
    s_mov_b32 s21, s61
    s_mov_b32 s22, 0x500000
    s_mov_b32 s23, 0x20000
    s_add_u32 m0, s29, 114688
    s_add_u32 s28, s31, 4718592
    buffer_load_dwordx4 v16, s[20:23], s28 offen offset:0 lds
    buffer_load_dwordx4 v17, s[20:23], s28 offen offset:1024 lds
    buffer_load_dwordx4 v18, s[20:23], s28 offen offset:2048 lds
    buffer_load_dwordx4 v19, s[20:23], s28 offen offset:3072 lds
    s_waitcnt lgkmcnt(0)
    s_waitcnt vmcnt(32)
    s_barrier
    v_add_u32 v28, 131072, v61
    v_xor_b32 v29, 32, v28
    ds_read_b64_tr_b16 a[112:113], v28 offset:0
    ds_read_b64_tr_b16 a[114:115], v28 offset:512
    ds_read_b64_tr_b16 a[116:117], v28 offset:8192
    ds_read_b64_tr_b16 a[118:119], v28 offset:8704
    ds_read_b64_tr_b16 a[120:121], v29 offset:0
    ds_read_b64_tr_b16 a[122:123], v29 offset:512
    ds_read_b64_tr_b16 a[124:125], v29 offset:8192
    ds_read_b64_tr_b16 a[126:127], v29 offset:8704
    s_waitcnt lgkmcnt(8)
    v_add_u32 v28, 147456, v59
    v_xor_b32 v29, 32, v28
    ds_read_b64_tr_b16 a[128:129], v28 offset:0
    ds_read_b64_tr_b16 a[130:131], v28 offset:512
    ds_read_b64_tr_b16 a[132:133], v28 offset:8192
    ds_read_b64_tr_b16 a[134:135], v28 offset:8704
    ds_read_b64_tr_b16 a[136:137], v29 offset:0
    ds_read_b64_tr_b16 a[138:139], v29 offset:512
    ds_read_b64_tr_b16 a[140:141], v29 offset:8192
    ds_read_b64_tr_b16 a[142:143], v29 offset:8704
    s_waitcnt lgkmcnt(0)
    s_barrier
    s_mov_b32 s20, s66
    s_mov_b32 s21, s67
    s_mov_b32 s22, 0x500000
    s_mov_b32 s23, 0x20000
    s_add_u32 m0, s29, 131072
    s_movk_i32 s28, 512
    buffer_load_dwordx4 v20, s[20:23], s28 offen offset:0 lds
    buffer_load_dwordx4 v21, s[20:23], s28 offen offset:1024 lds
    buffer_load_dwordx4 v22, s[20:23], s28 offen offset:2048 lds
    buffer_load_dwordx4 v23, s[20:23], s28 offen offset:3072 lds
    s_waitcnt lgkmcnt(0)
    s_waitcnt vmcnt(28)
    s_barrier
    v_add_u32 v28, 0, v61
    v_xor_b32 v29, 32, v28
    ds_read_b64_tr_b16 a[144:145], v28 offset:0
    ds_read_b64_tr_b16 a[146:147], v28 offset:512
    ds_read_b64_tr_b16 a[148:149], v28 offset:8192
    ds_read_b64_tr_b16 a[150:151], v28 offset:8704
    ds_read_b64_tr_b16 a[152:153], v29 offset:0
    ds_read_b64_tr_b16 a[154:155], v29 offset:512
    ds_read_b64_tr_b16 a[156:157], v29 offset:8192
    ds_read_b64_tr_b16 a[158:159], v29 offset:8704
    s_waitcnt lgkmcnt(8)
    v_add_u32 v28, 16384, v59
    v_xor_b32 v29, 32, v28
    ds_read_b64_tr_b16 a[160:161], v28 offset:0
    ds_read_b64_tr_b16 a[162:163], v28 offset:512
    ds_read_b64_tr_b16 a[164:165], v28 offset:8192
    ds_read_b64_tr_b16 a[166:167], v28 offset:8704
    ds_read_b64_tr_b16 a[168:169], v29 offset:0
    ds_read_b64_tr_b16 a[170:171], v29 offset:512
    ds_read_b64_tr_b16 a[172:173], v29 offset:8192
    ds_read_b64_tr_b16 a[174:175], v29 offset:8704
    s_waitcnt lgkmcnt(0)
    s_barrier
    s_add_u32 m0, s29, 0
    s_movk_i32 s28, 0
    buffer_load_dwordx4 v20, s[20:23], s28 offen offset:0 lds
    buffer_load_dwordx4 v21, s[20:23], s28 offen offset:1024 lds
    buffer_load_dwordx4 v22, s[20:23], s28 offen offset:2048 lds
    buffer_load_dwordx4 v23, s[20:23], s28 offen offset:3072 lds
    s_add_u32 m0, s29, 16384
    s_movk_i32 s28, 128
    buffer_load_dwordx4 v20, s[20:23], s28 offen offset:0 lds
    buffer_load_dwordx4 v21, s[20:23], s28 offen offset:1024 lds
    buffer_load_dwordx4 v22, s[20:23], s28 offen offset:2048 lds
    buffer_load_dwordx4 v23, s[20:23], s28 offen offset:3072 lds
    s_waitcnt lgkmcnt(0)
    s_waitcnt vmcnt(28)
    s_barrier
    v_add_u32 v28, 32768, v61
    v_xor_b32 v29, 32, v28
    ds_read_b64_tr_b16 a[176:177], v28 offset:0
    ds_read_b64_tr_b16 a[178:179], v28 offset:512
    ds_read_b64_tr_b16 a[180:181], v28 offset:8192
    ds_read_b64_tr_b16 a[182:183], v28 offset:8704
    ds_read_b64_tr_b16 a[184:185], v29 offset:0
    ds_read_b64_tr_b16 a[186:187], v29 offset:512
    ds_read_b64_tr_b16 a[188:189], v29 offset:8192
    ds_read_b64_tr_b16 a[190:191], v29 offset:8704
    s_waitcnt lgkmcnt(8)
    v_add_u32 v28, 49152, v59
    v_xor_b32 v29, 32, v28
    ds_read_b64_tr_b16 a[192:193], v28 offset:0
    ds_read_b64_tr_b16 a[194:195], v28 offset:512
    ds_read_b64_tr_b16 a[196:197], v28 offset:8192
    ds_read_b64_tr_b16 a[198:199], v28 offset:8704
    ds_read_b64_tr_b16 a[200:201], v29 offset:0
    ds_read_b64_tr_b16 a[202:203], v29 offset:512
    ds_read_b64_tr_b16 a[204:205], v29 offset:8192
    ds_read_b64_tr_b16 a[206:207], v29 offset:8704
    s_waitcnt lgkmcnt(0)
    s_barrier
    s_add_u32 m0, s29, 32768
    s_movk_i32 s28, 256
    buffer_load_dwordx4 v20, s[20:23], s28 offen offset:0 lds
    buffer_load_dwordx4 v21, s[20:23], s28 offen offset:1024 lds
    buffer_load_dwordx4 v22, s[20:23], s28 offen offset:2048 lds
    buffer_load_dwordx4 v23, s[20:23], s28 offen offset:3072 lds
    s_add_u32 m0, s29, 49152
    s_movk_i32 s28, 384
    buffer_load_dwordx4 v20, s[20:23], s28 offen offset:0 lds
    buffer_load_dwordx4 v21, s[20:23], s28 offen offset:1024 lds
    buffer_load_dwordx4 v22, s[20:23], s28 offen offset:2048 lds
    buffer_load_dwordx4 v23, s[20:23], s28 offen offset:3072 lds
    s_waitcnt lgkmcnt(0)
    s_waitcnt vmcnt(28)
    s_barrier
    v_add_u32 v28, 65536, v61
    v_xor_b32 v29, 32, v28
    ds_read_b64_tr_b16 a[208:209], v28 offset:0
    ds_read_b64_tr_b16 a[210:211], v28 offset:512
    ds_read_b64_tr_b16 a[212:213], v28 offset:8192
    ds_read_b64_tr_b16 a[214:215], v28 offset:8704
    ds_read_b64_tr_b16 a[216:217], v29 offset:0
    ds_read_b64_tr_b16 a[218:219], v29 offset:512
    ds_read_b64_tr_b16 a[220:221], v29 offset:8192
    ds_read_b64_tr_b16 a[222:223], v29 offset:8704
    s_waitcnt lgkmcnt(8)
    v_add_u32 v28, 81920, v59
    v_xor_b32 v29, 32, v28
    ds_read_b64_tr_b16 a[224:225], v28 offset:0
    ds_read_b64_tr_b16 a[226:227], v28 offset:512
    ds_read_b64_tr_b16 a[228:229], v28 offset:8192
    ds_read_b64_tr_b16 a[230:231], v28 offset:8704
    ds_read_b64_tr_b16 a[232:233], v29 offset:0
    ds_read_b64_tr_b16 a[234:235], v29 offset:512
    ds_read_b64_tr_b16 a[236:237], v29 offset:8192
    ds_read_b64_tr_b16 a[238:239], v29 offset:8704
    s_waitcnt lgkmcnt(0)
    s_barrier
    s_mov_b32 s20, s64
    s_mov_b32 s21, s65
    s_mov_b32 s22, 0x500000
    s_mov_b32 s23, 0x20000
    s_add_u32 m0, s29, 65536
    s_add_u32 s28, s30, 2097152
    buffer_load_dwordx4 v16, s[20:23], s28 offen offset:0 lds
    buffer_load_dwordx4 v17, s[20:23], s28 offen offset:1024 lds
    buffer_load_dwordx4 v18, s[20:23], s28 offen offset:2048 lds
    buffer_load_dwordx4 v19, s[20:23], s28 offen offset:3072 lds
    s_mov_b32 s20, s62
    s_mov_b32 s21, s63
    s_mov_b32 s22, 0x500000
    s_mov_b32 s23, 0x20000
    s_add_u32 m0, s29, 81920
    s_add_u32 s28, s31, 4718592
    buffer_load_dwordx4 v16, s[20:23], s28 offen offset:0 lds
    buffer_load_dwordx4 v17, s[20:23], s28 offen offset:1024 lds
    buffer_load_dwordx4 v18, s[20:23], s28 offen offset:2048 lds
    buffer_load_dwordx4 v19, s[20:23], s28 offen offset:3072 lds
    s_waitcnt lgkmcnt(0)
    s_waitcnt vmcnt(28)
    s_barrier
    v_add_u32 v28, 98304, v62
    v_xor_b32 v29, 32, v28
    ds_read_b64_tr_b16 a[240:241], v28 offset:0
    ds_read_b64_tr_b16 a[242:243], v29 offset:256
    ds_read_b64_tr_b16 a[244:245], v28 offset:8192
    ds_read_b64_tr_b16 a[246:247], v29 offset:8448
    ds_read_b64_tr_b16 a[248:249], v29 offset:0
    ds_read_b64_tr_b16 a[250:251], v28 offset:256
    ds_read_b64_tr_b16 a[252:253], v29 offset:8192
    ds_read_b64_tr_b16 a[254:255], v28 offset:8448
    s_waitcnt lgkmcnt(8)
    v_add_u32 v28, 114688, v62
    v_xor_b32 v29, 32, v28
    ds_read_b64_tr_b16 a[16:17], v28 offset:0
    ds_read_b64_tr_b16 a[18:19], v29 offset:256
    ds_read_b64_tr_b16 a[20:21], v28 offset:8192
    ds_read_b64_tr_b16 a[22:23], v29 offset:8448
    ds_read_b64_tr_b16 a[24:25], v29 offset:0
    ds_read_b64_tr_b16 a[26:27], v28 offset:256
    ds_read_b64_tr_b16 a[28:29], v29 offset:8192
    ds_read_b64_tr_b16 a[30:31], v28 offset:8448
    s_waitcnt lgkmcnt(0)
    s_barrier
    s_mov_b32 s20, s60
    s_mov_b32 s21, s61
    s_mov_b32 s22, 0x500000
    s_mov_b32 s23, 0x20000
    s_add_u32 m0, s29, 98304
    s_add_u32 s28, s31, 2621440
    buffer_load_dwordx4 v40, s[20:23], s28 offen offset:0 lds
    buffer_load_dwordx4 v41, s[20:23], s28 offen offset:1024 lds
    buffer_load_dwordx4 v42, s[20:23], s28 offen offset:2048 lds
    buffer_load_dwordx4 v43, s[20:23], s28 offen offset:3072 lds
    s_add_u32 m0, s29, 114688
    s_add_u32 s28, s31, 2621440
    buffer_load_dwordx4 v44, s[20:23], s28 offen offset:0 lds
    buffer_load_dwordx4 v45, s[20:23], s28 offen offset:1024 lds
    buffer_load_dwordx4 v46, s[20:23], s28 offen offset:2048 lds
    buffer_load_dwordx4 v47, s[20:23], s28 offen offset:3072 lds
    v_mov_b32 v36, 64
    buffer_load_dword v32, v36, s[12:15], 0 offen sc1
    buffer_load_dword v33, v36, s[12:15], 0 offen offset:8 sc1
    s_mov_b32 s48, s58
    s_mov_b32 s49, s59
    s_mov_b32 s50, 0x2800
    s_mov_b32 s51, 0x20000
    s_cmp_eq_u32 s11, -1
    s_cbranch_scc1 L_m0done
    v_and_b32 v70, 7, v15
    v_and_b32 v72, 1, v15
    v_lshrrev_b32 v73, 1, v70
    v_bfe_u32 v74, v15, 4, 1
    v_lshrrev_b32 v75, 5, v15
    s_cmp_eq_u32 s9, 1
    s_cbranch_scc1 L_m0t2
    s_and_b32 s24, s11, 6
    v_add_u32 v76, s24, v72
    v_lshl_add_u32 v77, v74, 1, v75
    v_lshlrev_b32 v77, 1, v77
    v_lshl_add_u32 v77, v73, 6, v77
    s_lshr_b32 s24, s11, 3
    s_lshl_b32 s24, s24, 1
    s_and_b32 s25, s11, 1
    s_add_u32 s24, s24, s25
    s_lshl_b32 s24, s24, 3
    s_mov_b32 s26, 2
    s_branch L_m0ld
L_m0t2:
    s_and_b32 s24, s11, 1
    s_lshl_b32 s24, s24, 2
    v_lshl_add_u32 v76, v74, 1, v72
    v_add_u32 v76, s24, v76
    v_lshl_add_u32 v77, v75, 3, v73
    s_sub_u32 s24, s11, 32
    s_lshr_b32 s24, s24, 1
    s_lshl_b32 s24, s24, 4
    s_add_u32 s24, s24, 256
    s_mov_b32 s26, 8
L_m0ld:
    s_mul_i32 s25, s8, 320
    s_add_u32 s24, s24, s25
    v_add_u32 v77, s24, v77
    v_mul_u32_u24 v76, 1280, v76
    v_lshl_add_u32 v76, v77, 1, v76
    buffer_load_ushort v34, v76, s[48:51], 0 offen
    buffer_load_ushort v35, v76, s[48:51], s26 offen
L_m0done:
    s_waitcnt lgkmcnt(0)
    s_waitcnt vmcnt(32)
    s_barrier
    v_add_u32 v28, 131072, v24
    ds_read_b64_tr_b16 v[144:145], v28 offset:0
    ds_read_b64_tr_b16 v[146:147], v28 offset:256
    ds_read_b64_tr_b16 v[148:149], v28 offset:1024
    ds_read_b64_tr_b16 v[150:151], v28 offset:1280
    ds_read_b64_tr_b16 v[152:153], v28 offset:8192
    ds_read_b64_tr_b16 v[154:155], v28 offset:8448
    ds_read_b64_tr_b16 v[156:157], v28 offset:9216
    ds_read_b64_tr_b16 v[158:159], v28 offset:9472
    s_waitcnt lgkmcnt(8)
    s_waitcnt lgkmcnt(0)
    s_waitcnt vmcnt(24)
    s_barrier
    v_add_u32 v28, 0, v24
    ds_read_b64_tr_b16 v[80:81], v28 offset:0
    ds_read_b64_tr_b16 v[82:83], v28 offset:256
    ds_read_b64_tr_b16 v[84:85], v28 offset:1024
    ds_read_b64_tr_b16 v[86:87], v28 offset:1280
    ds_read_b64_tr_b16 v[88:89], v28 offset:8192
    ds_read_b64_tr_b16 v[90:91], v28 offset:8448
    ds_read_b64_tr_b16 v[92:93], v28 offset:9216
    ds_read_b64_tr_b16 v[94:95], v28 offset:9472
    s_waitcnt lgkmcnt(8)
    v_add_u32 v28, 16384, v24
    ds_read_b64_tr_b16 v[96:97], v28 offset:0
    ds_read_b64_tr_b16 v[98:99], v28 offset:256
    ds_read_b64_tr_b16 v[100:101], v28 offset:1024
    ds_read_b64_tr_b16 v[102:103], v28 offset:1280
    ds_read_b64_tr_b16 v[104:105], v28 offset:8192
    ds_read_b64_tr_b16 v[106:107], v28 offset:8448
    ds_read_b64_tr_b16 v[108:109], v28 offset:9216
    ds_read_b64_tr_b16 v[110:111], v28 offset:9472
    s_waitcnt lgkmcnt(0)
    s_barrier
    s_mov_b32 s20, s64
    s_mov_b32 s21, s65
    s_mov_b32 s22, 0x500000
    s_mov_b32 s23, 0x20000
    s_add_u32 m0, s29, 0
    s_add_u32 s28, s30, 0
    buffer_load_dwordx4 v40, s[20:23], s28 offen offset:0 lds
    buffer_load_dwordx4 v41, s[20:23], s28 offen offset:1024 lds
    buffer_load_dwordx4 v42, s[20:23], s28 offen offset:2048 lds
    buffer_load_dwordx4 v43, s[20:23], s28 offen offset:3072 lds
    s_add_u32 m0, s29, 16384
    s_add_u32 s28, s30, 0
    buffer_load_dwordx4 v44, s[20:23], s28 offen offset:0 lds
    buffer_load_dwordx4 v45, s[20:23], s28 offen offset:1024 lds
    buffer_load_dwordx4 v46, s[20:23], s28 offen offset:2048 lds
    buffer_load_dwordx4 v47, s[20:23], s28 offen offset:3072 lds
    s_waitcnt lgkmcnt(0)
    s_waitcnt vmcnt(24)
    s_barrier
    v_add_u32 v28, 32768, v24
    ds_read_b64_tr_b16 v[112:113], v28 offset:0
    ds_read_b64_tr_b16 v[114:115], v28 offset:256
    ds_read_b64_tr_b16 v[116:117], v28 offset:1024
    ds_read_b64_tr_b16 v[118:119], v28 offset:1280
    ds_read_b64_tr_b16 v[120:121], v28 offset:8192
    ds_read_b64_tr_b16 v[122:123], v28 offset:8448
    ds_read_b64_tr_b16 v[124:125], v28 offset:9216
    ds_read_b64_tr_b16 v[126:127], v28 offset:9472
    s_waitcnt lgkmcnt(8)
    v_add_u32 v28, 49152, v24
    ds_read_b64_tr_b16 v[128:129], v28 offset:0
    ds_read_b64_tr_b16 v[130:131], v28 offset:256
    ds_read_b64_tr_b16 v[132:133], v28 offset:1024
    ds_read_b64_tr_b16 v[134:135], v28 offset:1280
    ds_read_b64_tr_b16 v[136:137], v28 offset:8192
    ds_read_b64_tr_b16 v[138:139], v28 offset:8448
    ds_read_b64_tr_b16 v[140:141], v28 offset:9216
    ds_read_b64_tr_b16 v[142:143], v28 offset:9472
    s_waitcnt lgkmcnt(0)
    s_barrier
    s_add_u32 m0, s29, 32768
    s_add_u32 s28, s30, 0
    buffer_load_dwordx4 v48, s[20:23], s28 offen offset:0 lds
    buffer_load_dwordx4 v49, s[20:23], s28 offen offset:1024 lds
    buffer_load_dwordx4 v50, s[20:23], s28 offen offset:2048 lds
    buffer_load_dwordx4 v51, s[20:23], s28 offen offset:3072 lds
    s_add_u32 m0, s29, 49152
    s_add_u32 s28, s30, 0
    buffer_load_dwordx4 v52, s[20:23], s28 offen offset:0 lds
    buffer_load_dwordx4 v53, s[20:23], s28 offen offset:1024 lds
    buffer_load_dwordx4 v54, s[20:23], s28 offen offset:2048 lds
    buffer_load_dwordx4 v55, s[20:23], s28 offen offset:3072 lds
    s_waitcnt lgkmcnt(0)
    s_waitcnt vmcnt(24)
    s_barrier
    v_add_u32 v28, 65536, v62
    v_xor_b32 v29, 32, v28
    ds_read_b64_tr_b16 v[64:65], v28 offset:0
    ds_read_b64_tr_b16 v[66:67], v29 offset:256
    ds_read_b64_tr_b16 v[68:69], v28 offset:8192
    ds_read_b64_tr_b16 v[70:71], v29 offset:8448
    ds_read_b64_tr_b16 v[72:73], v29 offset:0
    ds_read_b64_tr_b16 v[74:75], v28 offset:256
    ds_read_b64_tr_b16 v[76:77], v29 offset:8192
    ds_read_b64_tr_b16 v[78:79], v28 offset:8448
    s_waitcnt lgkmcnt(8)
    v_add_u32 v28, 81920, v62
    v_xor_b32 v29, 32, v28
    ds_read_b64_tr_b16 v[40:41], v28 offset:0
    ds_read_b64_tr_b16 v[42:43], v29 offset:256
    ds_read_b64_tr_b16 v[44:45], v28 offset:8192
    ds_read_b64_tr_b16 v[46:47], v29 offset:8448
    ds_read_b64_tr_b16 v[48:49], v29 offset:0
    ds_read_b64_tr_b16 v[50:51], v28 offset:256
    ds_read_b64_tr_b16 v[52:53], v29 offset:8192
    ds_read_b64_tr_b16 v[54:55], v28 offset:8448
    s_waitcnt lgkmcnt(0)
    s_barrier
    v_add_u32 v28, 65536, v63
    ds_write_b128 v28, v[64:67] offset:0
    ds_write_b128 v28, v[68:71] offset:1024
    ds_write_b128 v28, v[72:75] offset:2048
    ds_write_b128 v28, v[76:79] offset:3072
    v_add_u32 v28, 81920, v63
    ds_write_b128 v28, v[40:43] offset:0
    ds_write_b128 v28, v[44:47] offset:1024
    ds_write_b128 v28, v[48:51] offset:2048
    ds_write_b128 v28, v[52:55] offset:3072
    s_waitcnt lgkmcnt(0)
    s_waitcnt vmcnt(16)
    s_barrier
    v_add_u32 v28, 98304, v61
    v_xor_b32 v29, 32, v28
    ds_read_b64_tr_b16 v[64:65], v28 offset:0
    ds_read_b64_tr_b16 v[66:67], v28 offset:512
    ds_read_b64_tr_b16 v[68:69], v28 offset:8192
    ds_read_b64_tr_b16 v[70:71], v28 offset:8704
    ds_read_b64_tr_b16 v[72:73], v29 offset:0
    ds_read_b64_tr_b16 v[74:75], v29 offset:512
    ds_read_b64_tr_b16 v[76:77], v29 offset:8192
    ds_read_b64_tr_b16 v[78:79], v29 offset:8704
    s_waitcnt lgkmcnt(8)
    v_add_u32 v28, 114688, v59
    v_xor_b32 v29, 32, v28
    ds_read_b64_tr_b16 v[40:41], v28 offset:0
    ds_read_b64_tr_b16 v[42:43], v28 offset:512
    ds_read_b64_tr_b16 v[44:45], v28 offset:8192
    ds_read_b64_tr_b16 v[46:47], v28 offset:8704
    ds_read_b64_tr_b16 v[48:49], v29 offset:0
    ds_read_b64_tr_b16 v[50:51], v29 offset:512
    ds_read_b64_tr_b16 v[52:53], v29 offset:8192
    ds_read_b64_tr_b16 v[54:55], v29 offset:8704
    s_waitcnt lgkmcnt(0)
    s_barrier
    v_add_u32 v28, 98304, v63
    ds_write_b128 v28, v[64:67] offset:0
    ds_write_b128 v28, v[68:71] offset:1024
    ds_write_b128 v28, v[72:75] offset:2048
    ds_write_b128 v28, v[76:79] offset:3072
    v_add_u32 v28, 114688, v63
    ds_write_b128 v28, v[40:43] offset:0
    ds_write_b128 v28, v[44:47] offset:1024
    ds_write_b128 v28, v[48:51] offset:2048
    ds_write_b128 v28, v[52:55] offset:3072
    s_waitcnt lgkmcnt(0)
    s_waitcnt vmcnt(8)
    s_barrier
    s_mov_b32 s26, 200000
L_h2:
    v_readfirstlane_b32 s25, v32
    v_readfirstlane_b32 s24, v33
    s_cmp_lt_u32 s25, 256
    s_cselect_b32 s24, 0, s24
    s_cmp_lg_u32 s24, 0
    s_cbranch_scc1 L_h2ok
    buffer_load_dword v32, v36, s[12:15], 0 offen sc1
    buffer_load_dword v33, v36, s[12:15], 0 offen offset:8 sc1
    s_sub_u32 s26, s26, 1
    s_cbranch_scc1 L_fail
    s_waitcnt vmcnt(0)
    s_branch L_h2
L_h2ok:
    s_mov_b32 s2, 0
    s_mov_b32 s3, 0
    s_cmp_eq_u32 s9, 3
    s_cselect_b64 s[66:67], -1, 0
    v_lshrrev_b32 v0, 3, v15
    v_mul_u32_u24 v0, 5248, v0
    v_and_b32 v1, 7, v15
    v_lshl_add_u32 v0, v1, 4, v0
    v_bfe_u32 v2, v15, 4, 1
    v_lshrrev_b32 v3, 5, v15
    v_lshl_add_u32 v2, v2, 1, v3
    v_lshrrev_b32 v1, 1, v1
    v_and_b32 v4, 1, v15
    v_lshlrev_b32 v4, 4, v4
    v_lshl_add_u32 v3, v2, 2, v4
    v_lshl_add_u32 v3, v1, 10, v3
    v_lshl_add_u32 v2, v2, 5, v4
    v_lshl_add_u32 v2, v1, 2, v2
    v_cndmask_b32 v1, v3, v2, s[86:87]
    v_cndmask_b32 v1, v1, v8, s[66:67]
    v_add_u32 v4, 0xffff0000, v6
    s_ff1_i32_b32 s25, s24
    s_bitset0_b32 s24, s25
    s_lshl_b32 s25, s25, 2
    s_or_b32 s2, s2, s25
    s_ff1_i32_b32 s25, s24
    s_bitset0_b32 s24, s25
    s_lshl_b32 s25, s25, 10
    s_or_b32 s2, s2, s25
    s_ff1_i32_b32 s25, s24
    s_bitset0_b32 s24, s25
    s_lshl_b32 s25, s25, 18
    s_or_b32 s2, s2, s25
    s_ff1_i32_b32 s25, s24
    s_bitset0_b32 s24, s25
    s_lshl_b32 s25, s25, 26
    s_or_b32 s2, s2, s25
    s_ff1_i32_b32 s25, s24
    s_bitset0_b32 s24, s25
    s_lshl_b32 s25, s25, 2
    s_mov_b32 s4, s25
    s_ff1_i32_b32 s25, s24
    s_bitset0_b32 s24, s25
    s_lshl_b32 s25, s25, 2
    s_or_b32 s3, s3, s25
    s_ff1_i32_b32 s25, s24
    s_bitset0_b32 s24, s25
    s_lshl_b32 s25, s25, 10
    s_or_b32 s3, s3, s25
    s_ff1_i32_b32 s25, s24
    s_bitset0_b32 s24, s25
    s_lshl_b32 s25, s25, 18
    s_or_b32 s3, s3, s25
    s_ff1_i32_b32 s25, s24
    s_bitset0_b32 s24, s25
    s_lshl_b32 s25, s25, 26
    s_or_b32 s3, s3, s25
    s_ff1_i32_b32 s25, s24
    s_bitset0_b32 s24, s25
    s_lshl_b32 s25, s25, 2
    s_mov_b32 s5, s25
    s_cmp_eq_u32 s8, 0
    s_cselect_b32 s24, s2, s3
    s_cselect_b32 s3, s3, s2
    s_mov_b32 s2, s24
    s_cselect_b32 s24, s4, s5
    s_cselect_b32 s5, s5, s4
    s_mul_i32 s24, s24, 0x01010101
    s_add_u32 s24, s24, 0x03020100
    s_cmp_eq_u32 s9, 1
    s_cselect_b32 s2, s24, s2
    s_add_u32 s34, s83, 20840448
    s_lshl_b32 s5, s5, 10
    s_add_u32 s64, s5, s81
    s_add_u32 s64, s64, 20836352
    s_mov_b32 s44, 0
    s_mov_b32 s36, 1073741824
    s_mov_b32 s41, 1073741824
    s_and_b32 s24, s44, 3
    s_lshl_b32 s25, s24, 13
    s_add_u32 s35, s82, s25
    s_add_u32 s28, s32, s25
    s_sub_u32 s28, s28, 131072
    s_add_u32 s38, s28, s83
    s_add_u32 s28, s28, s81
    s_mov_b32 s65, s36
    s_lshl_b32 s26, s24, 3
    s_lshr_b32 s25, s2, s26
    s_and_b32 s25, s25, 0xff
    s_lshl_b32 s25, s25, 10
    s_add_u32 s36, s33, s25
    s_cmp_eq_u32 s11, -1
    s_cselect_b32 s24, 1073741824, s35
    v_lshl_or_b32 v34, v35, 16, v34
    buffer_store_dword v34, v1, s[16:19], s24 offen
    buffer_store_dword v34, v1, s[16:19], s36 offen sc1
    v_bfe_u32 v37, v15, 2, 2
    v_mul_u32_u24 v37, 768, v37
    v_and_b32 v38, 12, v8
    v_add_u32 v37, v37, v38
    s_lshl_b32 s24, s10, 4
    s_add_u32 s24, s24, 3145728
    buffer_load_dword v38, v37, s[16:19], s24 offen sc1
    v_add_u32 v28, 0, v61
    v_xor_b32 v29, 32, v28
    ds_read_b64_tr_b16 v[64:65], v28 offset:0
    ds_read_b64_tr_b16 v[66:67], v28 offset:512
    ds_read_b64_tr_b16 v[68:69], v28 offset:8192
    ds_read_b64_tr_b16 v[70:71], v28 offset:8704
    ds_read_b64_tr_b16 v[72:73], v29 offset:0
    ds_read_b64_tr_b16 v[74:75], v29 offset:512
    ds_read_b64_tr_b16 v[76:77], v29 offset:8192
    ds_read_b64_tr_b16 v[78:79], v29 offset:8704
    s_waitcnt lgkmcnt(8)
    v_add_u32 v28, 16384, v59
    v_xor_b32 v29, 32, v28
    ds_read_b64_tr_b16 v[40:41], v28 offset:0
    ds_read_b64_tr_b16 v[42:43], v28 offset:512
    ds_read_b64_tr_b16 v[44:45], v28 offset:8192
    ds_read_b64_tr_b16 v[46:47], v28 offset:8704
    ds_read_b64_tr_b16 v[48:49], v29 offset:0
    ds_read_b64_tr_b16 v[50:51], v29 offset:512
    ds_read_b64_tr_b16 v[52:53], v29 offset:8192
    ds_read_b64_tr_b16 v[54:55], v29 offset:8704
    s_waitcnt lgkmcnt(0)
    s_barrier
    v_add_u32 v28, 0, v63
    ds_write_b128 v28, v[64:67] offset:0
    ds_write_b128 v28, v[68:71] offset:1024
    ds_write_b128 v28, v[72:75] offset:2048
    ds_write_b128 v28, v[76:79] offset:3072
    v_add_u32 v28, 16384, v63
    ds_write_b128 v28, v[40:43] offset:0
    ds_write_b128 v28, v[44:47] offset:1024
    ds_write_b128 v28, v[48:51] offset:2048
    ds_write_b128 v28, v[52:55] offset:3072
    s_waitcnt lgkmcnt(0)
    s_waitcnt vmcnt(0)
    s_barrier
    v_add_u32 v28, 32768, v61
    v_xor_b32 v29, 32, v28
    ds_read_b64_tr_b16 v[64:65], v28 offset:0
    ds_read_b64_tr_b16 v[66:67], v28 offset:512
    ds_read_b64_tr_b16 v[68:69], v28 offset:8192
    ds_read_b64_tr_b16 v[70:71], v28 offset:8704
    ds_read_b64_tr_b16 v[72:73], v29 offset:0
    ds_read_b64_tr_b16 v[74:75], v29 offset:512
    ds_read_b64_tr_b16 v[76:77], v29 offset:8192
    ds_read_b64_tr_b16 v[78:79], v29 offset:8704
    s_waitcnt lgkmcnt(8)
    v_add_u32 v28, 49152, v59
    v_xor_b32 v29, 32, v28
    ds_read_b64_tr_b16 v[40:41], v28 offset:0
    ds_read_b64_tr_b16 v[42:43], v28 offset:512
    ds_read_b64_tr_b16 v[44:45], v28 offset:8192
    ds_read_b64_tr_b16 v[46:47], v28 offset:8704
    ds_read_b64_tr_b16 v[48:49], v29 offset:0
    ds_read_b64_tr_b16 v[50:51], v29 offset:512
    ds_read_b64_tr_b16 v[52:53], v29 offset:8192
    ds_read_b64_tr_b16 v[54:55], v29 offset:8704
    s_waitcnt lgkmcnt(0)
    s_barrier
    v_add_u32 v28, 32768, v63
    ds_write_b128 v28, v[64:67] offset:0
    ds_write_b128 v28, v[68:71] offset:1024
    ds_write_b128 v28, v[72:75] offset:2048
    ds_write_b128 v28, v[76:79] offset:3072
    v_add_u32 v28, 49152, v63
    ds_write_b128 v28, v[40:43] offset:0
    ds_write_b128 v28, v[44:47] offset:1024
    ds_write_b128 v28, v[48:51] offset:2048
    ds_write_b128 v28, v[52:55] offset:3072
    s_waitcnt lgkmcnt(0)
    s_lshl_b32 s45, s10, 13
    s_mov_b32 s71, s45
    s_lshl_b32 s24, s9, 11
    s_add_u32 s45, s45, s24
    s_add_u32 s45, s45, 33423360
    s_lshl_b32 s24, s10, 12
    s_add_u32 s24, s24, s83
    s_lshr_b32 s25, s83, 1
    s_sub_u32 s24, s24, s25
    s_add_u32 s43, s24, 12582912
    s_add_u32 s46, s24, 4194304
    s_cmp_eq_u32 s8, 0
    s_cselect_b32 s46, s46, 1073741824
    s_cselect_b32 s43, 1073741824, s43
    s_and_b32 s24, s9, 1
    s_mul_i32 s24, s24, 16777216
    s_lshr_b32 s25, s9, 1
    s_lshl_b32 s25, s25, 12
    s_add_u32 s24, s24, s25
    s_add_u32 s71, s71, s24
    s_add_u32 s71, s71, 33816576
    s_mov_b32 s72, 0
    s_nop 1
    v_min_u32_dpp v38, v38, v38 row_ror:1 row_mask:0xf bank_mask:0xf
    s_nop 1
    v_min_u32_dpp v38, v38, v38 row_ror:2 row_mask:0xf bank_mask:0xf
    s_nop 1
    v_min_u32_dpp v38, v38, v38 row_ror:4 row_mask:0xf bank_mask:0xf
    s_nop 1
    v_min_u32_dpp v38, v38, v38 row_ror:8 row_mask:0xf bank_mask:0xf
    s_nop 1
    v_readfirstlane_b32 s72, v38
    s_lshl_b32 s7, s9, 12
    s_add_u32 s7, s7, 141312
    s_add_u32 s27, s45, 16777216
    s_mov_b32 s42, 1
    s_and_b32 s24, s44, 3
    s_lshl_b32 s25, s24, 18
    s_add_u32 s30, s25, s79
    s_xor_b32 s25, s25, 0x80000
    s_add_u32 s29, s25, s79
    s_add_u32 s69, s29, s81
    s_add_u32 s29, s29, s83
    s_sub_u32 s29, s29, 131072
    s_add_u32 s70, s30, s81
    s_add_u32 s30, s30, s83
    s_sub_u32 s30, s30, 131072
    s_lshl_b32 s25, s24, 13
    s_xor_b32 s25, s25, 0x4000
    s_add_u32 s37, s68, s25
    s_lshl_b32 s26, s24, 3
    s_lshr_b32 s25, s3, s26
    s_and_b32 s25, s25, 0xff
    s_lshl_b32 s25, s25, 10
    s_add_u32 s39, s34, s25
    s_lshl_b32 s25, s24, 10
    s_add_u32 s40, s64, s25
    s_cmp_eq_u32 s9, 3
    s_cselect_b32 s65, s47, s65
    s_cselect_b32 s6, s44, -1
    s_mov_b32 s26, 400000
    s_min_u32 s25, s42, 63
    s_lshr_b32 s25, s25, 2
    s_cmp_gt_u32 s72, s25
    s_cbranch_scc1 p1d_2
    v_bfe_u32 v44, v15, 2, 2
    v_mul_u32_u24 v44, 768, v44
    v_and_b32 v45, 12, v8
    v_add_u32 v44, v44, v45
    s_lshl_b32 s24, s10, 4
    s_add_u32 s24, s24, 3145728
p1w_1:
    buffer_load_dword v45, v44, s[16:19], s24 offen sc1
    s_sub_u32 s26, s26, 1
    s_cbranch_scc1 L_fail
    s_waitcnt vmcnt(0)
    s_nop 1
    v_min_u32_dpp v45, v45, v45 row_ror:1 row_mask:0xf bank_mask:0xf
    s_nop 1
    v_min_u32_dpp v45, v45, v45 row_ror:2 row_mask:0xf bank_mask:0xf
    s_nop 1
    v_min_u32_dpp v45, v45, v45 row_ror:4 row_mask:0xf bank_mask:0xf
    s_nop 1
    v_min_u32_dpp v45, v45, v45 row_ror:8 row_mask:0xf bank_mask:0xf
    s_nop 1
    v_readfirstlane_b32 s72, v45
    s_cmp_gt_u32 s72, s25
    s_cbranch_scc0 p1w_1
p1d_2:
    s_add_u32 m0, s7, 2048
    s_nop 0
    buffer_load_dwordx4 v5, s[16:19], s45 offen offset:0 sc1 lds
    buffer_load_dwordx4 v5, s[16:19], s45 offen offset:1024 sc1 lds
    s_add_u32 m0, s7, 0
    s_nop 0
    buffer_load_dwordx4 v5, s[16:19], s27 offen offset:0 sc1 lds
    buffer_load_dwordx4 v5, s[16:19], s27 offen offset:1024 sc1 lds
    s_memtime s[76:77]
    s_mov_b32 s78, 0
    s_mov_b32 s73, 60000
    s_waitcnt lgkmcnt(0)
    s_barrier
    .p2align 6
L_step:
    v_mov_b64 v[16:17], 0
    v_mov_b64 v[18:19], 0
    v_mov_b64 v[20:21], 0
    v_mov_b64 v[22:23], 0
    v_mov_b64 v[24:25], 0
    v_mov_b64 v[26:27], 0
    v_mov_b64 v[28:29], 0
    v_mov_b64 v[30:31], 0
    v_mov_b64 v[32:33], 0
    v_mov_b64 v[34:35], 0
    v_mov_b64 v[36:37], 0
    v_mov_b64 v[38:39], 0
    v_add_u32 v72, s83, v5
    v_xor_b32 v0, 0x400, v72
    v_xor_b32 v2, 0x800, v72
    v_xor_b32 v3, 0xc00, v72
    v_and_b32 v73, 0xfffffcff, v5
    v_add_u32 v73, s81, v73
    s_nop 0
    s_nop 0
    s_nop 0
    s_nop 0
    s_nop 0
    s_nop 0
    s_nop 0
    s_nop 0
    s_nop 0
    s_add_u32 m0, s85, 0
    s_nop 0
    buffer_load_dwordx4 v5, s[16:19], s38 offen sc1 lds
    s_add_u32 m0, s84, 0
    s_mov_b64 exec, 0xffff
    buffer_load_dwordx4 v5, s[16:19], s28 offen sc1 lds
    s_mov_b64 exec, -1
    v_add_u32 v41, 0xfffec000, v6
    ds_read_b128 v[48:51], v41 offset:0
    ds_read_b128 v[52:55], v41 offset:1024
    ds_read_b128 v[56:59], v41 offset:2048
    ds_read_b128 v[60:63], v41 offset:3072
    ds_read_b128 v[64:67], v4 offset:0
    ds_read_b128 v[68:71], v4 offset:1024
    s_nop 0
    s_nop 0
    s_nop 0
    s_nop 0
    s_nop 0
    s_nop 0
    s_nop 0
    s_nop 0
    s_nop 0
    s_nop 0
    s_add_u32 m0, s85, 0
    s_nop 0
    buffer_load_dwordx4 v5, s[16:19], s38 offen sc1 lds
    s_add_u32 m0, s84, 0
    s_mov_b64 exec, 0xffff
    buffer_load_dwordx4 v5, s[16:19], s28 offen sc1 lds
    s_mov_b64 exec, -1
    v_mov_b64 v[44:45], -1
    v_mov_b64 v[46:47], -1
    buffer_store_dwordx4 v[44:47], v5, s[16:19], s29 offen
    buffer_store_dword v44, v8, s[16:19], s69 offen
    buffer_store_dword v44, v8, s[16:19], s37 offen
    s_waitcnt vmcnt(5) lgkmcnt(0)
    ds_read_b128 v[40:43], v72 offset:0
    s_add_u32 m0, s85, 5120
    ds_read_b128 v[76:79], v73 offset:0
    buffer_load_dwordx4 v5, s[16:19], s39 offen sc1 lds
    s_add_u32 m0, s84, 5120
    s_mov_b64 exec, 0xffff
    buffer_load_dwordx4 v5, s[16:19], s40 offen sc1 lds
    s_mov_b64 exec, -1
    s_waitcnt lgkmcnt(1)
    v_max3_u32 v74, v40, v41, v42
    s_waitcnt lgkmcnt(0)
    v_max3_u32 v76, v76, v77, v78
    v_max3_u32 v74, v74, v43, v79
    v_max_u32 v74, v74, v76
    v_cmp_eq_u32 vcc, -1, v74
    s_cbranch_vccnz L_lretry
L_lok:
    v_smfmac_f32_16x16x64_bf16 v[16:19], v[40:43], v[160:167], v7
    s_barrier
    ds_read_b128 v[44:47], v0 offset:0
    v_smfmac_f32_16x16x64_bf16 v[20:23], v[40:43], v[168:175], v7
    v_smfmac_f32_16x16x64_bf16 v[32:35], v[40:43], v[48:55], v7
    ds_read_b128 v[48:51], v4 offset:2048
    v_smfmac_f32_16x16x64_bf16 v[24:27], v[40:43], a[32:39], v7
    ds_read_b128 v[52:55], v4 offset:3072
    v_smfmac_f32_16x16x64_bf16 v[28:31], v[40:43], a[40:47], v7
    v_smfmac_f32_16x16x64_bf16 v[36:39], v[40:43], v[56:63], v7
    ds_read_b128 v[40:43], v2 offset:0
    s_waitcnt lgkmcnt(3)
    v_smfmac_f32_16x16x64_bf16 v[16:19], v[44:47], v[176:183], v7
    ds_read_b128 v[56:59], v4 offset:16384
    v_smfmac_f32_16x16x64_bf16 v[20:23], v[44:47], v[184:191], v7
    ds_read_b128 v[60:63], v4 offset:17408
    s_waitcnt lgkmcnt(3)
    v_smfmac_f32_16x16x64_bf16 v[32:35], v[44:47], v[64:71], v7
    ds_read_b128 v[64:67], v4 offset:18432
    v_smfmac_f32_16x16x64_bf16 v[24:27], v[44:47], a[48:55], v7
    ds_read_b128 v[68:71], v4 offset:19456
    v_smfmac_f32_16x16x64_bf16 v[28:31], v[44:47], a[56:63], v7
    s_waitcnt lgkmcnt(4)
    v_smfmac_f32_16x16x64_bf16 v[36:39], v[44:47], v[48:55], v7
    ds_read_b128 v[44:47], v3 offset:0
    v_smfmac_f32_16x16x64_bf16 v[16:19], v[40:43], v[192:199], v7
    ds_read_b128 v[48:51], v4 offset:32768
    v_smfmac_f32_16x16x64_bf16 v[20:23], v[40:43], v[200:207], v7
    ds_read_b128 v[52:55], v4 offset:33792
    s_waitcnt lgkmcnt(3)
    v_smfmac_f32_16x16x64_bf16 v[32:35], v[40:43], v[56:63], v7
    ds_read_b128 v[56:59], v4 offset:34816
    v_smfmac_f32_16x16x64_bf16 v[24:27], v[40:43], a[64:71], v7
    ds_read_b128 v[60:63], v4 offset:35840
    v_smfmac_f32_16x16x64_bf16 v[28:31], v[40:43], a[72:79], v7
    s_waitcnt lgkmcnt(4)
    v_smfmac_f32_16x16x64_bf16 v[36:39], v[40:43], v[64:71], v7
    ds_read_b128 v[40:43], v5 offset:4096
    v_smfmac_f32_16x16x64_bf16 v[16:19], v[44:47], v[208:215], v7
    ds_read_b128 v[64:67], v4 offset:49152
    v_smfmac_f32_16x16x64_bf16 v[20:23], v[44:47], v[216:223], v7
    ds_read_b128 v[68:71], v4 offset:50176
    s_waitcnt lgkmcnt(3)
    v_smfmac_f32_16x16x64_bf16 v[32:35], v[44:47], v[48:55], v7
    ds_read_b128 v[48:51], v4 offset:51200
    v_smfmac_f32_16x16x64_bf16 v[24:27], v[44:47], a[80:87], v7
    ds_read_b128 v[52:55], v4 offset:52224
    v_smfmac_f32_16x16x64_bf16 v[28:31], v[44:47], a[88:95], v7
    s_waitcnt lgkmcnt(4)
    s_lshr_b32 s24, s83, 2
    s_add_u32 m0, s24, 162304
    v_smfmac_f32_16x16x64_bf16 v[36:39], v[44:47], v[56:63], v7
    ds_read_b128 v[56:59], v6 offset:16384
    v_smfmac_f32_16x16x64_bf16 v[16:19], v[40:43], v[224:231], v7
    ds_read_b128 v[60:63], v6 offset:17408
    s_waitcnt vmcnt(0)
    ds_read_b128 v[76:79], v73 offset:5120
    v_smfmac_f32_16x16x64_bf16 v[20:23], v[40:43], v[232:239], v7
    ds_read_b128 v[72:75], v72 offset:5120
    s_waitcnt lgkmcnt(4)
    v_smfmac_f32_16x16x64_bf16 v[32:35], v[40:43], v[64:71], v7
    ds_read_b128 v[64:67], v6 offset:18432
    v_smfmac_f32_16x16x64_bf16 v[24:27], v[40:43], a[96:103], v7
    ds_read_b128 v[68:71], v6 offset:19456
    s_waitcnt lgkmcnt(3)
    v_max3_u32 v76, v76, v77, v78
    v_smfmac_f32_16x16x64_bf16 v[28:31], v[40:43], a[104:111], v7
    s_waitcnt lgkmcnt(2)
    v_max3_u32 v44, v72, v73, v74
    v_max3_u32 v44, v44, v75, v79
    v_smfmac_f32_16x16x64_bf16 v[36:39], v[40:43], v[48:55], v7
    v_max_u32 v44, v44, v76
    v_cmp_eq_u32 vcc, -1, v44
    s_cbranch_vccnz L_rretry
L_remok:
    v_smfmac_f32_16x16x64_bf16 v[24:27], v[72:75], a[112:119], v7
    s_barrier
    ds_read_b128 v[40:43], v3 offset:5120
    v_smfmac_f32_16x16x64_bf16 v[28:31], v[72:75], a[120:127], v7
    ds_read_b128 v[44:47], v2 offset:5120
    s_waitcnt lgkmcnt(2)
    v_smfmac_f32_16x16x64_bf16 v[16:19], v[72:75], v[56:63], v7
    ds_read_b128 v[48:51], v5 offset:9216
    v_mov_b32 v52, s6
    v_smfmac_f32_16x16x64_bf16 v[20:23], v[72:75], v[64:71], v7
    ds_read_b128 v[76:79], v0 offset:5120
    v_lshlrev_b32 v53, 4, v8
    v_smfmac_f32_16x16x64_bf16 v[32:35], v[72:75], a[176:183], v7
    ds_read_b128 v[56:59], v6 offset:32768
    s_waitcnt lgkmcnt(4)
    v_smfmac_f32_16x16x64_bf16 v[16:19], v[40:43], a[0:7], v7
    ds_read_b128 v[60:63], v6 offset:33792
    v_smfmac_f32_16x16x64_bf16 v[20:23], v[40:43], a[8:15], v7
    ds_read_b128 v[64:67], v6 offset:34816
    s_waitcnt lgkmcnt(5)
    v_smfmac_f32_16x16x64_bf16 v[16:19], v[44:47], v[240:247], v7
    ds_read_b128 v[68:71], v6 offset:35840
    v_smfmac_f32_16x16x64_bf16 v[20:23], v[44:47], v[248:255], v7
    buffer_store_dword v52, v1, s[16:19], s65 offen sc1
    s_waitcnt lgkmcnt(4)
    v_smfmac_f32_16x16x64_bf16 v[16:19], v[48:51], a[16:23], v7
    buffer_load_dword v53, s[16:19], s71 offen lds
    v_smfmac_f32_16x16x64_bf16 v[20:23], v[48:51], a[24:31], v7
    s_waitcnt lgkmcnt(0)
    v_smfmac_f32_16x16x64_bf16 v[16:19], v[76:79], v[56:63], v7
    ds_read_b128 v[56:59], v6 offset:0
    v_smfmac_f32_16x16x64_bf16 v[20:23], v[76:79], v[64:71], v7
    ds_read_b128 v[60:63], v6 offset:1024
    v_smfmac_f32_16x16x64_bf16 v[36:39], v[72:75], a[184:191], v7
    ds_read_b128 v[64:67], v6 offset:2048
    v_add_u32 v4, 2304, v9
    v_smfmac_f32_16x16x64_bf16 v[24:27], v[76:79], a[128:135], v7
    ds_read_b128 v[68:71], v6 offset:3072
    v_add_f32 v16, v16, v18
    v_add_f32 v17, v17, v19
    v_smfmac_f32_16x16x64_bf16 v[28:31], v[76:79], a[136:143], v7
    v_add_f32 v20, v20, v22
    v_add_f32 v21, v21, v23
    v_smfmac_f32_16x16x64_bf16 v[24:27], v[40:43], a[160:167], v7
    v_cvt_pk_bf16_f32 v16, v16, v20
    v_cvt_pk_bf16_f32 v17, v17, v21
    v_smfmac_f32_16x16x64_bf16 v[28:31], v[40:43], a[168:175], v7
    s_waitcnt lgkmcnt(0)
    ds_write2_b32 v9, v16, v17 offset0:0 offset1:72
    v_smfmac_f32_16x16x64_bf16 v[24:27], v[48:51], v[56:63], v7
    ds_read_b128 v[56:59], v5 offset:12288
    v_smfmac_f32_16x16x64_bf16 v[28:31], v[48:51], v[64:71], v7
    ds_read_b128 v[60:63], v5 offset:20480
    v_smfmac_f32_16x16x64_bf16 v[24:27], v[44:47], a[144:151], v7
    ds_read_b128 v[64:67], v5 offset:13312
    v_smfmac_f32_16x16x64_bf16 v[28:31], v[44:47], a[152:159], v7
    s_waitcnt lgkmcnt(3)
    s_barrier
    v_smfmac_f32_16x16x64_bf16 v[32:35], v[44:47], a[208:215], v7
    ds_read_b128 v[16:19], v10 offset:0
    v_smfmac_f32_16x16x64_bf16 v[36:39], v[44:47], a[216:223], v7
    ds_read_b128 v[20:23], v10 offset:64
    v_add_f32 v24, v24, v26
    v_add_f32 v25, v25, v27
    v_smfmac_f32_16x16x64_bf16 v[32:35], v[76:79], a[192:199], v7
    ds_read_b128 v[68:71], v5 offset:21504
    v_add_f32 v28, v28, v30
    v_add_f32 v29, v29, v31
    v_cvt_pk_bf16_f32 v24, v24, v28
    v_cvt_pk_bf16_f32 v25, v25, v29
    v_smfmac_f32_16x16x64_bf16 v[36:39], v[76:79], a[200:207], v7
    ds_write2_b32 v4, v24, v25 offset0:0 offset1:72
    v_smfmac_f32_16x16x64_bf16 v[32:35], v[40:43], a[224:231], v7
    ds_read_b128 v[52:55], v10 offset:128
    v_lshlrev_b32 v26, 1, v8
    v_smfmac_f32_16x16x64_bf16 v[36:39], v[40:43], a[232:239], v7
    ds_read_b128 v[44:47], v5 offset:16384
    s_waitcnt lgkmcnt(3)
    v_mfma_f32_16x16x32_bf16 v[72:75], v[56:59], v[16:19], 0
    buffer_store_dwordx2 v[24:25], v26, s[16:19], s46 offen sc1
    v_mfma_f32_16x16x32_bf16 v[76:79], v[60:63], v[16:19], 0
    ds_read_b128 v[28:31], v5 offset:17408
    s_waitcnt lgkmcnt(3)
    s_barrier
    v_mfma_f32_16x16x32_bf16 v[72:75], v[64:67], v[20:23], v[72:75]
    ds_read_b128 v[60:63], v11 offset:0
    v_mfma_f32_16x16x32_bf16 v[76:79], v[68:71], v[20:23], v[76:79]
    ds_read_b128 v[64:67], v11 offset:64
    v_smfmac_f32_16x16x64_bf16 v[32:35], v[48:51], a[240:247], v7
    ds_read_b128 v[24:27], v5 offset:24576
    s_waitcnt vmcnt(3)
    v_smfmac_f32_16x16x64_bf16 v[36:39], v[48:51], a[248:255], v7
    ds_read_b128 v[0:3], v10 offset:192
    s_waitcnt lgkmcnt(4)
    v_mfma_f32_16x16x32_bf16 v[72:75], v[44:47], v[52:55], v[72:75]
    ds_read_b128 v[56:59], v5 offset:25600
    s_waitcnt lgkmcnt(4)
    v_mfma_f32_16x16x32_bf16 v[48:51], v[60:63], v[16:19], 0
    ds_read_b128 v[68:71], v11 offset:128
    s_waitcnt lgkmcnt(4)
    v_mfma_f32_16x16x32_bf16 v[48:51], v[64:67], v[20:23], v[48:51]
    ds_read_b128 v[40:43], v11 offset:192
    s_waitcnt lgkmcnt(3)
    v_add_f32 v32, v32, v34
    v_mfma_f32_16x16x32_bf16 v[76:79], v[24:27], v[52:55], v[76:79]
    v_add_f32 v33, v33, v35
    v_add_f32 v36, v36, v38
    v_mfma_f32_16x16x32_bf16 v[72:75], v[28:31], v[0:3], v[72:75]
    s_waitcnt lgkmcnt(2)
    v_add_f32 v37, v37, v39
    v_cvt_pk_bf16_f32 v60, v32, v33
    v_mfma_f32_16x16x32_bf16 v[76:79], v[56:59], v[0:3], v[76:79]
    ds_read_b128 v[56:59], v6 offset:59392
    s_waitcnt lgkmcnt(2)
    v_cvt_pk_bf16_f32 v61, v36, v37
    v_mfma_f32_16x16x32_bf16 v[48:51], v[68:71], v[52:55], v[48:51]
    ds_read_b128 v[16:19], v6 offset:60416
    s_waitcnt lgkmcnt(2)
    v_lshlrev_b32 v62, 1, v8
    v_mfma_f32_16x16x32_bf16 v[48:51], v[40:43], v[0:3], v[48:51]
    s_cmp_eq_u32 s44, 63
    buffer_store_dwordx2 v[60:61], v62, s[16:19], s43 offen sc1
    s_cbranch_scc1 L_recend
    v_max3_f32 v44, v72, v73, v74
    v_max3_f32 v45, v76, v77, v78
    v_max3_f32 v44, v44, v75, v79
    v_mov_b32 v69, 0
    v_max3_f32 v45, v45, v48, v49
    v_max_f32 v44, v44, v45
    v_mov_b32 v45, v44
    v_mov_b32 v70, 0
    s_nop 0
    v_permlane32_swap_b32 v44, v45
    v_max_f32 v44, v44, v45
    v_mov_b32 v45, v44
    s_nop 1
    v_permlane16_swap_b32 v44, v45
    v_max_f32 v44, v44, v45
    v_mul_f32 v44, s80, v44
    v_pk_fma_f32 v[72:73], v[72:73], s[80:81], v[44:45] op_sel_hi:[1,0,0] neg_lo:[0,0,1] neg_hi:[0,0,1]
    v_pk_fma_f32 v[74:75], v[74:75], s[80:81], v[44:45] op_sel_hi:[1,0,0] neg_lo:[0,0,1] neg_hi:[0,0,1]
    v_pk_fma_f32 v[76:77], v[76:77], s[80:81], v[44:45] op_sel_hi:[1,0,0] neg_lo:[0,0,1] neg_hi:[0,0,1]
    v_pk_fma_f32 v[78:79], v[78:79], s[80:81], v[44:45] op_sel_hi:[1,0,0] neg_lo:[0,0,1] neg_hi:[0,0,1]
    v_pk_fma_f32 v[24:25], v[48:49], s[80:81], v[44:45] op_sel_hi:[1,0,0] neg_lo:[0,0,1] neg_hi:[0,0,1]
    v_exp_f32 v72, v72
    v_exp_f32 v73, v73
    v_exp_f32 v74, v74
    v_exp_f32 v75, v75
    v_exp_f32 v76, v76
    v_exp_f32 v77, v77
    v_exp_f32 v78, v78
    v_exp_f32 v79, v79
    v_cvt_pk_bf16_f32 v64, v72, v73
    v_cvt_pk_bf16_f32 v65, v74, v75
    v_cvt_pk_bf16_f32 v66, v76, v77
    v_cvt_pk_bf16_f32 v67, v78, v79
    v_exp_f32 v24, v24
    v_exp_f32 v25, v25
    s_waitcnt lgkmcnt(0)
    v_mfma_f32_16x16x32_bf16 v[48:51], v[56:59], v[64:67], 0
    v_cvt_pk_bf16_f32 v68, v24, v25
    v_cvt_pk_bf16_f32 v71, v24, v25
    v_mfma_f32_16x16x32_bf16 v[28:31], v[16:19], v[64:67], 0
    v_mfma_f32_16x16x16_bf16 v[48:51], v[60:61], v[68:69], v[48:51]
    v_add_f32 v44, v24, v25
    v_add_f32 v72, v72, v73
    v_mfma_f32_16x16x16_bf16 v[28:31], v[60:61], v[70:71], v[28:31]
    v_add_f32 v74, v74, v75
    v_add_f32 v76, v76, v77
    v_add_f32 v78, v78, v79
    v_add_f32 v72, v72, v74
    s_mov_b64 exec, s[88:89]
    v_cvt_pk_bf16_f32 v46, v48, v49
    v_cvt_pk_bf16_f32 v47, v50, v51
    s_mov_b64 exec, s[90:91]
    v_cvt_pk_bf16_f32 v46, v28, v29
    v_cvt_pk_bf16_f32 v47, v30, v31
    s_mov_b64 exec, -1
    ds_write_b64 v13, v[46:47]
    v_add_f32 v76, v76, v78
    v_add_f32 v44, v44, v72
    v_add_f32 v44, v44, v76
    v_mov_b32 v45, v44
    v_mov_b64 v[40:41], 0
    v_mov_b64 v[42:43], 0
    v_permlane32_swap_b32 v44, v45
    v_add_f32 v44, v44, v45
    v_mov_b32 v45, v44
    v_mov_b64 v[24:25], 0
    v_mov_b64 v[26:27], 0
    s_waitcnt lgkmcnt(0)
    v_permlane16_swap_b32 v44, v45
    s_barrier
    ds_read_b128 v[56:59], v12
    v_add_f32 v44, v44, v45
    ds_read_b128 v[68:71], v12 offset:1024
    v_rcp_f32 v44, v44
    s_add_u32 m0, s7, 2048
    s_add_u32 s24, s45, 0x40000
    v_mov_b64 v[28:29], 0
    buffer_load_dwordx4 v5, s[16:19], s24 offen sc1 lds
    v_mov_b64 v[30:31], 0
    buffer_load_dwordx4 v5, s[16:19], s24 offen offset:1024 sc1 lds
    s_waitcnt lgkmcnt(1)
    v_smfmac_f32_16x16x64_bf16 v[40:43], v[56:59], v[144:151], v7
    ds_bpermute_b32 v64, v14, v44
    v_mov_b64 v[32:33], 0
    v_smfmac_f32_16x16x64_bf16 v[24:27], v[56:59], v[80:87], v7
    ds_bpermute_b32 v65, v14, v44 offset:4
    s_waitcnt lgkmcnt(2)
    v_mov_b64 v[34:35], 0
    v_smfmac_f32_16x16x64_bf16 v[40:43], v[68:71], v[152:159], v7
    v_mov_b64 v[36:37], 0
    v_smfmac_f32_16x16x64_bf16 v[24:27], v[68:71], v[88:95], v7
    v_mov_b64 v[38:39], 0
    v_smfmac_f32_16x16x64_bf16 v[28:31], v[56:59], v[96:103], v7
    v_add_f32 v40, v40, v42
    v_smfmac_f32_16x16x64_bf16 v[28:31], v[68:71], v[104:111], v7
    s_waitcnt lgkmcnt(0)
    v_add_f32 v41, v41, v43
    v_mul_f32 v40, v40, v64
    v_smfmac_f32_16x16x64_bf16 v[32:35], v[56:59], v[112:119], v7
    v_mul_f32 v41, v41, v65
    v_cvt_pk_bf16_f32 v52, v40, v41
    v_smfmac_f32_16x16x64_bf16 v[32:35], v[68:71], v[120:127], v7
    buffer_store_dword v52, v8, s[16:19], s70 offen
    v_add_f32 v24, v24, v26
    v_add_f32 v25, v25, v27
    v_smfmac_f32_16x16x64_bf16 v[36:39], v[56:59], v[128:135], v7
    v_mul_f32 v24, v24, v64
    v_mul_f32 v25, v25, v65
    v_cvt_pk_bf16_f32 v48, v24, v25
    v_smfmac_f32_16x16x64_bf16 v[36:39], v[68:71], v[136:143], v7
    v_add_f32 v28, v28, v30
    v_add_f32 v29, v29, v31
    v_mul_f32 v28, v28, v64
    v_mul_f32 v29, v29, v65
    v_cvt_pk_bf16_f32 v49, v28, v29
    v_pk_add_f32 v[32:33], v[32:33], v[34:35]
    v_pk_mul_f32 v[32:33], v[32:33], v[64:65]
    v_cvt_pk_bf16_f32 v50, v32, v33
    v_pk_add_f32 v[36:37], v[36:37], v[38:39]
    v_pk_mul_f32 v[36:37], v[36:37], v[64:65]
    v_cvt_pk_bf16_f32 v51, v36, v37
    buffer_store_dwordx4 v[48:51], v5, s[16:19], s30 offen
    s_and_b32 s24, s44, 3
    s_lshl_b32 s24, s24, 18
    s_add_u32 s31, s24, s100
    v_lshrrev_b32 v0, 3, v15
    v_mul_u32_u24 v0, 5248, v0
    v_and_b32 v1, 7, v15
    v_lshl_add_u32 v0, v1, 4, v0
    s_cmp_eq_u32 s11, -1
    s_cbranch_scc1 L_nored
    s_cmp_eq_u32 s9, 1
    s_cbranch_scc1 L_r1
    s_nop 0
    s_nop 0
    s_nop 0
    s_nop 0
    s_nop 0
    s_nop 0
    s_nop 0
    s_nop 0
    s_nop 0
    s_nop 0
    s_nop 0
    s_nop 0
    s_nop 0
    s_nop 0
    s_nop 0
    s_nop 0
    s_nop 0
    s_nop 0
    s_nop 0
    s_nop 0
    s_nop 0
L_r1:
    v_bfe_u32 v2, v15, 4, 1
    v_lshrrev_b32 v3, 5, v15
    v_lshl_add_u32 v2, v2, 1, v3
    v_lshrrev_b32 v1, 1, v1
    v_and_b32 v4, 1, v15
    v_lshlrev_b32 v4, 4, v4
    v_lshl_add_u32 v3, v2, 2, v4
    v_lshl_add_u32 v3, v1, 10, v3
    v_lshl_add_u32 v2, v2, 5, v4
    v_lshl_add_u32 v2, v1, 2, v2
    v_cndmask_b32 v1, v3, v2, s[86:87]
    v_cndmask_b32 v1, v1, v8, s[66:67]
    v_add_u32 v4, 0xffff0000, v6
    s_add_u32 s44, s44, 1
    s_and_b32 s24, s44, 3
    s_lshl_b32 s25, s24, 13
    s_add_u32 s35, s82, s25
    s_add_u32 s28, s32, s25
    s_sub_u32 s28, s28, 131072
    s_add_u32 s38, s28, s83
    s_add_u32 s28, s28, s81
    s_mov_b32 s65, s36
    s_lshl_b32 s26, s24, 3
    s_lshr_b32 s25, s2, s26
    s_and_b32 s25, s25, 0xff
    s_lshl_b32 s25, s25, 10
    s_add_u32 s36, s33, s25
    v_and_b32 v3, 1, v15
    v_lshlrev_b32 v3, 4, v3
    s_movk_i32 s24, 0x3f80
    v_lshlrev_b32 v3, v3, s24
    v_cndmask_b32 v44, 0, v3, s[92:93]
    v_cndmask_b32 v45, 0, v3, s[94:95]
    v_cndmask_b32 v46, 0, v3, s[96:97]
    v_cndmask_b32 v47, 0, v3, s[98:99]
    s_mov_b32 s4, s31
    buffer_load_dwordx4 v[48:51], v0, s[16:19], s4 offen sc1
    s_add_u32 s4, s4, 41984
    buffer_load_dwordx4 v[52:55], v0, s[16:19], s4 offen sc1
    s_add_u32 s4, s4, 41984
    buffer_load_dwordx4 v[56:59], v0, s[16:19], s4 offen sc1
    s_add_u32 s4, s4, 41984
    buffer_load_dwordx4 v[60:63], v0, s[16:19], s4 offen sc1
    s_and_b32 s24, s44, 3
    s_lshl_b32 s25, s24, 18
    s_add_u32 s30, s25, s79
    s_xor_b32 s25, s25, 0x80000
    s_add_u32 s29, s25, s79
    s_add_u32 s69, s29, s81
    s_add_u32 s29, s29, s83
    s_sub_u32 s29, s29, 131072
    s_add_u32 s70, s30, s81
    s_add_u32 s30, s30, s83
    s_sub_u32 s30, s30, 131072
    s_lshl_b32 s25, s24, 13
    s_xor_b32 s25, s25, 0x4000
    s_add_u32 s37, s68, s25
    s_lshl_b32 s26, s24, 3
    s_lshr_b32 s25, s3, s26
    s_and_b32 s25, s25, 0xff
    s_lshl_b32 s25, s25, 10
    s_add_u32 s39, s34, s25
    s_lshl_b32 s25, s24, 10
    s_add_u32 s40, s64, s25
    s_cmp_eq_u32 s9, 3
    s_mov_b32 s4, s31
    buffer_load_dwordx4 v[64:67], v0, s[16:19], s4 offen sc1
    s_add_u32 s4, s4, 41984
    buffer_load_dwordx4 v[68:71], v0, s[16:19], s4 offen sc1
    s_add_u32 s4, s4, 41984
    buffer_load_dwordx4 v[72:75], v0, s[16:19], s4 offen sc1
    s_add_u32 s4, s4, 41984
    buffer_load_dwordx4 v[76:79], v0, s[16:19], s4 offen sc1
    s_cselect_b32 s65, s47, s65
    s_cselect_b32 s6, s44, -1
    s_nop 0
    s_nop 0
    s_nop 0
    s_nop 0
    s_nop 0
    s_mov_b32 s5, 20000
L_rp:
    s_waitcnt vmcnt(7)
    v_mfma_f32_16x16x32_bf16 v[40:43], v[48:51], v[44:47], 0
    v_max3_u32 v2, v48, v49, v50
    v_mov_b32 v3, v51
    s_waitcnt vmcnt(6)
    v_mfma_f32_16x16x32_bf16 v[40:43], v[52:55], v[44:47], v[40:43]
    v_max3_u32 v2, v2, v52, v53
    v_max3_u32 v3, v3, v54, v55
    s_waitcnt vmcnt(5)
    v_mfma_f32_16x16x32_bf16 v[40:43], v[56:59], v[44:47], v[40:43]
    v_max3_u32 v2, v2, v56, v57
    v_max3_u32 v3, v3, v58, v59
    s_waitcnt vmcnt(4)
    v_mfma_f32_16x16x32_bf16 v[40:43], v[60:63], v[44:47], v[40:43]
    v_max3_u32 v2, v2, v60, v61
    v_max3_u32 v3, v3, v62, v63
    v_max_u32 v2, v2, v3
    v_cmp_eq_u32 vcc, -1, v2
    s_nop 3
    v_permlane32_swap_b32 v40, v42
    v_permlane32_swap_b32 v41, v43
    v_add_f32 v40, v40, v42
    v_add_f32 v41, v41, v43
    v_cvt_pk_bf16_f32 v40, v40, v41
    s_cbranch_vccnz L_redretry
L_rok:
    buffer_store_dword v40, v1, s[16:19], s35 offen
    buffer_store_dword v40, v1, s[16:19], s36 offen sc1
    s_add_u32 s42, s42, 1
    s_add_u32 s46, s46, 131072
    s_add_u32 s43, s43, 131072
    s_add_u32 s71, s71, 262144
    s_add_u32 s45, s45, 262144
    s_add_u32 s27, s27, 262144
    s_waitcnt vmcnt(2)
L_b5:
    s_barrier
    s_branch L_step
L_nored:
    v_bfe_u32 v2, v15, 4, 1
    v_lshrrev_b32 v3, 5, v15
    v_lshl_add_u32 v2, v2, 1, v3
    v_lshrrev_b32 v1, 1, v1
    v_and_b32 v4, 1, v15
    v_lshlrev_b32 v4, 4, v4
    v_lshl_add_u32 v3, v2, 2, v4
    v_lshl_add_u32 v3, v1, 10, v3
    v_lshl_add_u32 v2, v2, 5, v4
    v_lshl_add_u32 v2, v1, 2, v2
    v_cndmask_b32 v1, v3, v2, s[86:87]
    v_cndmask_b32 v1, v1, v8, s[66:67]
    v_add_u32 v4, 0xffff0000, v6
    s_add_u32 s44, s44, 1
    s_and_b32 s24, s44, 3
    s_lshl_b32 s25, s24, 13
    s_add_u32 s35, s82, s25
    s_add_u32 s28, s32, s25
    s_sub_u32 s28, s28, 131072
    s_add_u32 s38, s28, s83
    s_add_u32 s28, s28, s81
    s_mov_b32 s65, s36
    s_lshl_b32 s26, s24, 3
    s_lshr_b32 s25, s2, s26
    s_and_b32 s25, s25, 0xff
    s_lshl_b32 s25, s25, 10
    s_add_u32 s36, s33, s25
    s_and_b32 s24, s44, 3
    s_lshl_b32 s25, s24, 18
    s_add_u32 s30, s25, s79
    s_xor_b32 s25, s25, 0x80000
    s_add_u32 s29, s25, s79
    s_add_u32 s69, s29, s81
    s_add_u32 s29, s29, s83
    s_sub_u32 s29, s29, 131072
    s_add_u32 s70, s30, s81
    s_add_u32 s30, s30, s83
    s_sub_u32 s30, s30, 131072
    s_lshl_b32 s25, s24, 13
    s_xor_b32 s25, s25, 0x4000
    s_add_u32 s37, s68, s25
    s_lshl_b32 s26, s24, 3
    s_lshr_b32 s25, s3, s26
    s_and_b32 s25, s25, 0xff
    s_lshl_b32 s25, s25, 10
    s_add_u32 s39, s34, s25
    s_lshl_b32 s25, s24, 10
    s_add_u32 s40, s64, s25
    s_cmp_eq_u32 s9, 3
    s_cselect_b32 s65, s47, s65
    s_cselect_b32 s6, s44, -1
    s_add_u32 s42, s42, 1
    s_add_u32 s46, s46, 131072
    s_add_u32 s43, s43, 131072
    s_add_u32 s71, s71, 262144
    s_add_u32 s45, s45, 262144
    s_add_u32 s27, s27, 0x40000
    s_cmp_lt_u32 s9, 2
    s_cbranch_scc1 L_nokv
    s_nop 0
    s_nop 0
    s_nop 0
    s_nop 0
    s_nop 0
    s_nop 0
    s_nop 0
    s_nop 0
    s_nop 0
    s_nop 0
    s_nop 0
    s_nop 0
    s_nop 0
    s_nop 0
    s_nop 0
    s_nop 0
    s_nop 0
    s_nop 0
    s_nop 0
    s_nop 0
    s_nop 0
    s_nop 0
    s_nop 0
    s_nop 0
    s_nop 0
    s_nop 0
    s_nop 0
    s_nop 0
    s_nop 0
    s_add_u32 m0, s7, 0
    s_nop 0
    buffer_load_dwordx4 v5, s[16:19], s27 offen offset:0 sc1 lds
    buffer_load_dwordx4 v5, s[16:19], s27 offen offset:1024 sc1 lds
    s_sub_u32 s27, s27, 4096
    s_sub_u32 s7, s7, 8192
    s_add_u32 m0, s7, 0
    s_nop 0
    buffer_load_dwordx4 v5, s[16:19], s27 offen offset:0 sc1 lds
    buffer_load_dwordx4 v5, s[16:19], s27 offen offset:1024 sc1 lds
    s_add_u32 s27, s27, 4096
    s_add_u32 s7, s7, 8192
L_nokv:
    s_cmp_lg_u32 s9, 3
    s_cbranch_scc1 L_b5
    s_mov_b32 s26, 400000
    s_min_u32 s25, s42, 63
    s_lshr_b32 s25, s25, 2
    s_cmp_gt_u32 s72, s25
    s_cbranch_scc1 p1d_4
    v_bfe_u32 v44, v15, 2, 2
    v_mul_u32_u24 v44, 768, v44
    v_and_b32 v45, 12, v8
    v_add_u32 v44, v44, v45
    s_lshl_b32 s24, s10, 4
    s_add_u32 s24, s24, 3145728
p1w_3:
    buffer_load_dword v45, v44, s[16:19], s24 offen sc1
    s_sub_u32 s26, s26, 1
    s_cbranch_scc1 L_fail
    s_waitcnt vmcnt(0)
    s_nop 1
    v_min_u32_dpp v45, v45, v45 row_ror:1 row_mask:0xf bank_mask:0xf
    s_nop 1
    v_min_u32_dpp v45, v45, v45 row_ror:2 row_mask:0xf bank_mask:0xf
    s_nop 1
    v_min_u32_dpp v45, v45, v45 row_ror:4 row_mask:0xf bank_mask:0xf
    s_nop 1
    v_min_u32_dpp v45, v45, v45 row_ror:8 row_mask:0xf bank_mask:0xf
    s_nop 1
    v_readfirstlane_b32 s72, v45
    s_cmp_gt_u32 s72, s25
    s_cbranch_scc0 p1w_3
p1d_4:
    s_branch L_b5
L_lretry:
    s_waitcnt vmcnt(5)
L_lre1:
    ds_read_b128 v[40:43], v72 offset:0
    ds_read_b128 v[76:79], v73 offset:0
    s_add_u32 m0, s85, 0
    s_nop 0
    buffer_load_dwordx4 v5, s[16:19], s38 offen sc1 lds
    s_add_u32 m0, s84, 0
    s_mov_b64 exec, 0xffff
    buffer_load_dwordx4 v5, s[16:19], s28 offen sc1 lds
    s_mov_b64 exec, -1
    s_add_u32 s78, s78, 1
    s_sub_u32 s73, s73, 1
    s_cbranch_scc1 L_fail
    s_waitcnt lgkmcnt(0)
    v_max3_u32 v74, v40, v41, v42
    v_max3_u32 v76, v76, v77, v78
    v_max3_u32 v74, v74, v43, v79
    v_max_u32 v74, v74, v76
    v_cmp_eq_u32 vcc, -1, v74
    s_cbranch_vccz L_lok
    s_waitcnt vmcnt(0)
    s_branch L_lre1
L_rretry:
    s_add_u32 m0, s85, 5120
    s_nop 0
    buffer_load_dwordx4 v5, s[16:19], s39 offen sc1 lds
    s_add_u32 m0, s84, 5120
    s_mov_b64 exec, 0xffff
    buffer_load_dwordx4 v5, s[16:19], s40 offen sc1 lds
    s_mov_b64 exec, -1
    s_nop 0
    s_nop 0
    s_nop 0
    s_nop 0
    s_nop 0
    s_nop 0
    s_nop 0
    s_nop 0
    s_nop 0
    s_nop 0
    s_nop 0
    s_nop 0
    s_nop 0
    s_nop 0
    s_nop 0
    s_nop 0
    s_nop 0
    s_nop 0
    s_nop 0
    s_nop 0
    s_nop 0
    s_nop 0
    s_nop 0
    s_nop 0
    s_nop 0
L_rre1:
    s_add_u32 m0, s85, 5120
    s_nop 0
    buffer_load_dwordx4 v5, s[16:19], s39 offen sc1 lds
    s_add_u32 m0, s84, 5120
    s_mov_b64 exec, 0xffff
    buffer_load_dwordx4 v5, s[16:19], s40 offen sc1 lds
    s_mov_b64 exec, -1
    v_add_u32 v72, s83, v5
    v_and_b32 v73, 0xfffffcff, v5
    v_add_u32 v73, s81, v73
    s_add_u32 s78, s78, 0x400
    s_sub_u32 s73, s73, 1
    s_cbranch_scc1 L_fail
    s_lshr_b32 s24, s83, 2
    s_add_u32 m0, s24, 162304
    s_waitcnt vmcnt(2)
    ds_read_b128 v[76:79], v73 offset:5120
    ds_read_b128 v[72:75], v72 offset:5120
    s_waitcnt lgkmcnt(0)
    v_max3_u32 v44, v72, v73, v74
    v_max3_u32 v76, v76, v77, v78
    v_max3_u32 v44, v44, v75, v79
    v_max_u32 v44, v44, v76
    v_cmp_eq_u32 vcc, -1, v44
    s_cbranch_vccnz L_rre1
    s_branch L_remok
L_redretry:
    s_mov_b32 s4, s31
    buffer_load_dwordx4 v[48:51], v0, s[16:19], s4 offen sc1
    s_add_u32 s4, s4, 41984
    buffer_load_dwordx4 v[52:55], v0, s[16:19], s4 offen sc1
    s_add_u32 s4, s4, 41984
    buffer_load_dwordx4 v[56:59], v0, s[16:19], s4 offen sc1
    s_add_u32 s4, s4, 41984
    buffer_load_dwordx4 v[60:63], v0, s[16:19], s4 offen sc1
    s_waitcnt vmcnt(7)
    v_mfma_f32_16x16x32_bf16 v[40:43], v[64:67], v[44:47], 0
    v_max3_u32 v2, v64, v65, v66
    v_mov_b32 v3, v67
    s_waitcnt vmcnt(6)
    v_mfma_f32_16x16x32_bf16 v[40:43], v[68:71], v[44:47], v[40:43]
    v_max3_u32 v2, v2, v68, v69
    v_max3_u32 v3, v3, v70, v71
    s_waitcnt vmcnt(5)
    v_mfma_f32_16x16x32_bf16 v[40:43], v[72:75], v[44:47], v[40:43]
    v_max3_u32 v2, v2, v72, v73
    v_max3_u32 v3, v3, v74, v75
    s_waitcnt vmcnt(4)
    v_mfma_f32_16x16x32_bf16 v[40:43], v[76:79], v[44:47], v[40:43]
    v_max3_u32 v2, v2, v76, v77
    v_max3_u32 v3, v3, v78, v79
    v_max_u32 v2, v2, v3
    v_cmp_eq_u32 vcc, -1, v2
    s_nop 3
    v_permlane32_swap_b32 v40, v42
    v_permlane32_swap_b32 v41, v43
    v_add_f32 v40, v40, v42
    v_add_f32 v41, v41, v43
    v_cvt_pk_bf16_f32 v40, v40, v41
    s_cbranch_vccz L_rok
    s_mov_b32 s4, s31
    buffer_load_dwordx4 v[64:67], v0, s[16:19], s4 offen sc1
    s_add_u32 s4, s4, 41984
    buffer_load_dwordx4 v[68:71], v0, s[16:19], s4 offen sc1
    s_add_u32 s4, s4, 41984
    buffer_load_dwordx4 v[72:75], v0, s[16:19], s4 offen sc1
    s_add_u32 s4, s4, 41984
    buffer_load_dwordx4 v[76:79], v0, s[16:19], s4 offen sc1
    s_add_u32 s78, s78, 0x100000
    s_sub_u32 s5, s5, 1
    s_cbranch_scc0 L_rp
    s_branch L_fail
L_recend:
    s_waitcnt vmcnt(0) lgkmcnt(0)
    s_barrier
    v_mov_b32 v16, 64
    buffer_store_dword v16, v8, s[16:19], s47 offen sc1
    s_waitcnt vmcnt(0)
    s_endpgm
L_fail:
    s_waitcnt vmcnt(0)
    v_mov_b32 v4, 68
    v_mov_b32 v3, 1
    s_mov_b64 exec, 1
    buffer_atomic_add v3, v4, s[12:15], 0 offen
    s_waitcnt vmcnt(0)
L_end:
    s_endpgm
L_help:

    s_sub_u32 s24, s8, 2
    s_lshl_b32 s24, s24, 3
    s_lshr_b32 s25, s10, 2
    s_add_u32 s30, s24, s25
    s_and_b32 s31, s10, 3
    s_lshr_b32 s32, s9, 1
    s_and_b32 s33, s9, 1
    s_sub_u32 s24, s30, 32
    s_lshl_b32 s24, s24, 1
    s_add_u32 s24, s24, s32
    s_cmp_lt_u32 s30, 32
    s_cselect_b32 s34, s30, s24
    s_cselect_b32 s35, s32, 0
    s_cselect_b32 s20, s62, s60
    s_cselect_b32 s21, s63, s61
    s_mov_b32 s36, 33554432
    s_cselect_b32 s36, s36, 67108864
    s_cmp_eq_u32 s35, 1
    s_cselect_b32 s20, s64, s20
    s_cselect_b32 s21, s65, s21
    s_cselect_b32 s36, 50331648, s36
    s_mov_b32 s22, 5242880
    s_mov_b32 s23, 0x20000
    s_mul_i32 s24, s31, 48
    s_add_u32 s24, s24, s30
    s_lshl_b32 s24, s24, 2
    s_add_u32 s24, s24, s9
    s_lshl_b32 s24, s24, 2
    s_add_u32 s37, s24, 3145728
    v_mov_b32 v27, 0
    s_mov_b64 exec, 1
    buffer_store_dword v27, v27, s[16:19], s37 offen sc1
    s_mov_b64 exec, -1
    s_sub_u32 s24, s8, 2
    s_lshl_b32 s24, s24, 9
    s_lshl_b32 s25, s10, 4
    s_add_u32 s24, s24, s25
    s_add_u32 s24, s24, 3153920
    s_lshl_b32 s25, s9, 2
    s_add_u32 s11, s24, s25
    s_mov_b64 exec, 1
    buffer_store_dword v27, v27, s[16:19], s11 offen
    s_add_u32 s24, s11, 8192
    buffer_store_dword v27, v27, s[16:19], s24 offen sc1
    s_mov_b64 exec, -1
    s_waitcnt vmcnt(0)
    s_barrier
    s_cmp_lg_u32 s9, 0
    s_cbranch_scc1 arr_5
    v_mov_b32 v16, 1
    v_mov_b32 v17, 64
    s_mov_b64 exec, 1
    buffer_atomic_add v16, v17, s[12:15], 0 offen
    s_mov_b64 exec, -1
arr_5:
    v_and_b32 v70, 15, v79
    v_lshrrev_b32 v71, 4, v79
    v_bfe_u32 v72, v79, 2, 2
    v_and_b32 v73, 3, v79
    v_lshlrev_b32 v74, 2, v71
    v_xor_b32 v74, v74, v70
    v_lshlrev_b32 v74, 4, v74
    s_lshl_b32 s24, s33, 4
    v_add_u32 v75, s24, v71
    v_lshl_add_u32 v60, v75, 13, v74
    s_lshl_b32 s24, s34, 8
    v_add_u32 v60, s24, v60
    v_lshrrev_b32 v74, 1, v71
    v_lshl_add_u32 v74, v74, 3, v72
    v_and_b32 v75, 1, v71
    v_lshlrev_b32 v75, 1, v75
    v_lshrrev_b32 v76, 1, v73
    v_add_u32 v75, v75, v76
    s_lshl_b32 s24, s33, 3
    v_add_u32 v75, s24, v75
    v_lshlrev_b32 v76, 2, v72
    v_xor_b32 v75, v75, v76
    v_lshlrev_b32 v75, 4, v75
    v_lshl_add_u32 v61, v74, 8, v75
    v_and_b32 v76, 1, v73
    v_lshl_add_u32 v61, v76, 3, v61
    s_lshl_b32 s24, s32, 13
    v_add_u32 v61, s24, v61
    s_lshl_b32 s24, s9, 12
    s_add_u32 m0, s24, 0
    s_mov_b32 s28, 0
    buffer_load_dwordx4 v60, s[20:23], s28 offen lds
    s_lshl_b32 s24, s9, 12
    s_add_u32 m0, s24, 1024
    s_mov_b32 s28, 32768
    buffer_load_dwordx4 v60, s[20:23], s28 offen lds
    s_lshl_b32 s24, s9, 12
    s_add_u32 m0, s24, 2048
    s_mov_b32 s28, 65536
    buffer_load_dwordx4 v60, s[20:23], s28 offen lds
    s_lshl_b32 s24, s9, 12
    s_add_u32 m0, s24, 3072
    s_mov_b32 s28, 98304
    buffer_load_dwordx4 v60, s[20:23], s28 offen lds
    s_lshl_b32 s24, s9, 12
    s_add_u32 m0, s24, 16384
    s_mov_b32 s28, 262144
    buffer_load_dwordx4 v60, s[20:23], s28 offen lds
    s_lshl_b32 s24, s9, 12
    s_add_u32 m0, s24, 17408
    s_mov_b32 s28, 294912
    buffer_load_dwordx4 v60, s[20:23], s28 offen lds
    s_lshl_b32 s24, s9, 12
    s_add_u32 m0, s24, 18432
    s_mov_b32 s28, 327680
    buffer_load_dwordx4 v60, s[20:23], s28 offen lds
    s_lshl_b32 s24, s9, 12
    s_add_u32 m0, s24, 19456
    s_mov_b32 s28, 360448
    buffer_load_dwordx4 v60, s[20:23], s28 offen lds
    s_lshl_b32 s24, s9, 12
    s_add_u32 m0, s24, 32768
    s_mov_b32 s28, 524288
    buffer_load_dwordx4 v60, s[20:23], s28 offen lds
    s_lshl_b32 s24, s9, 12
    s_add_u32 m0, s24, 33792
    s_mov_b32 s28, 557056
    buffer_load_dwordx4 v60, s[20:23], s28 offen lds
    s_lshl_b32 s24, s9, 12
    s_add_u32 m0, s24, 34816
    s_mov_b32 s28, 589824
    buffer_load_dwordx4 v60, s[20:23], s28 offen lds
    s_lshl_b32 s24, s9, 12
    s_add_u32 m0, s24, 35840
    s_mov_b32 s28, 622592
    buffer_load_dwordx4 v60, s[20:23], s28 offen lds
    s_lshl_b32 s24, s9, 12
    s_add_u32 m0, s24, 49152
    s_mov_b32 s28, 786432
    buffer_load_dwordx4 v60, s[20:23], s28 offen lds
    s_lshl_b32 s24, s9, 12
    s_add_u32 m0, s24, 50176
    s_mov_b32 s28, 819200
    buffer_load_dwordx4 v60, s[20:23], s28 offen lds
    s_lshl_b32 s24, s9, 12
    s_add_u32 m0, s24, 51200
    s_mov_b32 s28, 851968
    buffer_load_dwordx4 v60, s[20:23], s28 offen lds
    s_lshl_b32 s24, s9, 12
    s_add_u32 m0, s24, 52224
    s_mov_b32 s28, 884736
    buffer_load_dwordx4 v60, s[20:23], s28 offen lds
    s_lshl_b32 s24, s9, 12
    s_add_u32 m0, s24, 65536
    s_mov_b32 s28, 1048576
    buffer_load_dwordx4 v60, s[20:23], s28 offen lds
    s_lshl_b32 s24, s9, 12
    s_add_u32 m0, s24, 66560
    s_mov_b32 s28, 1081344
    buffer_load_dwordx4 v60, s[20:23], s28 offen lds
    s_lshl_b32 s24, s9, 12
    s_add_u32 m0, s24, 67584
    s_mov_b32 s28, 1114112
    buffer_load_dwordx4 v60, s[20:23], s28 offen lds
    s_lshl_b32 s24, s9, 12
    s_add_u32 m0, s24, 68608
    s_mov_b32 s28, 1146880
    buffer_load_dwordx4 v60, s[20:23], s28 offen lds
    s_lshl_b32 s24, s9, 12
    s_add_u32 m0, s24, 81920
    s_mov_b32 s28, 1310720
    buffer_load_dwordx4 v60, s[20:23], s28 offen lds
    s_lshl_b32 s24, s9, 12
    s_add_u32 m0, s24, 82944
    s_mov_b32 s28, 1343488
    buffer_load_dwordx4 v60, s[20:23], s28 offen lds
    s_lshl_b32 s24, s9, 12
    s_add_u32 m0, s24, 83968
    s_mov_b32 s28, 1376256
    buffer_load_dwordx4 v60, s[20:23], s28 offen lds
    s_lshl_b32 s24, s9, 12
    s_add_u32 m0, s24, 84992
    s_mov_b32 s28, 1409024
    buffer_load_dwordx4 v60, s[20:23], s28 offen lds
    s_lshl_b32 s24, s9, 12
    s_add_u32 m0, s24, 98304
    s_mov_b32 s28, 1572864
    buffer_load_dwordx4 v60, s[20:23], s28 offen lds
    s_lshl_b32 s24, s9, 12
    s_add_u32 m0, s24, 99328
    s_mov_b32 s28, 1605632
    buffer_load_dwordx4 v60, s[20:23], s28 offen lds
    s_lshl_b32 s24, s9, 12
    s_add_u32 m0, s24, 100352
    s_mov_b32 s28, 1638400
    buffer_load_dwordx4 v60, s[20:23], s28 offen lds
    s_lshl_b32 s24, s9, 12
    s_add_u32 m0, s24, 101376
    s_mov_b32 s28, 1671168
    buffer_load_dwordx4 v60, s[20:23], s28 offen lds
    s_lshl_b32 s24, s9, 12
    s_add_u32 m0, s24, 114688
    s_mov_b32 s28, 1835008
    buffer_load_dwordx4 v60, s[20:23], s28 offen lds
    s_lshl_b32 s24, s9, 12
    s_add_u32 m0, s24, 115712
    s_mov_b32 s28, 1867776
    buffer_load_dwordx4 v60, s[20:23], s28 offen lds
    s_lshl_b32 s24, s9, 12
    s_add_u32 m0, s24, 116736
    s_mov_b32 s28, 1900544
    buffer_load_dwordx4 v60, s[20:23], s28 offen lds
    s_lshl_b32 s24, s9, 12
    s_add_u32 m0, s24, 117760
    s_mov_b32 s28, 1933312
    buffer_load_dwordx4 v60, s[20:23], s28 offen lds
    s_mul_i32 s24, s9, 640
    s_add_u32 s24, s24, 0
    v_add_u32 v74, s24, v79
    v_mul_u32_u24 v75, 0xcccd, v74
    v_lshrrev_b32 v75, 22, v75
    v_mul_u32_u24 v76, 80, v75
    v_sub_u32 v76, v74, v76
    v_xor_b32 v77, v76, v75
    v_bfi_b32 v76, 15, v77, v76
    v_lshlrev_b32 v76, 4, v76
    v_mul_u32_u24 v75, 1280, v75
    v_add_u32 v0, v75, v76
    s_mul_i32 s24, s9, 640
    s_add_u32 s24, s24, 64
    v_add_u32 v74, s24, v79
    v_mul_u32_u24 v75, 0xcccd, v74
    v_lshrrev_b32 v75, 22, v75
    v_mul_u32_u24 v76, 80, v75
    v_sub_u32 v76, v74, v76
    v_xor_b32 v77, v76, v75
    v_bfi_b32 v76, 15, v77, v76
    v_lshlrev_b32 v76, 4, v76
    v_mul_u32_u24 v75, 1280, v75
    v_add_u32 v1, v75, v76
    s_mul_i32 s24, s9, 640
    s_add_u32 s24, s24, 128
    v_add_u32 v74, s24, v79
    v_mul_u32_u24 v75, 0xcccd, v74
    v_lshrrev_b32 v75, 22, v75
    v_mul_u32_u24 v76, 80, v75
    v_sub_u32 v76, v74, v76
    v_xor_b32 v77, v76, v75
    v_bfi_b32 v76, 15, v77, v76
    v_lshlrev_b32 v76, 4, v76
    v_mul_u32_u24 v75, 1280, v75
    v_add_u32 v2, v75, v76
    s_mul_i32 s24, s9, 640
    s_add_u32 s24, s24, 192
    v_add_u32 v74, s24, v79
    v_mul_u32_u24 v75, 0xcccd, v74
    v_lshrrev_b32 v75, 22, v75
    v_mul_u32_u24 v76, 80, v75
    v_sub_u32 v76, v74, v76
    v_xor_b32 v77, v76, v75
    v_bfi_b32 v76, 15, v77, v76
    v_lshlrev_b32 v76, 4, v76
    v_mul_u32_u24 v75, 1280, v75
    v_add_u32 v3, v75, v76
    s_mul_i32 s24, s9, 640
    s_add_u32 s24, s24, 256
    v_add_u32 v74, s24, v79
    v_mul_u32_u24 v75, 0xcccd, v74
    v_lshrrev_b32 v75, 22, v75
    v_mul_u32_u24 v76, 80, v75
    v_sub_u32 v76, v74, v76
    v_xor_b32 v77, v76, v75
    v_bfi_b32 v76, 15, v77, v76
    v_lshlrev_b32 v76, 4, v76
    v_mul_u32_u24 v75, 1280, v75
    v_add_u32 v4, v75, v76
    s_mul_i32 s24, s9, 640
    s_add_u32 s24, s24, 320
    v_add_u32 v74, s24, v79
    v_mul_u32_u24 v75, 0xcccd, v74
    v_lshrrev_b32 v75, 22, v75
    v_mul_u32_u24 v76, 80, v75
    v_sub_u32 v76, v74, v76
    v_xor_b32 v77, v76, v75
    v_bfi_b32 v76, 15, v77, v76
    v_lshlrev_b32 v76, 4, v76
    v_mul_u32_u24 v75, 1280, v75
    v_add_u32 v5, v75, v76
    s_mul_i32 s24, s9, 640
    s_add_u32 s24, s24, 384
    v_add_u32 v74, s24, v79
    v_mul_u32_u24 v75, 0xcccd, v74
    v_lshrrev_b32 v75, 22, v75
    v_mul_u32_u24 v76, 80, v75
    v_sub_u32 v76, v74, v76
    v_xor_b32 v77, v76, v75
    v_bfi_b32 v76, 15, v77, v76
    v_lshlrev_b32 v76, 4, v76
    v_mul_u32_u24 v75, 1280, v75
    v_add_u32 v6, v75, v76
    s_mul_i32 s24, s9, 640
    s_add_u32 s24, s24, 448
    v_add_u32 v74, s24, v79
    v_mul_u32_u24 v75, 0xcccd, v74
    v_lshrrev_b32 v75, 22, v75
    v_mul_u32_u24 v76, 80, v75
    v_sub_u32 v76, v74, v76
    v_xor_b32 v77, v76, v75
    v_bfi_b32 v76, 15, v77, v76
    v_lshlrev_b32 v76, 4, v76
    v_mul_u32_u24 v75, 1280, v75
    v_add_u32 v7, v75, v76
    s_mul_i32 s24, s9, 640
    s_add_u32 s24, s24, 512
    v_add_u32 v74, s24, v79
    v_mul_u32_u24 v75, 0xcccd, v74
    v_lshrrev_b32 v75, 22, v75
    v_mul_u32_u24 v76, 80, v75
    v_sub_u32 v76, v74, v76
    v_xor_b32 v77, v76, v75
    v_bfi_b32 v76, 15, v77, v76
    v_lshlrev_b32 v76, 4, v76
    v_mul_u32_u24 v75, 1280, v75
    v_add_u32 v8, v75, v76
    s_mul_i32 s24, s9, 640
    s_add_u32 s24, s24, 576
    v_add_u32 v74, s24, v79
    v_mul_u32_u24 v75, 0xcccd, v74
    v_lshrrev_b32 v75, 22, v75
    v_mul_u32_u24 v76, 80, v75
    v_sub_u32 v76, v74, v76
    v_xor_b32 v77, v76, v75
    v_bfi_b32 v76, 15, v77, v76
    v_lshlrev_b32 v76, 4, v76
    v_mul_u32_u24 v75, 1280, v75
    v_add_u32 v9, v75, v76
    v_and_b32 v74, 31, v79
    v_lshrrev_b32 v75, 5, v79
    v_mul_u32_u24 v76, 1280, v74
    v_add_u32 v77, 0, v75
    v_xor_b32 v77, v77, v74
    v_and_b32 v77, 15, v77
    v_lshl_add_u32 v10, v77, 4, v76
    v_add_u32 v77, 2, v75
    v_xor_b32 v77, v77, v74
    v_and_b32 v77, 15, v77
    v_lshl_add_u32 v11, v77, 4, v76
    v_add_u32 v77, 4, v75
    v_xor_b32 v77, v77, v74
    v_and_b32 v77, 15, v77
    v_lshl_add_u32 v12, v77, 4, v76
    v_add_u32 v77, 6, v75
    v_xor_b32 v77, v77, v74
    v_and_b32 v77, 15, v77
    v_lshl_add_u32 v13, v77, 4, v76
    v_add_u32 v77, 8, v75
    v_xor_b32 v77, v77, v74
    v_and_b32 v77, 15, v77
    v_lshl_add_u32 v14, v77, 4, v76
    v_add_u32 v77, 10, v75
    v_xor_b32 v77, v77, v74
    v_and_b32 v77, 15, v77
    v_lshl_add_u32 v15, v77, 4, v76
    v_add_u32 v77, 12, v75
    v_xor_b32 v77, v77, v74
    v_and_b32 v77, 15, v77
    v_lshl_add_u32 v16, v77, 4, v76
    v_add_u32 v77, 14, v75
    v_xor_b32 v77, v77, v74
    v_and_b32 v77, 15, v77
    v_lshl_add_u32 v17, v77, 4, v76
    v_lshrrev_b32 v76, 4, v74
    s_cmp_eq_u32 s35, 1
    s_cselect_b32 s24, 10, 12
    v_lshlrev_b32 v76, s24, v76
    v_lshl_add_u32 v76, v75, 8, v76
    v_lshl_add_u32 v26, v70, 4, v76
    s_cselect_b32 s24, 12, 11
    s_lshl_b32 s24, s33, s24
    s_add_u32 s36, s36, s24
    s_lshl_b32 s24, s34, 13
    s_add_u32 s36, s36, s24
    s_lshl_b32 s24, s31, 18
    s_add_u32 s36, s36, s24
    s_waitcnt vmcnt(28)
    s_barrier
    v_add_u32 v62, 0, v61
    v_xor_b32 v63, 64, v62
    ds_read_b64_tr_b16 v[128:129], v62 offset:0
    ds_read_b64_tr_b16 v[130:131], v62 offset:1024
    ds_read_b64_tr_b16 v[132:133], v63 offset:0
    ds_read_b64_tr_b16 v[134:135], v63 offset:1024
    ds_read_b64_tr_b16 v[136:137], v62 offset:4096
    ds_read_b64_tr_b16 v[138:139], v62 offset:5120
    ds_read_b64_tr_b16 v[140:141], v63 offset:4096
    ds_read_b64_tr_b16 v[142:143], v63 offset:5120
    s_waitcnt lgkmcnt(0)
    s_waitcnt vmcnt(24)
    s_barrier
    s_lshl_b32 s24, s9, 12
    s_add_u32 m0, s24, 0
    s_mov_b32 s28, 2097152
    buffer_load_dwordx4 v60, s[20:23], s28 offen lds
    s_lshl_b32 s24, s9, 12
    s_add_u32 m0, s24, 1024
    s_mov_b32 s28, 2129920
    buffer_load_dwordx4 v60, s[20:23], s28 offen lds
    s_lshl_b32 s24, s9, 12
    s_add_u32 m0, s24, 2048
    s_mov_b32 s28, 2162688
    buffer_load_dwordx4 v60, s[20:23], s28 offen lds
    s_lshl_b32 s24, s9, 12
    s_add_u32 m0, s24, 3072
    s_mov_b32 s28, 2195456
    buffer_load_dwordx4 v60, s[20:23], s28 offen lds
    v_add_u32 v62, 16384, v61
    v_xor_b32 v63, 64, v62
    ds_read_b64_tr_b16 v[144:145], v62 offset:0
    ds_read_b64_tr_b16 v[146:147], v62 offset:1024
    ds_read_b64_tr_b16 v[148:149], v63 offset:0
    ds_read_b64_tr_b16 v[150:151], v63 offset:1024
    ds_read_b64_tr_b16 v[152:153], v62 offset:4096
    ds_read_b64_tr_b16 v[154:155], v62 offset:5120
    ds_read_b64_tr_b16 v[156:157], v63 offset:4096
    ds_read_b64_tr_b16 v[158:159], v63 offset:5120
    s_waitcnt lgkmcnt(0)
    s_waitcnt vmcnt(24)
    s_barrier
    s_lshl_b32 s24, s9, 12
    s_add_u32 m0, s24, 16384
    s_mov_b32 s28, 2359296
    buffer_load_dwordx4 v60, s[20:23], s28 offen lds
    s_lshl_b32 s24, s9, 12
    s_add_u32 m0, s24, 17408
    s_mov_b32 s28, 2392064
    buffer_load_dwordx4 v60, s[20:23], s28 offen lds
    s_lshl_b32 s24, s9, 12
    s_add_u32 m0, s24, 18432
    s_mov_b32 s28, 2424832
    buffer_load_dwordx4 v60, s[20:23], s28 offen lds
    s_lshl_b32 s24, s9, 12
    s_add_u32 m0, s24, 19456
    s_mov_b32 s28, 2457600
    buffer_load_dwordx4 v60, s[20:23], s28 offen lds
    v_add_u32 v62, 32768, v61
    v_xor_b32 v63, 64, v62
    ds_read_b64_tr_b16 v[160:161], v62 offset:0
    ds_read_b64_tr_b16 v[162:163], v62 offset:1024
    ds_read_b64_tr_b16 v[164:165], v63 offset:0
    ds_read_b64_tr_b16 v[166:167], v63 offset:1024
    ds_read_b64_tr_b16 v[168:169], v62 offset:4096
    ds_read_b64_tr_b16 v[170:171], v62 offset:5120
    ds_read_b64_tr_b16 v[172:173], v63 offset:4096
    ds_read_b64_tr_b16 v[174:175], v63 offset:5120
    s_waitcnt lgkmcnt(0)
    s_waitcnt vmcnt(24)
    s_barrier
    s_lshl_b32 s24, s9, 12
    s_add_u32 m0, s24, 32768
    s_mov_b32 s28, 2621440
    buffer_load_dwordx4 v60, s[20:23], s28 offen lds
    s_lshl_b32 s24, s9, 12
    s_add_u32 m0, s24, 33792
    s_mov_b32 s28, 2654208
    buffer_load_dwordx4 v60, s[20:23], s28 offen lds
    s_lshl_b32 s24, s9, 12
    s_add_u32 m0, s24, 34816
    s_mov_b32 s28, 2686976
    buffer_load_dwordx4 v60, s[20:23], s28 offen lds
    s_lshl_b32 s24, s9, 12
    s_add_u32 m0, s24, 35840
    s_mov_b32 s28, 2719744
    buffer_load_dwordx4 v60, s[20:23], s28 offen lds
    v_add_u32 v62, 49152, v61
    v_xor_b32 v63, 64, v62
    ds_read_b64_tr_b16 v[176:177], v62 offset:0
    ds_read_b64_tr_b16 v[178:179], v62 offset:1024
    ds_read_b64_tr_b16 v[180:181], v63 offset:0
    ds_read_b64_tr_b16 v[182:183], v63 offset:1024
    ds_read_b64_tr_b16 v[184:185], v62 offset:4096
    ds_read_b64_tr_b16 v[186:187], v62 offset:5120
    ds_read_b64_tr_b16 v[188:189], v63 offset:4096
    ds_read_b64_tr_b16 v[190:191], v63 offset:5120
    s_waitcnt lgkmcnt(0)
    s_waitcnt vmcnt(24)
    s_barrier
    s_lshl_b32 s24, s9, 12
    s_add_u32 m0, s24, 49152
    s_mov_b32 s28, 2883584
    buffer_load_dwordx4 v60, s[20:23], s28 offen lds
    s_lshl_b32 s24, s9, 12
    s_add_u32 m0, s24, 50176
    s_mov_b32 s28, 2916352
    buffer_load_dwordx4 v60, s[20:23], s28 offen lds
    s_lshl_b32 s24, s9, 12
    s_add_u32 m0, s24, 51200
    s_mov_b32 s28, 2949120
    buffer_load_dwordx4 v60, s[20:23], s28 offen lds
    s_lshl_b32 s24, s9, 12
    s_add_u32 m0, s24, 52224
    s_mov_b32 s28, 2981888
    buffer_load_dwordx4 v60, s[20:23], s28 offen lds
    v_add_u32 v62, 65536, v61
    v_xor_b32 v63, 64, v62
    ds_read_b64_tr_b16 v[192:193], v62 offset:0
    ds_read_b64_tr_b16 v[194:195], v62 offset:1024
    ds_read_b64_tr_b16 v[196:197], v63 offset:0
    ds_read_b64_tr_b16 v[198:199], v63 offset:1024
    ds_read_b64_tr_b16 v[200:201], v62 offset:4096
    ds_read_b64_tr_b16 v[202:203], v62 offset:5120
    ds_read_b64_tr_b16 v[204:205], v63 offset:4096
    ds_read_b64_tr_b16 v[206:207], v63 offset:5120
    s_waitcnt lgkmcnt(0)
    s_waitcnt vmcnt(24)
    s_barrier
    s_lshl_b32 s24, s9, 12
    s_add_u32 m0, s24, 65536
    s_mov_b32 s28, 3145728
    buffer_load_dwordx4 v60, s[20:23], s28 offen lds
    s_lshl_b32 s24, s9, 12
    s_add_u32 m0, s24, 66560
    s_mov_b32 s28, 3178496
    buffer_load_dwordx4 v60, s[20:23], s28 offen lds
    s_lshl_b32 s24, s9, 12
    s_add_u32 m0, s24, 67584
    s_mov_b32 s28, 3211264
    buffer_load_dwordx4 v60, s[20:23], s28 offen lds
    s_lshl_b32 s24, s9, 12
    s_add_u32 m0, s24, 68608
    s_mov_b32 s28, 3244032
    buffer_load_dwordx4 v60, s[20:23], s28 offen lds
    v_add_u32 v62, 81920, v61
    v_xor_b32 v63, 64, v62
    ds_read_b64_tr_b16 v[208:209], v62 offset:0
    ds_read_b64_tr_b16 v[210:211], v62 offset:1024
    ds_read_b64_tr_b16 v[212:213], v63 offset:0
    ds_read_b64_tr_b16 v[214:215], v63 offset:1024
    ds_read_b64_tr_b16 v[216:217], v62 offset:4096
    ds_read_b64_tr_b16 v[218:219], v62 offset:5120
    ds_read_b64_tr_b16 v[220:221], v63 offset:4096
    ds_read_b64_tr_b16 v[222:223], v63 offset:5120
    s_waitcnt lgkmcnt(0)
    s_waitcnt vmcnt(24)
    s_barrier
    s_lshl_b32 s24, s9, 12
    s_add_u32 m0, s24, 81920
    s_mov_b32 s28, 3407872
    buffer_load_dwordx4 v60, s[20:23], s28 offen lds
    s_lshl_b32 s24, s9, 12
    s_add_u32 m0, s24, 82944
    s_mov_b32 s28, 3440640
    buffer_load_dwordx4 v60, s[20:23], s28 offen lds
    s_lshl_b32 s24, s9, 12
    s_add_u32 m0, s24, 83968
    s_mov_b32 s28, 3473408
    buffer_load_dwordx4 v60, s[20:23], s28 offen lds
    s_lshl_b32 s24, s9, 12
    s_add_u32 m0, s24, 84992
    s_mov_b32 s28, 3506176
    buffer_load_dwordx4 v60, s[20:23], s28 offen lds
    v_add_u32 v62, 98304, v61
    v_xor_b32 v63, 64, v62
    ds_read_b64_tr_b16 v[224:225], v62 offset:0
    ds_read_b64_tr_b16 v[226:227], v62 offset:1024
    ds_read_b64_tr_b16 v[228:229], v63 offset:0
    ds_read_b64_tr_b16 v[230:231], v63 offset:1024
    ds_read_b64_tr_b16 v[232:233], v62 offset:4096
    ds_read_b64_tr_b16 v[234:235], v62 offset:5120
    ds_read_b64_tr_b16 v[236:237], v63 offset:4096
    ds_read_b64_tr_b16 v[238:239], v63 offset:5120
    s_waitcnt lgkmcnt(0)
    s_waitcnt vmcnt(24)
    s_barrier
    s_lshl_b32 s24, s9, 12
    s_add_u32 m0, s24, 98304
    s_mov_b32 s28, 3670016
    buffer_load_dwordx4 v60, s[20:23], s28 offen lds
    s_lshl_b32 s24, s9, 12
    s_add_u32 m0, s24, 99328
    s_mov_b32 s28, 3702784
    buffer_load_dwordx4 v60, s[20:23], s28 offen lds
    s_lshl_b32 s24, s9, 12
    s_add_u32 m0, s24, 100352
    s_mov_b32 s28, 3735552
    buffer_load_dwordx4 v60, s[20:23], s28 offen lds
    s_lshl_b32 s24, s9, 12
    s_add_u32 m0, s24, 101376
    s_mov_b32 s28, 3768320
    buffer_load_dwordx4 v60, s[20:23], s28 offen lds
    v_add_u32 v62, 114688, v61
    v_xor_b32 v63, 64, v62
    ds_read_b64_tr_b16 v[240:241], v62 offset:0
    ds_read_b64_tr_b16 v[242:243], v62 offset:1024
    ds_read_b64_tr_b16 v[244:245], v63 offset:0
    ds_read_b64_tr_b16 v[246:247], v63 offset:1024
    ds_read_b64_tr_b16 v[248:249], v62 offset:4096
    ds_read_b64_tr_b16 v[250:251], v62 offset:5120
    ds_read_b64_tr_b16 v[252:253], v63 offset:4096
    ds_read_b64_tr_b16 v[254:255], v63 offset:5120
    s_waitcnt lgkmcnt(0)
    s_waitcnt vmcnt(24)
    s_barrier
    s_lshl_b32 s24, s9, 12
    s_add_u32 m0, s24, 114688
    s_mov_b32 s28, 3932160
    buffer_load_dwordx4 v60, s[20:23], s28 offen lds
    s_lshl_b32 s24, s9, 12
    s_add_u32 m0, s24, 115712
    s_mov_b32 s28, 3964928
    buffer_load_dwordx4 v60, s[20:23], s28 offen lds
    s_lshl_b32 s24, s9, 12
    s_add_u32 m0, s24, 116736
    s_mov_b32 s28, 3997696
    buffer_load_dwordx4 v60, s[20:23], s28 offen lds
    s_lshl_b32 s24, s9, 12
    s_add_u32 m0, s24, 117760
    s_mov_b32 s28, 4030464
    buffer_load_dwordx4 v60, s[20:23], s28 offen lds
    v_add_u32 v62, 0, v61
    v_xor_b32 v63, 64, v62
    ds_read_b64_tr_b16 a[0:1], v62 offset:0
    ds_read_b64_tr_b16 a[2:3], v62 offset:1024
    ds_read_b64_tr_b16 a[4:5], v63 offset:0
    ds_read_b64_tr_b16 a[6:7], v63 offset:1024
    ds_read_b64_tr_b16 a[8:9], v62 offset:4096
    ds_read_b64_tr_b16 a[10:11], v62 offset:5120
    ds_read_b64_tr_b16 a[12:13], v63 offset:4096
    ds_read_b64_tr_b16 a[14:15], v63 offset:5120
    s_waitcnt lgkmcnt(0)
    s_waitcnt vmcnt(24)
    s_barrier
    s_lshl_b32 s24, s9, 12
    s_add_u32 m0, s24, 0
    s_mov_b32 s28, 4194304
    buffer_load_dwordx4 v60, s[20:23], s28 offen lds
    s_lshl_b32 s24, s9, 12
    s_add_u32 m0, s24, 1024
    s_mov_b32 s28, 4227072
    buffer_load_dwordx4 v60, s[20:23], s28 offen lds
    s_lshl_b32 s24, s9, 12
    s_add_u32 m0, s24, 2048
    s_mov_b32 s28, 4259840
    buffer_load_dwordx4 v60, s[20:23], s28 offen lds
    s_lshl_b32 s24, s9, 12
    s_add_u32 m0, s24, 3072
    s_mov_b32 s28, 4292608
    buffer_load_dwordx4 v60, s[20:23], s28 offen lds
    v_add_u32 v62, 16384, v61
    v_xor_b32 v63, 64, v62
    ds_read_b64_tr_b16 a[16:17], v62 offset:0
    ds_read_b64_tr_b16 a[18:19], v62 offset:1024
    ds_read_b64_tr_b16 a[20:21], v63 offset:0
    ds_read_b64_tr_b16 a[22:23], v63 offset:1024
    ds_read_b64_tr_b16 a[24:25], v62 offset:4096
    ds_read_b64_tr_b16 a[26:27], v62 offset:5120
    ds_read_b64_tr_b16 a[28:29], v63 offset:4096
    ds_read_b64_tr_b16 a[30:31], v63 offset:5120
    s_waitcnt lgkmcnt(0)
    s_waitcnt vmcnt(24)
    s_barrier
    s_lshl_b32 s24, s9, 12
    s_add_u32 m0, s24, 16384
    s_mov_b32 s28, 4456448
    buffer_load_dwordx4 v60, s[20:23], s28 offen lds
    s_lshl_b32 s24, s9, 12
    s_add_u32 m0, s24, 17408
    s_mov_b32 s28, 4489216
    buffer_load_dwordx4 v60, s[20:23], s28 offen lds
    s_lshl_b32 s24, s9, 12
    s_add_u32 m0, s24, 18432
    s_mov_b32 s28, 4521984
    buffer_load_dwordx4 v60, s[20:23], s28 offen lds
    s_lshl_b32 s24, s9, 12
    s_add_u32 m0, s24, 19456
    s_mov_b32 s28, 4554752
    buffer_load_dwordx4 v60, s[20:23], s28 offen lds
    v_add_u32 v62, 32768, v61
    v_xor_b32 v63, 64, v62
    ds_read_b64_tr_b16 a[32:33], v62 offset:0
    ds_read_b64_tr_b16 a[34:35], v62 offset:1024
    ds_read_b64_tr_b16 a[36:37], v63 offset:0
    ds_read_b64_tr_b16 a[38:39], v63 offset:1024
    ds_read_b64_tr_b16 a[40:41], v62 offset:4096
    ds_read_b64_tr_b16 a[42:43], v62 offset:5120
    ds_read_b64_tr_b16 a[44:45], v63 offset:4096
    ds_read_b64_tr_b16 a[46:47], v63 offset:5120
    s_waitcnt lgkmcnt(0)
    s_waitcnt vmcnt(24)
    s_barrier
    s_lshl_b32 s24, s9, 12
    s_add_u32 m0, s24, 32768
    s_mov_b32 s28, 4718592
    buffer_load_dwordx4 v60, s[20:23], s28 offen lds
    s_lshl_b32 s24, s9, 12
    s_add_u32 m0, s24, 33792
    s_mov_b32 s28, 4751360
    buffer_load_dwordx4 v60, s[20:23], s28 offen lds
    s_lshl_b32 s24, s9, 12
    s_add_u32 m0, s24, 34816
    s_mov_b32 s28, 4784128
    buffer_load_dwordx4 v60, s[20:23], s28 offen lds
    s_lshl_b32 s24, s9, 12
    s_add_u32 m0, s24, 35840
    s_mov_b32 s28, 4816896
    buffer_load_dwordx4 v60, s[20:23], s28 offen lds
    v_add_u32 v62, 49152, v61
    v_xor_b32 v63, 64, v62
    ds_read_b64_tr_b16 a[48:49], v62 offset:0
    ds_read_b64_tr_b16 a[50:51], v62 offset:1024
    ds_read_b64_tr_b16 a[52:53], v63 offset:0
    ds_read_b64_tr_b16 a[54:55], v63 offset:1024
    ds_read_b64_tr_b16 a[56:57], v62 offset:4096
    ds_read_b64_tr_b16 a[58:59], v62 offset:5120
    ds_read_b64_tr_b16 a[60:61], v63 offset:4096
    ds_read_b64_tr_b16 a[62:63], v63 offset:5120
    s_waitcnt lgkmcnt(0)
    s_waitcnt vmcnt(24)
    s_barrier
    s_lshl_b32 s24, s9, 12
    s_add_u32 m0, s24, 49152
    s_mov_b32 s28, 4980736
    buffer_load_dwordx4 v60, s[20:23], s28 offen lds
    s_lshl_b32 s24, s9, 12
    s_add_u32 m0, s24, 50176
    s_mov_b32 s28, 5013504
    buffer_load_dwordx4 v60, s[20:23], s28 offen lds
    s_lshl_b32 s24, s9, 12
    s_add_u32 m0, s24, 51200
    s_mov_b32 s28, 5046272
    buffer_load_dwordx4 v60, s[20:23], s28 offen lds
    s_lshl_b32 s24, s9, 12
    s_add_u32 m0, s24, 52224
    s_mov_b32 s28, 5079040
    buffer_load_dwordx4 v60, s[20:23], s28 offen lds
    v_add_u32 v62, 65536, v61
    v_xor_b32 v63, 64, v62
    ds_read_b64_tr_b16 a[64:65], v62 offset:0
    ds_read_b64_tr_b16 a[66:67], v62 offset:1024
    ds_read_b64_tr_b16 a[68:69], v63 offset:0
    ds_read_b64_tr_b16 a[70:71], v63 offset:1024
    ds_read_b64_tr_b16 a[72:73], v62 offset:4096
    ds_read_b64_tr_b16 a[74:75], v62 offset:5120
    ds_read_b64_tr_b16 a[76:77], v63 offset:4096
    ds_read_b64_tr_b16 a[78:79], v63 offset:5120
    s_waitcnt lgkmcnt(0)
    s_waitcnt vmcnt(24)
    s_barrier
    v_add_u32 v62, 81920, v61
    v_xor_b32 v63, 64, v62
    ds_read_b64_tr_b16 a[80:81], v62 offset:0
    ds_read_b64_tr_b16 a[82:83], v62 offset:1024
    ds_read_b64_tr_b16 a[84:85], v63 offset:0
    ds_read_b64_tr_b16 a[86:87], v63 offset:1024
    ds_read_b64_tr_b16 a[88:89], v62 offset:4096
    ds_read_b64_tr_b16 a[90:91], v62 offset:5120
    ds_read_b64_tr_b16 a[92:93], v63 offset:4096
    ds_read_b64_tr_b16 a[94:95], v63 offset:5120
    s_waitcnt lgkmcnt(0)
    s_waitcnt vmcnt(20)
    s_barrier
    v_add_u32 v62, 98304, v61
    v_xor_b32 v63, 64, v62
    ds_read_b64_tr_b16 a[96:97], v62 offset:0
    ds_read_b64_tr_b16 a[98:99], v62 offset:1024
    ds_read_b64_tr_b16 a[100:101], v63 offset:0
    ds_read_b64_tr_b16 a[102:103], v63 offset:1024
    ds_read_b64_tr_b16 a[104:105], v62 offset:4096
    ds_read_b64_tr_b16 a[106:107], v62 offset:5120
    ds_read_b64_tr_b16 a[108:109], v63 offset:4096
    ds_read_b64_tr_b16 a[110:111], v63 offset:5120
    s_waitcnt lgkmcnt(0)
    s_waitcnt vmcnt(16)
    s_barrier
    v_add_u32 v62, 114688, v61
    v_xor_b32 v63, 64, v62
    ds_read_b64_tr_b16 a[112:113], v62 offset:0
    ds_read_b64_tr_b16 a[114:115], v62 offset:1024
    ds_read_b64_tr_b16 a[116:117], v63 offset:0
    ds_read_b64_tr_b16 a[118:119], v63 offset:1024
    ds_read_b64_tr_b16 a[120:121], v62 offset:4096
    ds_read_b64_tr_b16 a[122:123], v62 offset:5120
    ds_read_b64_tr_b16 a[124:125], v63 offset:4096
    ds_read_b64_tr_b16 a[126:127], v63 offset:5120
    s_waitcnt lgkmcnt(0)
    s_waitcnt vmcnt(12)
    s_barrier
    v_add_u32 v62, 0, v61
    v_xor_b32 v63, 64, v62
    ds_read_b64_tr_b16 a[128:129], v62 offset:0
    ds_read_b64_tr_b16 a[130:131], v62 offset:1024
    ds_read_b64_tr_b16 a[132:133], v63 offset:0
    ds_read_b64_tr_b16 a[134:135], v63 offset:1024
    ds_read_b64_tr_b16 a[136:137], v62 offset:4096
    ds_read_b64_tr_b16 a[138:139], v62 offset:5120
    ds_read_b64_tr_b16 a[140:141], v63 offset:4096
    ds_read_b64_tr_b16 a[142:143], v63 offset:5120
    s_waitcnt lgkmcnt(0)
    s_waitcnt vmcnt(8)
    s_barrier
    v_add_u32 v62, 16384, v61
    v_xor_b32 v63, 64, v62
    ds_read_b64_tr_b16 a[144:145], v62 offset:0
    ds_read_b64_tr_b16 a[146:147], v62 offset:1024
    ds_read_b64_tr_b16 a[148:149], v63 offset:0
    ds_read_b64_tr_b16 a[150:151], v63 offset:1024
    ds_read_b64_tr_b16 a[152:153], v62 offset:4096
    ds_read_b64_tr_b16 a[154:155], v62 offset:5120
    ds_read_b64_tr_b16 a[156:157], v63 offset:4096
    ds_read_b64_tr_b16 a[158:159], v63 offset:5120
    s_waitcnt lgkmcnt(0)
    s_waitcnt vmcnt(4)
    s_barrier
    v_add_u32 v62, 32768, v61
    v_xor_b32 v63, 64, v62
    ds_read_b64_tr_b16 a[160:161], v62 offset:0
    ds_read_b64_tr_b16 a[162:163], v62 offset:1024
    ds_read_b64_tr_b16 a[164:165], v63 offset:0
    ds_read_b64_tr_b16 a[166:167], v63 offset:1024
    ds_read_b64_tr_b16 a[168:169], v62 offset:4096
    ds_read_b64_tr_b16 a[170:171], v62 offset:5120
    ds_read_b64_tr_b16 a[172:173], v63 offset:4096
    ds_read_b64_tr_b16 a[174:175], v63 offset:5120
    s_waitcnt lgkmcnt(0)
    s_waitcnt vmcnt(0)
    s_barrier
    v_add_u32 v62, 49152, v61
    v_xor_b32 v63, 64, v62
    ds_read_b64_tr_b16 a[176:177], v62 offset:0
    ds_read_b64_tr_b16 a[178:179], v62 offset:1024
    ds_read_b64_tr_b16 a[180:181], v63 offset:0
    ds_read_b64_tr_b16 a[182:183], v63 offset:1024
    ds_read_b64_tr_b16 a[184:185], v62 offset:4096
    ds_read_b64_tr_b16 a[186:187], v62 offset:5120
    ds_read_b64_tr_b16 a[188:189], v63 offset:4096
    ds_read_b64_tr_b16 a[190:191], v63 offset:5120
    s_waitcnt lgkmcnt(0)
    s_barrier
    s_mov_b32 s20, s56
    s_mov_b32 s21, s57
    s_mov_b32 s22, 0x280000
    s_mov_b32 s23, 0x20000
    s_mul_i32 s38, s31, 40960
    s_mov_b32 s39, 0
    s_mul_i32 s24, s9, 10240
    s_add_u32 s24, s24, s39
    s_add_u32 m0, s24, 0
    s_nop 0
    buffer_load_dwordx4 v0, s[20:23], s38 offen lds
    s_add_u32 m0, s24, 1024
    s_nop 0
    buffer_load_dwordx4 v1, s[20:23], s38 offen lds
    s_add_u32 m0, s24, 2048
    s_nop 0
    buffer_load_dwordx4 v2, s[20:23], s38 offen lds
    s_add_u32 m0, s24, 3072
    s_nop 0
    buffer_load_dwordx4 v3, s[20:23], s38 offen lds
    s_add_u32 m0, s24, 4096
    s_nop 0
    buffer_load_dwordx4 v4, s[20:23], s38 offen lds
    s_add_u32 m0, s24, 5120
    s_nop 0
    buffer_load_dwordx4 v5, s[20:23], s38 offen lds
    s_add_u32 m0, s24, 6144
    s_nop 0
    buffer_load_dwordx4 v6, s[20:23], s38 offen lds
    s_add_u32 m0, s24, 7168
    s_nop 0
    buffer_load_dwordx4 v7, s[20:23], s38 offen lds
    s_add_u32 m0, s24, 8192
    s_nop 0
    buffer_load_dwordx4 v8, s[20:23], s38 offen lds
    s_add_u32 m0, s24, 9216
    s_nop 0
    buffer_load_dwordx4 v9, s[20:23], s38 offen lds
    s_add_u32 s38, s38, 163840
    s_add_u32 s39, s39, 40960
    s_cmp_eq_u32 s39, 122880
    s_cselect_b32 s39, 0, s39
    s_mul_i32 s24, s9, 10240
    s_add_u32 s24, s24, s39
    s_add_u32 m0, s24, 0
    s_nop 0
    buffer_load_dwordx4 v0, s[20:23], s38 offen lds
    s_add_u32 m0, s24, 1024
    s_nop 0
    buffer_load_dwordx4 v1, s[20:23], s38 offen lds
    s_add_u32 m0, s24, 2048
    s_nop 0
    buffer_load_dwordx4 v2, s[20:23], s38 offen lds
    s_add_u32 m0, s24, 3072
    s_nop 0
    buffer_load_dwordx4 v3, s[20:23], s38 offen lds
    s_add_u32 m0, s24, 4096
    s_nop 0
    buffer_load_dwordx4 v4, s[20:23], s38 offen lds
    s_add_u32 m0, s24, 5120
    s_nop 0
    buffer_load_dwordx4 v5, s[20:23], s38 offen lds
    s_add_u32 m0, s24, 6144
    s_nop 0
    buffer_load_dwordx4 v6, s[20:23], s38 offen lds
    s_add_u32 m0, s24, 7168
    s_nop 0
    buffer_load_dwordx4 v7, s[20:23], s38 offen lds
    s_add_u32 m0, s24, 8192
    s_nop 0
    buffer_load_dwordx4 v8, s[20:23], s38 offen lds
    s_add_u32 m0, s24, 9216
    s_nop 0
    buffer_load_dwordx4 v9, s[20:23], s38 offen lds
    s_add_u32 s38, s38, 163840
    s_add_u32 s39, s39, 40960
    s_cmp_eq_u32 s39, 122880
    s_cselect_b32 s39, 0, s39
    s_mov_b32 s40, 0
    s_mov_b32 s41, 0
    s_waitcnt vmcnt(10)
    s_cmp_eq_u32 s35, 1
    s_cbranch_scc1 L_p1v
    s_barrier
    v_add_u32 v18, s41, v10
    v_add_u32 v19, s41, v11
    v_add_u32 v20, s41, v12
    v_add_u32 v21, s41, v13
    v_add_u32 v22, s41, v14
    v_add_u32 v23, s41, v15
    v_add_u32 v24, s41, v16
    v_add_u32 v25, s41, v17
    ds_read_b128 v[28:31], v18 offset:0
    ds_read_b128 v[32:35], v19 offset:0
    ds_read_b128 v[36:39], v20 offset:0
    ds_read_b128 v[40:43], v21 offset:0
    s_waitcnt lgkmcnt(3)
    v_mfma_f32_32x32x16_bf16 v[64:79], v[128:131], v[28:31], 0
    v_mfma_f32_32x32x16_bf16 v[80:95], v[132:135], v[28:31], 0
    ds_read_b128 v[28:31], v22 offset:0
    s_waitcnt lgkmcnt(3)
    v_mfma_f32_32x32x16_bf16 v[64:79], v[136:139], v[32:35], v[64:79]
    s_mul_i32 s24, s9, 10240
    s_add_u32 s24, s24, s39
    v_mfma_f32_32x32x16_bf16 v[80:95], v[140:143], v[32:35], v[80:95]
    s_add_u32 m0, s24, 0
    s_nop 0
    ds_read_b128 v[32:35], v23 offset:0
    s_waitcnt lgkmcnt(3)
    v_mfma_f32_32x32x16_bf16 v[64:79], v[144:147], v[36:39], v[64:79]
    buffer_load_dwordx4 v0, s[20:23], s38 offen lds
    s_add_u32 m0, s24, 1024
    v_mfma_f32_32x32x16_bf16 v[80:95], v[148:151], v[36:39], v[80:95]
    s_nop 0
    buffer_load_dwordx4 v1, s[20:23], s38 offen lds
    ds_read_b128 v[36:39], v24 offset:0
    s_waitcnt lgkmcnt(3)
    v_mfma_f32_32x32x16_bf16 v[64:79], v[152:155], v[40:43], v[64:79]
    s_add_u32 m0, s24, 2048
    s_nop 0
    v_mfma_f32_32x32x16_bf16 v[80:95], v[156:159], v[40:43], v[80:95]
    buffer_load_dwordx4 v2, s[20:23], s38 offen lds
    s_add_u32 m0, s24, 3072
    ds_read_b128 v[40:43], v25 offset:0
    s_waitcnt lgkmcnt(3)
    v_mfma_f32_32x32x16_bf16 v[64:79], v[160:163], v[28:31], v[64:79]
    s_nop 0
    buffer_load_dwordx4 v3, s[20:23], s38 offen lds
    v_mfma_f32_32x32x16_bf16 v[80:95], v[164:167], v[28:31], v[80:95]
    s_add_u32 m0, s24, 4096
    s_nop 0
    ds_read_b128 v[28:31], v18 offset:256
    s_waitcnt lgkmcnt(3)
    v_mfma_f32_32x32x16_bf16 v[64:79], v[168:171], v[32:35], v[64:79]
    buffer_load_dwordx4 v4, s[20:23], s38 offen lds
    s_add_u32 m0, s24, 5120
    v_mfma_f32_32x32x16_bf16 v[80:95], v[172:175], v[32:35], v[80:95]
    s_nop 0
    buffer_load_dwordx4 v5, s[20:23], s38 offen lds
    ds_read_b128 v[32:35], v19 offset:256
    s_waitcnt lgkmcnt(3)
    v_mfma_f32_32x32x16_bf16 v[64:79], v[176:179], v[36:39], v[64:79]
    s_add_u32 m0, s24, 6144
    s_nop 0
    v_mfma_f32_32x32x16_bf16 v[80:95], v[180:183], v[36:39], v[80:95]
    buffer_load_dwordx4 v6, s[20:23], s38 offen lds
    s_add_u32 m0, s24, 7168
    ds_read_b128 v[36:39], v20 offset:256
    s_waitcnt lgkmcnt(3)
    v_mfma_f32_32x32x16_bf16 v[64:79], v[184:187], v[40:43], v[64:79]
    s_nop 0
    buffer_load_dwordx4 v7, s[20:23], s38 offen lds
    v_mfma_f32_32x32x16_bf16 v[80:95], v[188:191], v[40:43], v[80:95]
    s_add_u32 m0, s24, 8192
    s_nop 0
    ds_read_b128 v[40:43], v21 offset:256
    s_waitcnt lgkmcnt(3)
    v_mfma_f32_32x32x16_bf16 v[64:79], v[192:195], v[28:31], v[64:79]
    buffer_load_dwordx4 v8, s[20:23], s38 offen lds
    s_add_u32 m0, s24, 9216
    v_mfma_f32_32x32x16_bf16 v[80:95], v[196:199], v[28:31], v[80:95]
    s_nop 0
    buffer_load_dwordx4 v9, s[20:23], s38 offen lds
    ds_read_b128 v[28:31], v22 offset:256
    s_waitcnt lgkmcnt(3)
    v_mfma_f32_32x32x16_bf16 v[64:79], v[200:203], v[32:35], v[64:79]
    s_add_u32 s38, s38, 163840
    s_add_u32 s39, s39, 40960
    v_mfma_f32_32x32x16_bf16 v[80:95], v[204:207], v[32:35], v[80:95]
    s_cmp_eq_u32 s39, 122880
    s_cselect_b32 s39, 0, s39
    ds_read_b128 v[32:35], v23 offset:256
    s_waitcnt lgkmcnt(3)
    v_mfma_f32_32x32x16_bf16 v[64:79], v[208:211], v[36:39], v[64:79]
    v_mfma_f32_32x32x16_bf16 v[80:95], v[212:215], v[36:39], v[80:95]
    ds_read_b128 v[36:39], v24 offset:256
    s_waitcnt lgkmcnt(3)
    v_mfma_f32_32x32x16_bf16 v[64:79], v[216:219], v[40:43], v[64:79]
    v_mfma_f32_32x32x16_bf16 v[80:95], v[220:223], v[40:43], v[80:95]
    ds_read_b128 v[40:43], v25 offset:256
    s_waitcnt lgkmcnt(3)
    v_mfma_f32_32x32x16_bf16 v[64:79], v[224:227], v[28:31], v[64:79]
    v_mfma_f32_32x32x16_bf16 v[80:95], v[228:231], v[28:31], v[80:95]
    ds_read_b128 v[28:31], v18 offset:512
    s_waitcnt lgkmcnt(3)
    v_mfma_f32_32x32x16_bf16 v[64:79], v[232:235], v[32:35], v[64:79]
    v_mfma_f32_32x32x16_bf16 v[80:95], v[236:239], v[32:35], v[80:95]
    ds_read_b128 v[32:35], v19 offset:512
    s_waitcnt lgkmcnt(3)
    v_mfma_f32_32x32x16_bf16 v[64:79], v[240:243], v[36:39], v[64:79]
    v_mfma_f32_32x32x16_bf16 v[80:95], v[244:247], v[36:39], v[80:95]
    ds_read_b128 v[36:39], v20 offset:512
    s_waitcnt lgkmcnt(3)
    v_mfma_f32_32x32x16_bf16 v[64:79], v[248:251], v[40:43], v[64:79]
    v_mfma_f32_32x32x16_bf16 v[80:95], v[252:255], v[40:43], v[80:95]
    ds_read_b128 v[40:43], v21 offset:512
    s_waitcnt lgkmcnt(3)
    v_mfma_f32_32x32x16_bf16 v[64:79], a[0:3], v[28:31], v[64:79]
    v_mfma_f32_32x32x16_bf16 v[80:95], a[4:7], v[28:31], v[80:95]
    ds_read_b128 v[28:31], v22 offset:512
    s_waitcnt lgkmcnt(3)
    v_mfma_f32_32x32x16_bf16 v[64:79], a[8:11], v[32:35], v[64:79]
    v_mfma_f32_32x32x16_bf16 v[80:95], a[12:15], v[32:35], v[80:95]
    ds_read_b128 v[32:35], v23 offset:512
    s_waitcnt lgkmcnt(3)
    v_mfma_f32_32x32x16_bf16 v[64:79], a[16:19], v[36:39], v[64:79]
    v_mfma_f32_32x32x16_bf16 v[80:95], a[20:23], v[36:39], v[80:95]
    ds_read_b128 v[36:39], v24 offset:512
    s_waitcnt lgkmcnt(3)
    v_mfma_f32_32x32x16_bf16 v[64:79], a[24:27], v[40:43], v[64:79]
    v_mfma_f32_32x32x16_bf16 v[80:95], a[28:31], v[40:43], v[80:95]
    ds_read_b128 v[40:43], v25 offset:512
    s_waitcnt lgkmcnt(3)
    v_mfma_f32_32x32x16_bf16 v[64:79], a[32:35], v[28:31], v[64:79]
    v_mfma_f32_32x32x16_bf16 v[80:95], a[36:39], v[28:31], v[80:95]
    ds_read_b128 v[28:31], v18 offset:768
    s_waitcnt lgkmcnt(3)
    v_mfma_f32_32x32x16_bf16 v[64:79], a[40:43], v[32:35], v[64:79]
    v_mfma_f32_32x32x16_bf16 v[80:95], a[44:47], v[32:35], v[80:95]
    ds_read_b128 v[32:35], v19 offset:768
    s_waitcnt lgkmcnt(3)
    v_mfma_f32_32x32x16_bf16 v[64:79], a[48:51], v[36:39], v[64:79]
    v_mfma_f32_32x32x16_bf16 v[80:95], a[52:55], v[36:39], v[80:95]
    ds_read_b128 v[36:39], v20 offset:768
    s_waitcnt lgkmcnt(3)
    v_mfma_f32_32x32x16_bf16 v[64:79], a[56:59], v[40:43], v[64:79]
    v_mfma_f32_32x32x16_bf16 v[80:95], a[60:63], v[40:43], v[80:95]
    ds_read_b128 v[40:43], v21 offset:768
    s_waitcnt lgkmcnt(3)
    v_mfma_f32_32x32x16_bf16 v[64:79], a[64:67], v[28:31], v[64:79]
    v_mfma_f32_32x32x16_bf16 v[80:95], a[68:71], v[28:31], v[80:95]
    ds_read_b128 v[28:31], v22 offset:768
    s_waitcnt lgkmcnt(3)
    v_mfma_f32_32x32x16_bf16 v[64:79], a[72:75], v[32:35], v[64:79]
    v_mfma_f32_32x32x16_bf16 v[80:95], a[76:79], v[32:35], v[80:95]
    ds_read_b128 v[32:35], v23 offset:768
    s_waitcnt lgkmcnt(3)
    v_mfma_f32_32x32x16_bf16 v[64:79], a[80:83], v[36:39], v[64:79]
    v_mfma_f32_32x32x16_bf16 v[80:95], a[84:87], v[36:39], v[80:95]
    ds_read_b128 v[36:39], v24 offset:768
    s_waitcnt lgkmcnt(3)
    v_mfma_f32_32x32x16_bf16 v[64:79], a[88:91], v[40:43], v[64:79]
    v_mfma_f32_32x32x16_bf16 v[80:95], a[92:95], v[40:43], v[80:95]
    ds_read_b128 v[40:43], v25 offset:768
    s_waitcnt lgkmcnt(3)
    v_mfma_f32_32x32x16_bf16 v[64:79], a[96:99], v[28:31], v[64:79]
    v_mfma_f32_32x32x16_bf16 v[80:95], a[100:103], v[28:31], v[80:95]
    ds_read_b128 v[28:31], v18 offset:1024
    s_waitcnt lgkmcnt(3)
    v_mfma_f32_32x32x16_bf16 v[64:79], a[104:107], v[32:35], v[64:79]
    v_mfma_f32_32x32x16_bf16 v[80:95], a[108:111], v[32:35], v[80:95]
    ds_read_b128 v[32:35], v19 offset:1024
    s_waitcnt lgkmcnt(3)
    v_mfma_f32_32x32x16_bf16 v[64:79], a[112:115], v[36:39], v[64:79]
    v_mfma_f32_32x32x16_bf16 v[80:95], a[116:119], v[36:39], v[80:95]
    ds_read_b128 v[36:39], v20 offset:1024
    s_waitcnt lgkmcnt(3)
    v_mfma_f32_32x32x16_bf16 v[64:79], a[120:123], v[40:43], v[64:79]
    v_mfma_f32_32x32x16_bf16 v[80:95], a[124:127], v[40:43], v[80:95]
    ds_read_b128 v[40:43], v21 offset:1024
    s_waitcnt lgkmcnt(3)
    v_mfma_f32_32x32x16_bf16 v[64:79], a[128:131], v[28:31], v[64:79]
    v_mfma_f32_32x32x16_bf16 v[80:95], a[132:135], v[28:31], v[80:95]
    ds_read_b128 v[28:31], v22 offset:1024
    s_waitcnt lgkmcnt(3)
    v_mfma_f32_32x32x16_bf16 v[64:79], a[136:139], v[32:35], v[64:79]
    v_mfma_f32_32x32x16_bf16 v[80:95], a[140:143], v[32:35], v[80:95]
    ds_read_b128 v[32:35], v23 offset:1024
    s_waitcnt lgkmcnt(3)
    v_mfma_f32_32x32x16_bf16 v[64:79], a[144:147], v[36:39], v[64:79]
    v_mfma_f32_32x32x16_bf16 v[80:95], a[148:151], v[36:39], v[80:95]
    ds_read_b128 v[36:39], v24 offset:1024
    s_waitcnt lgkmcnt(3)
    v_mfma_f32_32x32x16_bf16 v[64:79], a[152:155], v[40:43], v[64:79]
    v_mfma_f32_32x32x16_bf16 v[80:95], a[156:159], v[40:43], v[80:95]
    ds_read_b128 v[40:43], v25 offset:1024
    s_waitcnt lgkmcnt(3)
    v_mfma_f32_32x32x16_bf16 v[64:79], a[160:163], v[28:31], v[64:79]
    v_mfma_f32_32x32x16_bf16 v[80:95], a[164:167], v[28:31], v[80:95]
    s_waitcnt vmcnt(10)
    v_mov_b32 v60, s40
    s_mov_b64 exec, 1
    buffer_store_dword v60, v27, s[16:19], s37 offen sc1
    s_mov_b64 exec, -1
    s_waitcnt lgkmcnt(2)
    v_mfma_f32_32x32x16_bf16 v[64:79], a[168:171], v[32:35], v[64:79]
    v_mfma_f32_32x32x16_bf16 v[80:95], a[172:175], v[32:35], v[80:95]
    s_waitcnt lgkmcnt(1)
    v_mfma_f32_32x32x16_bf16 v[64:79], a[176:179], v[36:39], v[64:79]
    v_mfma_f32_32x32x16_bf16 v[80:95], a[180:183], v[36:39], v[80:95]
    s_waitcnt lgkmcnt(0)
    v_mfma_f32_32x32x16_bf16 v[64:79], a[184:187], v[40:43], v[64:79]
    v_mfma_f32_32x32x16_bf16 v[80:95], a[188:191], v[40:43], v[80:95]
    s_add_u32 s36, s36, 0x100000
    s_add_u32 s41, s41, 40960
    s_cmp_eq_u32 s41, 122880
    s_cselect_b32 s41, 0, s41
    s_add_u32 s40, s40, 1
L_p1loop0:
    s_barrier
    v_add_u32 v18, s41, v10
    v_add_u32 v19, s41, v11
    v_add_u32 v20, s41, v12
    v_add_u32 v21, s41, v13
    v_add_u32 v22, s41, v14
    v_add_u32 v23, s41, v15
    v_add_u32 v24, s41, v16
    v_add_u32 v25, s41, v17
    ds_read_b128 v[28:31], v18 offset:0
    ds_read_b128 v[32:35], v19 offset:0
    ds_read_b128 v[36:39], v20 offset:0
    ds_read_b128 v[40:43], v21 offset:0
    s_waitcnt lgkmcnt(3)
    v_mfma_f32_32x32x16_bf16 v[96:111], v[128:131], v[28:31], 0
    v_mfma_f32_32x32x16_bf16 v[112:127], v[132:135], v[28:31], 0
    ds_read_b128 v[28:31], v22 offset:0
    s_waitcnt lgkmcnt(3)
    v_mfma_f32_32x32x16_bf16 v[96:111], v[136:139], v[32:35], v[96:111]
    s_sub_u32 s42, s36, 0x100000
    v_cvt_pk_bf16_f32 v44, v64, v72
    v_mfma_f32_32x32x16_bf16 v[112:127], v[140:143], v[32:35], v[112:127]
    v_cvt_pk_bf16_f32 v45, v65, v73
    v_cvt_pk_bf16_f32 v46, v66, v74
    ds_read_b128 v[32:35], v23 offset:0
    s_waitcnt lgkmcnt(3)
    v_mfma_f32_32x32x16_bf16 v[96:111], v[144:147], v[36:39], v[96:111]
    v_cvt_pk_bf16_f32 v47, v67, v75
    buffer_store_dwordx4 v[44:47], v26, s[16:19], s42 offen offset:0 sc1
    v_mfma_f32_32x32x16_bf16 v[112:127], v[148:151], v[36:39], v[112:127]
    v_cvt_pk_bf16_f32 v48, v68, v76
    v_cvt_pk_bf16_f32 v49, v69, v77
    ds_read_b128 v[36:39], v24 offset:0
    s_waitcnt lgkmcnt(3)
    v_mfma_f32_32x32x16_bf16 v[96:111], v[152:155], v[40:43], v[96:111]
    v_cvt_pk_bf16_f32 v50, v70, v78
    v_cvt_pk_bf16_f32 v51, v71, v79
    v_mfma_f32_32x32x16_bf16 v[112:127], v[156:159], v[40:43], v[112:127]
    buffer_store_dwordx4 v[48:51], v26, s[16:19], s42 offen offset:512 sc1
    v_cvt_pk_bf16_f32 v52, v80, v88
    ds_read_b128 v[40:43], v25 offset:0
    s_waitcnt lgkmcnt(3)
    v_mfma_f32_32x32x16_bf16 v[96:111], v[160:163], v[28:31], v[96:111]
    v_cvt_pk_bf16_f32 v53, v81, v89
    v_cvt_pk_bf16_f32 v54, v82, v90
    v_mfma_f32_32x32x16_bf16 v[112:127], v[164:167], v[28:31], v[112:127]
    v_cvt_pk_bf16_f32 v55, v83, v91
    buffer_store_dwordx4 v[52:55], v26, s[16:19], s42 offen offset:1024 sc1
    ds_read_b128 v[28:31], v18 offset:256
    s_waitcnt lgkmcnt(3)
    v_mfma_f32_32x32x16_bf16 v[96:111], v[168:171], v[32:35], v[96:111]
    v_cvt_pk_bf16_f32 v56, v84, v92
    v_cvt_pk_bf16_f32 v57, v85, v93
    v_mfma_f32_32x32x16_bf16 v[112:127], v[172:175], v[32:35], v[112:127]
    v_cvt_pk_bf16_f32 v58, v86, v94
    v_cvt_pk_bf16_f32 v59, v87, v95
    ds_read_b128 v[32:35], v19 offset:256
    s_waitcnt lgkmcnt(3)
    v_mfma_f32_32x32x16_bf16 v[96:111], v[176:179], v[36:39], v[96:111]
    buffer_store_dwordx4 v[56:59], v26, s[16:19], s42 offen offset:1536 sc1
    s_mul_i32 s24, s9, 10240
    v_mfma_f32_32x32x16_bf16 v[112:127], v[180:183], v[36:39], v[112:127]
    s_add_u32 s24, s24, s39
    s_add_u32 m0, s24, 0
    ds_read_b128 v[36:39], v20 offset:256
    s_waitcnt lgkmcnt(3)
    v_mfma_f32_32x32x16_bf16 v[96:111], v[184:187], v[40:43], v[96:111]
    s_nop 0
    buffer_load_dwordx4 v0, s[20:23], s38 offen lds
    v_mfma_f32_32x32x16_bf16 v[112:127], v[188:191], v[40:43], v[112:127]
    s_add_u32 m0, s24, 1024
    s_nop 0
    ds_read_b128 v[40:43], v21 offset:256
    s_waitcnt lgkmcnt(3)
    v_mfma_f32_32x32x16_bf16 v[96:111], v[192:195], v[28:31], v[96:111]
    buffer_load_dwordx4 v1, s[20:23], s38 offen lds
    s_add_u32 m0, s24, 2048
    v_mfma_f32_32x32x16_bf16 v[112:127], v[196:199], v[28:31], v[112:127]
    s_nop 0
    buffer_load_dwordx4 v2, s[20:23], s38 offen lds
    ds_read_b128 v[28:31], v22 offset:256
    s_waitcnt lgkmcnt(3)
    v_mfma_f32_32x32x16_bf16 v[96:111], v[200:203], v[32:35], v[96:111]
    s_add_u32 m0, s24, 3072
    s_nop 0
    v_mfma_f32_32x32x16_bf16 v[112:127], v[204:207], v[32:35], v[112:127]
    buffer_load_dwordx4 v3, s[20:23], s38 offen lds
    s_add_u32 m0, s24, 4096
    ds_read_b128 v[32:35], v23 offset:256
    s_waitcnt lgkmcnt(3)
    v_mfma_f32_32x32x16_bf16 v[96:111], v[208:211], v[36:39], v[96:111]
    s_nop 0
    buffer_load_dwordx4 v4, s[20:23], s38 offen lds
    v_mfma_f32_32x32x16_bf16 v[112:127], v[212:215], v[36:39], v[112:127]
    s_add_u32 m0, s24, 5120
    s_nop 0
    ds_read_b128 v[36:39], v24 offset:256
    s_waitcnt lgkmcnt(3)
    v_mfma_f32_32x32x16_bf16 v[96:111], v[216:219], v[40:43], v[96:111]
    buffer_load_dwordx4 v5, s[20:23], s38 offen lds
    s_add_u32 m0, s24, 6144
    v_mfma_f32_32x32x16_bf16 v[112:127], v[220:223], v[40:43], v[112:127]
    s_nop 0
    buffer_load_dwordx4 v6, s[20:23], s38 offen lds
    ds_read_b128 v[40:43], v25 offset:256
    s_waitcnt lgkmcnt(3)
    v_mfma_f32_32x32x16_bf16 v[96:111], v[224:227], v[28:31], v[96:111]
    s_add_u32 m0, s24, 7168
    s_nop 0
    v_mfma_f32_32x32x16_bf16 v[112:127], v[228:231], v[28:31], v[112:127]
    buffer_load_dwordx4 v7, s[20:23], s38 offen lds
    s_add_u32 m0, s24, 8192
    ds_read_b128 v[28:31], v18 offset:512
    s_waitcnt lgkmcnt(3)
    v_mfma_f32_32x32x16_bf16 v[96:111], v[232:235], v[32:35], v[96:111]
    s_nop 0
    buffer_load_dwordx4 v8, s[20:23], s38 offen lds
    v_mfma_f32_32x32x16_bf16 v[112:127], v[236:239], v[32:35], v[112:127]
    s_add_u32 m0, s24, 9216
    s_nop 0
    ds_read_b128 v[32:35], v19 offset:512
    s_waitcnt lgkmcnt(3)
    v_mfma_f32_32x32x16_bf16 v[96:111], v[240:243], v[36:39], v[96:111]
    buffer_load_dwordx4 v9, s[20:23], s38 offen lds
    s_add_u32 s38, s38, 163840
    v_mfma_f32_32x32x16_bf16 v[112:127], v[244:247], v[36:39], v[112:127]
    s_add_u32 s39, s39, 40960
    s_cmp_eq_u32 s39, 122880
    ds_read_b128 v[36:39], v20 offset:512
    s_waitcnt lgkmcnt(3)
    v_mfma_f32_32x32x16_bf16 v[96:111], v[248:251], v[40:43], v[96:111]
    s_cselect_b32 s39, 0, s39
    v_mfma_f32_32x32x16_bf16 v[112:127], v[252:255], v[40:43], v[112:127]
    ds_read_b128 v[40:43], v21 offset:512
    s_waitcnt lgkmcnt(3)
    v_mfma_f32_32x32x16_bf16 v[96:111], a[0:3], v[28:31], v[96:111]
    v_mfma_f32_32x32x16_bf16 v[112:127], a[4:7], v[28:31], v[112:127]
    ds_read_b128 v[28:31], v22 offset:512
    s_waitcnt lgkmcnt(3)
    v_mfma_f32_32x32x16_bf16 v[96:111], a[8:11], v[32:35], v[96:111]
    v_mfma_f32_32x32x16_bf16 v[112:127], a[12:15], v[32:35], v[112:127]
    ds_read_b128 v[32:35], v23 offset:512
    s_waitcnt lgkmcnt(3)
    v_mfma_f32_32x32x16_bf16 v[96:111], a[16:19], v[36:39], v[96:111]
    v_mfma_f32_32x32x16_bf16 v[112:127], a[20:23], v[36:39], v[112:127]
    ds_read_b128 v[36:39], v24 offset:512
    s_waitcnt lgkmcnt(3)
    v_mfma_f32_32x32x16_bf16 v[96:111], a[24:27], v[40:43], v[96:111]
    v_mfma_f32_32x32x16_bf16 v[112:127], a[28:31], v[40:43], v[112:127]
    ds_read_b128 v[40:43], v25 offset:512
    s_waitcnt lgkmcnt(3)
    v_mfma_f32_32x32x16_bf16 v[96:111], a[32:35], v[28:31], v[96:111]
    v_mfma_f32_32x32x16_bf16 v[112:127], a[36:39], v[28:31], v[112:127]
    ds_read_b128 v[28:31], v18 offset:768
    s_waitcnt lgkmcnt(3)
    v_mfma_f32_32x32x16_bf16 v[96:111], a[40:43], v[32:35], v[96:111]
    v_mfma_f32_32x32x16_bf16 v[112:127], a[44:47], v[32:35], v[112:127]
    ds_read_b128 v[32:35], v19 offset:768
    s_waitcnt lgkmcnt(3)
    v_mfma_f32_32x32x16_bf16 v[96:111], a[48:51], v[36:39], v[96:111]
    v_mfma_f32_32x32x16_bf16 v[112:127], a[52:55], v[36:39], v[112:127]
    ds_read_b128 v[36:39], v20 offset:768
    s_waitcnt lgkmcnt(3)
    v_mfma_f32_32x32x16_bf16 v[96:111], a[56:59], v[40:43], v[96:111]
    v_mfma_f32_32x32x16_bf16 v[112:127], a[60:63], v[40:43], v[112:127]
    ds_read_b128 v[40:43], v21 offset:768
    s_waitcnt lgkmcnt(3)
    v_mfma_f32_32x32x16_bf16 v[96:111], a[64:67], v[28:31], v[96:111]
    v_mfma_f32_32x32x16_bf16 v[112:127], a[68:71], v[28:31], v[112:127]
    ds_read_b128 v[28:31], v22 offset:768
    s_waitcnt lgkmcnt(3)
    v_mfma_f32_32x32x16_bf16 v[96:111], a[72:75], v[32:35], v[96:111]
    v_mfma_f32_32x32x16_bf16 v[112:127], a[76:79], v[32:35], v[112:127]
    ds_read_b128 v[32:35], v23 offset:768
    s_waitcnt lgkmcnt(3)
    v_mfma_f32_32x32x16_bf16 v[96:111], a[80:83], v[36:39], v[96:111]
    v_mfma_f32_32x32x16_bf16 v[112:127], a[84:87], v[36:39], v[112:127]
    ds_read_b128 v[36:39], v24 offset:768
    s_waitcnt lgkmcnt(3)
    v_mfma_f32_32x32x16_bf16 v[96:111], a[88:91], v[40:43], v[96:111]
    v_mfma_f32_32x32x16_bf16 v[112:127], a[92:95], v[40:43], v[112:127]
    ds_read_b128 v[40:43], v25 offset:768
    s_waitcnt lgkmcnt(3)
    v_mfma_f32_32x32x16_bf16 v[96:111], a[96:99], v[28:31], v[96:111]
    v_mfma_f32_32x32x16_bf16 v[112:127], a[100:103], v[28:31], v[112:127]
    ds_read_b128 v[28:31], v18 offset:1024
    s_waitcnt lgkmcnt(3)
    v_mfma_f32_32x32x16_bf16 v[96:111], a[104:107], v[32:35], v[96:111]
    v_mfma_f32_32x32x16_bf16 v[112:127], a[108:111], v[32:35], v[112:127]
    ds_read_b128 v[32:35], v19 offset:1024
    s_waitcnt lgkmcnt(3)
    v_mfma_f32_32x32x16_bf16 v[96:111], a[112:115], v[36:39], v[96:111]
    v_mfma_f32_32x32x16_bf16 v[112:127], a[116:119], v[36:39], v[112:127]
    ds_read_b128 v[36:39], v20 offset:1024
    s_waitcnt lgkmcnt(3)
    v_mfma_f32_32x32x16_bf16 v[96:111], a[120:123], v[40:43], v[96:111]
    v_mfma_f32_32x32x16_bf16 v[112:127], a[124:127], v[40:43], v[112:127]
    ds_read_b128 v[40:43], v21 offset:1024
    s_waitcnt lgkmcnt(3)
    v_mfma_f32_32x32x16_bf16 v[96:111], a[128:131], v[28:31], v[96:111]
    v_mfma_f32_32x32x16_bf16 v[112:127], a[132:135], v[28:31], v[112:127]
    ds_read_b128 v[28:31], v22 offset:1024
    s_waitcnt lgkmcnt(3)
    v_mfma_f32_32x32x16_bf16 v[96:111], a[136:139], v[32:35], v[96:111]
    v_mfma_f32_32x32x16_bf16 v[112:127], a[140:143], v[32:35], v[112:127]
    ds_read_b128 v[32:35], v23 offset:1024
    s_waitcnt lgkmcnt(3)
    v_mfma_f32_32x32x16_bf16 v[96:111], a[144:147], v[36:39], v[96:111]
    v_mfma_f32_32x32x16_bf16 v[112:127], a[148:151], v[36:39], v[112:127]
    ds_read_b128 v[36:39], v24 offset:1024
    s_waitcnt lgkmcnt(3)
    v_mfma_f32_32x32x16_bf16 v[96:111], a[152:155], v[40:43], v[96:111]
    v_mfma_f32_32x32x16_bf16 v[112:127], a[156:159], v[40:43], v[112:127]
    ds_read_b128 v[40:43], v25 offset:1024
    s_waitcnt lgkmcnt(3)
    v_mfma_f32_32x32x16_bf16 v[96:111], a[160:163], v[28:31], v[96:111]
    v_mfma_f32_32x32x16_bf16 v[112:127], a[164:167], v[28:31], v[112:127]
    s_waitcnt vmcnt(10)
    v_mov_b32 v60, s40
    s_mov_b64 exec, 1
    buffer_store_dword v60, v27, s[16:19], s37 offen sc1
    s_mov_b64 exec, -1
    s_waitcnt lgkmcnt(2)
    v_mfma_f32_32x32x16_bf16 v[96:111], a[168:171], v[32:35], v[96:111]
    v_mfma_f32_32x32x16_bf16 v[112:127], a[172:175], v[32:35], v[112:127]
    s_waitcnt lgkmcnt(1)
    v_mfma_f32_32x32x16_bf16 v[96:111], a[176:179], v[36:39], v[96:111]
    v_mfma_f32_32x32x16_bf16 v[112:127], a[180:183], v[36:39], v[112:127]
    s_waitcnt lgkmcnt(0)
    v_mfma_f32_32x32x16_bf16 v[96:111], a[184:187], v[40:43], v[96:111]
    v_mfma_f32_32x32x16_bf16 v[112:127], a[188:191], v[40:43], v[112:127]
    s_add_u32 s36, s36, 0x100000
    s_add_u32 s41, s41, 40960
    s_cmp_eq_u32 s41, 122880
    s_cselect_b32 s41, 0, s41
    s_add_u32 s40, s40, 1
    s_cmp_eq_u32 s40, 16
    s_cbranch_scc1 L_p1end0
    s_barrier
    v_add_u32 v18, s41, v10
    v_add_u32 v19, s41, v11
    v_add_u32 v20, s41, v12
    v_add_u32 v21, s41, v13
    v_add_u32 v22, s41, v14
    v_add_u32 v23, s41, v15
    v_add_u32 v24, s41, v16
    v_add_u32 v25, s41, v17
    ds_read_b128 v[28:31], v18 offset:0
    ds_read_b128 v[32:35], v19 offset:0
    ds_read_b128 v[36:39], v20 offset:0
    ds_read_b128 v[40:43], v21 offset:0
    s_waitcnt lgkmcnt(3)
    v_mfma_f32_32x32x16_bf16 v[64:79], v[128:131], v[28:31], 0
    v_mfma_f32_32x32x16_bf16 v[80:95], v[132:135], v[28:31], 0
    ds_read_b128 v[28:31], v22 offset:0
    s_waitcnt lgkmcnt(3)
    v_mfma_f32_32x32x16_bf16 v[64:79], v[136:139], v[32:35], v[64:79]
    s_sub_u32 s42, s36, 0x100000
    v_cvt_pk_bf16_f32 v44, v96, v104
    v_mfma_f32_32x32x16_bf16 v[80:95], v[140:143], v[32:35], v[80:95]
    v_cvt_pk_bf16_f32 v45, v97, v105
    v_cvt_pk_bf16_f32 v46, v98, v106
    ds_read_b128 v[32:35], v23 offset:0
    s_waitcnt lgkmcnt(3)
    v_mfma_f32_32x32x16_bf16 v[64:79], v[144:147], v[36:39], v[64:79]
    v_cvt_pk_bf16_f32 v47, v99, v107
    buffer_store_dwordx4 v[44:47], v26, s[16:19], s42 offen offset:0 sc1
    v_mfma_f32_32x32x16_bf16 v[80:95], v[148:151], v[36:39], v[80:95]
    v_cvt_pk_bf16_f32 v48, v100, v108
    v_cvt_pk_bf16_f32 v49, v101, v109
    ds_read_b128 v[36:39], v24 offset:0
    s_waitcnt lgkmcnt(3)
    v_mfma_f32_32x32x16_bf16 v[64:79], v[152:155], v[40:43], v[64:79]
    v_cvt_pk_bf16_f32 v50, v102, v110
    v_cvt_pk_bf16_f32 v51, v103, v111
    v_mfma_f32_32x32x16_bf16 v[80:95], v[156:159], v[40:43], v[80:95]
    buffer_store_dwordx4 v[48:51], v26, s[16:19], s42 offen offset:512 sc1
    v_cvt_pk_bf16_f32 v52, v112, v120
    ds_read_b128 v[40:43], v25 offset:0
    s_waitcnt lgkmcnt(3)
    v_mfma_f32_32x32x16_bf16 v[64:79], v[160:163], v[28:31], v[64:79]
    v_cvt_pk_bf16_f32 v53, v113, v121
    v_cvt_pk_bf16_f32 v54, v114, v122
    v_mfma_f32_32x32x16_bf16 v[80:95], v[164:167], v[28:31], v[80:95]
    v_cvt_pk_bf16_f32 v55, v115, v123
    buffer_store_dwordx4 v[52:55], v26, s[16:19], s42 offen offset:1024 sc1
    ds_read_b128 v[28:31], v18 offset:256
    s_waitcnt lgkmcnt(3)
    v_mfma_f32_32x32x16_bf16 v[64:79], v[168:171], v[32:35], v[64:79]
    v_cvt_pk_bf16_f32 v56, v116, v124
    v_cvt_pk_bf16_f32 v57, v117, v125
    v_mfma_f32_32x32x16_bf16 v[80:95], v[172:175], v[32:35], v[80:95]
    v_cvt_pk_bf16_f32 v58, v118, v126
    v_cvt_pk_bf16_f32 v59, v119, v127
    ds_read_b128 v[32:35], v19 offset:256
    s_waitcnt lgkmcnt(3)
    v_mfma_f32_32x32x16_bf16 v[64:79], v[176:179], v[36:39], v[64:79]
    buffer_store_dwordx4 v[56:59], v26, s[16:19], s42 offen offset:1536 sc1
    s_mul_i32 s24, s9, 10240
    v_mfma_f32_32x32x16_bf16 v[80:95], v[180:183], v[36:39], v[80:95]
    s_add_u32 s24, s24, s39
    s_add_u32 m0, s24, 0
    ds_read_b128 v[36:39], v20 offset:256
    s_waitcnt lgkmcnt(3)
    v_mfma_f32_32x32x16_bf16 v[64:79], v[184:187], v[40:43], v[64:79]
    s_nop 0
    buffer_load_dwordx4 v0, s[20:23], s38 offen lds
    v_mfma_f32_32x32x16_bf16 v[80:95], v[188:191], v[40:43], v[80:95]
    s_add_u32 m0, s24, 1024
    s_nop 0
    ds_read_b128 v[40:43], v21 offset:256
    s_waitcnt lgkmcnt(3)
    v_mfma_f32_32x32x16_bf16 v[64:79], v[192:195], v[28:31], v[64:79]
    buffer_load_dwordx4 v1, s[20:23], s38 offen lds
    s_add_u32 m0, s24, 2048
    v_mfma_f32_32x32x16_bf16 v[80:95], v[196:199], v[28:31], v[80:95]
    s_nop 0
    buffer_load_dwordx4 v2, s[20:23], s38 offen lds
    ds_read_b128 v[28:31], v22 offset:256
    s_waitcnt lgkmcnt(3)
    v_mfma_f32_32x32x16_bf16 v[64:79], v[200:203], v[32:35], v[64:79]
    s_add_u32 m0, s24, 3072
    s_nop 0
    v_mfma_f32_32x32x16_bf16 v[80:95], v[204:207], v[32:35], v[80:95]
    buffer_load_dwordx4 v3, s[20:23], s38 offen lds
    s_add_u32 m0, s24, 4096
    ds_read_b128 v[32:35], v23 offset:256
    s_waitcnt lgkmcnt(3)
    v_mfma_f32_32x32x16_bf16 v[64:79], v[208:211], v[36:39], v[64:79]
    s_nop 0
    buffer_load_dwordx4 v4, s[20:23], s38 offen lds
    v_mfma_f32_32x32x16_bf16 v[80:95], v[212:215], v[36:39], v[80:95]
    s_add_u32 m0, s24, 5120
    s_nop 0
    ds_read_b128 v[36:39], v24 offset:256
    s_waitcnt lgkmcnt(3)
    v_mfma_f32_32x32x16_bf16 v[64:79], v[216:219], v[40:43], v[64:79]
    buffer_load_dwordx4 v5, s[20:23], s38 offen lds
    s_add_u32 m0, s24, 6144
    v_mfma_f32_32x32x16_bf16 v[80:95], v[220:223], v[40:43], v[80:95]
    s_nop 0
    buffer_load_dwordx4 v6, s[20:23], s38 offen lds
    ds_read_b128 v[40:43], v25 offset:256
    s_waitcnt lgkmcnt(3)
    v_mfma_f32_32x32x16_bf16 v[64:79], v[224:227], v[28:31], v[64:79]
    s_add_u32 m0, s24, 7168
    s_nop 0
    v_mfma_f32_32x32x16_bf16 v[80:95], v[228:231], v[28:31], v[80:95]
    buffer_load_dwordx4 v7, s[20:23], s38 offen lds
    s_add_u32 m0, s24, 8192
    ds_read_b128 v[28:31], v18 offset:512
    s_waitcnt lgkmcnt(3)
    v_mfma_f32_32x32x16_bf16 v[64:79], v[232:235], v[32:35], v[64:79]
    s_nop 0
    buffer_load_dwordx4 v8, s[20:23], s38 offen lds
    v_mfma_f32_32x32x16_bf16 v[80:95], v[236:239], v[32:35], v[80:95]
    s_add_u32 m0, s24, 9216
    s_nop 0
    ds_read_b128 v[32:35], v19 offset:512
    s_waitcnt lgkmcnt(3)
    v_mfma_f32_32x32x16_bf16 v[64:79], v[240:243], v[36:39], v[64:79]
    buffer_load_dwordx4 v9, s[20:23], s38 offen lds
    s_add_u32 s38, s38, 163840
    v_mfma_f32_32x32x16_bf16 v[80:95], v[244:247], v[36:39], v[80:95]
    s_add_u32 s39, s39, 40960
    s_cmp_eq_u32 s39, 122880
    ds_read_b128 v[36:39], v20 offset:512
    s_waitcnt lgkmcnt(3)
    v_mfma_f32_32x32x16_bf16 v[64:79], v[248:251], v[40:43], v[64:79]
    s_cselect_b32 s39, 0, s39
    v_mfma_f32_32x32x16_bf16 v[80:95], v[252:255], v[40:43], v[80:95]
    ds_read_b128 v[40:43], v21 offset:512
    s_waitcnt lgkmcnt(3)
    v_mfma_f32_32x32x16_bf16 v[64:79], a[0:3], v[28:31], v[64:79]
    v_mfma_f32_32x32x16_bf16 v[80:95], a[4:7], v[28:31], v[80:95]
    ds_read_b128 v[28:31], v22 offset:512
    s_waitcnt lgkmcnt(3)
    v_mfma_f32_32x32x16_bf16 v[64:79], a[8:11], v[32:35], v[64:79]
    v_mfma_f32_32x32x16_bf16 v[80:95], a[12:15], v[32:35], v[80:95]
    ds_read_b128 v[32:35], v23 offset:512
    s_waitcnt lgkmcnt(3)
    v_mfma_f32_32x32x16_bf16 v[64:79], a[16:19], v[36:39], v[64:79]
    v_mfma_f32_32x32x16_bf16 v[80:95], a[20:23], v[36:39], v[80:95]
    ds_read_b128 v[36:39], v24 offset:512
    s_waitcnt lgkmcnt(3)
    v_mfma_f32_32x32x16_bf16 v[64:79], a[24:27], v[40:43], v[64:79]
    v_mfma_f32_32x32x16_bf16 v[80:95], a[28:31], v[40:43], v[80:95]
    ds_read_b128 v[40:43], v25 offset:512
    s_waitcnt lgkmcnt(3)
    v_mfma_f32_32x32x16_bf16 v[64:79], a[32:35], v[28:31], v[64:79]
    v_mfma_f32_32x32x16_bf16 v[80:95], a[36:39], v[28:31], v[80:95]
    ds_read_b128 v[28:31], v18 offset:768
    s_waitcnt lgkmcnt(3)
    v_mfma_f32_32x32x16_bf16 v[64:79], a[40:43], v[32:35], v[64:79]
    v_mfma_f32_32x32x16_bf16 v[80:95], a[44:47], v[32:35], v[80:95]
    ds_read_b128 v[32:35], v19 offset:768
    s_waitcnt lgkmcnt(3)
    v_mfma_f32_32x32x16_bf16 v[64:79], a[48:51], v[36:39], v[64:79]
    v_mfma_f32_32x32x16_bf16 v[80:95], a[52:55], v[36:39], v[80:95]
    ds_read_b128 v[36:39], v20 offset:768
    s_waitcnt lgkmcnt(3)
    v_mfma_f32_32x32x16_bf16 v[64:79], a[56:59], v[40:43], v[64:79]
    v_mfma_f32_32x32x16_bf16 v[80:95], a[60:63], v[40:43], v[80:95]
    ds_read_b128 v[40:43], v21 offset:768
    s_waitcnt lgkmcnt(3)
    v_mfma_f32_32x32x16_bf16 v[64:79], a[64:67], v[28:31], v[64:79]
    v_mfma_f32_32x32x16_bf16 v[80:95], a[68:71], v[28:31], v[80:95]
    ds_read_b128 v[28:31], v22 offset:768
    s_waitcnt lgkmcnt(3)
    v_mfma_f32_32x32x16_bf16 v[64:79], a[72:75], v[32:35], v[64:79]
    v_mfma_f32_32x32x16_bf16 v[80:95], a[76:79], v[32:35], v[80:95]
    ds_read_b128 v[32:35], v23 offset:768
    s_waitcnt lgkmcnt(3)
    v_mfma_f32_32x32x16_bf16 v[64:79], a[80:83], v[36:39], v[64:79]
    v_mfma_f32_32x32x16_bf16 v[80:95], a[84:87], v[36:39], v[80:95]
    ds_read_b128 v[36:39], v24 offset:768
    s_waitcnt lgkmcnt(3)
    v_mfma_f32_32x32x16_bf16 v[64:79], a[88:91], v[40:43], v[64:79]
    v_mfma_f32_32x32x16_bf16 v[80:95], a[92:95], v[40:43], v[80:95]
    ds_read_b128 v[40:43], v25 offset:768
    s_waitcnt lgkmcnt(3)
    v_mfma_f32_32x32x16_bf16 v[64:79], a[96:99], v[28:31], v[64:79]
    v_mfma_f32_32x32x16_bf16 v[80:95], a[100:103], v[28:31], v[80:95]
    ds_read_b128 v[28:31], v18 offset:1024
    s_waitcnt lgkmcnt(3)
    v_mfma_f32_32x32x16_bf16 v[64:79], a[104:107], v[32:35], v[64:79]
    v_mfma_f32_32x32x16_bf16 v[80:95], a[108:111], v[32:35], v[80:95]
    ds_read_b128 v[32:35], v19 offset:1024
    s_waitcnt lgkmcnt(3)
    v_mfma_f32_32x32x16_bf16 v[64:79], a[112:115], v[36:39], v[64:79]
    v_mfma_f32_32x32x16_bf16 v[80:95], a[116:119], v[36:39], v[80:95]
    ds_read_b128 v[36:39], v20 offset:1024
    s_waitcnt lgkmcnt(3)
    v_mfma_f32_32x32x16_bf16 v[64:79], a[120:123], v[40:43], v[64:79]
    v_mfma_f32_32x32x16_bf16 v[80:95], a[124:127], v[40:43], v[80:95]
    ds_read_b128 v[40:43], v21 offset:1024
    s_waitcnt lgkmcnt(3)
    v_mfma_f32_32x32x16_bf16 v[64:79], a[128:131], v[28:31], v[64:79]
    v_mfma_f32_32x32x16_bf16 v[80:95], a[132:135], v[28:31], v[80:95]
    ds_read_b128 v[28:31], v22 offset:1024
    s_waitcnt lgkmcnt(3)
    v_mfma_f32_32x32x16_bf16 v[64:79], a[136:139], v[32:35], v[64:79]
    v_mfma_f32_32x32x16_bf16 v[80:95], a[140:143], v[32:35], v[80:95]
    ds_read_b128 v[32:35], v23 offset:1024
    s_waitcnt lgkmcnt(3)
    v_mfma_f32_32x32x16_bf16 v[64:79], a[144:147], v[36:39], v[64:79]
    v_mfma_f32_32x32x16_bf16 v[80:95], a[148:151], v[36:39], v[80:95]
    ds_read_b128 v[36:39], v24 offset:1024
    s_waitcnt lgkmcnt(3)
    v_mfma_f32_32x32x16_bf16 v[64:79], a[152:155], v[40:43], v[64:79]
    v_mfma_f32_32x32x16_bf16 v[80:95], a[156:159], v[40:43], v[80:95]
    ds_read_b128 v[40:43], v25 offset:1024
    s_waitcnt lgkmcnt(3)
    v_mfma_f32_32x32x16_bf16 v[64:79], a[160:163], v[28:31], v[64:79]
    v_mfma_f32_32x32x16_bf16 v[80:95], a[164:167], v[28:31], v[80:95]
    s_waitcnt vmcnt(10)
    v_mov_b32 v60, s40
    s_mov_b64 exec, 1
    buffer_store_dword v60, v27, s[16:19], s37 offen sc1
    s_mov_b64 exec, -1
    s_waitcnt lgkmcnt(2)
    v_mfma_f32_32x32x16_bf16 v[64:79], a[168:171], v[32:35], v[64:79]
    v_mfma_f32_32x32x16_bf16 v[80:95], a[172:175], v[32:35], v[80:95]
    s_waitcnt lgkmcnt(1)
    v_mfma_f32_32x32x16_bf16 v[64:79], a[176:179], v[36:39], v[64:79]
    v_mfma_f32_32x32x16_bf16 v[80:95], a[180:183], v[36:39], v[80:95]
    s_waitcnt lgkmcnt(0)
    v_mfma_f32_32x32x16_bf16 v[64:79], a[184:187], v[40:43], v[64:79]
    v_mfma_f32_32x32x16_bf16 v[80:95], a[188:191], v[40:43], v[80:95]
    s_add_u32 s36, s36, 0x100000
    s_add_u32 s41, s41, 40960
    s_cmp_eq_u32 s41, 122880
    s_cselect_b32 s41, 0, s41
    s_add_u32 s40, s40, 1
    s_branch L_p1loop0
L_p1end0:
    s_nop 7
    s_nop 7
    s_sub_u32 s42, s36, 0x100000
    v_cvt_pk_bf16_f32 v44, v96, v104
    v_cvt_pk_bf16_f32 v45, v97, v105
    v_cvt_pk_bf16_f32 v46, v98, v106
    v_cvt_pk_bf16_f32 v47, v99, v107
    buffer_store_dwordx4 v[44:47], v26, s[16:19], s42 offen offset:0 sc1
    v_cvt_pk_bf16_f32 v48, v100, v108
    v_cvt_pk_bf16_f32 v49, v101, v109
    v_cvt_pk_bf16_f32 v50, v102, v110
    v_cvt_pk_bf16_f32 v51, v103, v111
    buffer_store_dwordx4 v[48:51], v26, s[16:19], s42 offen offset:512 sc1
    v_cvt_pk_bf16_f32 v52, v112, v120
    v_cvt_pk_bf16_f32 v53, v113, v121
    v_cvt_pk_bf16_f32 v54, v114, v122
    v_cvt_pk_bf16_f32 v55, v115, v123
    buffer_store_dwordx4 v[52:55], v26, s[16:19], s42 offen offset:1024 sc1
    v_cvt_pk_bf16_f32 v56, v116, v124
    v_cvt_pk_bf16_f32 v57, v117, v125
    v_cvt_pk_bf16_f32 v58, v118, v126
    v_cvt_pk_bf16_f32 v59, v119, v127
    buffer_store_dwordx4 v[56:59], v26, s[16:19], s42 offen offset:1536 sc1
    s_branch L_p1fin
L_p1v:
    s_barrier
    v_add_u32 v18, s41, v10
    v_add_u32 v19, s41, v11
    v_add_u32 v20, s41, v12
    v_add_u32 v21, s41, v13
    v_add_u32 v22, s41, v14
    v_add_u32 v23, s41, v15
    v_add_u32 v24, s41, v16
    v_add_u32 v25, s41, v17
    ds_read_b128 v[28:31], v18 offset:0
    ds_read_b128 v[32:35], v19 offset:0
    ds_read_b128 v[36:39], v20 offset:0
    ds_read_b128 v[40:43], v21 offset:0
    s_waitcnt lgkmcnt(3)
    v_mfma_f32_32x32x16_bf16 v[64:79], v[28:31], v[128:131], 0
    v_mfma_f32_32x32x16_bf16 v[80:95], v[28:31], v[132:135], 0
    ds_read_b128 v[28:31], v22 offset:0
    s_waitcnt lgkmcnt(3)
    v_mfma_f32_32x32x16_bf16 v[64:79], v[32:35], v[136:139], v[64:79]
    s_mul_i32 s24, s9, 10240
    s_add_u32 s24, s24, s39
    v_mfma_f32_32x32x16_bf16 v[80:95], v[32:35], v[140:143], v[80:95]
    s_add_u32 m0, s24, 0
    s_nop 0
    ds_read_b128 v[32:35], v23 offset:0
    s_waitcnt lgkmcnt(3)
    v_mfma_f32_32x32x16_bf16 v[64:79], v[36:39], v[144:147], v[64:79]
    buffer_load_dwordx4 v0, s[20:23], s38 offen lds
    s_add_u32 m0, s24, 1024
    v_mfma_f32_32x32x16_bf16 v[80:95], v[36:39], v[148:151], v[80:95]
    s_nop 0
    buffer_load_dwordx4 v1, s[20:23], s38 offen lds
    ds_read_b128 v[36:39], v24 offset:0
    s_waitcnt lgkmcnt(3)
    v_mfma_f32_32x32x16_bf16 v[64:79], v[40:43], v[152:155], v[64:79]
    s_add_u32 m0, s24, 2048
    s_nop 0
    v_mfma_f32_32x32x16_bf16 v[80:95], v[40:43], v[156:159], v[80:95]
    buffer_load_dwordx4 v2, s[20:23], s38 offen lds
    s_add_u32 m0, s24, 3072
    ds_read_b128 v[40:43], v25 offset:0
    s_waitcnt lgkmcnt(3)
    v_mfma_f32_32x32x16_bf16 v[64:79], v[28:31], v[160:163], v[64:79]
    s_nop 0
    buffer_load_dwordx4 v3, s[20:23], s38 offen lds
    v_mfma_f32_32x32x16_bf16 v[80:95], v[28:31], v[164:167], v[80:95]
    s_add_u32 m0, s24, 4096
    s_nop 0
    ds_read_b128 v[28:31], v18 offset:256
    s_waitcnt lgkmcnt(3)
    v_mfma_f32_32x32x16_bf16 v[64:79], v[32:35], v[168:171], v[64:79]
    buffer_load_dwordx4 v4, s[20:23], s38 offen lds
    s_add_u32 m0, s24, 5120
    v_mfma_f32_32x32x16_bf16 v[80:95], v[32:35], v[172:175], v[80:95]
    s_nop 0
    buffer_load_dwordx4 v5, s[20:23], s38 offen lds
    ds_read_b128 v[32:35], v19 offset:256
    s_waitcnt lgkmcnt(3)
    v_mfma_f32_32x32x16_bf16 v[64:79], v[36:39], v[176:179], v[64:79]
    s_add_u32 m0, s24, 6144
    s_nop 0
    v_mfma_f32_32x32x16_bf16 v[80:95], v[36:39], v[180:183], v[80:95]
    buffer_load_dwordx4 v6, s[20:23], s38 offen lds
    s_add_u32 m0, s24, 7168
    ds_read_b128 v[36:39], v20 offset:256
    s_waitcnt lgkmcnt(3)
    v_mfma_f32_32x32x16_bf16 v[64:79], v[40:43], v[184:187], v[64:79]
    s_nop 0
    buffer_load_dwordx4 v7, s[20:23], s38 offen lds
    v_mfma_f32_32x32x16_bf16 v[80:95], v[40:43], v[188:191], v[80:95]
    s_add_u32 m0, s24, 8192
    s_nop 0
    ds_read_b128 v[40:43], v21 offset:256
    s_waitcnt lgkmcnt(3)
    v_mfma_f32_32x32x16_bf16 v[64:79], v[28:31], v[192:195], v[64:79]
    buffer_load_dwordx4 v8, s[20:23], s38 offen lds
    s_add_u32 m0, s24, 9216
    v_mfma_f32_32x32x16_bf16 v[80:95], v[28:31], v[196:199], v[80:95]
    s_nop 0
    buffer_load_dwordx4 v9, s[20:23], s38 offen lds
    ds_read_b128 v[28:31], v22 offset:256
    s_waitcnt lgkmcnt(3)
    v_mfma_f32_32x32x16_bf16 v[64:79], v[32:35], v[200:203], v[64:79]
    s_add_u32 s38, s38, 163840
    s_add_u32 s39, s39, 40960
    v_mfma_f32_32x32x16_bf16 v[80:95], v[32:35], v[204:207], v[80:95]
    s_cmp_eq_u32 s39, 122880
    s_cselect_b32 s39, 0, s39
    ds_read_b128 v[32:35], v23 offset:256
    s_waitcnt lgkmcnt(3)
    v_mfma_f32_32x32x16_bf16 v[64:79], v[36:39], v[208:211], v[64:79]
    v_mfma_f32_32x32x16_bf16 v[80:95], v[36:39], v[212:215], v[80:95]
    ds_read_b128 v[36:39], v24 offset:256
    s_waitcnt lgkmcnt(3)
    v_mfma_f32_32x32x16_bf16 v[64:79], v[40:43], v[216:219], v[64:79]
    v_mfma_f32_32x32x16_bf16 v[80:95], v[40:43], v[220:223], v[80:95]
    ds_read_b128 v[40:43], v25 offset:256
    s_waitcnt lgkmcnt(3)
    v_mfma_f32_32x32x16_bf16 v[64:79], v[28:31], v[224:227], v[64:79]
    v_mfma_f32_32x32x16_bf16 v[80:95], v[28:31], v[228:231], v[80:95]
    ds_read_b128 v[28:31], v18 offset:512
    s_waitcnt lgkmcnt(3)
    v_mfma_f32_32x32x16_bf16 v[64:79], v[32:35], v[232:235], v[64:79]
    v_mfma_f32_32x32x16_bf16 v[80:95], v[32:35], v[236:239], v[80:95]
    ds_read_b128 v[32:35], v19 offset:512
    s_waitcnt lgkmcnt(3)
    v_mfma_f32_32x32x16_bf16 v[64:79], v[36:39], v[240:243], v[64:79]
    v_mfma_f32_32x32x16_bf16 v[80:95], v[36:39], v[244:247], v[80:95]
    ds_read_b128 v[36:39], v20 offset:512
    s_waitcnt lgkmcnt(3)
    v_mfma_f32_32x32x16_bf16 v[64:79], v[40:43], v[248:251], v[64:79]
    v_mfma_f32_32x32x16_bf16 v[80:95], v[40:43], v[252:255], v[80:95]
    ds_read_b128 v[40:43], v21 offset:512
    s_waitcnt lgkmcnt(3)
    v_mfma_f32_32x32x16_bf16 v[64:79], v[28:31], a[0:3], v[64:79]
    v_mfma_f32_32x32x16_bf16 v[80:95], v[28:31], a[4:7], v[80:95]
    ds_read_b128 v[28:31], v22 offset:512
    s_waitcnt lgkmcnt(3)
    v_mfma_f32_32x32x16_bf16 v[64:79], v[32:35], a[8:11], v[64:79]
    v_mfma_f32_32x32x16_bf16 v[80:95], v[32:35], a[12:15], v[80:95]
    ds_read_b128 v[32:35], v23 offset:512
    s_waitcnt lgkmcnt(3)
    v_mfma_f32_32x32x16_bf16 v[64:79], v[36:39], a[16:19], v[64:79]
    v_mfma_f32_32x32x16_bf16 v[80:95], v[36:39], a[20:23], v[80:95]
    ds_read_b128 v[36:39], v24 offset:512
    s_waitcnt lgkmcnt(3)
    v_mfma_f32_32x32x16_bf16 v[64:79], v[40:43], a[24:27], v[64:79]
    v_mfma_f32_32x32x16_bf16 v[80:95], v[40:43], a[28:31], v[80:95]
    ds_read_b128 v[40:43], v25 offset:512
    s_waitcnt lgkmcnt(3)
    v_mfma_f32_32x32x16_bf16 v[64:79], v[28:31], a[32:35], v[64:79]
    v_mfma_f32_32x32x16_bf16 v[80:95], v[28:31], a[36:39], v[80:95]
    ds_read_b128 v[28:31], v18 offset:768
    s_waitcnt lgkmcnt(3)
    v_mfma_f32_32x32x16_bf16 v[64:79], v[32:35], a[40:43], v[64:79]
    v_mfma_f32_32x32x16_bf16 v[80:95], v[32:35], a[44:47], v[80:95]
    ds_read_b128 v[32:35], v19 offset:768
    s_waitcnt lgkmcnt(3)
    v_mfma_f32_32x32x16_bf16 v[64:79], v[36:39], a[48:51], v[64:79]
    v_mfma_f32_32x32x16_bf16 v[80:95], v[36:39], a[52:55], v[80:95]
    ds_read_b128 v[36:39], v20 offset:768
    s_waitcnt lgkmcnt(3)
    v_mfma_f32_32x32x16_bf16 v[64:79], v[40:43], a[56:59], v[64:79]
    v_mfma_f32_32x32x16_bf16 v[80:95], v[40:43], a[60:63], v[80:95]
    ds_read_b128 v[40:43], v21 offset:768
    s_waitcnt lgkmcnt(3)
    v_mfma_f32_32x32x16_bf16 v[64:79], v[28:31], a[64:67], v[64:79]
    v_mfma_f32_32x32x16_bf16 v[80:95], v[28:31], a[68:71], v[80:95]
    ds_read_b128 v[28:31], v22 offset:768
    s_waitcnt lgkmcnt(3)
    v_mfma_f32_32x32x16_bf16 v[64:79], v[32:35], a[72:75], v[64:79]
    v_mfma_f32_32x32x16_bf16 v[80:95], v[32:35], a[76:79], v[80:95]
    ds_read_b128 v[32:35], v23 offset:768
    s_waitcnt lgkmcnt(3)
    v_mfma_f32_32x32x16_bf16 v[64:79], v[36:39], a[80:83], v[64:79]
    v_mfma_f32_32x32x16_bf16 v[80:95], v[36:39], a[84:87], v[80:95]
    ds_read_b128 v[36:39], v24 offset:768
    s_waitcnt lgkmcnt(3)
    v_mfma_f32_32x32x16_bf16 v[64:79], v[40:43], a[88:91], v[64:79]
    v_mfma_f32_32x32x16_bf16 v[80:95], v[40:43], a[92:95], v[80:95]
    ds_read_b128 v[40:43], v25 offset:768
    s_waitcnt lgkmcnt(3)
    v_mfma_f32_32x32x16_bf16 v[64:79], v[28:31], a[96:99], v[64:79]
    v_mfma_f32_32x32x16_bf16 v[80:95], v[28:31], a[100:103], v[80:95]
    ds_read_b128 v[28:31], v18 offset:1024
    s_waitcnt lgkmcnt(3)
    v_mfma_f32_32x32x16_bf16 v[64:79], v[32:35], a[104:107], v[64:79]
    v_mfma_f32_32x32x16_bf16 v[80:95], v[32:35], a[108:111], v[80:95]
    ds_read_b128 v[32:35], v19 offset:1024
    s_waitcnt lgkmcnt(3)
    v_mfma_f32_32x32x16_bf16 v[64:79], v[36:39], a[112:115], v[64:79]
    v_mfma_f32_32x32x16_bf16 v[80:95], v[36:39], a[116:119], v[80:95]
    ds_read_b128 v[36:39], v20 offset:1024
    s_waitcnt lgkmcnt(3)
    v_mfma_f32_32x32x16_bf16 v[64:79], v[40:43], a[120:123], v[64:79]
    v_mfma_f32_32x32x16_bf16 v[80:95], v[40:43], a[124:127], v[80:95]
    ds_read_b128 v[40:43], v21 offset:1024
    s_waitcnt lgkmcnt(3)
    v_mfma_f32_32x32x16_bf16 v[64:79], v[28:31], a[128:131], v[64:79]
    v_mfma_f32_32x32x16_bf16 v[80:95], v[28:31], a[132:135], v[80:95]
    ds_read_b128 v[28:31], v22 offset:1024
    s_waitcnt lgkmcnt(3)
    v_mfma_f32_32x32x16_bf16 v[64:79], v[32:35], a[136:139], v[64:79]
    v_mfma_f32_32x32x16_bf16 v[80:95], v[32:35], a[140:143], v[80:95]
    ds_read_b128 v[32:35], v23 offset:1024
    s_waitcnt lgkmcnt(3)
    v_mfma_f32_32x32x16_bf16 v[64:79], v[36:39], a[144:147], v[64:79]
    v_mfma_f32_32x32x16_bf16 v[80:95], v[36:39], a[148:151], v[80:95]
    ds_read_b128 v[36:39], v24 offset:1024
    s_waitcnt lgkmcnt(3)
    v_mfma_f32_32x32x16_bf16 v[64:79], v[40:43], a[152:155], v[64:79]
    v_mfma_f32_32x32x16_bf16 v[80:95], v[40:43], a[156:159], v[80:95]
    ds_read_b128 v[40:43], v25 offset:1024
    s_waitcnt lgkmcnt(3)
    v_mfma_f32_32x32x16_bf16 v[64:79], v[28:31], a[160:163], v[64:79]
    v_mfma_f32_32x32x16_bf16 v[80:95], v[28:31], a[164:167], v[80:95]
    s_waitcnt vmcnt(10)
    v_mov_b32 v60, s40
    s_mov_b64 exec, 1
    buffer_store_dword v60, v27, s[16:19], s37 offen sc1
    s_mov_b64 exec, -1
    s_waitcnt lgkmcnt(2)
    v_mfma_f32_32x32x16_bf16 v[64:79], v[32:35], a[168:171], v[64:79]
    v_mfma_f32_32x32x16_bf16 v[80:95], v[32:35], a[172:175], v[80:95]
    s_waitcnt lgkmcnt(1)
    v_mfma_f32_32x32x16_bf16 v[64:79], v[36:39], a[176:179], v[64:79]
    v_mfma_f32_32x32x16_bf16 v[80:95], v[36:39], a[180:183], v[80:95]
    s_waitcnt lgkmcnt(0)
    v_mfma_f32_32x32x16_bf16 v[64:79], v[40:43], a[184:187], v[64:79]
    v_mfma_f32_32x32x16_bf16 v[80:95], v[40:43], a[188:191], v[80:95]
    s_add_u32 s36, s36, 0x100000
    s_add_u32 s41, s41, 40960
    s_cmp_eq_u32 s41, 122880
    s_cselect_b32 s41, 0, s41
    s_add_u32 s40, s40, 1
L_p1loop1:
    s_barrier
    v_add_u32 v18, s41, v10
    v_add_u32 v19, s41, v11
    v_add_u32 v20, s41, v12
    v_add_u32 v21, s41, v13
    v_add_u32 v22, s41, v14
    v_add_u32 v23, s41, v15
    v_add_u32 v24, s41, v16
    v_add_u32 v25, s41, v17
    ds_read_b128 v[28:31], v18 offset:0
    ds_read_b128 v[32:35], v19 offset:0
    ds_read_b128 v[36:39], v20 offset:0
    ds_read_b128 v[40:43], v21 offset:0
    s_waitcnt lgkmcnt(3)
    v_mfma_f32_32x32x16_bf16 v[96:111], v[28:31], v[128:131], 0
    v_mfma_f32_32x32x16_bf16 v[112:127], v[28:31], v[132:135], 0
    ds_read_b128 v[28:31], v22 offset:0
    s_waitcnt lgkmcnt(3)
    v_mfma_f32_32x32x16_bf16 v[96:111], v[32:35], v[136:139], v[96:111]
    s_sub_u32 s42, s36, 0x100000
    v_cvt_pk_bf16_f32 v44, v64, v65
    v_mfma_f32_32x32x16_bf16 v[112:127], v[32:35], v[140:143], v[112:127]
    v_cvt_pk_bf16_f32 v45, v66, v67
    v_cvt_pk_bf16_f32 v46, v72, v73
    ds_read_b128 v[32:35], v23 offset:0
    s_waitcnt lgkmcnt(3)
    v_mfma_f32_32x32x16_bf16 v[96:111], v[36:39], v[144:147], v[96:111]
    v_cvt_pk_bf16_f32 v47, v74, v75
    buffer_store_dwordx4 v[44:47], v26, s[16:19], s42 offen offset:0 sc1
    v_mfma_f32_32x32x16_bf16 v[112:127], v[36:39], v[148:151], v[112:127]
    v_cvt_pk_bf16_f32 v48, v68, v69
    v_cvt_pk_bf16_f32 v49, v70, v71
    ds_read_b128 v[36:39], v24 offset:0
    s_waitcnt lgkmcnt(3)
    v_mfma_f32_32x32x16_bf16 v[96:111], v[40:43], v[152:155], v[96:111]
    v_cvt_pk_bf16_f32 v50, v76, v77
    v_cvt_pk_bf16_f32 v51, v78, v79
    v_mfma_f32_32x32x16_bf16 v[112:127], v[40:43], v[156:159], v[112:127]
    buffer_store_dwordx4 v[48:51], v26, s[16:19], s42 offen offset:512 sc1
    v_cvt_pk_bf16_f32 v52, v80, v81
    ds_read_b128 v[40:43], v25 offset:0
    s_waitcnt lgkmcnt(3)
    v_mfma_f32_32x32x16_bf16 v[96:111], v[28:31], v[160:163], v[96:111]
    v_cvt_pk_bf16_f32 v53, v82, v83
    v_cvt_pk_bf16_f32 v54, v88, v89
    v_mfma_f32_32x32x16_bf16 v[112:127], v[28:31], v[164:167], v[112:127]
    v_cvt_pk_bf16_f32 v55, v90, v91
    buffer_store_dwordx4 v[52:55], v26, s[16:19], s42 offen offset:2048 sc1
    ds_read_b128 v[28:31], v18 offset:256
    s_waitcnt lgkmcnt(3)
    v_mfma_f32_32x32x16_bf16 v[96:111], v[32:35], v[168:171], v[96:111]
    v_cvt_pk_bf16_f32 v56, v84, v85
    v_cvt_pk_bf16_f32 v57, v86, v87
    v_mfma_f32_32x32x16_bf16 v[112:127], v[32:35], v[172:175], v[112:127]
    v_cvt_pk_bf16_f32 v58, v92, v93
    v_cvt_pk_bf16_f32 v59, v94, v95
    ds_read_b128 v[32:35], v19 offset:256
    s_waitcnt lgkmcnt(3)
    v_mfma_f32_32x32x16_bf16 v[96:111], v[36:39], v[176:179], v[96:111]
    buffer_store_dwordx4 v[56:59], v26, s[16:19], s42 offen offset:2560 sc1
    s_mul_i32 s24, s9, 10240
    v_mfma_f32_32x32x16_bf16 v[112:127], v[36:39], v[180:183], v[112:127]
    s_add_u32 s24, s24, s39
    s_add_u32 m0, s24, 0
    ds_read_b128 v[36:39], v20 offset:256
    s_waitcnt lgkmcnt(3)
    v_mfma_f32_32x32x16_bf16 v[96:111], v[40:43], v[184:187], v[96:111]
    s_nop 0
    buffer_load_dwordx4 v0, s[20:23], s38 offen lds
    v_mfma_f32_32x32x16_bf16 v[112:127], v[40:43], v[188:191], v[112:127]
    s_add_u32 m0, s24, 1024
    s_nop 0
    ds_read_b128 v[40:43], v21 offset:256
    s_waitcnt lgkmcnt(3)
    v_mfma_f32_32x32x16_bf16 v[96:111], v[28:31], v[192:195], v[96:111]
    buffer_load_dwordx4 v1, s[20:23], s38 offen lds
    s_add_u32 m0, s24, 2048
    v_mfma_f32_32x32x16_bf16 v[112:127], v[28:31], v[196:199], v[112:127]
    s_nop 0
    buffer_load_dwordx4 v2, s[20:23], s38 offen lds
    ds_read_b128 v[28:31], v22 offset:256
    s_waitcnt lgkmcnt(3)
    v_mfma_f32_32x32x16_bf16 v[96:111], v[32:35], v[200:203], v[96:111]
    s_add_u32 m0, s24, 3072
    s_nop 0
    v_mfma_f32_32x32x16_bf16 v[112:127], v[32:35], v[204:207], v[112:127]
    buffer_load_dwordx4 v3, s[20:23], s38 offen lds
    s_add_u32 m0, s24, 4096
    ds_read_b128 v[32:35], v23 offset:256
    s_waitcnt lgkmcnt(3)
    v_mfma_f32_32x32x16_bf16 v[96:111], v[36:39], v[208:211], v[96:111]
    s_nop 0
    buffer_load_dwordx4 v4, s[20:23], s38 offen lds
    v_mfma_f32_32x32x16_bf16 v[112:127], v[36:39], v[212:215], v[112:127]
    s_add_u32 m0, s24, 5120
    s_nop 0
    ds_read_b128 v[36:39], v24 offset:256
    s_waitcnt lgkmcnt(3)
    v_mfma_f32_32x32x16_bf16 v[96:111], v[40:43], v[216:219], v[96:111]
    buffer_load_dwordx4 v5, s[20:23], s38 offen lds
    s_add_u32 m0, s24, 6144
    v_mfma_f32_32x32x16_bf16 v[112:127], v[40:43], v[220:223], v[112:127]
    s_nop 0
    buffer_load_dwordx4 v6, s[20:23], s38 offen lds
    ds_read_b128 v[40:43], v25 offset:256
    s_waitcnt lgkmcnt(3)
    v_mfma_f32_32x32x16_bf16 v[96:111], v[28:31], v[224:227], v[96:111]
    s_add_u32 m0, s24, 7168
    s_nop 0
    v_mfma_f32_32x32x16_bf16 v[112:127], v[28:31], v[228:231], v[112:127]
    buffer_load_dwordx4 v7, s[20:23], s38 offen lds
    s_add_u32 m0, s24, 8192
    ds_read_b128 v[28:31], v18 offset:512
    s_waitcnt lgkmcnt(3)
    v_mfma_f32_32x32x16_bf16 v[96:111], v[32:35], v[232:235], v[96:111]
    s_nop 0
    buffer_load_dwordx4 v8, s[20:23], s38 offen lds
    v_mfma_f32_32x32x16_bf16 v[112:127], v[32:35], v[236:239], v[112:127]
    s_add_u32 m0, s24, 9216
    s_nop 0
    ds_read_b128 v[32:35], v19 offset:512
    s_waitcnt lgkmcnt(3)
    v_mfma_f32_32x32x16_bf16 v[96:111], v[36:39], v[240:243], v[96:111]
    buffer_load_dwordx4 v9, s[20:23], s38 offen lds
    s_add_u32 s38, s38, 163840
    v_mfma_f32_32x32x16_bf16 v[112:127], v[36:39], v[244:247], v[112:127]
    s_add_u32 s39, s39, 40960
    s_cmp_eq_u32 s39, 122880
    ds_read_b128 v[36:39], v20 offset:512
    s_waitcnt lgkmcnt(3)
    v_mfma_f32_32x32x16_bf16 v[96:111], v[40:43], v[248:251], v[96:111]
    s_cselect_b32 s39, 0, s39
    v_mfma_f32_32x32x16_bf16 v[112:127], v[40:43], v[252:255], v[112:127]
    ds_read_b128 v[40:43], v21 offset:512
    s_waitcnt lgkmcnt(3)
    v_mfma_f32_32x32x16_bf16 v[96:111], v[28:31], a[0:3], v[96:111]
    v_mfma_f32_32x32x16_bf16 v[112:127], v[28:31], a[4:7], v[112:127]
    ds_read_b128 v[28:31], v22 offset:512
    s_waitcnt lgkmcnt(3)
    v_mfma_f32_32x32x16_bf16 v[96:111], v[32:35], a[8:11], v[96:111]
    v_mfma_f32_32x32x16_bf16 v[112:127], v[32:35], a[12:15], v[112:127]
    ds_read_b128 v[32:35], v23 offset:512
    s_waitcnt lgkmcnt(3)
    v_mfma_f32_32x32x16_bf16 v[96:111], v[36:39], a[16:19], v[96:111]
    v_mfma_f32_32x32x16_bf16 v[112:127], v[36:39], a[20:23], v[112:127]
    ds_read_b128 v[36:39], v24 offset:512
    s_waitcnt lgkmcnt(3)
    v_mfma_f32_32x32x16_bf16 v[96:111], v[40:43], a[24:27], v[96:111]
    v_mfma_f32_32x32x16_bf16 v[112:127], v[40:43], a[28:31], v[112:127]
    ds_read_b128 v[40:43], v25 offset:512
    s_waitcnt lgkmcnt(3)
    v_mfma_f32_32x32x16_bf16 v[96:111], v[28:31], a[32:35], v[96:111]
    v_mfma_f32_32x32x16_bf16 v[112:127], v[28:31], a[36:39], v[112:127]
    ds_read_b128 v[28:31], v18 offset:768
    s_waitcnt lgkmcnt(3)
    v_mfma_f32_32x32x16_bf16 v[96:111], v[32:35], a[40:43], v[96:111]
    v_mfma_f32_32x32x16_bf16 v[112:127], v[32:35], a[44:47], v[112:127]
    ds_read_b128 v[32:35], v19 offset:768
    s_waitcnt lgkmcnt(3)
    v_mfma_f32_32x32x16_bf16 v[96:111], v[36:39], a[48:51], v[96:111]
    v_mfma_f32_32x32x16_bf16 v[112:127], v[36:39], a[52:55], v[112:127]
    ds_read_b128 v[36:39], v20 offset:768
    s_waitcnt lgkmcnt(3)
    v_mfma_f32_32x32x16_bf16 v[96:111], v[40:43], a[56:59], v[96:111]
    v_mfma_f32_32x32x16_bf16 v[112:127], v[40:43], a[60:63], v[112:127]
    ds_read_b128 v[40:43], v21 offset:768
    s_waitcnt lgkmcnt(3)
    v_mfma_f32_32x32x16_bf16 v[96:111], v[28:31], a[64:67], v[96:111]
    v_mfma_f32_32x32x16_bf16 v[112:127], v[28:31], a[68:71], v[112:127]
    ds_read_b128 v[28:31], v22 offset:768
    s_waitcnt lgkmcnt(3)
    v_mfma_f32_32x32x16_bf16 v[96:111], v[32:35], a[72:75], v[96:111]
    v_mfma_f32_32x32x16_bf16 v[112:127], v[32:35], a[76:79], v[112:127]
    ds_read_b128 v[32:35], v23 offset:768
    s_waitcnt lgkmcnt(3)
    v_mfma_f32_32x32x16_bf16 v[96:111], v[36:39], a[80:83], v[96:111]
    v_mfma_f32_32x32x16_bf16 v[112:127], v[36:39], a[84:87], v[112:127]
    ds_read_b128 v[36:39], v24 offset:768
    s_waitcnt lgkmcnt(3)
    v_mfma_f32_32x32x16_bf16 v[96:111], v[40:43], a[88:91], v[96:111]
    v_mfma_f32_32x32x16_bf16 v[112:127], v[40:43], a[92:95], v[112:127]
    ds_read_b128 v[40:43], v25 offset:768
    s_waitcnt lgkmcnt(3)
    v_mfma_f32_32x32x16_bf16 v[96:111], v[28:31], a[96:99], v[96:111]
    v_mfma_f32_32x32x16_bf16 v[112:127], v[28:31], a[100:103], v[112:127]
    ds_read_b128 v[28:31], v18 offset:1024
    s_waitcnt lgkmcnt(3)
    v_mfma_f32_32x32x16_bf16 v[96:111], v[32:35], a[104:107], v[96:111]
    v_mfma_f32_32x32x16_bf16 v[112:127], v[32:35], a[108:111], v[112:127]
    ds_read_b128 v[32:35], v19 offset:1024
    s_waitcnt lgkmcnt(3)
    v_mfma_f32_32x32x16_bf16 v[96:111], v[36:39], a[112:115], v[96:111]
    v_mfma_f32_32x32x16_bf16 v[112:127], v[36:39], a[116:119], v[112:127]
    ds_read_b128 v[36:39], v20 offset:1024
    s_waitcnt lgkmcnt(3)
    v_mfma_f32_32x32x16_bf16 v[96:111], v[40:43], a[120:123], v[96:111]
    v_mfma_f32_32x32x16_bf16 v[112:127], v[40:43], a[124:127], v[112:127]
    ds_read_b128 v[40:43], v21 offset:1024
    s_waitcnt lgkmcnt(3)
    v_mfma_f32_32x32x16_bf16 v[96:111], v[28:31], a[128:131], v[96:111]
    v_mfma_f32_32x32x16_bf16 v[112:127], v[28:31], a[132:135], v[112:127]
    ds_read_b128 v[28:31], v22 offset:1024
    s_waitcnt lgkmcnt(3)
    v_mfma_f32_32x32x16_bf16 v[96:111], v[32:35], a[136:139], v[96:111]
    v_mfma_f32_32x32x16_bf16 v[112:127], v[32:35], a[140:143], v[112:127]
    ds_read_b128 v[32:35], v23 offset:1024
    s_waitcnt lgkmcnt(3)
    v_mfma_f32_32x32x16_bf16 v[96:111], v[36:39], a[144:147], v[96:111]
    v_mfma_f32_32x32x16_bf16 v[112:127], v[36:39], a[148:151], v[112:127]
    ds_read_b128 v[36:39], v24 offset:1024
    s_waitcnt lgkmcnt(3)
    v_mfma_f32_32x32x16_bf16 v[96:111], v[40:43], a[152:155], v[96:111]
    v_mfma_f32_32x32x16_bf16 v[112:127], v[40:43], a[156:159], v[112:127]
    ds_read_b128 v[40:43], v25 offset:1024
    s_waitcnt lgkmcnt(3)
    v_mfma_f32_32x32x16_bf16 v[96:111], v[28:31], a[160:163], v[96:111]
    v_mfma_f32_32x32x16_bf16 v[112:127], v[28:31], a[164:167], v[112:127]
    s_waitcnt vmcnt(10)
    v_mov_b32 v60, s40
    s_mov_b64 exec, 1
    buffer_store_dword v60, v27, s[16:19], s37 offen sc1
    s_mov_b64 exec, -1
    s_waitcnt lgkmcnt(2)
    v_mfma_f32_32x32x16_bf16 v[96:111], v[32:35], a[168:171], v[96:111]
    v_mfma_f32_32x32x16_bf16 v[112:127], v[32:35], a[172:175], v[112:127]
    s_waitcnt lgkmcnt(1)
    v_mfma_f32_32x32x16_bf16 v[96:111], v[36:39], a[176:179], v[96:111]
    v_mfma_f32_32x32x16_bf16 v[112:127], v[36:39], a[180:183], v[112:127]
    s_waitcnt lgkmcnt(0)
    v_mfma_f32_32x32x16_bf16 v[96:111], v[40:43], a[184:187], v[96:111]
    v_mfma_f32_32x32x16_bf16 v[112:127], v[40:43], a[188:191], v[112:127]
    s_add_u32 s36, s36, 0x100000
    s_add_u32 s41, s41, 40960
    s_cmp_eq_u32 s41, 122880
    s_cselect_b32 s41, 0, s41
    s_add_u32 s40, s40, 1
    s_cmp_eq_u32 s40, 16
    s_cbranch_scc1 L_p1end1
    s_barrier
    v_add_u32 v18, s41, v10
    v_add_u32 v19, s41, v11
    v_add_u32 v20, s41, v12
    v_add_u32 v21, s41, v13
    v_add_u32 v22, s41, v14
    v_add_u32 v23, s41, v15
    v_add_u32 v24, s41, v16
    v_add_u32 v25, s41, v17
    ds_read_b128 v[28:31], v18 offset:0
    ds_read_b128 v[32:35], v19 offset:0
    ds_read_b128 v[36:39], v20 offset:0
    ds_read_b128 v[40:43], v21 offset:0
    s_waitcnt lgkmcnt(3)
    v_mfma_f32_32x32x16_bf16 v[64:79], v[28:31], v[128:131], 0
    v_mfma_f32_32x32x16_bf16 v[80:95], v[28:31], v[132:135], 0
    ds_read_b128 v[28:31], v22 offset:0
    s_waitcnt lgkmcnt(3)
    v_mfma_f32_32x32x16_bf16 v[64:79], v[32:35], v[136:139], v[64:79]
    s_sub_u32 s42, s36, 0x100000
    v_cvt_pk_bf16_f32 v44, v96, v97
    v_mfma_f32_32x32x16_bf16 v[80:95], v[32:35], v[140:143], v[80:95]
    v_cvt_pk_bf16_f32 v45, v98, v99
    v_cvt_pk_bf16_f32 v46, v104, v105
    ds_read_b128 v[32:35], v23 offset:0
    s_waitcnt lgkmcnt(3)
    v_mfma_f32_32x32x16_bf16 v[64:79], v[36:39], v[144:147], v[64:79]
    v_cvt_pk_bf16_f32 v47, v106, v107
    buffer_store_dwordx4 v[44:47], v26, s[16:19], s42 offen offset:0 sc1
    v_mfma_f32_32x32x16_bf16 v[80:95], v[36:39], v[148:151], v[80:95]
    v_cvt_pk_bf16_f32 v48, v100, v101
    v_cvt_pk_bf16_f32 v49, v102, v103
    ds_read_b128 v[36:39], v24 offset:0
    s_waitcnt lgkmcnt(3)
    v_mfma_f32_32x32x16_bf16 v[64:79], v[40:43], v[152:155], v[64:79]
    v_cvt_pk_bf16_f32 v50, v108, v109
    v_cvt_pk_bf16_f32 v51, v110, v111
    v_mfma_f32_32x32x16_bf16 v[80:95], v[40:43], v[156:159], v[80:95]
    buffer_store_dwordx4 v[48:51], v26, s[16:19], s42 offen offset:512 sc1
    v_cvt_pk_bf16_f32 v52, v112, v113
    ds_read_b128 v[40:43], v25 offset:0
    s_waitcnt lgkmcnt(3)
    v_mfma_f32_32x32x16_bf16 v[64:79], v[28:31], v[160:163], v[64:79]
    v_cvt_pk_bf16_f32 v53, v114, v115
    v_cvt_pk_bf16_f32 v54, v120, v121
    v_mfma_f32_32x32x16_bf16 v[80:95], v[28:31], v[164:167], v[80:95]
    v_cvt_pk_bf16_f32 v55, v122, v123
    buffer_store_dwordx4 v[52:55], v26, s[16:19], s42 offen offset:2048 sc1
    ds_read_b128 v[28:31], v18 offset:256
    s_waitcnt lgkmcnt(3)
    v_mfma_f32_32x32x16_bf16 v[64:79], v[32:35], v[168:171], v[64:79]
    v_cvt_pk_bf16_f32 v56, v116, v117
    v_cvt_pk_bf16_f32 v57, v118, v119
    v_mfma_f32_32x32x16_bf16 v[80:95], v[32:35], v[172:175], v[80:95]
    v_cvt_pk_bf16_f32 v58, v124, v125
    v_cvt_pk_bf16_f32 v59, v126, v127
    ds_read_b128 v[32:35], v19 offset:256
    s_waitcnt lgkmcnt(3)
    v_mfma_f32_32x32x16_bf16 v[64:79], v[36:39], v[176:179], v[64:79]
    buffer_store_dwordx4 v[56:59], v26, s[16:19], s42 offen offset:2560 sc1
    s_mul_i32 s24, s9, 10240
    v_mfma_f32_32x32x16_bf16 v[80:95], v[36:39], v[180:183], v[80:95]
    s_add_u32 s24, s24, s39
    s_add_u32 m0, s24, 0
    ds_read_b128 v[36:39], v20 offset:256
    s_waitcnt lgkmcnt(3)
    v_mfma_f32_32x32x16_bf16 v[64:79], v[40:43], v[184:187], v[64:79]
    s_nop 0
    buffer_load_dwordx4 v0, s[20:23], s38 offen lds
    v_mfma_f32_32x32x16_bf16 v[80:95], v[40:43], v[188:191], v[80:95]
    s_add_u32 m0, s24, 1024
    s_nop 0
    ds_read_b128 v[40:43], v21 offset:256
    s_waitcnt lgkmcnt(3)
    v_mfma_f32_32x32x16_bf16 v[64:79], v[28:31], v[192:195], v[64:79]
    buffer_load_dwordx4 v1, s[20:23], s38 offen lds
    s_add_u32 m0, s24, 2048
    v_mfma_f32_32x32x16_bf16 v[80:95], v[28:31], v[196:199], v[80:95]
    s_nop 0
    buffer_load_dwordx4 v2, s[20:23], s38 offen lds
    ds_read_b128 v[28:31], v22 offset:256
    s_waitcnt lgkmcnt(3)
    v_mfma_f32_32x32x16_bf16 v[64:79], v[32:35], v[200:203], v[64:79]
    s_add_u32 m0, s24, 3072
    s_nop 0
    v_mfma_f32_32x32x16_bf16 v[80:95], v[32:35], v[204:207], v[80:95]
    buffer_load_dwordx4 v3, s[20:23], s38 offen lds
    s_add_u32 m0, s24, 4096
    ds_read_b128 v[32:35], v23 offset:256
    s_waitcnt lgkmcnt(3)
    v_mfma_f32_32x32x16_bf16 v[64:79], v[36:39], v[208:211], v[64:79]
    s_nop 0
    buffer_load_dwordx4 v4, s[20:23], s38 offen lds
    v_mfma_f32_32x32x16_bf16 v[80:95], v[36:39], v[212:215], v[80:95]
    s_add_u32 m0, s24, 5120
    s_nop 0
    ds_read_b128 v[36:39], v24 offset:256
    s_waitcnt lgkmcnt(3)
    v_mfma_f32_32x32x16_bf16 v[64:79], v[40:43], v[216:219], v[64:79]
    buffer_load_dwordx4 v5, s[20:23], s38 offen lds
    s_add_u32 m0, s24, 6144
    v_mfma_f32_32x32x16_bf16 v[80:95], v[40:43], v[220:223], v[80:95]
    s_nop 0
    buffer_load_dwordx4 v6, s[20:23], s38 offen lds
    ds_read_b128 v[40:43], v25 offset:256
    s_waitcnt lgkmcnt(3)
    v_mfma_f32_32x32x16_bf16 v[64:79], v[28:31], v[224:227], v[64:79]
    s_add_u32 m0, s24, 7168
    s_nop 0
    v_mfma_f32_32x32x16_bf16 v[80:95], v[28:31], v[228:231], v[80:95]
    buffer_load_dwordx4 v7, s[20:23], s38 offen lds
    s_add_u32 m0, s24, 8192
    ds_read_b128 v[28:31], v18 offset:512
    s_waitcnt lgkmcnt(3)
    v_mfma_f32_32x32x16_bf16 v[64:79], v[32:35], v[232:235], v[64:79]
    s_nop 0
    buffer_load_dwordx4 v8, s[20:23], s38 offen lds
    v_mfma_f32_32x32x16_bf16 v[80:95], v[32:35], v[236:239], v[80:95]
    s_add_u32 m0, s24, 9216
    s_nop 0
    ds_read_b128 v[32:35], v19 offset:512
    s_waitcnt lgkmcnt(3)
    v_mfma_f32_32x32x16_bf16 v[64:79], v[36:39], v[240:243], v[64:79]
    buffer_load_dwordx4 v9, s[20:23], s38 offen lds
    s_add_u32 s38, s38, 163840
    v_mfma_f32_32x32x16_bf16 v[80:95], v[36:39], v[244:247], v[80:95]
    s_add_u32 s39, s39, 40960
    s_cmp_eq_u32 s39, 122880
    ds_read_b128 v[36:39], v20 offset:512
    s_waitcnt lgkmcnt(3)
    v_mfma_f32_32x32x16_bf16 v[64:79], v[40:43], v[248:251], v[64:79]
    s_cselect_b32 s39, 0, s39
    v_mfma_f32_32x32x16_bf16 v[80:95], v[40:43], v[252:255], v[80:95]
    ds_read_b128 v[40:43], v21 offset:512
    s_waitcnt lgkmcnt(3)
    v_mfma_f32_32x32x16_bf16 v[64:79], v[28:31], a[0:3], v[64:79]
    v_mfma_f32_32x32x16_bf16 v[80:95], v[28:31], a[4:7], v[80:95]
    ds_read_b128 v[28:31], v22 offset:512
    s_waitcnt lgkmcnt(3)
    v_mfma_f32_32x32x16_bf16 v[64:79], v[32:35], a[8:11], v[64:79]
    v_mfma_f32_32x32x16_bf16 v[80:95], v[32:35], a[12:15], v[80:95]
    ds_read_b128 v[32:35], v23 offset:512
    s_waitcnt lgkmcnt(3)
    v_mfma_f32_32x32x16_bf16 v[64:79], v[36:39], a[16:19], v[64:79]
    v_mfma_f32_32x32x16_bf16 v[80:95], v[36:39], a[20:23], v[80:95]
    ds_read_b128 v[36:39], v24 offset:512
    s_waitcnt lgkmcnt(3)
    v_mfma_f32_32x32x16_bf16 v[64:79], v[40:43], a[24:27], v[64:79]
    v_mfma_f32_32x32x16_bf16 v[80:95], v[40:43], a[28:31], v[80:95]
    ds_read_b128 v[40:43], v25 offset:512
    s_waitcnt lgkmcnt(3)
    v_mfma_f32_32x32x16_bf16 v[64:79], v[28:31], a[32:35], v[64:79]
    v_mfma_f32_32x32x16_bf16 v[80:95], v[28:31], a[36:39], v[80:95]
    ds_read_b128 v[28:31], v18 offset:768
    s_waitcnt lgkmcnt(3)
    v_mfma_f32_32x32x16_bf16 v[64:79], v[32:35], a[40:43], v[64:79]
    v_mfma_f32_32x32x16_bf16 v[80:95], v[32:35], a[44:47], v[80:95]
    ds_read_b128 v[32:35], v19 offset:768
    s_waitcnt lgkmcnt(3)
    v_mfma_f32_32x32x16_bf16 v[64:79], v[36:39], a[48:51], v[64:79]
    v_mfma_f32_32x32x16_bf16 v[80:95], v[36:39], a[52:55], v[80:95]
    ds_read_b128 v[36:39], v20 offset:768
    s_waitcnt lgkmcnt(3)
    v_mfma_f32_32x32x16_bf16 v[64:79], v[40:43], a[56:59], v[64:79]
    v_mfma_f32_32x32x16_bf16 v[80:95], v[40:43], a[60:63], v[80:95]
    ds_read_b128 v[40:43], v21 offset:768
    s_waitcnt lgkmcnt(3)
    v_mfma_f32_32x32x16_bf16 v[64:79], v[28:31], a[64:67], v[64:79]
    v_mfma_f32_32x32x16_bf16 v[80:95], v[28:31], a[68:71], v[80:95]
    ds_read_b128 v[28:31], v22 offset:768
    s_waitcnt lgkmcnt(3)
    v_mfma_f32_32x32x16_bf16 v[64:79], v[32:35], a[72:75], v[64:79]
    v_mfma_f32_32x32x16_bf16 v[80:95], v[32:35], a[76:79], v[80:95]
    ds_read_b128 v[32:35], v23 offset:768
    s_waitcnt lgkmcnt(3)
    v_mfma_f32_32x32x16_bf16 v[64:79], v[36:39], a[80:83], v[64:79]
    v_mfma_f32_32x32x16_bf16 v[80:95], v[36:39], a[84:87], v[80:95]
    ds_read_b128 v[36:39], v24 offset:768
    s_waitcnt lgkmcnt(3)
    v_mfma_f32_32x32x16_bf16 v[64:79], v[40:43], a[88:91], v[64:79]
    v_mfma_f32_32x32x16_bf16 v[80:95], v[40:43], a[92:95], v[80:95]
    ds_read_b128 v[40:43], v25 offset:768
    s_waitcnt lgkmcnt(3)
    v_mfma_f32_32x32x16_bf16 v[64:79], v[28:31], a[96:99], v[64:79]
    v_mfma_f32_32x32x16_bf16 v[80:95], v[28:31], a[100:103], v[80:95]
    ds_read_b128 v[28:31], v18 offset:1024
    s_waitcnt lgkmcnt(3)
    v_mfma_f32_32x32x16_bf16 v[64:79], v[32:35], a[104:107], v[64:79]
    v_mfma_f32_32x32x16_bf16 v[80:95], v[32:35], a[108:111], v[80:95]
    ds_read_b128 v[32:35], v19 offset:1024
    s_waitcnt lgkmcnt(3)
    v_mfma_f32_32x32x16_bf16 v[64:79], v[36:39], a[112:115], v[64:79]
    v_mfma_f32_32x32x16_bf16 v[80:95], v[36:39], a[116:119], v[80:95]
    ds_read_b128 v[36:39], v20 offset:1024
    s_waitcnt lgkmcnt(3)
    v_mfma_f32_32x32x16_bf16 v[64:79], v[40:43], a[120:123], v[64:79]
    v_mfma_f32_32x32x16_bf16 v[80:95], v[40:43], a[124:127], v[80:95]
    ds_read_b128 v[40:43], v21 offset:1024
    s_waitcnt lgkmcnt(3)
    v_mfma_f32_32x32x16_bf16 v[64:79], v[28:31], a[128:131], v[64:79]
    v_mfma_f32_32x32x16_bf16 v[80:95], v[28:31], a[132:135], v[80:95]
    ds_read_b128 v[28:31], v22 offset:1024
    s_waitcnt lgkmcnt(3)
    v_mfma_f32_32x32x16_bf16 v[64:79], v[32:35], a[136:139], v[64:79]
    v_mfma_f32_32x32x16_bf16 v[80:95], v[32:35], a[140:143], v[80:95]
    ds_read_b128 v[32:35], v23 offset:1024
    s_waitcnt lgkmcnt(3)
    v_mfma_f32_32x32x16_bf16 v[64:79], v[36:39], a[144:147], v[64:79]
    v_mfma_f32_32x32x16_bf16 v[80:95], v[36:39], a[148:151], v[80:95]
    ds_read_b128 v[36:39], v24 offset:1024
    s_waitcnt lgkmcnt(3)
    v_mfma_f32_32x32x16_bf16 v[64:79], v[40:43], a[152:155], v[64:79]
    v_mfma_f32_32x32x16_bf16 v[80:95], v[40:43], a[156:159], v[80:95]
    ds_read_b128 v[40:43], v25 offset:1024
    s_waitcnt lgkmcnt(3)
    v_mfma_f32_32x32x16_bf16 v[64:79], v[28:31], a[160:163], v[64:79]
    v_mfma_f32_32x32x16_bf16 v[80:95], v[28:31], a[164:167], v[80:95]
    s_waitcnt vmcnt(10)
    v_mov_b32 v60, s40
    s_mov_b64 exec, 1
    buffer_store_dword v60, v27, s[16:19], s37 offen sc1
    s_mov_b64 exec, -1
    s_waitcnt lgkmcnt(2)
    v_mfma_f32_32x32x16_bf16 v[64:79], v[32:35], a[168:171], v[64:79]
    v_mfma_f32_32x32x16_bf16 v[80:95], v[32:35], a[172:175], v[80:95]
    s_waitcnt lgkmcnt(1)
    v_mfma_f32_32x32x16_bf16 v[64:79], v[36:39], a[176:179], v[64:79]
    v_mfma_f32_32x32x16_bf16 v[80:95], v[36:39], a[180:183], v[80:95]
    s_waitcnt lgkmcnt(0)
    v_mfma_f32_32x32x16_bf16 v[64:79], v[40:43], a[184:187], v[64:79]
    v_mfma_f32_32x32x16_bf16 v[80:95], v[40:43], a[188:191], v[80:95]
    s_add_u32 s36, s36, 0x100000
    s_add_u32 s41, s41, 40960
    s_cmp_eq_u32 s41, 122880
    s_cselect_b32 s41, 0, s41
    s_add_u32 s40, s40, 1
    s_branch L_p1loop1
L_p1end1:
    s_nop 7
    s_nop 7
    s_sub_u32 s42, s36, 0x100000
    v_cvt_pk_bf16_f32 v44, v96, v97
    v_cvt_pk_bf16_f32 v45, v98, v99
    v_cvt_pk_bf16_f32 v46, v104, v105
    v_cvt_pk_bf16_f32 v47, v106, v107
    buffer_store_dwordx4 v[44:47], v26, s[16:19], s42 offen offset:0 sc1
    v_cvt_pk_bf16_f32 v48, v100, v101
    v_cvt_pk_bf16_f32 v49, v102, v103
    v_cvt_pk_bf16_f32 v50, v108, v109
    v_cvt_pk_bf16_f32 v51, v110, v111
    buffer_store_dwordx4 v[48:51], v26, s[16:19], s42 offen offset:512 sc1
    v_cvt_pk_bf16_f32 v52, v112, v113
    v_cvt_pk_bf16_f32 v53, v114, v115
    v_cvt_pk_bf16_f32 v54, v120, v121
    v_cvt_pk_bf16_f32 v55, v122, v123
    buffer_store_dwordx4 v[52:55], v26, s[16:19], s42 offen offset:2048 sc1
    v_cvt_pk_bf16_f32 v56, v116, v117
    v_cvt_pk_bf16_f32 v57, v118, v119
    v_cvt_pk_bf16_f32 v58, v124, v125
    v_cvt_pk_bf16_f32 v59, v126, v127
    buffer_store_dwordx4 v[56:59], v26, s[16:19], s42 offen offset:2560 sc1
L_p1fin:
    s_waitcnt vmcnt(0)
    v_mov_b32 v60, s40
    s_mov_b64 exec, 1
    buffer_store_dword v60, v27, s[16:19], s37 offen sc1
    s_mov_b64 exec, -1
    s_barrier
    s_cmp_ge_u32 s10, 20
    s_cbranch_scc1 L_arole
    v_mbcnt_lo_u32_b32 v79, -1, 0
    v_mbcnt_hi_u32_b32 v79, -1, v79
    v_and_b32 v70, 15, v79
    v_lshrrev_b32 v71, 4, v79
    v_bfe_u32 v72, v79, 2, 2
    v_and_b32 v73, 3, v79
    s_mov_b32 s20, s66
    s_mov_b32 s21, s67
    s_mov_b32 s22, 0x500000
    s_mov_b32 s23, 0x20000
    v_lshrrev_b32 v74, 2, v79
    v_mul_u32_u24 v74, 1280, v74
    v_lshl_add_u32 v0, v73, 4, v74
    s_lshl_b32 s24, s10, 6
    s_mul_i32 s25, s9, 1310720
    s_add_u32 s30, s24, s25
    s_lshl_b32 s31, s9, 15
    v_lshrrev_b32 v74, 1, v71
    v_lshl_add_u32 v74, v74, 2, v72
    v_lshlrev_b32 v74, 6, v74
    v_and_b32 v75, 1, v71
    v_lshl_add_u32 v74, v75, 5, v74
    v_lshl_add_u32 v74, v73, 3, v74
    v_add_u32 v1, s31, v74
    s_add_u32 m0, s31, 0
    s_add_u32 s28, s30, 0
    buffer_load_dwordx4 v0, s[20:23], s28 offen lds
    s_add_u32 m0, s31, 1024
    s_add_u32 s28, s30, 20480
    buffer_load_dwordx4 v0, s[20:23], s28 offen lds
    s_add_u32 m0, s31, 2048
    s_add_u32 s28, s30, 40960
    buffer_load_dwordx4 v0, s[20:23], s28 offen lds
    s_add_u32 m0, s31, 3072
    s_add_u32 s28, s30, 61440
    buffer_load_dwordx4 v0, s[20:23], s28 offen lds
    s_add_u32 m0, s31, 4096
    s_add_u32 s28, s30, 81920
    buffer_load_dwordx4 v0, s[20:23], s28 offen lds
    s_add_u32 m0, s31, 5120
    s_add_u32 s28, s30, 102400
    buffer_load_dwordx4 v0, s[20:23], s28 offen lds
    s_add_u32 m0, s31, 6144
    s_add_u32 s28, s30, 122880
    buffer_load_dwordx4 v0, s[20:23], s28 offen lds
    s_add_u32 m0, s31, 7168
    s_add_u32 s28, s30, 143360
    buffer_load_dwordx4 v0, s[20:23], s28 offen lds
    s_add_u32 m0, s31, 8192
    s_add_u32 s28, s30, 163840
    buffer_load_dwordx4 v0, s[20:23], s28 offen lds
    s_add_u32 m0, s31, 9216
    s_add_u32 s28, s30, 184320
    buffer_load_dwordx4 v0, s[20:23], s28 offen lds
    s_add_u32 m0, s31, 10240
    s_add_u32 s28, s30, 204800
    buffer_load_dwordx4 v0, s[20:23], s28 offen lds
    s_add_u32 m0, s31, 11264
    s_add_u32 s28, s30, 225280
    buffer_load_dwordx4 v0, s[20:23], s28 offen lds
    s_add_u32 m0, s31, 12288
    s_add_u32 s28, s30, 245760
    buffer_load_dwordx4 v0, s[20:23], s28 offen lds
    s_add_u32 m0, s31, 13312
    s_add_u32 s28, s30, 266240
    buffer_load_dwordx4 v0, s[20:23], s28 offen lds
    s_add_u32 m0, s31, 14336
    s_add_u32 s28, s30, 286720
    buffer_load_dwordx4 v0, s[20:23], s28 offen lds
    s_add_u32 m0, s31, 15360
    s_add_u32 s28, s30, 307200
    buffer_load_dwordx4 v0, s[20:23], s28 offen lds
    s_add_u32 m0, s31, 16384
    s_add_u32 s28, s30, 327680
    buffer_load_dwordx4 v0, s[20:23], s28 offen lds
    s_add_u32 m0, s31, 17408
    s_add_u32 s28, s30, 348160
    buffer_load_dwordx4 v0, s[20:23], s28 offen lds
    s_add_u32 m0, s31, 18432
    s_add_u32 s28, s30, 368640
    buffer_load_dwordx4 v0, s[20:23], s28 offen lds
    s_add_u32 m0, s31, 19456
    s_add_u32 s28, s30, 389120
    buffer_load_dwordx4 v0, s[20:23], s28 offen lds
    s_add_u32 m0, s31, 20480
    s_add_u32 s28, s30, 409600
    buffer_load_dwordx4 v0, s[20:23], s28 offen lds
    s_add_u32 m0, s31, 21504
    s_add_u32 s28, s30, 430080
    buffer_load_dwordx4 v0, s[20:23], s28 offen lds
    s_add_u32 m0, s31, 22528
    s_add_u32 s28, s30, 450560
    buffer_load_dwordx4 v0, s[20:23], s28 offen lds
    s_add_u32 m0, s31, 23552
    s_add_u32 s28, s30, 471040
    buffer_load_dwordx4 v0, s[20:23], s28 offen lds
    s_add_u32 m0, s31, 24576
    s_add_u32 s28, s30, 491520
    buffer_load_dwordx4 v0, s[20:23], s28 offen lds
    s_add_u32 m0, s31, 25600
    s_add_u32 s28, s30, 512000
    buffer_load_dwordx4 v0, s[20:23], s28 offen lds
    s_add_u32 m0, s31, 26624
    s_add_u32 s28, s30, 532480
    buffer_load_dwordx4 v0, s[20:23], s28 offen lds
    s_add_u32 m0, s31, 27648
    s_add_u32 s28, s30, 552960
    buffer_load_dwordx4 v0, s[20:23], s28 offen lds
    s_add_u32 m0, s31, 28672
    s_add_u32 s28, s30, 573440
    buffer_load_dwordx4 v0, s[20:23], s28 offen lds
    s_add_u32 m0, s31, 29696
    s_add_u32 s28, s30, 593920
    buffer_load_dwordx4 v0, s[20:23], s28 offen lds
    s_add_u32 m0, s31, 30720
    s_add_u32 s28, s30, 614400
    buffer_load_dwordx4 v0, s[20:23], s28 offen lds
    s_add_u32 m0, s31, 31744
    s_add_u32 s28, s30, 634880
    buffer_load_dwordx4 v0, s[20:23], s28 offen lds
    s_waitcnt vmcnt(24)
    ds_read_b64_tr_b16 a[0:1], v1 offset:0
    ds_read_b64_tr_b16 a[2:3], v1 offset:1024
    ds_read_b64_tr_b16 a[4:5], v1 offset:512
    ds_read_b64_tr_b16 a[6:7], v1 offset:1536
    ds_read_b64_tr_b16 a[8:9], v1 offset:2048
    ds_read_b64_tr_b16 a[10:11], v1 offset:3072
    ds_read_b64_tr_b16 a[12:13], v1 offset:2560
    ds_read_b64_tr_b16 a[14:15], v1 offset:3584
    ds_read_b64_tr_b16 a[16:17], v1 offset:4096
    ds_read_b64_tr_b16 a[18:19], v1 offset:5120
    ds_read_b64_tr_b16 a[20:21], v1 offset:4608
    ds_read_b64_tr_b16 a[22:23], v1 offset:5632
    ds_read_b64_tr_b16 a[24:25], v1 offset:6144
    ds_read_b64_tr_b16 a[26:27], v1 offset:7168
    ds_read_b64_tr_b16 a[28:29], v1 offset:6656
    ds_read_b64_tr_b16 a[30:31], v1 offset:7680
    s_waitcnt lgkmcnt(0)
    s_add_u32 m0, s31, 0
    s_add_u32 s28, s30, 655360
    buffer_load_dwordx4 v0, s[20:23], s28 offen lds
    s_add_u32 m0, s31, 1024
    s_add_u32 s28, s30, 675840
    buffer_load_dwordx4 v0, s[20:23], s28 offen lds
    s_add_u32 m0, s31, 2048
    s_add_u32 s28, s30, 696320
    buffer_load_dwordx4 v0, s[20:23], s28 offen lds
    s_add_u32 m0, s31, 3072
    s_add_u32 s28, s30, 716800
    buffer_load_dwordx4 v0, s[20:23], s28 offen lds
    s_add_u32 m0, s31, 4096
    s_add_u32 s28, s30, 737280
    buffer_load_dwordx4 v0, s[20:23], s28 offen lds
    s_add_u32 m0, s31, 5120
    s_add_u32 s28, s30, 757760
    buffer_load_dwordx4 v0, s[20:23], s28 offen lds
    s_add_u32 m0, s31, 6144
    s_add_u32 s28, s30, 778240
    buffer_load_dwordx4 v0, s[20:23], s28 offen lds
    s_add_u32 m0, s31, 7168
    s_add_u32 s28, s30, 798720
    buffer_load_dwordx4 v0, s[20:23], s28 offen lds
    s_waitcnt vmcnt(24)
    ds_read_b64_tr_b16 a[32:33], v1 offset:8192
    ds_read_b64_tr_b16 a[34:35], v1 offset:9216
    ds_read_b64_tr_b16 a[36:37], v1 offset:8704
    ds_read_b64_tr_b16 a[38:39], v1 offset:9728
    ds_read_b64_tr_b16 a[40:41], v1 offset:10240
    ds_read_b64_tr_b16 a[42:43], v1 offset:11264
    ds_read_b64_tr_b16 a[44:45], v1 offset:10752
    ds_read_b64_tr_b16 a[46:47], v1 offset:11776
    ds_read_b64_tr_b16 a[48:49], v1 offset:12288
    ds_read_b64_tr_b16 a[50:51], v1 offset:13312
    ds_read_b64_tr_b16 a[52:53], v1 offset:12800
    ds_read_b64_tr_b16 a[54:55], v1 offset:13824
    ds_read_b64_tr_b16 a[56:57], v1 offset:14336
    ds_read_b64_tr_b16 a[58:59], v1 offset:15360
    ds_read_b64_tr_b16 a[60:61], v1 offset:14848
    ds_read_b64_tr_b16 a[62:63], v1 offset:15872
    s_waitcnt lgkmcnt(0)
    s_add_u32 m0, s31, 8192
    s_add_u32 s28, s30, 819200
    buffer_load_dwordx4 v0, s[20:23], s28 offen lds
    s_add_u32 m0, s31, 9216
    s_add_u32 s28, s30, 839680
    buffer_load_dwordx4 v0, s[20:23], s28 offen lds
    s_add_u32 m0, s31, 10240
    s_add_u32 s28, s30, 860160
    buffer_load_dwordx4 v0, s[20:23], s28 offen lds
    s_add_u32 m0, s31, 11264
    s_add_u32 s28, s30, 880640
    buffer_load_dwordx4 v0, s[20:23], s28 offen lds
    s_add_u32 m0, s31, 12288
    s_add_u32 s28, s30, 901120
    buffer_load_dwordx4 v0, s[20:23], s28 offen lds
    s_add_u32 m0, s31, 13312
    s_add_u32 s28, s30, 921600
    buffer_load_dwordx4 v0, s[20:23], s28 offen lds
    s_add_u32 m0, s31, 14336
    s_add_u32 s28, s30, 942080
    buffer_load_dwordx4 v0, s[20:23], s28 offen lds
    s_add_u32 m0, s31, 15360
    s_add_u32 s28, s30, 962560
    buffer_load_dwordx4 v0, s[20:23], s28 offen lds
    s_waitcnt vmcnt(24)
    ds_read_b64_tr_b16 a[64:65], v1 offset:16384
    ds_read_b64_tr_b16 a[66:67], v1 offset:17408
    ds_read_b64_tr_b16 a[68:69], v1 offset:16896
    ds_read_b64_tr_b16 a[70:71], v1 offset:17920
    ds_read_b64_tr_b16 a[72:73], v1 offset:18432
    ds_read_b64_tr_b16 a[74:75], v1 offset:19456
    ds_read_b64_tr_b16 a[76:77], v1 offset:18944
    ds_read_b64_tr_b16 a[78:79], v1 offset:19968
    ds_read_b64_tr_b16 a[80:81], v1 offset:20480
    ds_read_b64_tr_b16 a[82:83], v1 offset:21504
    ds_read_b64_tr_b16 a[84:85], v1 offset:20992
    ds_read_b64_tr_b16 a[86:87], v1 offset:22016
    ds_read_b64_tr_b16 a[88:89], v1 offset:22528
    ds_read_b64_tr_b16 a[90:91], v1 offset:23552
    ds_read_b64_tr_b16 a[92:93], v1 offset:23040
    ds_read_b64_tr_b16 a[94:95], v1 offset:24064
    s_waitcnt lgkmcnt(0)
    s_add_u32 m0, s31, 16384
    s_add_u32 s28, s30, 983040
    buffer_load_dwordx4 v0, s[20:23], s28 offen lds
    s_add_u32 m0, s31, 17408
    s_add_u32 s28, s30, 1003520
    buffer_load_dwordx4 v0, s[20:23], s28 offen lds
    s_add_u32 m0, s31, 18432
    s_add_u32 s28, s30, 1024000
    buffer_load_dwordx4 v0, s[20:23], s28 offen lds
    s_add_u32 m0, s31, 19456
    s_add_u32 s28, s30, 1044480
    buffer_load_dwordx4 v0, s[20:23], s28 offen lds
    s_add_u32 m0, s31, 20480
    s_add_u32 s28, s30, 1064960
    buffer_load_dwordx4 v0, s[20:23], s28 offen lds
    s_add_u32 m0, s31, 21504
    s_add_u32 s28, s30, 1085440
    buffer_load_dwordx4 v0, s[20:23], s28 offen lds
    s_add_u32 m0, s31, 22528
    s_add_u32 s28, s30, 1105920
    buffer_load_dwordx4 v0, s[20:23], s28 offen lds
    s_add_u32 m0, s31, 23552
    s_add_u32 s28, s30, 1126400
    buffer_load_dwordx4 v0, s[20:23], s28 offen lds
    s_waitcnt vmcnt(24)
    ds_read_b64_tr_b16 a[96:97], v1 offset:24576
    ds_read_b64_tr_b16 a[98:99], v1 offset:25600
    ds_read_b64_tr_b16 a[100:101], v1 offset:25088
    ds_read_b64_tr_b16 a[102:103], v1 offset:26112
    ds_read_b64_tr_b16 a[104:105], v1 offset:26624
    ds_read_b64_tr_b16 a[106:107], v1 offset:27648
    ds_read_b64_tr_b16 a[108:109], v1 offset:27136
    ds_read_b64_tr_b16 a[110:111], v1 offset:28160
    ds_read_b64_tr_b16 a[112:113], v1 offset:28672
    ds_read_b64_tr_b16 a[114:115], v1 offset:29696
    ds_read_b64_tr_b16 a[116:117], v1 offset:29184
    ds_read_b64_tr_b16 a[118:119], v1 offset:30208
    ds_read_b64_tr_b16 a[120:121], v1 offset:30720
    ds_read_b64_tr_b16 a[122:123], v1 offset:31744
    ds_read_b64_tr_b16 a[124:125], v1 offset:31232
    ds_read_b64_tr_b16 a[126:127], v1 offset:32256
    s_waitcnt lgkmcnt(0)
    s_add_u32 m0, s31, 24576
    s_add_u32 s28, s30, 1146880
    buffer_load_dwordx4 v0, s[20:23], s28 offen lds
    s_add_u32 m0, s31, 25600
    s_add_u32 s28, s30, 1167360
    buffer_load_dwordx4 v0, s[20:23], s28 offen lds
    s_add_u32 m0, s31, 26624
    s_add_u32 s28, s30, 1187840
    buffer_load_dwordx4 v0, s[20:23], s28 offen lds
    s_add_u32 m0, s31, 27648
    s_add_u32 s28, s30, 1208320
    buffer_load_dwordx4 v0, s[20:23], s28 offen lds
    s_add_u32 m0, s31, 28672
    s_add_u32 s28, s30, 1228800
    buffer_load_dwordx4 v0, s[20:23], s28 offen lds
    s_add_u32 m0, s31, 29696
    s_add_u32 s28, s30, 1249280
    buffer_load_dwordx4 v0, s[20:23], s28 offen lds
    s_add_u32 m0, s31, 30720
    s_add_u32 s28, s30, 1269760
    buffer_load_dwordx4 v0, s[20:23], s28 offen lds
    s_add_u32 m0, s31, 31744
    s_add_u32 s28, s30, 1290240
    buffer_load_dwordx4 v0, s[20:23], s28 offen lds
    s_waitcnt vmcnt(24)
    ds_read_b64_tr_b16 a[128:129], v1 offset:0
    ds_read_b64_tr_b16 a[130:131], v1 offset:1024
    ds_read_b64_tr_b16 a[132:133], v1 offset:512
    ds_read_b64_tr_b16 a[134:135], v1 offset:1536
    ds_read_b64_tr_b16 a[136:137], v1 offset:2048
    ds_read_b64_tr_b16 a[138:139], v1 offset:3072
    ds_read_b64_tr_b16 a[140:141], v1 offset:2560
    ds_read_b64_tr_b16 a[142:143], v1 offset:3584
    ds_read_b64_tr_b16 a[144:145], v1 offset:4096
    ds_read_b64_tr_b16 a[146:147], v1 offset:5120
    ds_read_b64_tr_b16 a[148:149], v1 offset:4608
    ds_read_b64_tr_b16 a[150:151], v1 offset:5632
    ds_read_b64_tr_b16 a[152:153], v1 offset:6144
    ds_read_b64_tr_b16 a[154:155], v1 offset:7168
    ds_read_b64_tr_b16 a[156:157], v1 offset:6656
    ds_read_b64_tr_b16 a[158:159], v1 offset:7680
    s_waitcnt lgkmcnt(0)
    s_waitcnt vmcnt(16)
    ds_read_b64_tr_b16 a[160:161], v1 offset:8192
    ds_read_b64_tr_b16 a[162:163], v1 offset:9216
    ds_read_b64_tr_b16 a[164:165], v1 offset:8704
    ds_read_b64_tr_b16 a[166:167], v1 offset:9728
    ds_read_b64_tr_b16 a[168:169], v1 offset:10240
    ds_read_b64_tr_b16 a[170:171], v1 offset:11264
    ds_read_b64_tr_b16 a[172:173], v1 offset:10752
    ds_read_b64_tr_b16 a[174:175], v1 offset:11776
    ds_read_b64_tr_b16 a[176:177], v1 offset:12288
    ds_read_b64_tr_b16 a[178:179], v1 offset:13312
    ds_read_b64_tr_b16 a[180:181], v1 offset:12800
    ds_read_b64_tr_b16 a[182:183], v1 offset:13824
    ds_read_b64_tr_b16 a[184:185], v1 offset:14336
    ds_read_b64_tr_b16 a[186:187], v1 offset:15360
    ds_read_b64_tr_b16 a[188:189], v1 offset:14848
    ds_read_b64_tr_b16 a[190:191], v1 offset:15872
    s_waitcnt lgkmcnt(0)
    s_waitcnt vmcnt(8)
    ds_read_b64_tr_b16 a[192:193], v1 offset:16384
    ds_read_b64_tr_b16 a[194:195], v1 offset:17408
    ds_read_b64_tr_b16 a[196:197], v1 offset:16896
    ds_read_b64_tr_b16 a[198:199], v1 offset:17920
    ds_read_b64_tr_b16 a[200:201], v1 offset:18432
    ds_read_b64_tr_b16 a[202:203], v1 offset:19456
    ds_read_b64_tr_b16 a[204:205], v1 offset:18944
    ds_read_b64_tr_b16 a[206:207], v1 offset:19968
    ds_read_b64_tr_b16 a[208:209], v1 offset:20480
    ds_read_b64_tr_b16 a[210:211], v1 offset:21504
    ds_read_b64_tr_b16 a[212:213], v1 offset:20992
    ds_read_b64_tr_b16 a[214:215], v1 offset:22016
    ds_read_b64_tr_b16 a[216:217], v1 offset:22528
    ds_read_b64_tr_b16 a[218:219], v1 offset:23552
    ds_read_b64_tr_b16 a[220:221], v1 offset:23040
    ds_read_b64_tr_b16 a[222:223], v1 offset:24064
    s_waitcnt lgkmcnt(0)
    s_waitcnt vmcnt(0)
    ds_read_b64_tr_b16 a[224:225], v1 offset:24576
    ds_read_b64_tr_b16 a[226:227], v1 offset:25600
    ds_read_b64_tr_b16 a[228:229], v1 offset:25088
    ds_read_b64_tr_b16 a[230:231], v1 offset:26112
    ds_read_b64_tr_b16 a[232:233], v1 offset:26624
    ds_read_b64_tr_b16 a[234:235], v1 offset:27648
    ds_read_b64_tr_b16 a[236:237], v1 offset:27136
    ds_read_b64_tr_b16 a[238:239], v1 offset:28160
    ds_read_b64_tr_b16 a[240:241], v1 offset:28672
    ds_read_b64_tr_b16 a[242:243], v1 offset:29696
    ds_read_b64_tr_b16 a[244:245], v1 offset:29184
    ds_read_b64_tr_b16 a[246:247], v1 offset:30208
    ds_read_b64_tr_b16 a[248:249], v1 offset:30720
    ds_read_b64_tr_b16 a[250:251], v1 offset:31744
    ds_read_b64_tr_b16 a[252:253], v1 offset:31232
    ds_read_b64_tr_b16 a[254:255], v1 offset:32256
    s_waitcnt lgkmcnt(0)
    v_mov_b32 v17, 64
    s_mov_b32 s26, 200000
wa_6:
    buffer_load_dword v16, v17, s[12:15], 0 offen sc1
    s_waitcnt vmcnt(0)
    v_readfirstlane_b32 s24, v16
    s_sub_u32 s26, s26, 1
    s_cbranch_scc1 L_fail2
    s_cmp_lt_u32 s24, 256
    s_cbranch_scc1 wa_6
    s_barrier
    s_lshl_b32 s32, s10, 2
    s_add_u32 s32, s32, s9
    s_lshr_b32 s33, s32, 1
    s_and_b32 s34, s32, 1
    s_sub_u32 s35, s8, 2
    s_mov_b32 s36, 0
    v_lshlrev_b32 v0, 4, v79
    v_lshrrev_b32 v74, 1, v71
    v_lshlrev_b32 v74, 6, v74
    v_and_b32 v75, 1, v71
    v_lshl_add_u32 v74, v75, 5, v74
    v_add_u32 v74, v74, v70
    s_lshl_b32 s24, s34, 4
    v_add_u32 v74, s24, v74
    v_lshlrev_b32 v1, 4, v74
    v_add_u32 v2, s24, v70
    v_lshlrev_b32 v74, 2, v71
    v_sub_u32 v2, v2, v74
    s_lshl_b32 s24, s33, 4
    s_lshr_b32 s25, s33, 1
    s_add_u32 s25, s25, 32
    s_lshl_b32 s25, s25, 4
    v_mov_b32 v74, s24
    v_mov_b32 v75, s25
    v_and_b32 v77, 4, v79
    v_cmp_ne_u32 vcc, 0, v77
    v_lshlrev_b32 v76, 2, v73
    s_lshl_b32 s24, s33, 8
    v_cndmask_b32 v74, v74, v75, vcc
    v_add_u32 v3, v74, v76
    v_add_u32 v3, 3145728, v3
    s_add_u32 s24, s24, 3178496
    v_and_b32 v75, 1, v79
    v_lshlrev_b32 v75, 13, v75
    v_add_u32 v4, s24, v75
    v_cmp_gt_u32 s[40:41], 8, v79
    s_sub_u32 s24, s8, 2
    s_lshl_b32 s24, s24, 9
    s_add_u32 s24, s24, 3153920
    v_min_u32 v5, 39, v79
    v_lshlrev_b32 v5, 3, v5
    v_add_u32 v5, s24, v5
    s_lshl_b32 s24, s9, 12
    v_add_u32 v6, s24, v0
    s_lshl_b32 s24, s9, 10
    v_add_u32 v7, s24, v0
    v_and_b32 v74, 31, v79
    v_mul_u32_u24 v8, 2560, v74
    v_lshrrev_b32 v74, 5, v79
    v_lshl_add_u32 v8, v74, 3, v8
    s_lshl_b32 s24, s10, 6
    s_lshl_b32 s25, s9, 4
    s_add_u32 s24, s24, s25
    s_add_u32 s24, s24, 1280
    v_add_u32 v8, s24, v8
    v_mov_b32 v9, 0
    s_lshl_b32 s24, s9, 12
    s_add_u32 s24, s24, 32768
    v_mul_u32_u24 v74, 576, v71
    v_lshl_add_u32 v74, v70, 2, v74
    v_add_u32 v180, s24, v74
    v_lshrrev_b32 v74, 2, v70
    v_and_b32 v75, 1, v70
    v_lshl_add_u32 v74, v74, 1, v75
    v_mul_u32_u24 v74, 288, v74
    v_lshl_add_u32 v74, v71, 4, v74
    v_add_u32 v181, s24, v74
    s_mov_b32 s20, s70
    s_mov_b32 s21, s71
    s_mov_b32 s22, 0x500000
    s_mov_b32 s23, 0x20000
L_p3loop:
    s_cmp_ge_u32 s32, 64
    s_cbranch_scc1 L_p3flag
    s_and_b32 s24, s35, 3
    s_mul_i32 s24, s24, 768
    v_add_u32 v10, s24, v3
    s_lshr_b32 s39, s35, 2
    s_mov_b32 s26, 100000
p1w_7:
    buffer_load_dword v12, v10, s[16:19], 0 offen sc1
    s_waitcnt vmcnt(0)
    v_cmp_ge_u32 vcc, s39, v12
    s_cbranch_vccz p1wd_8
    v_readfirstlane_b32 s24, v12
    s_sub_u32 s26, s26, 1
    s_cbranch_scc1 L_fail2
    s_sleep 8
    s_branch p1w_7
p1wd_8:
    s_lshl_b32 s24, s35, 5
    s_add_u32 s24, s24, s33
    s_lshl_b32 s37, s24, 13
    s_lshl_b32 s38, s24, 12
    s_lshl_b32 s25, s34, 12
    s_add_u32 s24, s37, s25
    s_add_u32 s24, s24, 67108864
    s_nop 0
    buffer_load_dwordx4 v[16:19], v0, s[16:19], s24 offen offset:0 sc1
    buffer_load_dwordx4 v[20:23], v0, s[16:19], s24 offen offset:1024 sc1
    buffer_load_dwordx4 v[24:27], v0, s[16:19], s24 offen offset:2048 sc1
    buffer_load_dwordx4 v[28:31], v0, s[16:19], s24 offen offset:3072 sc1
    s_add_u32 s24, s37, 33554432
    buffer_load_dwordx4 v[32:35], v0, s[16:19], s24 offen offset:0 sc1
    buffer_load_dwordx4 v[36:39], v0, s[16:19], s24 offen offset:1024 sc1
    buffer_load_dwordx4 v[40:43], v0, s[16:19], s24 offen offset:2048 sc1
    buffer_load_dwordx4 v[44:47], v0, s[16:19], s24 offen offset:3072 sc1
    s_add_u32 s24, s37, 33558528
    buffer_load_dwordx4 v[48:51], v0, s[16:19], s24 offen offset:0 sc1
    buffer_load_dwordx4 v[52:55], v0, s[16:19], s24 offen offset:1024 sc1
    buffer_load_dwordx4 v[56:59], v0, s[16:19], s24 offen offset:2048 sc1
    buffer_load_dwordx4 v[60:63], v0, s[16:19], s24 offen offset:3072 sc1
    s_add_u32 s24, s37, 50331648
    buffer_load_dwordx4 v[80:83], v0, s[16:19], s24 offen offset:0 sc1
    buffer_load_dwordx4 v[84:87], v0, s[16:19], s24 offen offset:1024 sc1
    buffer_load_dwordx4 v[88:91], v0, s[16:19], s24 offen offset:2048 sc1
    buffer_load_dwordx4 v[92:95], v0, s[16:19], s24 offen offset:3072 sc1
    s_add_u32 s24, s37, 50335744
    buffer_load_dwordx4 v[96:99], v0, s[16:19], s24 offen offset:0 sc1
    buffer_load_dwordx4 v[100:103], v0, s[16:19], s24 offen offset:1024 sc1
    buffer_load_dwordx4 v[104:107], v0, s[16:19], s24 offen offset:2048 sc1
    buffer_load_dwordx4 v[108:111], v0, s[16:19], s24 offen offset:3072 sc1
    s_waitcnt vmcnt(8)
    v_mfma_f32_16x16x32_bf16 v[128:131], v[32:35], v[16:19], 0
    v_mfma_f32_16x16x32_bf16 v[132:135], v[48:51], v[16:19], 0
    v_mfma_f32_16x16x32_bf16 v[128:131], v[36:39], v[20:23], v[128:131]
    v_mfma_f32_16x16x32_bf16 v[132:135], v[52:55], v[20:23], v[132:135]
    v_mfma_f32_16x16x32_bf16 v[128:131], v[40:43], v[24:27], v[128:131]
    v_mfma_f32_16x16x32_bf16 v[132:135], v[56:59], v[24:27], v[132:135]
    v_mfma_f32_16x16x32_bf16 v[128:131], v[44:47], v[28:31], v[128:131]
    v_mfma_f32_16x16x32_bf16 v[132:135], v[60:63], v[28:31], v[132:135]
    v_mov_b32 v13, 0xff800000
    s_nop 7
    v_cmp_le_i32 vcc, 0, v2
    s_nop 1
    v_cndmask_b32 v128, v13, v128, vcc
    v_cmp_le_i32 vcc, 1, v2
    s_nop 1
    v_cndmask_b32 v129, v13, v129, vcc
    v_cmp_le_i32 vcc, 2, v2
    s_nop 1
    v_cndmask_b32 v130, v13, v130, vcc
    v_cmp_le_i32 vcc, 3, v2
    s_nop 1
    v_cndmask_b32 v131, v13, v131, vcc
    v_cmp_le_i32 vcc, 16, v2
    s_nop 1
    v_cndmask_b32 v132, v13, v132, vcc
    v_cmp_le_i32 vcc, 17, v2
    s_nop 1
    v_cndmask_b32 v133, v13, v133, vcc
    v_cmp_le_i32 vcc, 18, v2
    s_nop 1
    v_cndmask_b32 v134, v13, v134, vcc
    v_cmp_le_i32 vcc, 19, v2
    s_nop 1
    v_cndmask_b32 v135, v13, v135, vcc
    s_mov_b32 s26, 100000
recw_9:
    buffer_load_dword v12, v4, s[16:19], 0 offen sc1
    s_waitcnt vmcnt(0)
    v_cmp_ge_u32 vcc, s35, v12
    s_cbranch_vccz recwd_10
    v_readfirstlane_b32 s24, v12
    s_sub_u32 s26, s26, 1
    s_cbranch_scc1 L_fail2
    s_sleep 0
    s_add_u32 s24, s24, 0
    s_cmp_ge_u32 s24, s35
    s_cbranch_scc1 recw_9
    s_sleep 24
    s_branch recw_9
recwd_10:
    s_add_u32 s24, s38, 4194304
    s_add_u32 s25, s38, 12582912
    v_lshrrev_b32 v14, 1, v0
    buffer_load_dwordx2 v[64:65], v14, s[16:19], s24 offen offset:0 sc1
    buffer_load_dwordx2 v[68:69], v14, s[16:19], s24 offen offset:512 sc1
    buffer_load_dwordx2 v[72:73], v14, s[16:19], s24 offen offset:1024 sc1
    buffer_load_dwordx2 v[76:77], v14, s[16:19], s24 offen offset:1536 sc1
    buffer_load_dwordx2 v[112:113], v14, s[16:19], s25 offen offset:0 sc1
    buffer_load_dwordx2 v[114:115], v14, s[16:19], s25 offen offset:512 sc1
    buffer_load_dwordx2 v[116:117], v14, s[16:19], s25 offen offset:1024 sc1
    buffer_load_dwordx2 v[118:119], v14, s[16:19], s25 offen offset:1536 sc1
    s_waitcnt vmcnt(4)
    ds_write2_b32 v180, v64, v65 offset0:0 offset1:72
    ds_write2_b32 v180, v68, v69 offset0:16 offset1:88
    ds_write2_b32 v180, v72, v73 offset0:32 offset1:104
    ds_write2_b32 v180, v76, v77 offset0:48 offset1:120
    s_waitcnt lgkmcnt(0)
    ds_read_b128 v[64:67], v181 offset:0
    ds_read_b128 v[68:71], v181 offset:64
    ds_read_b128 v[72:75], v181 offset:128
    ds_read_b128 v[76:79], v181 offset:192
    s_waitcnt lgkmcnt(3)
    v_mfma_f32_16x16x32_bf16 v[136:139], v[64:67], v[16:19], 0
    s_waitcnt lgkmcnt(2)
    v_mfma_f32_16x16x32_bf16 v[136:139], v[68:71], v[20:23], v[136:139]
    s_waitcnt lgkmcnt(1)
    v_mfma_f32_16x16x32_bf16 v[136:139], v[72:75], v[24:27], v[136:139]
    s_waitcnt lgkmcnt(0)
    v_mfma_f32_16x16x32_bf16 v[136:139], v[76:79], v[28:31], v[136:139]
    s_mov_b32 s24, 0x3e0293ee
    s_nop 6
    v_max3_f32 v14, v128, v129, v130
    v_max3_f32 v15, v131, v132, v133
    v_max3_f32 v14, v14, v134, v135
    v_max3_f32 v15, v15, v136, v137
    v_max_f32 v14, v14, v15
    v_mov_b32 v15, v14
    s_nop 1
    v_permlane32_swap_b32 v14, v15
    v_max_f32 v14, v14, v15
    v_mov_b32 v15, v14
    s_nop 1
    v_permlane16_swap_b32 v14, v15
    v_max_f32 v14, v14, v15
    v_mul_f32 v14, s24, v14
    v_fma_f32 v128, v128, s24, -v14
    v_fma_f32 v129, v129, s24, -v14
    v_fma_f32 v130, v130, s24, -v14
    v_fma_f32 v131, v131, s24, -v14
    v_fma_f32 v132, v132, s24, -v14
    v_fma_f32 v133, v133, s24, -v14
    v_fma_f32 v134, v134, s24, -v14
    v_fma_f32 v135, v135, s24, -v14
    v_fma_f32 v136, v136, s24, -v14
    v_fma_f32 v137, v137, s24, -v14
    v_exp_f32 v128, v128
    v_exp_f32 v129, v129
    v_exp_f32 v130, v130
    v_exp_f32 v131, v131
    v_exp_f32 v132, v132
    v_exp_f32 v133, v133
    v_exp_f32 v134, v134
    v_exp_f32 v135, v135
    v_exp_f32 v136, v136
    v_exp_f32 v137, v137
    s_nop 0
    v_add_f32 v14, v128, v129
    v_add_f32 v14, v14, v130
    v_add_f32 v14, v14, v131
    v_add_f32 v14, v14, v132
    v_add_f32 v14, v14, v133
    v_add_f32 v14, v14, v134
    v_add_f32 v14, v14, v135
    v_add_f32 v14, v14, v136
    v_add_f32 v14, v14, v137
    v_mov_b32 v15, v14
    s_nop 1
    v_permlane32_swap_b32 v14, v15
    v_add_f32 v14, v14, v15
    v_mov_b32 v15, v14
    s_nop 1
    v_permlane16_swap_b32 v14, v15
    v_add_f32 v14, v14, v15
    v_rcp_f32 v14, v14
    s_nop 0
    v_mul_f32 v128, v128, v14
    v_mul_f32 v129, v129, v14
    v_mul_f32 v130, v130, v14
    v_mul_f32 v131, v131, v14
    v_mul_f32 v132, v132, v14
    v_mul_f32 v133, v133, v14
    v_mul_f32 v134, v134, v14
    v_mul_f32 v135, v135, v14
    v_mul_f32 v136, v136, v14
    v_mul_f32 v137, v137, v14
    v_cvt_pk_bf16_f32 v140, v128, v129
    v_cvt_pk_bf16_f32 v141, v130, v131
    v_cvt_pk_bf16_f32 v142, v132, v133
    v_cvt_pk_bf16_f32 v143, v134, v135
    v_cvt_pk_bf16_f32 v144, v136, v137
    v_mov_b32 v145, 0
    v_mov_b32 v146, 0
    v_mov_b32 v147, v144
    s_waitcnt vmcnt(0)
    s_nop 0
    v_mfma_f32_16x16x32_bf16 v[148:151], v[80:83], v[140:143], 0
    v_mfma_f32_16x16x32_bf16 v[152:155], v[84:87], v[140:143], 0
    v_mfma_f32_16x16x32_bf16 v[156:159], v[88:91], v[140:143], 0
    v_mfma_f32_16x16x32_bf16 v[160:163], v[92:95], v[140:143], 0
    v_mfma_f32_16x16x32_bf16 v[164:167], v[96:99], v[140:143], 0
    v_mfma_f32_16x16x32_bf16 v[168:171], v[100:103], v[140:143], 0
    v_mfma_f32_16x16x32_bf16 v[172:175], v[104:107], v[140:143], 0
    v_mfma_f32_16x16x32_bf16 v[176:179], v[108:111], v[140:143], 0
    v_mfma_f32_16x16x16_bf16 v[148:151], v[112:113], v[144:145], v[148:151]
    v_mfma_f32_16x16x16_bf16 v[152:155], v[112:113], v[146:147], v[152:155]
    v_mfma_f32_16x16x16_bf16 v[156:159], v[114:115], v[144:145], v[156:159]
    v_mfma_f32_16x16x16_bf16 v[160:163], v[114:115], v[146:147], v[160:163]
    v_mfma_f32_16x16x16_bf16 v[164:167], v[116:117], v[144:145], v[164:167]
    v_mfma_f32_16x16x16_bf16 v[168:171], v[116:117], v[146:147], v[168:171]
    v_mfma_f32_16x16x16_bf16 v[172:175], v[118:119], v[144:145], v[172:175]
    v_mfma_f32_16x16x16_bf16 v[176:179], v[118:119], v[146:147], v[176:179]
    s_and_b32 s24, s36, 1
    s_lshl_b32 s24, s24, 3
    s_add_u32 s24, s24, s8
    s_lshl_b32 s24, s24, 5
    s_add_u32 s24, s24, s33
    s_lshl_b32 s37, s24, 13
    s_add_u32 s24, s37, 83886080
    s_add_u32 s25, s24, 4096
    s_nop 5
    v_cvt_pk_bf16_f32 v16, v148, v149
    v_cvt_pk_bf16_f32 v17, v150, v151
    v_cvt_pk_bf16_f32 v18, v152, v153
    v_cvt_pk_bf16_f32 v19, v154, v155
    buffer_store_dwordx4 v[16:19], v1, s[16:19], s24 offen offset:0
    v_cvt_pk_bf16_f32 v20, v156, v157
    v_cvt_pk_bf16_f32 v21, v158, v159
    v_cvt_pk_bf16_f32 v22, v160, v161
    v_cvt_pk_bf16_f32 v23, v162, v163
    buffer_store_dwordx4 v[20:23], v1, s[16:19], s24 offen offset:2048
    v_cvt_pk_bf16_f32 v24, v164, v165
    v_cvt_pk_bf16_f32 v25, v166, v167
    v_cvt_pk_bf16_f32 v26, v168, v169
    v_cvt_pk_bf16_f32 v27, v170, v171
    buffer_store_dwordx4 v[24:27], v1, s[16:19], s25 offen offset:0
    v_cvt_pk_bf16_f32 v28, v172, v173
    v_cvt_pk_bf16_f32 v29, v174, v175
    v_cvt_pk_bf16_f32 v30, v176, v177
    v_cvt_pk_bf16_f32 v31, v178, v179
    buffer_store_dwordx4 v[28:31], v1, s[16:19], s25 offen offset:2048
L_p3flag:
    s_add_u32 s24, s36, 1
    v_mov_b32 v12, s24
    s_waitcnt vmcnt(0)
    s_mov_b64 exec, 1
    buffer_store_dword v12, v9, s[16:19], s11 offen
    s_mov_b64 exec, -1
L_p4:
    s_mov_b32 s26, 2000000
L_p4w:
    buffer_load_dwordx2 v[12:13], v5, s[16:19], 0 offen sc1
    s_waitcnt vmcnt(0)
    v_min_u32 v12, v12, v13
    v_cmp_ge_u32 vcc, s36, v12
    s_cbranch_vccz L_p4go
    s_sub_u32 s26, s26, 1
    s_cbranch_scc1 L_fail2
    s_sleep 2
    s_branch L_p4w
L_p4go:
    s_and_b32 s24, s36, 1
    s_lshl_b32 s24, s24, 3
    s_add_u32 s24, s24, s8
    s_lshl_b32 s24, s24, 18
    s_lshl_b32 s25, s9, 16
    s_add_u32 s24, s24, s25
    s_add_u32 s24, s24, 83886080
    buffer_load_dwordx4 v[16:19], v0, s[16:19], s24 offen offset:0 sc1
    buffer_load_dwordx4 v[20:23], v0, s[16:19], s24 offen offset:1024 sc1
    buffer_load_dwordx4 v[24:27], v0, s[16:19], s24 offen offset:2048 sc1
    buffer_load_dwordx4 v[28:31], v0, s[16:19], s24 offen offset:3072 sc1
    s_add_u32 s24, s24, 4096
    buffer_load_dwordx4 v[32:35], v0, s[16:19], s24 offen offset:0 sc1
    buffer_load_dwordx4 v[36:39], v0, s[16:19], s24 offen offset:1024 sc1
    buffer_load_dwordx4 v[40:43], v0, s[16:19], s24 offen offset:2048 sc1
    buffer_load_dwordx4 v[44:47], v0, s[16:19], s24 offen offset:3072 sc1
    s_add_u32 s24, s24, 4096
    buffer_load_dwordx4 v[48:51], v0, s[16:19], s24 offen offset:0 sc1
    buffer_load_dwordx4 v[52:55], v0, s[16:19], s24 offen offset:1024 sc1
    buffer_load_dwordx4 v[56:59], v0, s[16:19], s24 offen offset:2048 sc1
    buffer_load_dwordx4 v[60:63], v0, s[16:19], s24 offen offset:3072 sc1
    s_add_u32 s24, s24, 4096
    buffer_load_dwordx4 v[64:67], v0, s[16:19], s24 offen offset:0 sc1
    buffer_load_dwordx4 v[68:71], v0, s[16:19], s24 offen offset:1024 sc1
    buffer_load_dwordx4 v[72:75], v0, s[16:19], s24 offen offset:2048 sc1
    buffer_load_dwordx4 v[76:79], v0, s[16:19], s24 offen offset:3072 sc1
    s_add_u32 s24, s24, 4096
    buffer_load_dwordx4 v[80:83], v0, s[16:19], s24 offen offset:0 sc1
    buffer_load_dwordx4 v[84:87], v0, s[16:19], s24 offen offset:1024 sc1
    buffer_load_dwordx4 v[88:91], v0, s[16:19], s24 offen offset:2048 sc1
    buffer_load_dwordx4 v[92:95], v0, s[16:19], s24 offen offset:3072 sc1
    s_add_u32 s24, s24, 4096
    buffer_load_dwordx4 v[96:99], v0, s[16:19], s24 offen offset:0 sc1
    buffer_load_dwordx4 v[100:103], v0, s[16:19], s24 offen offset:1024 sc1
    buffer_load_dwordx4 v[104:107], v0, s[16:19], s24 offen offset:2048 sc1
    buffer_load_dwordx4 v[108:111], v0, s[16:19], s24 offen offset:3072 sc1
    s_waitcnt vmcnt(23)
    v_mfma_f32_32x32x16_bf16 v[128:143], a[0:3], v[16:19], 0
    s_waitcnt vmcnt(22)
    v_mfma_f32_32x32x16_bf16 v[128:143], a[4:7], v[20:23], v[128:143]
    s_add_u32 s24, s24, 4096
    buffer_load_dwordx4 v[16:19], v0, s[16:19], s24 offen offset:0 sc1
    s_waitcnt vmcnt(22)
    v_mfma_f32_32x32x16_bf16 v[128:143], a[8:11], v[24:27], v[128:143]
    buffer_load_dwordx4 v[20:23], v0, s[16:19], s24 offen offset:1024 sc1
    s_waitcnt vmcnt(22)
    v_mfma_f32_32x32x16_bf16 v[128:143], a[12:15], v[28:31], v[128:143]
    buffer_load_dwordx4 v[24:27], v0, s[16:19], s24 offen offset:2048 sc1
    s_waitcnt vmcnt(22)
    v_mfma_f32_32x32x16_bf16 v[128:143], a[16:19], v[32:35], v[128:143]
    buffer_load_dwordx4 v[28:31], v0, s[16:19], s24 offen offset:3072 sc1
    s_waitcnt vmcnt(22)
    v_mfma_f32_32x32x16_bf16 v[128:143], a[20:23], v[36:39], v[128:143]
    s_add_u32 s24, s24, 4096
    buffer_load_dwordx4 v[32:35], v0, s[16:19], s24 offen offset:0 sc1
    s_waitcnt vmcnt(22)
    v_mfma_f32_32x32x16_bf16 v[128:143], a[24:27], v[40:43], v[128:143]
    buffer_load_dwordx4 v[36:39], v0, s[16:19], s24 offen offset:1024 sc1
    s_waitcnt vmcnt(22)
    v_mfma_f32_32x32x16_bf16 v[128:143], a[28:31], v[44:47], v[128:143]
    buffer_load_dwordx4 v[40:43], v0, s[16:19], s24 offen offset:2048 sc1
    s_waitcnt vmcnt(22)
    v_mfma_f32_32x32x16_bf16 v[128:143], a[32:35], v[48:51], v[128:143]
    buffer_load_dwordx4 v[44:47], v0, s[16:19], s24 offen offset:3072 sc1
    s_waitcnt vmcnt(22)
    v_mfma_f32_32x32x16_bf16 v[128:143], a[36:39], v[52:55], v[128:143]
    s_add_u32 s24, s24, 4096
    buffer_load_dwordx4 v[48:51], v0, s[16:19], s24 offen offset:0 sc1
    s_waitcnt vmcnt(22)
    v_mfma_f32_32x32x16_bf16 v[128:143], a[40:43], v[56:59], v[128:143]
    buffer_load_dwordx4 v[52:55], v0, s[16:19], s24 offen offset:1024 sc1
    s_waitcnt vmcnt(22)
    v_mfma_f32_32x32x16_bf16 v[128:143], a[44:47], v[60:63], v[128:143]
    buffer_load_dwordx4 v[56:59], v0, s[16:19], s24 offen offset:2048 sc1
    s_waitcnt vmcnt(22)
    v_mfma_f32_32x32x16_bf16 v[128:143], a[48:51], v[64:67], v[128:143]
    buffer_load_dwordx4 v[60:63], v0, s[16:19], s24 offen offset:3072 sc1
    s_waitcnt vmcnt(22)
    v_mfma_f32_32x32x16_bf16 v[128:143], a[52:55], v[68:71], v[128:143]
    s_add_u32 s24, s24, 4096
    buffer_load_dwordx4 v[64:67], v0, s[16:19], s24 offen offset:0 sc1
    s_waitcnt vmcnt(22)
    v_mfma_f32_32x32x16_bf16 v[128:143], a[56:59], v[72:75], v[128:143]
    buffer_load_dwordx4 v[68:71], v0, s[16:19], s24 offen offset:1024 sc1
    s_waitcnt vmcnt(22)
    v_mfma_f32_32x32x16_bf16 v[128:143], a[60:63], v[76:79], v[128:143]
    buffer_load_dwordx4 v[72:75], v0, s[16:19], s24 offen offset:2048 sc1
    s_waitcnt vmcnt(22)
    v_mfma_f32_32x32x16_bf16 v[128:143], a[64:67], v[80:83], v[128:143]
    buffer_load_dwordx4 v[76:79], v0, s[16:19], s24 offen offset:3072 sc1
    s_waitcnt vmcnt(22)
    v_mfma_f32_32x32x16_bf16 v[128:143], a[68:71], v[84:87], v[128:143]
    s_add_u32 s24, s24, 4096
    buffer_load_dwordx4 v[80:83], v0, s[16:19], s24 offen offset:0 sc1
    s_waitcnt vmcnt(22)
    v_mfma_f32_32x32x16_bf16 v[128:143], a[72:75], v[88:91], v[128:143]
    buffer_load_dwordx4 v[84:87], v0, s[16:19], s24 offen offset:1024 sc1
    s_waitcnt vmcnt(22)
    v_mfma_f32_32x32x16_bf16 v[128:143], a[76:79], v[92:95], v[128:143]
    buffer_load_dwordx4 v[88:91], v0, s[16:19], s24 offen offset:2048 sc1
    s_waitcnt vmcnt(22)
    v_mfma_f32_32x32x16_bf16 v[128:143], a[80:83], v[96:99], v[128:143]
    buffer_load_dwordx4 v[92:95], v0, s[16:19], s24 offen offset:3072 sc1
    s_waitcnt vmcnt(22)
    v_mfma_f32_32x32x16_bf16 v[128:143], a[84:87], v[100:103], v[128:143]
    s_add_u32 s24, s24, 4096
    buffer_load_dwordx4 v[96:99], v0, s[16:19], s24 offen offset:0 sc1
    s_waitcnt vmcnt(22)
    v_mfma_f32_32x32x16_bf16 v[128:143], a[88:91], v[104:107], v[128:143]
    buffer_load_dwordx4 v[100:103], v0, s[16:19], s24 offen offset:1024 sc1
    s_waitcnt vmcnt(22)
    v_mfma_f32_32x32x16_bf16 v[128:143], a[92:95], v[108:111], v[128:143]
    buffer_load_dwordx4 v[104:107], v0, s[16:19], s24 offen offset:2048 sc1
    s_waitcnt vmcnt(22)
    v_mfma_f32_32x32x16_bf16 v[128:143], a[96:99], v[16:19], v[128:143]
    buffer_load_dwordx4 v[108:111], v0, s[16:19], s24 offen offset:3072 sc1
    s_waitcnt vmcnt(22)
    v_mfma_f32_32x32x16_bf16 v[128:143], a[100:103], v[20:23], v[128:143]
    s_add_u32 s24, s24, 4096
    buffer_load_dwordx4 v[16:19], v0, s[16:19], s24 offen offset:0 sc1
    s_waitcnt vmcnt(22)
    v_mfma_f32_32x32x16_bf16 v[128:143], a[104:107], v[24:27], v[128:143]
    buffer_load_dwordx4 v[20:23], v0, s[16:19], s24 offen offset:1024 sc1
    s_waitcnt vmcnt(22)
    v_mfma_f32_32x32x16_bf16 v[128:143], a[108:111], v[28:31], v[128:143]
    buffer_load_dwordx4 v[24:27], v0, s[16:19], s24 offen offset:2048 sc1
    s_waitcnt vmcnt(22)
    v_mfma_f32_32x32x16_bf16 v[128:143], a[112:115], v[32:35], v[128:143]
    buffer_load_dwordx4 v[28:31], v0, s[16:19], s24 offen offset:3072 sc1
    s_waitcnt vmcnt(22)
    v_mfma_f32_32x32x16_bf16 v[128:143], a[116:119], v[36:39], v[128:143]
    s_add_u32 s24, s24, 4096
    buffer_load_dwordx4 v[32:35], v0, s[16:19], s24 offen offset:0 sc1
    s_waitcnt vmcnt(22)
    v_mfma_f32_32x32x16_bf16 v[128:143], a[120:123], v[40:43], v[128:143]
    buffer_load_dwordx4 v[36:39], v0, s[16:19], s24 offen offset:1024 sc1
    s_waitcnt vmcnt(22)
    v_mfma_f32_32x32x16_bf16 v[128:143], a[124:127], v[44:47], v[128:143]
    buffer_load_dwordx4 v[40:43], v0, s[16:19], s24 offen offset:2048 sc1
    s_waitcnt vmcnt(22)
    v_mfma_f32_32x32x16_bf16 v[128:143], a[128:131], v[48:51], v[128:143]
    buffer_load_dwordx4 v[44:47], v0, s[16:19], s24 offen offset:3072 sc1
    s_waitcnt vmcnt(22)
    v_mfma_f32_32x32x16_bf16 v[128:143], a[132:135], v[52:55], v[128:143]
    s_add_u32 s24, s24, 4096
    buffer_load_dwordx4 v[48:51], v0, s[16:19], s24 offen offset:0 sc1
    s_waitcnt vmcnt(22)
    v_mfma_f32_32x32x16_bf16 v[128:143], a[136:139], v[56:59], v[128:143]
    buffer_load_dwordx4 v[52:55], v0, s[16:19], s24 offen offset:1024 sc1
    s_waitcnt vmcnt(22)
    v_mfma_f32_32x32x16_bf16 v[128:143], a[140:143], v[60:63], v[128:143]
    buffer_load_dwordx4 v[56:59], v0, s[16:19], s24 offen offset:2048 sc1
    s_waitcnt vmcnt(22)
    v_mfma_f32_32x32x16_bf16 v[128:143], a[144:147], v[64:67], v[128:143]
    buffer_load_dwordx4 v[60:63], v0, s[16:19], s24 offen offset:3072 sc1
    s_waitcnt vmcnt(22)
    v_mfma_f32_32x32x16_bf16 v[128:143], a[148:151], v[68:71], v[128:143]
    s_add_u32 s24, s24, 4096
    buffer_load_dwordx4 v[64:67], v0, s[16:19], s24 offen offset:0 sc1
    s_waitcnt vmcnt(22)
    v_mfma_f32_32x32x16_bf16 v[128:143], a[152:155], v[72:75], v[128:143]
    buffer_load_dwordx4 v[68:71], v0, s[16:19], s24 offen offset:1024 sc1
    s_waitcnt vmcnt(22)
    v_mfma_f32_32x32x16_bf16 v[128:143], a[156:159], v[76:79], v[128:143]
    buffer_load_dwordx4 v[72:75], v0, s[16:19], s24 offen offset:2048 sc1
    s_waitcnt vmcnt(22)
    v_mfma_f32_32x32x16_bf16 v[128:143], a[160:163], v[80:83], v[128:143]
    buffer_load_dwordx4 v[76:79], v0, s[16:19], s24 offen offset:3072 sc1
    s_waitcnt vmcnt(22)
    v_mfma_f32_32x32x16_bf16 v[128:143], a[164:167], v[84:87], v[128:143]
    s_waitcnt vmcnt(21)
    v_mfma_f32_32x32x16_bf16 v[128:143], a[168:171], v[88:91], v[128:143]
    s_waitcnt vmcnt(20)
    v_mfma_f32_32x32x16_bf16 v[128:143], a[172:175], v[92:95], v[128:143]
    s_waitcnt vmcnt(19)
    v_mfma_f32_32x32x16_bf16 v[128:143], a[176:179], v[96:99], v[128:143]
    s_waitcnt vmcnt(18)
    v_mfma_f32_32x32x16_bf16 v[128:143], a[180:183], v[100:103], v[128:143]
    s_waitcnt vmcnt(17)
    v_mfma_f32_32x32x16_bf16 v[128:143], a[184:187], v[104:107], v[128:143]
    s_waitcnt vmcnt(16)
    v_mfma_f32_32x32x16_bf16 v[128:143], a[188:191], v[108:111], v[128:143]
    s_waitcnt vmcnt(15)
    v_mfma_f32_32x32x16_bf16 v[128:143], a[192:195], v[16:19], v[128:143]
    s_waitcnt vmcnt(14)
    v_mfma_f32_32x32x16_bf16 v[128:143], a[196:199], v[20:23], v[128:143]
    s_waitcnt vmcnt(13)
    v_mfma_f32_32x32x16_bf16 v[128:143], a[200:203], v[24:27], v[128:143]
    s_waitcnt vmcnt(12)
    v_mfma_f32_32x32x16_bf16 v[128:143], a[204:207], v[28:31], v[128:143]
    s_waitcnt vmcnt(11)
    v_mfma_f32_32x32x16_bf16 v[128:143], a[208:211], v[32:35], v[128:143]
    s_waitcnt vmcnt(10)
    v_mfma_f32_32x32x16_bf16 v[128:143], a[212:215], v[36:39], v[128:143]
    s_waitcnt vmcnt(9)
    v_mfma_f32_32x32x16_bf16 v[128:143], a[216:219], v[40:43], v[128:143]
    s_waitcnt vmcnt(8)
    v_mfma_f32_32x32x16_bf16 v[128:143], a[220:223], v[44:47], v[128:143]
    s_waitcnt vmcnt(7)
    v_mfma_f32_32x32x16_bf16 v[128:143], a[224:227], v[48:51], v[128:143]
    s_waitcnt vmcnt(6)
    v_mfma_f32_32x32x16_bf16 v[128:143], a[228:231], v[52:55], v[128:143]
    s_waitcnt vmcnt(5)
    v_mfma_f32_32x32x16_bf16 v[128:143], a[232:235], v[56:59], v[128:143]
    s_waitcnt vmcnt(4)
    v_mfma_f32_32x32x16_bf16 v[128:143], a[236:239], v[60:63], v[128:143]
    s_waitcnt vmcnt(3)
    v_mfma_f32_32x32x16_bf16 v[128:143], a[240:243], v[64:67], v[128:143]
    s_waitcnt vmcnt(2)
    v_mfma_f32_32x32x16_bf16 v[128:143], a[244:247], v[68:71], v[128:143]
    s_waitcnt vmcnt(1)
    v_mfma_f32_32x32x16_bf16 v[128:143], a[248:251], v[72:75], v[128:143]
    s_waitcnt vmcnt(0)
    v_mfma_f32_32x32x16_bf16 v[128:143], a[252:255], v[76:79], v[128:143]
    s_and_b32 s24, s36, 1
    s_lshl_b32 s24, s24, 14
    v_add_u32 v10, s24, v6
    v_add_u32 v11, s24, v7
    s_nop 7
    s_nop 1
    ds_write_b128 v10, v[128:131] offset:0
    ds_write_b128 v10, v[132:135] offset:1024
    ds_write_b128 v10, v[136:139] offset:2048
    ds_write_b128 v10, v[140:143] offset:3072
    s_waitcnt lgkmcnt(0)
    s_barrier
    ds_read_b128 v[16:19], v11 offset:0
    ds_read_b128 v[20:23], v11 offset:4096
    ds_read_b128 v[24:27], v11 offset:8192
    ds_read_b128 v[28:31], v11 offset:12288
    s_mul_i32 s24, s35, 81920
    s_waitcnt lgkmcnt(0)
    v_pk_add_f32 v[16:17], v[16:17], v[20:21]
    v_pk_add_f32 v[18:19], v[18:19], v[22:23]
    v_pk_add_f32 v[24:25], v[24:25], v[28:29]
    v_pk_add_f32 v[26:27], v[26:27], v[30:31]
    v_pk_add_f32 v[16:17], v[16:17], v[24:25]
    v_pk_add_f32 v[18:19], v[18:19], v[26:27]
    v_cvt_pk_bf16_f32 v16, v16, v17
    v_cvt_pk_bf16_f32 v17, v18, v19
    buffer_store_dwordx2 v[16:17], v8, s[20:23], s24 offen sc1
    s_add_u32 s35, s35, 6
    s_add_u32 s36, s36, 1
    s_cmp_lt_u32 s35, 64
    s_cbranch_scc1 L_p3loop
    s_waitcnt vmcnt(0)
    s_endpgm
L_arole:
    s_sub_u32 s24, s8, 2
    s_mul_i32 s24, s24, 12
    s_add_u32 s30, s24, s10
    s_sub_u32 s30, s30, 20
    s_cmp_ge_u32 s30, 64
    s_cbranch_scc1 L_end2
    s_lshr_b32 s31, s30, 2
    s_and_b32 s32, s30, 3
    s_add_u32 s11, s11, 8192
    v_mbcnt_lo_u32_b32 v31, -1, 0
    v_mbcnt_hi_u32_b32 v31, -1, v31
    v_and_b32 v30, 15, v31
    v_lshrrev_b32 v29, 4, v31
    v_bfe_u32 v28, v31, 2, 2
    v_and_b32 v27, 3, v31
    v_lshlrev_b32 v26, 4, v31
    v_mov_b32 v25, 0
    s_mul_i32 s24, s9, 448
    s_add_u32 s24, s24, 0
    v_add_u32 v8, s24, v31
    v_mul_u32_u24 v9, 0xcccd, v8
    v_lshrrev_b32 v9, 19, v9
    v_mul_u32_u24 v10, 10, v9
    v_sub_u32 v10, v8, v10
    v_lshlrev_b32 v10, 4, v10
    s_movk_i32 s25, 3840
    v_mad_u32_u24 v10, v9, s25, v10
    v_cmp_gt_u32 vcc, 1600, v8
    v_mov_b32 v9, 0x40000000
    v_cndmask_b32 v0, v9, v10, vcc
    s_mul_i32 s24, s9, 448
    s_add_u32 s24, s24, 64
    v_add_u32 v8, s24, v31
    v_mul_u32_u24 v9, 0xcccd, v8
    v_lshrrev_b32 v9, 19, v9
    v_mul_u32_u24 v10, 10, v9
    v_sub_u32 v10, v8, v10
    v_lshlrev_b32 v10, 4, v10
    s_movk_i32 s25, 3840
    v_mad_u32_u24 v10, v9, s25, v10
    v_cmp_gt_u32 vcc, 1600, v8
    v_mov_b32 v9, 0x40000000
    v_cndmask_b32 v1, v9, v10, vcc
    s_mul_i32 s24, s9, 448
    s_add_u32 s24, s24, 128
    v_add_u32 v8, s24, v31
    v_mul_u32_u24 v9, 0xcccd, v8
    v_lshrrev_b32 v9, 19, v9
    v_mul_u32_u24 v10, 10, v9
    v_sub_u32 v10, v8, v10
    v_lshlrev_b32 v10, 4, v10
    s_movk_i32 s25, 3840
    v_mad_u32_u24 v10, v9, s25, v10
    v_cmp_gt_u32 vcc, 1600, v8
    v_mov_b32 v9, 0x40000000
    v_cndmask_b32 v2, v9, v10, vcc
    s_mul_i32 s24, s9, 448
    s_add_u32 s24, s24, 192
    v_add_u32 v8, s24, v31
    v_mul_u32_u24 v9, 0xcccd, v8
    v_lshrrev_b32 v9, 19, v9
    v_mul_u32_u24 v10, 10, v9
    v_sub_u32 v10, v8, v10
    v_lshlrev_b32 v10, 4, v10
    s_movk_i32 s25, 3840
    v_mad_u32_u24 v10, v9, s25, v10
    v_cmp_gt_u32 vcc, 1600, v8
    v_mov_b32 v9, 0x40000000
    v_cndmask_b32 v3, v9, v10, vcc
    s_mul_i32 s24, s9, 448
    s_add_u32 s24, s24, 256
    v_add_u32 v8, s24, v31
    v_mul_u32_u24 v9, 0xcccd, v8
    v_lshrrev_b32 v9, 19, v9
    v_mul_u32_u24 v10, 10, v9
    v_sub_u32 v10, v8, v10
    v_lshlrev_b32 v10, 4, v10
    s_movk_i32 s25, 3840
    v_mad_u32_u24 v10, v9, s25, v10
    v_cmp_gt_u32 vcc, 1600, v8
    v_mov_b32 v9, 0x40000000
    v_cndmask_b32 v4, v9, v10, vcc
    s_mul_i32 s24, s9, 448
    s_add_u32 s24, s24, 320
    v_add_u32 v8, s24, v31
    v_mul_u32_u24 v9, 0xcccd, v8
    v_lshrrev_b32 v9, 19, v9
    v_mul_u32_u24 v10, 10, v9
    v_sub_u32 v10, v8, v10
    v_lshlrev_b32 v10, 4, v10
    s_movk_i32 s25, 3840
    v_mad_u32_u24 v10, v9, s25, v10
    v_cmp_gt_u32 vcc, 1600, v8
    v_mov_b32 v9, 0x40000000
    v_cndmask_b32 v5, v9, v10, vcc
    s_mul_i32 s24, s9, 448
    s_add_u32 s24, s24, 384
    v_add_u32 v8, s24, v31
    v_mul_u32_u24 v9, 0xcccd, v8
    v_lshrrev_b32 v9, 19, v9
    v_mul_u32_u24 v10, 10, v9
    v_sub_u32 v10, v8, v10
    v_lshlrev_b32 v10, 4, v10
    s_movk_i32 s25, 3840
    v_mad_u32_u24 v10, v9, s25, v10
    v_cmp_gt_u32 vcc, 1600, v8
    v_mov_b32 v9, 0x40000000
    v_cndmask_b32 v6, v9, v10, vcc
    s_mov_b32 s20, s50
    s_mov_b32 s21, s51
    s_mov_b32 s22, 0x258000
    s_mov_b32 s23, 0x20000
    s_mul_i32 s33, s32, 320
    s_add_u32 s28, s33, 1280
    s_mul_i32 s24, s9, 7168
    s_add_u32 m0, s24, 0
    s_nop 0
    buffer_load_dwordx4 v0, s[20:23], s28 offen lds
    s_add_u32 m0, s24, 1024
    s_nop 0
    buffer_load_dwordx4 v1, s[20:23], s28 offen lds
    s_add_u32 m0, s24, 2048
    s_nop 0
    buffer_load_dwordx4 v2, s[20:23], s28 offen lds
    s_add_u32 m0, s24, 3072
    s_nop 0
    buffer_load_dwordx4 v3, s[20:23], s28 offen lds
    s_add_u32 m0, s24, 4096
    s_nop 0
    buffer_load_dwordx4 v4, s[20:23], s28 offen lds
    s_add_u32 m0, s24, 5120
    s_nop 0
    buffer_load_dwordx4 v5, s[20:23], s28 offen lds
    s_add_u32 m0, s24, 6144
    s_nop 0
    buffer_load_dwordx4 v6, s[20:23], s28 offen lds
    s_add_u32 s28, s33, 615680
    s_mul_i32 s24, s9, 7168
    s_add_u32 m0, s24, 28672
    s_nop 0
    buffer_load_dwordx4 v0, s[20:23], s28 offen lds
    s_add_u32 m0, s24, 29696
    s_nop 0
    buffer_load_dwordx4 v1, s[20:23], s28 offen lds
    s_add_u32 m0, s24, 30720
    s_nop 0
    buffer_load_dwordx4 v2, s[20:23], s28 offen lds
    s_add_u32 m0, s24, 31744
    s_nop 0
    buffer_load_dwordx4 v3, s[20:23], s28 offen lds
    s_add_u32 m0, s24, 32768
    s_nop 0
    buffer_load_dwordx4 v4, s[20:23], s28 offen lds
    s_add_u32 m0, s24, 33792
    s_nop 0
    buffer_load_dwordx4 v5, s[20:23], s28 offen lds
    s_add_u32 m0, s24, 34816
    s_nop 0
    buffer_load_dwordx4 v6, s[20:23], s28 offen lds
    s_add_u32 s28, s33, 1230080
    s_mul_i32 s24, s9, 7168
    s_add_u32 m0, s24, 57344
    s_nop 0
    buffer_load_dwordx4 v0, s[20:23], s28 offen lds
    s_add_u32 m0, s24, 58368
    s_nop 0
    buffer_load_dwordx4 v1, s[20:23], s28 offen lds
    s_add_u32 m0, s24, 59392
    s_nop 0
    buffer_load_dwordx4 v2, s[20:23], s28 offen lds
    s_add_u32 m0, s24, 60416
    s_nop 0
    buffer_load_dwordx4 v3, s[20:23], s28 offen lds
    s_add_u32 m0, s24, 61440
    s_nop 0
    buffer_load_dwordx4 v4, s[20:23], s28 offen lds
    s_add_u32 m0, s24, 62464
    s_nop 0
    buffer_load_dwordx4 v5, s[20:23], s28 offen lds
    s_add_u32 m0, s24, 63488
    s_nop 0
    buffer_load_dwordx4 v6, s[20:23], s28 offen lds
    s_add_u32 s28, s33, 1844480
    s_mul_i32 s24, s9, 7168
    s_add_u32 m0, s24, 86016
    s_nop 0
    buffer_load_dwordx4 v0, s[20:23], s28 offen lds
    s_add_u32 m0, s24, 87040
    s_nop 0
    buffer_load_dwordx4 v1, s[20:23], s28 offen lds
    s_add_u32 m0, s24, 88064
    s_nop 0
    buffer_load_dwordx4 v2, s[20:23], s28 offen lds
    s_add_u32 m0, s24, 89088
    s_nop 0
    buffer_load_dwordx4 v3, s[20:23], s28 offen lds
    s_add_u32 m0, s24, 90112
    s_nop 0
    buffer_load_dwordx4 v4, s[20:23], s28 offen lds
    s_add_u32 m0, s24, 91136
    s_nop 0
    buffer_load_dwordx4 v5, s[20:23], s28 offen lds
    s_add_u32 m0, s24, 92160
    s_nop 0
    buffer_load_dwordx4 v6, s[20:23], s28 offen lds
    s_mov_b32 s44, s48
    s_mov_b32 s45, s49
    s_mov_b32 s46, 2621440
    s_mov_b32 s47, 0x20000
    v_mul_u32_u24 v8, 1280, v30
    v_lshl_add_u32 v8, v29, 4, v8
    s_lshl_b32 s24, s31, 7
    s_lshl_b32 s25, s9, 5
    s_add_u32 s34, s24, s25
    s_mul_i32 s24, s34, 1280
    s_add_u32 s25, s24, 20480
    buffer_load_dwordx4 a[0:3], v8, s[44:47], s24 offen offset:0
    buffer_load_dwordx4 a[4:7], v8, s[44:47], s24 offen offset:64
    buffer_load_dwordx4 a[8:11], v8, s[44:47], s24 offen offset:128
    buffer_load_dwordx4 a[12:15], v8, s[44:47], s24 offen offset:192
    buffer_load_dwordx4 a[16:19], v8, s[44:47], s24 offen offset:256
    buffer_load_dwordx4 a[20:23], v8, s[44:47], s24 offen offset:320
    buffer_load_dwordx4 a[24:27], v8, s[44:47], s24 offen offset:384
    buffer_load_dwordx4 a[28:31], v8, s[44:47], s24 offen offset:448
    buffer_load_dwordx4 a[32:35], v8, s[44:47], s24 offen offset:512
    buffer_load_dwordx4 a[36:39], v8, s[44:47], s24 offen offset:576
    buffer_load_dwordx4 a[40:43], v8, s[44:47], s24 offen offset:640
    buffer_load_dwordx4 a[44:47], v8, s[44:47], s24 offen offset:704
    buffer_load_dwordx4 a[48:51], v8, s[44:47], s24 offen offset:768
    buffer_load_dwordx4 a[52:55], v8, s[44:47], s24 offen offset:832
    buffer_load_dwordx4 a[56:59], v8, s[44:47], s24 offen offset:896
    buffer_load_dwordx4 a[60:63], v8, s[44:47], s24 offen offset:960
    buffer_load_dwordx4 a[64:67], v8, s[44:47], s24 offen offset:1024
    buffer_load_dwordx4 a[68:71], v8, s[44:47], s24 offen offset:1088
    buffer_load_dwordx4 a[72:75], v8, s[44:47], s24 offen offset:1152
    buffer_load_dwordx4 a[76:79], v8, s[44:47], s24 offen offset:1216
    buffer_load_dwordx4 a[80:83], v8, s[44:47], s25 offen offset:0
    buffer_load_dwordx4 a[84:87], v8, s[44:47], s25 offen offset:64
    buffer_load_dwordx4 a[88:91], v8, s[44:47], s25 offen offset:128
    buffer_load_dwordx4 a[92:95], v8, s[44:47], s25 offen offset:192
    buffer_load_dwordx4 a[96:99], v8, s[44:47], s25 offen offset:256
    buffer_load_dwordx4 a[100:103], v8, s[44:47], s25 offen offset:320
    buffer_load_dwordx4 a[104:107], v8, s[44:47], s25 offen offset:384
    buffer_load_dwordx4 a[108:111], v8, s[44:47], s25 offen offset:448
    buffer_load_dwordx4 a[112:115], v8, s[44:47], s25 offen offset:512
    buffer_load_dwordx4 a[116:119], v8, s[44:47], s25 offen offset:576
    buffer_load_dwordx4 a[120:123], v8, s[44:47], s25 offen offset:640
    buffer_load_dwordx4 a[124:127], v8, s[44:47], s25 offen offset:704
    buffer_load_dwordx4 a[128:131], v8, s[44:47], s25 offen offset:768
    buffer_load_dwordx4 a[132:135], v8, s[44:47], s25 offen offset:832
    buffer_load_dwordx4 a[136:139], v8, s[44:47], s25 offen offset:896
    buffer_load_dwordx4 a[140:143], v8, s[44:47], s25 offen offset:960
    buffer_load_dwordx4 a[144:147], v8, s[44:47], s25 offen offset:1024
    buffer_load_dwordx4 a[148:151], v8, s[44:47], s25 offen offset:1088
    buffer_load_dwordx4 a[152:155], v8, s[44:47], s25 offen offset:1152
    buffer_load_dwordx4 a[156:159], v8, s[44:47], s25 offen offset:1216
    s_mov_b32 s44, s52
    s_mov_b32 s45, s53
    s_mov_b32 s46, 25600
    s_mul_i32 s24, s32, 6400
    s_lshl_b32 s25, s9, 11
    s_add_u32 s24, s24, s25
    s_add_u32 m0, s25, 139264
    s_nop 0
    buffer_load_dwordx4 v26, s[44:47], s24 offen lds
    buffer_load_dwordx4 v26, s[44:47], s24 offen offset:1024 lds
    v_mov_b32 v8, 0
    v_mov_b32 v9, 0
    v_mov_b32 v10, 0
    v_mov_b32 v11, 0
    v_add_u32 v12, 147456, v26
    ds_write_b128 v12, v[8:11]
    ds_write_b128 v12, v[8:11] offset:1024
    v_and_b32 v8, 1, v30
    v_lshlrev_b32 v8, 4, v8
    s_movk_i32 s24, 0x3f80
    v_lshlrev_b32 v8, v8, s24
    v_lshrrev_b32 v9, 1, v30
    v_lshl_add_u32 v9, v29, 3, v9
    v_cmp_eq_u32 vcc, 0, v9
    s_nop 1
    v_cndmask_b32 v202, 0, v8, vcc
    v_cmp_eq_u32 vcc, 1, v9
    s_nop 1
    v_cndmask_b32 v203, 0, v8, vcc
    v_cmp_eq_u32 vcc, 2, v9
    s_nop 1
    v_cndmask_b32 v204, 0, v8, vcc
    v_cmp_eq_u32 vcc, 3, v9
    s_nop 1
    v_cndmask_b32 v205, 0, v8, vcc
    v_cmp_eq_u32 vcc, 4, v9
    s_nop 1
    v_cndmask_b32 v206, 0, v8, vcc
    v_cmp_eq_u32 vcc, 5, v9
    s_nop 1
    v_cndmask_b32 v207, 0, v8, vcc
    v_cmp_eq_u32 vcc, 6, v9
    s_nop 1
    v_cndmask_b32 v208, 0, v8, vcc
    v_cmp_eq_u32 vcc, 7, v9
    s_nop 1
    v_cndmask_b32 v209, 0, v8, vcc
    v_cmp_eq_u32 vcc, 8, v9
    s_nop 1
    v_cndmask_b32 v210, 0, v8, vcc
    v_cmp_eq_u32 vcc, 9, v9
    s_nop 1
    v_cndmask_b32 v211, 0, v8, vcc
    v_cmp_eq_u32 vcc, 10, v9
    s_nop 1
    v_cndmask_b32 v212, 0, v8, vcc
    v_cmp_eq_u32 vcc, 11, v9
    s_nop 1
    v_cndmask_b32 v213, 0, v8, vcc
    v_cmp_eq_u32 vcc, 12, v9
    s_nop 1
    v_cndmask_b32 v214, 0, v8, vcc
    v_cmp_eq_u32 vcc, 13, v9
    s_nop 1
    v_cndmask_b32 v215, 0, v8, vcc
    v_cmp_eq_u32 vcc, 14, v9
    s_nop 1
    v_cndmask_b32 v216, 0, v8, vcc
    v_cmp_eq_u32 vcc, 15, v9
    s_nop 1
    v_cndmask_b32 v217, 0, v8, vcc
    v_cmp_eq_u32 vcc, 16, v9
    s_nop 1
    v_cndmask_b32 v218, 0, v8, vcc
    v_cmp_eq_u32 vcc, 17, v9
    s_nop 1
    v_cndmask_b32 v219, 0, v8, vcc
    v_cmp_eq_u32 vcc, 18, v9
    s_nop 1
    v_cndmask_b32 v220, 0, v8, vcc
    v_cmp_eq_u32 vcc, 19, v9
    s_nop 1
    v_cndmask_b32 v221, 0, v8, vcc
    v_cmp_eq_u32 vcc, 20, v9
    s_nop 1
    v_cndmask_b32 v222, 0, v8, vcc
    v_cmp_eq_u32 vcc, 21, v9
    s_nop 1
    v_cndmask_b32 v223, 0, v8, vcc
    v_cmp_eq_u32 vcc, 22, v9
    s_nop 1
    v_cndmask_b32 v224, 0, v8, vcc
    v_cmp_eq_u32 vcc, 23, v9
    s_nop 1
    v_cndmask_b32 v225, 0, v8, vcc
    v_cmp_eq_u32 vcc, 24, v9
    s_nop 1
    v_cndmask_b32 v226, 0, v8, vcc
    v_cmp_eq_u32 vcc, 25, v9
    s_nop 1
    v_cndmask_b32 v227, 0, v8, vcc
    v_cmp_eq_u32 vcc, 26, v9
    s_nop 1
    v_cndmask_b32 v228, 0, v8, vcc
    v_cmp_eq_u32 vcc, 27, v9
    s_nop 1
    v_cndmask_b32 v229, 0, v8, vcc
    v_cmp_eq_u32 vcc, 28, v9
    s_nop 1
    v_cndmask_b32 v230, 0, v8, vcc
    v_cmp_eq_u32 vcc, 29, v9
    s_nop 1
    v_cndmask_b32 v231, 0, v8, vcc
    v_cmp_eq_u32 vcc, 30, v9
    s_nop 1
    v_cndmask_b32 v232, 0, v8, vcc
    v_cmp_eq_u32 vcc, 31, v9
    s_nop 1
    v_cndmask_b32 v233, 0, v8, vcc
    v_lshl_add_u32 v8, v29, 3, v28
    v_mul_u32_u24 v8, 160, v8
    v_mul_u32_u24 v9, 40, v27
    v_add_u32 v16, v8, v9
    v_lshl_add_u32 v17, v27, 3, v8
    v_mul_u32_u24 v8, 20, v29
    v_add_u32 v8, v8, v28
    v_mul_u32_u24 v8, 160, v8
    v_lshl_add_u32 v18, v27, 3, v8
    v_mul_u32_u24 v8, 800, v29
    v_mul_u32_u24 v9, 40, v28
    v_add_u32 v8, v8, v9
    v_add_u32 v8, 139264, v8
    v_mov_b32 v10, 147456
    v_cmp_eq_u32 s[40:41], v27, v29
    v_mul_u32_u24 v9, 1920, v29
    v_mul_u32_u24 v11, 48, v28
    v_cndmask_b32 v19, v10, v8, s[40:41]
    v_add_u32 v9, v9, v11
    v_add_u32 v9, 114688, v9
    v_cndmask_b32 v20, v10, v9, s[40:41]
    s_waitcnt vmcnt(0)
    s_barrier
    v_add_u32 v21, 0, v16
    ds_read_b64_tr_b16 v[72:73], v21 offset:0
    ds_read_b64_tr_b16 v[74:75], v21 offset:640
    ds_read_b64_tr_b16 v[76:77], v21 offset:8
    ds_read_b64_tr_b16 v[78:79], v21 offset:648
    ds_read_b64_tr_b16 v[80:81], v21 offset:16
    ds_read_b64_tr_b16 v[82:83], v21 offset:656
    ds_read_b64_tr_b16 v[84:85], v21 offset:24
    ds_read_b64_tr_b16 v[86:87], v21 offset:664
    ds_read_b64_tr_b16 v[88:89], v21 offset:32
    ds_read_b64_tr_b16 v[90:91], v21 offset:672
    s_waitcnt lgkmcnt(0)
    v_mfma_f32_16x16x32_bf16 v[32:35], v[72:75], a[0:3], 0
    ds_read_b64_tr_b16 v[92:93], v21 offset:5120
    v_mfma_f32_16x16x32_bf16 v[36:39], v[72:75], a[80:83], 0
    ds_read_b64_tr_b16 v[94:95], v21 offset:5760
    v_mfma_f32_16x16x32_bf16 v[40:43], v[76:79], a[0:3], 0
    ds_read_b64_tr_b16 v[96:97], v21 offset:5128
    v_mfma_f32_16x16x32_bf16 v[44:47], v[76:79], a[80:83], 0
    ds_read_b64_tr_b16 v[98:99], v21 offset:5768
    v_mfma_f32_16x16x32_bf16 v[48:51], v[80:83], a[0:3], 0
    ds_read_b64_tr_b16 v[100:101], v21 offset:5136
    v_mfma_f32_16x16x32_bf16 v[52:55], v[80:83], a[80:83], 0
    ds_read_b64_tr_b16 v[102:103], v21 offset:5776
    v_mfma_f32_16x16x32_bf16 v[56:59], v[84:87], a[0:3], 0
    ds_read_b64_tr_b16 v[104:105], v21 offset:5144
    v_mfma_f32_16x16x32_bf16 v[60:63], v[84:87], a[80:83], 0
    ds_read_b64_tr_b16 v[106:107], v21 offset:5784
    v_mfma_f32_16x16x32_bf16 v[64:67], v[88:91], a[0:3], 0
    ds_read_b64_tr_b16 v[108:109], v21 offset:5152
    v_mfma_f32_16x16x32_bf16 v[68:71], v[88:91], a[80:83], 0
    ds_read_b64_tr_b16 v[110:111], v21 offset:5792
    s_waitcnt lgkmcnt(0)
    v_mfma_f32_16x16x32_bf16 v[32:35], v[92:95], a[4:7], v[32:35]
    ds_read_b64_tr_b16 v[72:73], v21 offset:10240
    v_mfma_f32_16x16x32_bf16 v[36:39], v[92:95], a[84:87], v[36:39]
    ds_read_b64_tr_b16 v[74:75], v21 offset:10880
    v_mfma_f32_16x16x32_bf16 v[40:43], v[96:99], a[4:7], v[40:43]
    ds_read_b64_tr_b16 v[76:77], v21 offset:10248
    v_mfma_f32_16x16x32_bf16 v[44:47], v[96:99], a[84:87], v[44:47]
    ds_read_b64_tr_b16 v[78:79], v21 offset:10888
    v_mfma_f32_16x16x32_bf16 v[48:51], v[100:103], a[4:7], v[48:51]
    ds_read_b64_tr_b16 v[80:81], v21 offset:10256
    v_mfma_f32_16x16x32_bf16 v[52:55], v[100:103], a[84:87], v[52:55]
    ds_read_b64_tr_b16 v[82:83], v21 offset:10896
    v_mfma_f32_16x16x32_bf16 v[56:59], v[104:107], a[4:7], v[56:59]
    ds_read_b64_tr_b16 v[84:85], v21 offset:10264
    v_mfma_f32_16x16x32_bf16 v[60:63], v[104:107], a[84:87], v[60:63]
    ds_read_b64_tr_b16 v[86:87], v21 offset:10904
    v_mfma_f32_16x16x32_bf16 v[64:67], v[108:111], a[4:7], v[64:67]
    ds_read_b64_tr_b16 v[88:89], v21 offset:10272
    v_mfma_f32_16x16x32_bf16 v[68:71], v[108:111], a[84:87], v[68:71]
    ds_read_b64_tr_b16 v[90:91], v21 offset:10912
    s_waitcnt lgkmcnt(0)
    v_mfma_f32_16x16x32_bf16 v[32:35], v[72:75], a[8:11], v[32:35]
    ds_read_b64_tr_b16 v[92:93], v21 offset:15360
    v_mfma_f32_16x16x32_bf16 v[36:39], v[72:75], a[88:91], v[36:39]
    ds_read_b64_tr_b16 v[94:95], v21 offset:16000
    v_mfma_f32_16x16x32_bf16 v[40:43], v[76:79], a[8:11], v[40:43]
    ds_read_b64_tr_b16 v[96:97], v21 offset:15368
    v_mfma_f32_16x16x32_bf16 v[44:47], v[76:79], a[88:91], v[44:47]
    ds_read_b64_tr_b16 v[98:99], v21 offset:16008
    v_mfma_f32_16x16x32_bf16 v[48:51], v[80:83], a[8:11], v[48:51]
    ds_read_b64_tr_b16 v[100:101], v21 offset:15376
    v_mfma_f32_16x16x32_bf16 v[52:55], v[80:83], a[88:91], v[52:55]
    ds_read_b64_tr_b16 v[102:103], v21 offset:16016
    v_mfma_f32_16x16x32_bf16 v[56:59], v[84:87], a[8:11], v[56:59]
    ds_read_b64_tr_b16 v[104:105], v21 offset:15384
    v_mfma_f32_16x16x32_bf16 v[60:63], v[84:87], a[88:91], v[60:63]
    ds_read_b64_tr_b16 v[106:107], v21 offset:16024
    v_mfma_f32_16x16x32_bf16 v[64:67], v[88:91], a[8:11], v[64:67]
    ds_read_b64_tr_b16 v[108:109], v21 offset:15392
    v_mfma_f32_16x16x32_bf16 v[68:71], v[88:91], a[88:91], v[68:71]
    ds_read_b64_tr_b16 v[110:111], v21 offset:16032
    s_waitcnt lgkmcnt(0)
    v_mfma_f32_16x16x32_bf16 v[32:35], v[92:95], a[12:15], v[32:35]
    ds_read_b64_tr_b16 v[72:73], v21 offset:20480
    v_mfma_f32_16x16x32_bf16 v[36:39], v[92:95], a[92:95], v[36:39]
    ds_read_b64_tr_b16 v[74:75], v21 offset:21120
    v_mfma_f32_16x16x32_bf16 v[40:43], v[96:99], a[12:15], v[40:43]
    ds_read_b64_tr_b16 v[76:77], v21 offset:20488
    v_mfma_f32_16x16x32_bf16 v[44:47], v[96:99], a[92:95], v[44:47]
    ds_read_b64_tr_b16 v[78:79], v21 offset:21128
    v_mfma_f32_16x16x32_bf16 v[48:51], v[100:103], a[12:15], v[48:51]
    ds_read_b64_tr_b16 v[80:81], v21 offset:20496
    v_mfma_f32_16x16x32_bf16 v[52:55], v[100:103], a[92:95], v[52:55]
    ds_read_b64_tr_b16 v[82:83], v21 offset:21136
    v_mfma_f32_16x16x32_bf16 v[56:59], v[104:107], a[12:15], v[56:59]
    ds_read_b64_tr_b16 v[84:85], v21 offset:20504
    v_mfma_f32_16x16x32_bf16 v[60:63], v[104:107], a[92:95], v[60:63]
    ds_read_b64_tr_b16 v[86:87], v21 offset:21144
    v_mfma_f32_16x16x32_bf16 v[64:67], v[108:111], a[12:15], v[64:67]
    ds_read_b64_tr_b16 v[88:89], v21 offset:20512
    v_mfma_f32_16x16x32_bf16 v[68:71], v[108:111], a[92:95], v[68:71]
    ds_read_b64_tr_b16 v[90:91], v21 offset:21152
    s_waitcnt lgkmcnt(0)
    v_mfma_f32_16x16x32_bf16 v[32:35], v[72:75], a[16:19], v[32:35]
    v_mfma_f32_16x16x32_bf16 v[36:39], v[72:75], a[96:99], v[36:39]
    v_mfma_f32_16x16x32_bf16 v[40:43], v[76:79], a[16:19], v[40:43]
    v_mfma_f32_16x16x32_bf16 v[44:47], v[76:79], a[96:99], v[44:47]
    v_mfma_f32_16x16x32_bf16 v[48:51], v[80:83], a[16:19], v[48:51]
    v_mfma_f32_16x16x32_bf16 v[52:55], v[80:83], a[96:99], v[52:55]
    v_mfma_f32_16x16x32_bf16 v[56:59], v[84:87], a[16:19], v[56:59]
    v_mfma_f32_16x16x32_bf16 v[60:63], v[84:87], a[96:99], v[60:63]
    v_mfma_f32_16x16x32_bf16 v[64:67], v[88:91], a[16:19], v[64:67]
    v_mfma_f32_16x16x32_bf16 v[68:71], v[88:91], a[96:99], v[68:71]
    s_barrier
    s_add_u32 s28, s33, 2560
    s_mul_i32 s24, s9, 7168
    s_add_u32 m0, s24, 0
    s_nop 0
    buffer_load_dwordx4 v0, s[20:23], s28 offen lds
    s_add_u32 m0, s24, 1024
    s_nop 0
    buffer_load_dwordx4 v1, s[20:23], s28 offen lds
    s_add_u32 m0, s24, 2048
    s_nop 0
    buffer_load_dwordx4 v2, s[20:23], s28 offen lds
    s_add_u32 m0, s24, 3072
    s_nop 0
    buffer_load_dwordx4 v3, s[20:23], s28 offen lds
    s_add_u32 m0, s24, 4096
    s_nop 0
    buffer_load_dwordx4 v4, s[20:23], s28 offen lds
    s_add_u32 m0, s24, 5120
    s_nop 0
    buffer_load_dwordx4 v5, s[20:23], s28 offen lds
    s_add_u32 m0, s24, 6144
    s_nop 0
    buffer_load_dwordx4 v6, s[20:23], s28 offen lds
    v_add_u32 v21, 28672, v16
    ds_read_b64_tr_b16 v[72:73], v21 offset:0
    ds_read_b64_tr_b16 v[74:75], v21 offset:640
    ds_read_b64_tr_b16 v[76:77], v21 offset:8
    ds_read_b64_tr_b16 v[78:79], v21 offset:648
    ds_read_b64_tr_b16 v[80:81], v21 offset:16
    ds_read_b64_tr_b16 v[82:83], v21 offset:656
    ds_read_b64_tr_b16 v[84:85], v21 offset:24
    ds_read_b64_tr_b16 v[86:87], v21 offset:664
    ds_read_b64_tr_b16 v[88:89], v21 offset:32
    ds_read_b64_tr_b16 v[90:91], v21 offset:672
    s_waitcnt lgkmcnt(0)
    v_mfma_f32_16x16x32_bf16 v[32:35], v[72:75], a[20:23], v[32:35]
    ds_read_b64_tr_b16 v[92:93], v21 offset:5120
    v_mfma_f32_16x16x32_bf16 v[36:39], v[72:75], a[100:103], v[36:39]
    ds_read_b64_tr_b16 v[94:95], v21 offset:5760
    v_mfma_f32_16x16x32_bf16 v[40:43], v[76:79], a[20:23], v[40:43]
    ds_read_b64_tr_b16 v[96:97], v21 offset:5128
    v_mfma_f32_16x16x32_bf16 v[44:47], v[76:79], a[100:103], v[44:47]
    ds_read_b64_tr_b16 v[98:99], v21 offset:5768
    v_mfma_f32_16x16x32_bf16 v[48:51], v[80:83], a[20:23], v[48:51]
    ds_read_b64_tr_b16 v[100:101], v21 offset:5136
    v_mfma_f32_16x16x32_bf16 v[52:55], v[80:83], a[100:103], v[52:55]
    ds_read_b64_tr_b16 v[102:103], v21 offset:5776
    v_mfma_f32_16x16x32_bf16 v[56:59], v[84:87], a[20:23], v[56:59]
    ds_read_b64_tr_b16 v[104:105], v21 offset:5144
    v_mfma_f32_16x16x32_bf16 v[60:63], v[84:87], a[100:103], v[60:63]
    ds_read_b64_tr_b16 v[106:107], v21 offset:5784
    v_mfma_f32_16x16x32_bf16 v[64:67], v[88:91], a[20:23], v[64:67]
    ds_read_b64_tr_b16 v[108:109], v21 offset:5152
    v_mfma_f32_16x16x32_bf16 v[68:71], v[88:91], a[100:103], v[68:71]
    ds_read_b64_tr_b16 v[110:111], v21 offset:5792
    s_waitcnt lgkmcnt(0)
    v_mfma_f32_16x16x32_bf16 v[32:35], v[92:95], a[24:27], v[32:35]
    ds_read_b64_tr_b16 v[72:73], v21 offset:10240
    v_mfma_f32_16x16x32_bf16 v[36:39], v[92:95], a[104:107], v[36:39]
    ds_read_b64_tr_b16 v[74:75], v21 offset:10880
    v_mfma_f32_16x16x32_bf16 v[40:43], v[96:99], a[24:27], v[40:43]
    ds_read_b64_tr_b16 v[76:77], v21 offset:10248
    v_mfma_f32_16x16x32_bf16 v[44:47], v[96:99], a[104:107], v[44:47]
    ds_read_b64_tr_b16 v[78:79], v21 offset:10888
    v_mfma_f32_16x16x32_bf16 v[48:51], v[100:103], a[24:27], v[48:51]
    ds_read_b64_tr_b16 v[80:81], v21 offset:10256
    v_mfma_f32_16x16x32_bf16 v[52:55], v[100:103], a[104:107], v[52:55]
    ds_read_b64_tr_b16 v[82:83], v21 offset:10896
    v_mfma_f32_16x16x32_bf16 v[56:59], v[104:107], a[24:27], v[56:59]
    ds_read_b64_tr_b16 v[84:85], v21 offset:10264
    v_mfma_f32_16x16x32_bf16 v[60:63], v[104:107], a[104:107], v[60:63]
    ds_read_b64_tr_b16 v[86:87], v21 offset:10904
    v_mfma_f32_16x16x32_bf16 v[64:67], v[108:111], a[24:27], v[64:67]
    ds_read_b64_tr_b16 v[88:89], v21 offset:10272
    v_mfma_f32_16x16x32_bf16 v[68:71], v[108:111], a[104:107], v[68:71]
    ds_read_b64_tr_b16 v[90:91], v21 offset:10912
    s_waitcnt lgkmcnt(0)
    v_mfma_f32_16x16x32_bf16 v[32:35], v[72:75], a[28:31], v[32:35]
    ds_read_b64_tr_b16 v[92:93], v21 offset:15360
    v_mfma_f32_16x16x32_bf16 v[36:39], v[72:75], a[108:111], v[36:39]
    ds_read_b64_tr_b16 v[94:95], v21 offset:16000
    v_mfma_f32_16x16x32_bf16 v[40:43], v[76:79], a[28:31], v[40:43]
    ds_read_b64_tr_b16 v[96:97], v21 offset:15368
    v_mfma_f32_16x16x32_bf16 v[44:47], v[76:79], a[108:111], v[44:47]
    ds_read_b64_tr_b16 v[98:99], v21 offset:16008
    v_mfma_f32_16x16x32_bf16 v[48:51], v[80:83], a[28:31], v[48:51]
    ds_read_b64_tr_b16 v[100:101], v21 offset:15376
    v_mfma_f32_16x16x32_bf16 v[52:55], v[80:83], a[108:111], v[52:55]
    ds_read_b64_tr_b16 v[102:103], v21 offset:16016
    v_mfma_f32_16x16x32_bf16 v[56:59], v[84:87], a[28:31], v[56:59]
    ds_read_b64_tr_b16 v[104:105], v21 offset:15384
    v_mfma_f32_16x16x32_bf16 v[60:63], v[84:87], a[108:111], v[60:63]
    ds_read_b64_tr_b16 v[106:107], v21 offset:16024
    v_mfma_f32_16x16x32_bf16 v[64:67], v[88:91], a[28:31], v[64:67]
    ds_read_b64_tr_b16 v[108:109], v21 offset:15392
    v_mfma_f32_16x16x32_bf16 v[68:71], v[88:91], a[108:111], v[68:71]
    ds_read_b64_tr_b16 v[110:111], v21 offset:16032
    s_waitcnt lgkmcnt(0)
    v_mfma_f32_16x16x32_bf16 v[32:35], v[92:95], a[32:35], v[32:35]
    ds_read_b64_tr_b16 v[72:73], v21 offset:20480
    v_mfma_f32_16x16x32_bf16 v[36:39], v[92:95], a[112:115], v[36:39]
    ds_read_b64_tr_b16 v[74:75], v21 offset:21120
    v_mfma_f32_16x16x32_bf16 v[40:43], v[96:99], a[32:35], v[40:43]
    ds_read_b64_tr_b16 v[76:77], v21 offset:20488
    v_mfma_f32_16x16x32_bf16 v[44:47], v[96:99], a[112:115], v[44:47]
    ds_read_b64_tr_b16 v[78:79], v21 offset:21128
    v_mfma_f32_16x16x32_bf16 v[48:51], v[100:103], a[32:35], v[48:51]
    ds_read_b64_tr_b16 v[80:81], v21 offset:20496
    v_mfma_f32_16x16x32_bf16 v[52:55], v[100:103], a[112:115], v[52:55]
    ds_read_b64_tr_b16 v[82:83], v21 offset:21136
    v_mfma_f32_16x16x32_bf16 v[56:59], v[104:107], a[32:35], v[56:59]
    ds_read_b64_tr_b16 v[84:85], v21 offset:20504
    v_mfma_f32_16x16x32_bf16 v[60:63], v[104:107], a[112:115], v[60:63]
    ds_read_b64_tr_b16 v[86:87], v21 offset:21144
    v_mfma_f32_16x16x32_bf16 v[64:67], v[108:111], a[32:35], v[64:67]
    ds_read_b64_tr_b16 v[88:89], v21 offset:20512
    v_mfma_f32_16x16x32_bf16 v[68:71], v[108:111], a[112:115], v[68:71]
    ds_read_b64_tr_b16 v[90:91], v21 offset:21152
    s_waitcnt lgkmcnt(0)
    v_mfma_f32_16x16x32_bf16 v[32:35], v[72:75], a[36:39], v[32:35]
    v_mfma_f32_16x16x32_bf16 v[36:39], v[72:75], a[116:119], v[36:39]
    v_mfma_f32_16x16x32_bf16 v[40:43], v[76:79], a[36:39], v[40:43]
    v_mfma_f32_16x16x32_bf16 v[44:47], v[76:79], a[116:119], v[44:47]
    v_mfma_f32_16x16x32_bf16 v[48:51], v[80:83], a[36:39], v[48:51]
    v_mfma_f32_16x16x32_bf16 v[52:55], v[80:83], a[116:119], v[52:55]
    v_mfma_f32_16x16x32_bf16 v[56:59], v[84:87], a[36:39], v[56:59]
    v_mfma_f32_16x16x32_bf16 v[60:63], v[84:87], a[116:119], v[60:63]
    v_mfma_f32_16x16x32_bf16 v[64:67], v[88:91], a[36:39], v[64:67]
    v_mfma_f32_16x16x32_bf16 v[68:71], v[88:91], a[116:119], v[68:71]
    s_barrier
    s_add_u32 s28, s33, 616960
    s_mul_i32 s24, s9, 7168
    s_add_u32 m0, s24, 28672
    s_nop 0
    buffer_load_dwordx4 v0, s[20:23], s28 offen lds
    s_add_u32 m0, s24, 29696
    s_nop 0
    buffer_load_dwordx4 v1, s[20:23], s28 offen lds
    s_add_u32 m0, s24, 30720
    s_nop 0
    buffer_load_dwordx4 v2, s[20:23], s28 offen lds
    s_add_u32 m0, s24, 31744
    s_nop 0
    buffer_load_dwordx4 v3, s[20:23], s28 offen lds
    s_add_u32 m0, s24, 32768
    s_nop 0
    buffer_load_dwordx4 v4, s[20:23], s28 offen lds
    s_add_u32 m0, s24, 33792
    s_nop 0
    buffer_load_dwordx4 v5, s[20:23], s28 offen lds
    s_add_u32 m0, s24, 34816
    s_nop 0
    buffer_load_dwordx4 v6, s[20:23], s28 offen lds
    v_add_u32 v21, 57344, v16
    ds_read_b64_tr_b16 v[72:73], v21 offset:0
    ds_read_b64_tr_b16 v[74:75], v21 offset:640
    ds_read_b64_tr_b16 v[76:77], v21 offset:8
    ds_read_b64_tr_b16 v[78:79], v21 offset:648
    ds_read_b64_tr_b16 v[80:81], v21 offset:16
    ds_read_b64_tr_b16 v[82:83], v21 offset:656
    ds_read_b64_tr_b16 v[84:85], v21 offset:24
    ds_read_b64_tr_b16 v[86:87], v21 offset:664
    ds_read_b64_tr_b16 v[88:89], v21 offset:32
    ds_read_b64_tr_b16 v[90:91], v21 offset:672
    s_waitcnt lgkmcnt(0)
    v_mfma_f32_16x16x32_bf16 v[32:35], v[72:75], a[40:43], v[32:35]
    ds_read_b64_tr_b16 v[92:93], v21 offset:5120
    v_mfma_f32_16x16x32_bf16 v[36:39], v[72:75], a[120:123], v[36:39]
    ds_read_b64_tr_b16 v[94:95], v21 offset:5760
    v_mfma_f32_16x16x32_bf16 v[40:43], v[76:79], a[40:43], v[40:43]
    ds_read_b64_tr_b16 v[96:97], v21 offset:5128
    v_mfma_f32_16x16x32_bf16 v[44:47], v[76:79], a[120:123], v[44:47]
    ds_read_b64_tr_b16 v[98:99], v21 offset:5768
    v_mfma_f32_16x16x32_bf16 v[48:51], v[80:83], a[40:43], v[48:51]
    ds_read_b64_tr_b16 v[100:101], v21 offset:5136
    v_mfma_f32_16x16x32_bf16 v[52:55], v[80:83], a[120:123], v[52:55]
    ds_read_b64_tr_b16 v[102:103], v21 offset:5776
    v_mfma_f32_16x16x32_bf16 v[56:59], v[84:87], a[40:43], v[56:59]
    ds_read_b64_tr_b16 v[104:105], v21 offset:5144
    v_mfma_f32_16x16x32_bf16 v[60:63], v[84:87], a[120:123], v[60:63]
    ds_read_b64_tr_b16 v[106:107], v21 offset:5784
    v_mfma_f32_16x16x32_bf16 v[64:67], v[88:91], a[40:43], v[64:67]
    ds_read_b64_tr_b16 v[108:109], v21 offset:5152
    v_mfma_f32_16x16x32_bf16 v[68:71], v[88:91], a[120:123], v[68:71]
    ds_read_b64_tr_b16 v[110:111], v21 offset:5792
    s_waitcnt lgkmcnt(0)
    v_mfma_f32_16x16x32_bf16 v[32:35], v[92:95], a[44:47], v[32:35]
    ds_read_b64_tr_b16 v[72:73], v21 offset:10240
    v_mfma_f32_16x16x32_bf16 v[36:39], v[92:95], a[124:127], v[36:39]
    ds_read_b64_tr_b16 v[74:75], v21 offset:10880
    v_mfma_f32_16x16x32_bf16 v[40:43], v[96:99], a[44:47], v[40:43]
    ds_read_b64_tr_b16 v[76:77], v21 offset:10248
    v_mfma_f32_16x16x32_bf16 v[44:47], v[96:99], a[124:127], v[44:47]
    ds_read_b64_tr_b16 v[78:79], v21 offset:10888
    v_mfma_f32_16x16x32_bf16 v[48:51], v[100:103], a[44:47], v[48:51]
    ds_read_b64_tr_b16 v[80:81], v21 offset:10256
    v_mfma_f32_16x16x32_bf16 v[52:55], v[100:103], a[124:127], v[52:55]
    ds_read_b64_tr_b16 v[82:83], v21 offset:10896
    v_mfma_f32_16x16x32_bf16 v[56:59], v[104:107], a[44:47], v[56:59]
    ds_read_b64_tr_b16 v[84:85], v21 offset:10264
    v_mfma_f32_16x16x32_bf16 v[60:63], v[104:107], a[124:127], v[60:63]
    ds_read_b64_tr_b16 v[86:87], v21 offset:10904
    v_mfma_f32_16x16x32_bf16 v[64:67], v[108:111], a[44:47], v[64:67]
    ds_read_b64_tr_b16 v[88:89], v21 offset:10272
    v_mfma_f32_16x16x32_bf16 v[68:71], v[108:111], a[124:127], v[68:71]
    ds_read_b64_tr_b16 v[90:91], v21 offset:10912
    s_waitcnt lgkmcnt(0)
    v_mfma_f32_16x16x32_bf16 v[32:35], v[72:75], a[48:51], v[32:35]
    ds_read_b64_tr_b16 v[92:93], v21 offset:15360
    v_mfma_f32_16x16x32_bf16 v[36:39], v[72:75], a[128:131], v[36:39]
    ds_read_b64_tr_b16 v[94:95], v21 offset:16000
    v_mfma_f32_16x16x32_bf16 v[40:43], v[76:79], a[48:51], v[40:43]
    ds_read_b64_tr_b16 v[96:97], v21 offset:15368
    v_mfma_f32_16x16x32_bf16 v[44:47], v[76:79], a[128:131], v[44:47]
    ds_read_b64_tr_b16 v[98:99], v21 offset:16008
    v_mfma_f32_16x16x32_bf16 v[48:51], v[80:83], a[48:51], v[48:51]
    ds_read_b64_tr_b16 v[100:101], v21 offset:15376
    v_mfma_f32_16x16x32_bf16 v[52:55], v[80:83], a[128:131], v[52:55]
    ds_read_b64_tr_b16 v[102:103], v21 offset:16016
    v_mfma_f32_16x16x32_bf16 v[56:59], v[84:87], a[48:51], v[56:59]
    ds_read_b64_tr_b16 v[104:105], v21 offset:15384
    v_mfma_f32_16x16x32_bf16 v[60:63], v[84:87], a[128:131], v[60:63]
    ds_read_b64_tr_b16 v[106:107], v21 offset:16024
    v_mfma_f32_16x16x32_bf16 v[64:67], v[88:91], a[48:51], v[64:67]
    ds_read_b64_tr_b16 v[108:109], v21 offset:15392
    v_mfma_f32_16x16x32_bf16 v[68:71], v[88:91], a[128:131], v[68:71]
    ds_read_b64_tr_b16 v[110:111], v21 offset:16032
    s_waitcnt lgkmcnt(0)
    v_mfma_f32_16x16x32_bf16 v[32:35], v[92:95], a[52:55], v[32:35]
    ds_read_b64_tr_b16 v[72:73], v21 offset:20480
    v_mfma_f32_16x16x32_bf16 v[36:39], v[92:95], a[132:135], v[36:39]
    ds_read_b64_tr_b16 v[74:75], v21 offset:21120
    v_mfma_f32_16x16x32_bf16 v[40:43], v[96:99], a[52:55], v[40:43]
    ds_read_b64_tr_b16 v[76:77], v21 offset:20488
    v_mfma_f32_16x16x32_bf16 v[44:47], v[96:99], a[132:135], v[44:47]
    ds_read_b64_tr_b16 v[78:79], v21 offset:21128
    v_mfma_f32_16x16x32_bf16 v[48:51], v[100:103], a[52:55], v[48:51]
    ds_read_b64_tr_b16 v[80:81], v21 offset:20496
    v_mfma_f32_16x16x32_bf16 v[52:55], v[100:103], a[132:135], v[52:55]
    ds_read_b64_tr_b16 v[82:83], v21 offset:21136
    v_mfma_f32_16x16x32_bf16 v[56:59], v[104:107], a[52:55], v[56:59]
    ds_read_b64_tr_b16 v[84:85], v21 offset:20504
    v_mfma_f32_16x16x32_bf16 v[60:63], v[104:107], a[132:135], v[60:63]
    ds_read_b64_tr_b16 v[86:87], v21 offset:21144
    v_mfma_f32_16x16x32_bf16 v[64:67], v[108:111], a[52:55], v[64:67]
    ds_read_b64_tr_b16 v[88:89], v21 offset:20512
    v_mfma_f32_16x16x32_bf16 v[68:71], v[108:111], a[132:135], v[68:71]
    ds_read_b64_tr_b16 v[90:91], v21 offset:21152
    s_waitcnt lgkmcnt(0)
    v_mfma_f32_16x16x32_bf16 v[32:35], v[72:75], a[56:59], v[32:35]
    v_mfma_f32_16x16x32_bf16 v[36:39], v[72:75], a[136:139], v[36:39]
    v_mfma_f32_16x16x32_bf16 v[40:43], v[76:79], a[56:59], v[40:43]
    v_mfma_f32_16x16x32_bf16 v[44:47], v[76:79], a[136:139], v[44:47]
    v_mfma_f32_16x16x32_bf16 v[48:51], v[80:83], a[56:59], v[48:51]
    v_mfma_f32_16x16x32_bf16 v[52:55], v[80:83], a[136:139], v[52:55]
    v_mfma_f32_16x16x32_bf16 v[56:59], v[84:87], a[56:59], v[56:59]
    v_mfma_f32_16x16x32_bf16 v[60:63], v[84:87], a[136:139], v[60:63]
    v_mfma_f32_16x16x32_bf16 v[64:67], v[88:91], a[56:59], v[64:67]
    v_mfma_f32_16x16x32_bf16 v[68:71], v[88:91], a[136:139], v[68:71]
    s_barrier
    s_add_u32 s28, s33, 1231360
    s_mul_i32 s24, s9, 7168
    s_add_u32 m0, s24, 57344
    s_nop 0
    buffer_load_dwordx4 v0, s[20:23], s28 offen lds
    s_add_u32 m0, s24, 58368
    s_nop 0
    buffer_load_dwordx4 v1, s[20:23], s28 offen lds
    s_add_u32 m0, s24, 59392
    s_nop 0
    buffer_load_dwordx4 v2, s[20:23], s28 offen lds
    s_add_u32 m0, s24, 60416
    s_nop 0
    buffer_load_dwordx4 v3, s[20:23], s28 offen lds
    s_add_u32 m0, s24, 61440
    s_nop 0
    buffer_load_dwordx4 v4, s[20:23], s28 offen lds
    s_add_u32 m0, s24, 62464
    s_nop 0
    buffer_load_dwordx4 v5, s[20:23], s28 offen lds
    s_add_u32 m0, s24, 63488
    s_nop 0
    buffer_load_dwordx4 v6, s[20:23], s28 offen lds
    v_add_u32 v21, 86016, v16
    ds_read_b64_tr_b16 v[72:73], v21 offset:0
    ds_read_b64_tr_b16 v[74:75], v21 offset:640
    ds_read_b64_tr_b16 v[76:77], v21 offset:8
    ds_read_b64_tr_b16 v[78:79], v21 offset:648
    ds_read_b64_tr_b16 v[80:81], v21 offset:16
    ds_read_b64_tr_b16 v[82:83], v21 offset:656
    ds_read_b64_tr_b16 v[84:85], v21 offset:24
    ds_read_b64_tr_b16 v[86:87], v21 offset:664
    ds_read_b64_tr_b16 v[88:89], v21 offset:32
    ds_read_b64_tr_b16 v[90:91], v21 offset:672
    s_waitcnt lgkmcnt(0)
    v_mfma_f32_16x16x32_bf16 v[32:35], v[72:75], a[60:63], v[32:35]
    ds_read_b64_tr_b16 v[92:93], v21 offset:5120
    v_mfma_f32_16x16x32_bf16 v[36:39], v[72:75], a[140:143], v[36:39]
    ds_read_b64_tr_b16 v[94:95], v21 offset:5760
    v_mfma_f32_16x16x32_bf16 v[40:43], v[76:79], a[60:63], v[40:43]
    ds_read_b64_tr_b16 v[96:97], v21 offset:5128
    v_mfma_f32_16x16x32_bf16 v[44:47], v[76:79], a[140:143], v[44:47]
    ds_read_b64_tr_b16 v[98:99], v21 offset:5768
    v_mfma_f32_16x16x32_bf16 v[48:51], v[80:83], a[60:63], v[48:51]
    ds_read_b64_tr_b16 v[100:101], v21 offset:5136
    v_mfma_f32_16x16x32_bf16 v[52:55], v[80:83], a[140:143], v[52:55]
    ds_read_b64_tr_b16 v[102:103], v21 offset:5776
    v_mfma_f32_16x16x32_bf16 v[56:59], v[84:87], a[60:63], v[56:59]
    ds_read_b64_tr_b16 v[104:105], v21 offset:5144
    v_mfma_f32_16x16x32_bf16 v[60:63], v[84:87], a[140:143], v[60:63]
    ds_read_b64_tr_b16 v[106:107], v21 offset:5784
    v_mfma_f32_16x16x32_bf16 v[64:67], v[88:91], a[60:63], v[64:67]
    ds_read_b64_tr_b16 v[108:109], v21 offset:5152
    v_mfma_f32_16x16x32_bf16 v[68:71], v[88:91], a[140:143], v[68:71]
    ds_read_b64_tr_b16 v[110:111], v21 offset:5792
    s_waitcnt lgkmcnt(0)
    v_mfma_f32_16x16x32_bf16 v[32:35], v[92:95], a[64:67], v[32:35]
    ds_read_b64_tr_b16 v[72:73], v21 offset:10240
    v_mfma_f32_16x16x32_bf16 v[36:39], v[92:95], a[144:147], v[36:39]
    ds_read_b64_tr_b16 v[74:75], v21 offset:10880
    v_mfma_f32_16x16x32_bf16 v[40:43], v[96:99], a[64:67], v[40:43]
    ds_read_b64_tr_b16 v[76:77], v21 offset:10248
    v_mfma_f32_16x16x32_bf16 v[44:47], v[96:99], a[144:147], v[44:47]
    ds_read_b64_tr_b16 v[78:79], v21 offset:10888
    v_mfma_f32_16x16x32_bf16 v[48:51], v[100:103], a[64:67], v[48:51]
    ds_read_b64_tr_b16 v[80:81], v21 offset:10256
    v_mfma_f32_16x16x32_bf16 v[52:55], v[100:103], a[144:147], v[52:55]
    ds_read_b64_tr_b16 v[82:83], v21 offset:10896
    v_mfma_f32_16x16x32_bf16 v[56:59], v[104:107], a[64:67], v[56:59]
    ds_read_b64_tr_b16 v[84:85], v21 offset:10264
    v_mfma_f32_16x16x32_bf16 v[60:63], v[104:107], a[144:147], v[60:63]
    ds_read_b64_tr_b16 v[86:87], v21 offset:10904
    v_mfma_f32_16x16x32_bf16 v[64:67], v[108:111], a[64:67], v[64:67]
    ds_read_b64_tr_b16 v[88:89], v21 offset:10272
    v_mfma_f32_16x16x32_bf16 v[68:71], v[108:111], a[144:147], v[68:71]
    ds_read_b64_tr_b16 v[90:91], v21 offset:10912
    s_waitcnt lgkmcnt(0)
    v_mfma_f32_16x16x32_bf16 v[32:35], v[72:75], a[68:71], v[32:35]
    ds_read_b64_tr_b16 v[92:93], v21 offset:15360
    v_mfma_f32_16x16x32_bf16 v[36:39], v[72:75], a[148:151], v[36:39]
    ds_read_b64_tr_b16 v[94:95], v21 offset:16000
    v_mfma_f32_16x16x32_bf16 v[40:43], v[76:79], a[68:71], v[40:43]
    ds_read_b64_tr_b16 v[96:97], v21 offset:15368
    v_mfma_f32_16x16x32_bf16 v[44:47], v[76:79], a[148:151], v[44:47]
    ds_read_b64_tr_b16 v[98:99], v21 offset:16008
    v_mfma_f32_16x16x32_bf16 v[48:51], v[80:83], a[68:71], v[48:51]
    ds_read_b64_tr_b16 v[100:101], v21 offset:15376
    v_mfma_f32_16x16x32_bf16 v[52:55], v[80:83], a[148:151], v[52:55]
    ds_read_b64_tr_b16 v[102:103], v21 offset:16016
    v_mfma_f32_16x16x32_bf16 v[56:59], v[84:87], a[68:71], v[56:59]
    ds_read_b64_tr_b16 v[104:105], v21 offset:15384
    v_mfma_f32_16x16x32_bf16 v[60:63], v[84:87], a[148:151], v[60:63]
    ds_read_b64_tr_b16 v[106:107], v21 offset:16024
    v_mfma_f32_16x16x32_bf16 v[64:67], v[88:91], a[68:71], v[64:67]
    ds_read_b64_tr_b16 v[108:109], v21 offset:15392
    v_mfma_f32_16x16x32_bf16 v[68:71], v[88:91], a[148:151], v[68:71]
    ds_read_b64_tr_b16 v[110:111], v21 offset:16032
    s_waitcnt lgkmcnt(0)
    v_mfma_f32_16x16x32_bf16 v[32:35], v[92:95], a[72:75], v[32:35]
    ds_read_b64_tr_b16 v[72:73], v21 offset:20480
    v_mfma_f32_16x16x32_bf16 v[36:39], v[92:95], a[152:155], v[36:39]
    ds_read_b64_tr_b16 v[74:75], v21 offset:21120
    v_mfma_f32_16x16x32_bf16 v[40:43], v[96:99], a[72:75], v[40:43]
    ds_read_b64_tr_b16 v[76:77], v21 offset:20488
    v_mfma_f32_16x16x32_bf16 v[44:47], v[96:99], a[152:155], v[44:47]
    ds_read_b64_tr_b16 v[78:79], v21 offset:21128
    v_mfma_f32_16x16x32_bf16 v[48:51], v[100:103], a[72:75], v[48:51]
    ds_read_b64_tr_b16 v[80:81], v21 offset:20496
    v_mfma_f32_16x16x32_bf16 v[52:55], v[100:103], a[152:155], v[52:55]
    ds_read_b64_tr_b16 v[82:83], v21 offset:21136
    v_mfma_f32_16x16x32_bf16 v[56:59], v[104:107], a[72:75], v[56:59]
    ds_read_b64_tr_b16 v[84:85], v21 offset:20504
    v_mfma_f32_16x16x32_bf16 v[60:63], v[104:107], a[152:155], v[60:63]
    ds_read_b64_tr_b16 v[86:87], v21 offset:21144
    v_mfma_f32_16x16x32_bf16 v[64:67], v[108:111], a[72:75], v[64:67]
    ds_read_b64_tr_b16 v[88:89], v21 offset:20512
    v_mfma_f32_16x16x32_bf16 v[68:71], v[108:111], a[152:155], v[68:71]
    ds_read_b64_tr_b16 v[90:91], v21 offset:21152
    s_waitcnt lgkmcnt(0)
    v_mfma_f32_16x16x32_bf16 v[32:35], v[72:75], a[76:79], v[32:35]
    v_mfma_f32_16x16x32_bf16 v[36:39], v[72:75], a[156:159], v[36:39]
    v_mfma_f32_16x16x32_bf16 v[40:43], v[76:79], a[76:79], v[40:43]
    v_mfma_f32_16x16x32_bf16 v[44:47], v[76:79], a[156:159], v[44:47]
    v_mfma_f32_16x16x32_bf16 v[48:51], v[80:83], a[76:79], v[48:51]
    v_mfma_f32_16x16x32_bf16 v[52:55], v[80:83], a[156:159], v[52:55]
    v_mfma_f32_16x16x32_bf16 v[56:59], v[84:87], a[76:79], v[56:59]
    v_mfma_f32_16x16x32_bf16 v[60:63], v[84:87], a[156:159], v[60:63]
    v_mfma_f32_16x16x32_bf16 v[64:67], v[88:91], a[76:79], v[64:67]
    v_mfma_f32_16x16x32_bf16 v[68:71], v[88:91], a[156:159], v[68:71]
    s_nop 7
    v_add_u32 v21, 0, v19
    v_cndmask_b32 v21, v19, v21, s[40:41]
    ds_read_b64_tr_b16 v[112:113], v21 offset:0
    ds_read_b64_tr_b16 v[114:115], v21 offset:160
    ds_read_b64_tr_b16 v[116:117], v21 offset:320
    ds_read_b64_tr_b16 v[118:119], v21 offset:480
    ds_read_b64_tr_b16 v[120:121], v21 offset:640
    ds_read_b64_tr_b16 v[122:123], v21 offset:8
    ds_read_b64_tr_b16 v[124:125], v21 offset:168
    ds_read_b64_tr_b16 v[126:127], v21 offset:328
    ds_read_b64_tr_b16 v[128:129], v21 offset:488
    ds_read_b64_tr_b16 v[130:131], v21 offset:648
    s_waitcnt lgkmcnt(0)
    ds_read_b64_tr_b16 v[132:133], v21 offset:16
    ds_read_b64_tr_b16 v[134:135], v21 offset:176
    ds_read_b64_tr_b16 v[136:137], v21 offset:336
    ds_read_b64_tr_b16 v[138:139], v21 offset:496
    ds_read_b64_tr_b16 v[140:141], v21 offset:656
    ds_read_b64_tr_b16 v[142:143], v21 offset:24
    ds_read_b64_tr_b16 v[144:145], v21 offset:184
    ds_read_b64_tr_b16 v[146:147], v21 offset:344
    ds_read_b64_tr_b16 v[148:149], v21 offset:504
    ds_read_b64_tr_b16 v[150:151], v21 offset:664
    s_waitcnt lgkmcnt(0)
    ds_read_b64_tr_b16 v[152:153], v21 offset:32
    ds_read_b64_tr_b16 v[154:155], v21 offset:192
    ds_read_b64_tr_b16 v[156:157], v21 offset:352
    ds_read_b64_tr_b16 v[158:159], v21 offset:512
    ds_read_b64_tr_b16 v[160:161], v21 offset:672
    v_cvt_pk_bf16_f32 v234, v32, v33
    v_cvt_pk_bf16_f32 v235, v34, v35
    v_cvt_pk_bf16_f32 v236, v40, v41
    v_cvt_pk_bf16_f32 v237, v42, v43
    v_cvt_pk_bf16_f32 v238, v48, v49
    v_cvt_pk_bf16_f32 v239, v50, v51
    v_cvt_pk_bf16_f32 v240, v56, v57
    v_cvt_pk_bf16_f32 v241, v58, v59
    v_cvt_pk_bf16_f32 v242, v64, v65
    v_cvt_pk_bf16_f32 v243, v66, v67
    v_cvt_pk_bf16_f32 v244, v36, v37
    v_cvt_pk_bf16_f32 v245, v38, v39
    v_cvt_pk_bf16_f32 v246, v44, v45
    v_cvt_pk_bf16_f32 v247, v46, v47
    v_cvt_pk_bf16_f32 v248, v52, v53
    v_cvt_pk_bf16_f32 v249, v54, v55
    v_cvt_pk_bf16_f32 v250, v60, v61
    v_cvt_pk_bf16_f32 v251, v62, v63
    v_cvt_pk_bf16_f32 v252, v68, v69
    v_cvt_pk_bf16_f32 v253, v70, v71
    s_waitcnt lgkmcnt(0)
    s_nop 1
    v_mfma_f32_16x16x32_bf16 v[72:75], v[112:115], v[234:237], 0
    v_mfma_f32_16x16x32_bf16 v[92:95], v[112:115], v[244:247], 0
    v_mfma_f32_16x16x32_bf16 v[76:79], v[122:125], v[234:237], 0
    v_mfma_f32_16x16x32_bf16 v[96:99], v[122:125], v[244:247], 0
    v_mfma_f32_16x16x32_bf16 v[80:83], v[132:135], v[234:237], 0
    v_mfma_f32_16x16x32_bf16 v[100:103], v[132:135], v[244:247], 0
    v_mfma_f32_16x16x32_bf16 v[84:87], v[142:145], v[234:237], 0
    v_mfma_f32_16x16x32_bf16 v[104:107], v[142:145], v[244:247], 0
    v_mfma_f32_16x16x32_bf16 v[88:91], v[152:155], v[234:237], 0
    v_mfma_f32_16x16x32_bf16 v[108:111], v[152:155], v[244:247], 0
    v_mfma_f32_16x16x32_bf16 v[72:75], v[116:119], v[238:241], v[72:75]
    v_mfma_f32_16x16x32_bf16 v[92:95], v[116:119], v[248:251], v[92:95]
    v_mfma_f32_16x16x32_bf16 v[76:79], v[126:129], v[238:241], v[76:79]
    v_mfma_f32_16x16x32_bf16 v[96:99], v[126:129], v[248:251], v[96:99]
    v_mfma_f32_16x16x32_bf16 v[80:83], v[136:139], v[238:241], v[80:83]
    v_mfma_f32_16x16x32_bf16 v[100:103], v[136:139], v[248:251], v[100:103]
    v_mfma_f32_16x16x32_bf16 v[84:87], v[146:149], v[238:241], v[84:87]
    v_mfma_f32_16x16x32_bf16 v[104:107], v[146:149], v[248:251], v[104:107]
    v_mfma_f32_16x16x32_bf16 v[88:91], v[156:159], v[238:241], v[88:91]
    v_mfma_f32_16x16x32_bf16 v[108:111], v[156:159], v[248:251], v[108:111]
    v_mfma_f32_16x16x16_bf16 v[72:75], v[120:121], v[242:243], v[72:75]
    v_mfma_f32_16x16x16_bf16 v[92:95], v[120:121], v[252:253], v[92:95]
    v_mfma_f32_16x16x16_bf16 v[76:79], v[130:131], v[242:243], v[76:79]
    v_mfma_f32_16x16x16_bf16 v[96:99], v[130:131], v[252:253], v[96:99]
    v_mfma_f32_16x16x16_bf16 v[80:83], v[140:141], v[242:243], v[80:83]
    v_mfma_f32_16x16x16_bf16 v[100:103], v[140:141], v[252:253], v[100:103]
    v_mfma_f32_16x16x16_bf16 v[84:87], v[150:151], v[242:243], v[84:87]
    v_mfma_f32_16x16x16_bf16 v[104:107], v[150:151], v[252:253], v[104:107]
    v_mfma_f32_16x16x16_bf16 v[88:91], v[160:161], v[242:243], v[88:91]
    v_mfma_f32_16x16x16_bf16 v[108:111], v[160:161], v[252:253], v[108:111]
    s_mov_b32 s24, 0x3fb8aa3b
    s_nop 7
    v_cvt_pk_bf16_f32 v8, v72, v73
    v_lshlrev_b32 v72, 16, v8
    v_and_b32 v73, 0xffff0000, v8
    v_cvt_pk_bf16_f32 v8, v74, v75
    v_lshlrev_b32 v74, 16, v8
    v_and_b32 v75, 0xffff0000, v8
    v_cvt_pk_bf16_f32 v8, v76, v77
    v_lshlrev_b32 v76, 16, v8
    v_and_b32 v77, 0xffff0000, v8
    v_cvt_pk_bf16_f32 v8, v78, v79
    v_lshlrev_b32 v78, 16, v8
    v_and_b32 v79, 0xffff0000, v8
    v_cvt_pk_bf16_f32 v8, v80, v81
    v_lshlrev_b32 v80, 16, v8
    v_and_b32 v81, 0xffff0000, v8
    v_cvt_pk_bf16_f32 v8, v82, v83
    v_lshlrev_b32 v82, 16, v8
    v_and_b32 v83, 0xffff0000, v8
    v_cvt_pk_bf16_f32 v8, v84, v85
    v_lshlrev_b32 v84, 16, v8
    v_and_b32 v85, 0xffff0000, v8
    v_cvt_pk_bf16_f32 v8, v86, v87
    v_lshlrev_b32 v86, 16, v8
    v_and_b32 v87, 0xffff0000, v8
    v_cvt_pk_bf16_f32 v8, v88, v89
    v_lshlrev_b32 v88, 16, v8
    v_and_b32 v89, 0xffff0000, v8
    v_cvt_pk_bf16_f32 v8, v90, v91
    v_lshlrev_b32 v90, 16, v8
    v_and_b32 v91, 0xffff0000, v8
    v_max3_f32 v8, v72, v73, v74
    v_max3_f32 v8, v8, v75, v76
    v_max3_f32 v8, v8, v77, v78
    v_max3_f32 v8, v8, v79, v80
    v_max3_f32 v8, v8, v81, v82
    v_max3_f32 v8, v8, v83, v84
    v_max3_f32 v8, v8, v85, v86
    v_max3_f32 v8, v8, v87, v88
    v_max3_f32 v8, v8, v89, v90
    v_max_f32 v8, v8, v91
    v_min3_f32 v9, v72, v73, v74
    v_min3_f32 v9, v9, v75, v76
    v_min3_f32 v9, v9, v77, v78
    v_min3_f32 v9, v9, v79, v80
    v_min3_f32 v9, v9, v81, v82
    v_min3_f32 v9, v9, v83, v84
    v_min3_f32 v9, v9, v85, v86
    v_min3_f32 v9, v9, v87, v88
    v_min3_f32 v9, v9, v89, v90
    v_min_f32 v9, v9, v91
    v_mul_f32 v8, s24, v8
    v_mul_f32 v9, s24, v9
    v_fma_f32 v32, -v72, s24, v9
    v_fma_f32 v72, v72, s24, -v8
    v_fma_f32 v33, -v73, s24, v9
    v_fma_f32 v73, v73, s24, -v8
    v_fma_f32 v34, -v74, s24, v9
    v_fma_f32 v74, v74, s24, -v8
    v_fma_f32 v35, -v75, s24, v9
    v_fma_f32 v75, v75, s24, -v8
    v_fma_f32 v36, -v76, s24, v9
    v_fma_f32 v76, v76, s24, -v8
    v_fma_f32 v37, -v77, s24, v9
    v_fma_f32 v77, v77, s24, -v8
    v_fma_f32 v38, -v78, s24, v9
    v_fma_f32 v78, v78, s24, -v8
    v_fma_f32 v39, -v79, s24, v9
    v_fma_f32 v79, v79, s24, -v8
    v_fma_f32 v40, -v80, s24, v9
    v_fma_f32 v80, v80, s24, -v8
    v_fma_f32 v41, -v81, s24, v9
    v_fma_f32 v81, v81, s24, -v8
    v_fma_f32 v42, -v82, s24, v9
    v_fma_f32 v82, v82, s24, -v8
    v_fma_f32 v43, -v83, s24, v9
    v_fma_f32 v83, v83, s24, -v8
    v_fma_f32 v44, -v84, s24, v9
    v_fma_f32 v84, v84, s24, -v8
    v_fma_f32 v45, -v85, s24, v9
    v_fma_f32 v85, v85, s24, -v8
    v_fma_f32 v46, -v86, s24, v9
    v_fma_f32 v86, v86, s24, -v8
    v_fma_f32 v47, -v87, s24, v9
    v_fma_f32 v87, v87, s24, -v8
    v_fma_f32 v48, -v88, s24, v9
    v_fma_f32 v88, v88, s24, -v8
    v_fma_f32 v49, -v89, s24, v9
    v_fma_f32 v89, v89, s24, -v8
    v_fma_f32 v50, -v90, s24, v9
    v_fma_f32 v90, v90, s24, -v8
    v_fma_f32 v51, -v91, s24, v9
    v_fma_f32 v91, v91, s24, -v8
    v_exp_f32 v32, v32
    v_exp_f32 v72, v72
    v_exp_f32 v33, v33
    v_exp_f32 v73, v73
    v_exp_f32 v34, v34
    v_exp_f32 v74, v74
    v_exp_f32 v35, v35
    v_exp_f32 v75, v75
    v_exp_f32 v36, v36
    v_exp_f32 v76, v76
    v_exp_f32 v37, v37
    v_exp_f32 v77, v77
    v_exp_f32 v38, v38
    v_exp_f32 v78, v78
    v_exp_f32 v39, v39
    v_exp_f32 v79, v79
    v_exp_f32 v40, v40
    v_exp_f32 v80, v80
    v_exp_f32 v41, v41
    v_exp_f32 v81, v81
    v_exp_f32 v42, v42
    v_exp_f32 v82, v82
    v_exp_f32 v43, v43
    v_exp_f32 v83, v83
    v_exp_f32 v44, v44
    v_exp_f32 v84, v84
    v_exp_f32 v45, v45
    v_exp_f32 v85, v85
    v_exp_f32 v46, v46
    v_exp_f32 v86, v86
    v_exp_f32 v47, v47
    v_exp_f32 v87, v87
    v_exp_f32 v48, v48
    v_exp_f32 v88, v88
    v_exp_f32 v49, v49
    v_exp_f32 v89, v89
    v_exp_f32 v50, v50
    v_exp_f32 v90, v90
    v_exp_f32 v51, v51
    v_exp_f32 v91, v91
    v_add_f32 v9, v32, v33
    v_add_f32 v9, v9, v34
    v_add_f32 v9, v9, v35
    v_add_f32 v9, v9, v36
    v_add_f32 v9, v9, v37
    v_add_f32 v9, v9, v38
    v_add_f32 v9, v9, v39
    v_add_f32 v9, v9, v40
    v_add_f32 v9, v9, v41
    v_add_f32 v9, v9, v42
    v_add_f32 v9, v9, v43
    v_add_f32 v9, v9, v44
    v_add_f32 v9, v9, v45
    v_add_f32 v9, v9, v46
    v_add_f32 v9, v9, v47
    v_add_f32 v9, v9, v48
    v_add_f32 v9, v9, v49
    v_add_f32 v9, v9, v50
    v_add_f32 v9, v9, v51
    v_add_f32 v8, v72, v73
    v_add_f32 v8, v8, v74
    v_add_f32 v8, v8, v75
    v_add_f32 v8, v8, v76
    v_add_f32 v8, v8, v77
    v_add_f32 v8, v8, v78
    v_add_f32 v8, v8, v79
    v_add_f32 v8, v8, v80
    v_add_f32 v8, v8, v81
    v_add_f32 v8, v8, v82
    v_add_f32 v8, v8, v83
    v_add_f32 v8, v8, v84
    v_add_f32 v8, v8, v85
    v_add_f32 v8, v8, v86
    v_add_f32 v8, v8, v87
    v_add_f32 v8, v8, v88
    v_add_f32 v8, v8, v89
    v_add_f32 v8, v8, v90
    v_add_f32 v8, v8, v91
    v_rcp_f32 v8, v8
    v_rcp_f32 v9, v9
    s_nop 0
    v_mul_f32 v72, v72, v8
    v_mul_f32 v32, v32, v9
    v_mul_f32 v73, v73, v8
    v_mul_f32 v33, v33, v9
    v_mul_f32 v74, v74, v8
    v_mul_f32 v34, v34, v9
    v_mul_f32 v75, v75, v8
    v_mul_f32 v35, v35, v9
    v_mul_f32 v76, v76, v8
    v_mul_f32 v36, v36, v9
    v_mul_f32 v77, v77, v8
    v_mul_f32 v37, v37, v9
    v_mul_f32 v78, v78, v8
    v_mul_f32 v38, v38, v9
    v_mul_f32 v79, v79, v8
    v_mul_f32 v39, v39, v9
    v_mul_f32 v80, v80, v8
    v_mul_f32 v40, v40, v9
    v_mul_f32 v81, v81, v8
    v_mul_f32 v41, v41, v9
    v_mul_f32 v82, v82, v8
    v_mul_f32 v42, v42, v9
    v_mul_f32 v83, v83, v8
    v_mul_f32 v43, v43, v9
    v_mul_f32 v84, v84, v8
    v_mul_f32 v44, v44, v9
    v_mul_f32 v85, v85, v8
    v_mul_f32 v45, v45, v9
    v_mul_f32 v86, v86, v8
    v_mul_f32 v46, v46, v9
    v_mul_f32 v87, v87, v8
    v_mul_f32 v47, v47, v9
    v_mul_f32 v88, v88, v8
    v_mul_f32 v48, v48, v9
    v_mul_f32 v89, v89, v8
    v_mul_f32 v49, v49, v9
    v_mul_f32 v90, v90, v8
    v_mul_f32 v50, v50, v9
    v_mul_f32 v91, v91, v8
    v_mul_f32 v51, v51, v9
    v_cvt_pk_bf16_f32 v162, v72, v73
    v_cvt_pk_bf16_f32 v172, v32, v33
    v_cvt_pk_bf16_f32 v163, v74, v75
    v_cvt_pk_bf16_f32 v173, v34, v35
    v_cvt_pk_bf16_f32 v164, v76, v77
    v_cvt_pk_bf16_f32 v174, v36, v37
    v_cvt_pk_bf16_f32 v165, v78, v79
    v_cvt_pk_bf16_f32 v175, v38, v39
    v_cvt_pk_bf16_f32 v166, v80, v81
    v_cvt_pk_bf16_f32 v176, v40, v41
    v_cvt_pk_bf16_f32 v167, v82, v83
    v_cvt_pk_bf16_f32 v177, v42, v43
    v_cvt_pk_bf16_f32 v168, v84, v85
    v_cvt_pk_bf16_f32 v178, v44, v45
    v_cvt_pk_bf16_f32 v169, v86, v87
    v_cvt_pk_bf16_f32 v179, v46, v47
    v_cvt_pk_bf16_f32 v170, v88, v89
    v_cvt_pk_bf16_f32 v180, v48, v49
    v_cvt_pk_bf16_f32 v171, v90, v91
    v_cvt_pk_bf16_f32 v181, v50, v51
    v_cvt_pk_bf16_f32 v8, v92, v93
    v_lshlrev_b32 v92, 16, v8
    v_and_b32 v93, 0xffff0000, v8
    v_cvt_pk_bf16_f32 v8, v94, v95
    v_lshlrev_b32 v94, 16, v8
    v_and_b32 v95, 0xffff0000, v8
    v_cvt_pk_bf16_f32 v8, v96, v97
    v_lshlrev_b32 v96, 16, v8
    v_and_b32 v97, 0xffff0000, v8
    v_cvt_pk_bf16_f32 v8, v98, v99
    v_lshlrev_b32 v98, 16, v8
    v_and_b32 v99, 0xffff0000, v8
    v_cvt_pk_bf16_f32 v8, v100, v101
    v_lshlrev_b32 v100, 16, v8
    v_and_b32 v101, 0xffff0000, v8
    v_cvt_pk_bf16_f32 v8, v102, v103
    v_lshlrev_b32 v102, 16, v8
    v_and_b32 v103, 0xffff0000, v8
    v_cvt_pk_bf16_f32 v8, v104, v105
    v_lshlrev_b32 v104, 16, v8
    v_and_b32 v105, 0xffff0000, v8
    v_cvt_pk_bf16_f32 v8, v106, v107
    v_lshlrev_b32 v106, 16, v8
    v_and_b32 v107, 0xffff0000, v8
    v_cvt_pk_bf16_f32 v8, v108, v109
    v_lshlrev_b32 v108, 16, v8
    v_and_b32 v109, 0xffff0000, v8
    v_cvt_pk_bf16_f32 v8, v110, v111
    v_lshlrev_b32 v110, 16, v8
    v_and_b32 v111, 0xffff0000, v8
    v_max3_f32 v8, v92, v93, v94
    v_max3_f32 v8, v8, v95, v96
    v_max3_f32 v8, v8, v97, v98
    v_max3_f32 v8, v8, v99, v100
    v_max3_f32 v8, v8, v101, v102
    v_max3_f32 v8, v8, v103, v104
    v_max3_f32 v8, v8, v105, v106
    v_max3_f32 v8, v8, v107, v108
    v_max3_f32 v8, v8, v109, v110
    v_max_f32 v8, v8, v111
    v_min3_f32 v9, v92, v93, v94
    v_min3_f32 v9, v9, v95, v96
    v_min3_f32 v9, v9, v97, v98
    v_min3_f32 v9, v9, v99, v100
    v_min3_f32 v9, v9, v101, v102
    v_min3_f32 v9, v9, v103, v104
    v_min3_f32 v9, v9, v105, v106
    v_min3_f32 v9, v9, v107, v108
    v_min3_f32 v9, v9, v109, v110
    v_min_f32 v9, v9, v111
    v_mul_f32 v8, s24, v8
    v_mul_f32 v9, s24, v9
    v_fma_f32 v32, -v92, s24, v9
    v_fma_f32 v92, v92, s24, -v8
    v_fma_f32 v33, -v93, s24, v9
    v_fma_f32 v93, v93, s24, -v8
    v_fma_f32 v34, -v94, s24, v9
    v_fma_f32 v94, v94, s24, -v8
    v_fma_f32 v35, -v95, s24, v9
    v_fma_f32 v95, v95, s24, -v8
    v_fma_f32 v36, -v96, s24, v9
    v_fma_f32 v96, v96, s24, -v8
    v_fma_f32 v37, -v97, s24, v9
    v_fma_f32 v97, v97, s24, -v8
    v_fma_f32 v38, -v98, s24, v9
    v_fma_f32 v98, v98, s24, -v8
    v_fma_f32 v39, -v99, s24, v9
    v_fma_f32 v99, v99, s24, -v8
    v_fma_f32 v40, -v100, s24, v9
    v_fma_f32 v100, v100, s24, -v8
    v_fma_f32 v41, -v101, s24, v9
    v_fma_f32 v101, v101, s24, -v8
    v_fma_f32 v42, -v102, s24, v9
    v_fma_f32 v102, v102, s24, -v8
    v_fma_f32 v43, -v103, s24, v9
    v_fma_f32 v103, v103, s24, -v8
    v_fma_f32 v44, -v104, s24, v9
    v_fma_f32 v104, v104, s24, -v8
    v_fma_f32 v45, -v105, s24, v9
    v_fma_f32 v105, v105, s24, -v8
    v_fma_f32 v46, -v106, s24, v9
    v_fma_f32 v106, v106, s24, -v8
    v_fma_f32 v47, -v107, s24, v9
    v_fma_f32 v107, v107, s24, -v8
    v_fma_f32 v48, -v108, s24, v9
    v_fma_f32 v108, v108, s24, -v8
    v_fma_f32 v49, -v109, s24, v9
    v_fma_f32 v109, v109, s24, -v8
    v_fma_f32 v50, -v110, s24, v9
    v_fma_f32 v110, v110, s24, -v8
    v_fma_f32 v51, -v111, s24, v9
    v_fma_f32 v111, v111, s24, -v8
    v_exp_f32 v32, v32
    v_exp_f32 v92, v92
    v_exp_f32 v33, v33
    v_exp_f32 v93, v93
    v_exp_f32 v34, v34
    v_exp_f32 v94, v94
    v_exp_f32 v35, v35
    v_exp_f32 v95, v95
    v_exp_f32 v36, v36
    v_exp_f32 v96, v96
    v_exp_f32 v37, v37
    v_exp_f32 v97, v97
    v_exp_f32 v38, v38
    v_exp_f32 v98, v98
    v_exp_f32 v39, v39
    v_exp_f32 v99, v99
    v_exp_f32 v40, v40
    v_exp_f32 v100, v100
    v_exp_f32 v41, v41
    v_exp_f32 v101, v101
    v_exp_f32 v42, v42
    v_exp_f32 v102, v102
    v_exp_f32 v43, v43
    v_exp_f32 v103, v103
    v_exp_f32 v44, v44
    v_exp_f32 v104, v104
    v_exp_f32 v45, v45
    v_exp_f32 v105, v105
    v_exp_f32 v46, v46
    v_exp_f32 v106, v106
    v_exp_f32 v47, v47
    v_exp_f32 v107, v107
    v_exp_f32 v48, v48
    v_exp_f32 v108, v108
    v_exp_f32 v49, v49
    v_exp_f32 v109, v109
    v_exp_f32 v50, v50
    v_exp_f32 v110, v110
    v_exp_f32 v51, v51
    v_exp_f32 v111, v111
    v_add_f32 v9, v32, v33
    v_add_f32 v9, v9, v34
    v_add_f32 v9, v9, v35
    v_add_f32 v9, v9, v36
    v_add_f32 v9, v9, v37
    v_add_f32 v9, v9, v38
    v_add_f32 v9, v9, v39
    v_add_f32 v9, v9, v40
    v_add_f32 v9, v9, v41
    v_add_f32 v9, v9, v42
    v_add_f32 v9, v9, v43
    v_add_f32 v9, v9, v44
    v_add_f32 v9, v9, v45
    v_add_f32 v9, v9, v46
    v_add_f32 v9, v9, v47
    v_add_f32 v9, v9, v48
    v_add_f32 v9, v9, v49
    v_add_f32 v9, v9, v50
    v_add_f32 v9, v9, v51
    v_add_f32 v8, v92, v93
    v_add_f32 v8, v8, v94
    v_add_f32 v8, v8, v95
    v_add_f32 v8, v8, v96
    v_add_f32 v8, v8, v97
    v_add_f32 v8, v8, v98
    v_add_f32 v8, v8, v99
    v_add_f32 v8, v8, v100
    v_add_f32 v8, v8, v101
    v_add_f32 v8, v8, v102
    v_add_f32 v8, v8, v103
    v_add_f32 v8, v8, v104
    v_add_f32 v8, v8, v105
    v_add_f32 v8, v8, v106
    v_add_f32 v8, v8, v107
    v_add_f32 v8, v8, v108
    v_add_f32 v8, v8, v109
    v_add_f32 v8, v8, v110
    v_add_f32 v8, v8, v111
    v_rcp_f32 v8, v8
    v_rcp_f32 v9, v9
    s_nop 0
    v_mul_f32 v92, v92, v8
    v_mul_f32 v32, v32, v9
    v_mul_f32 v93, v93, v8
    v_mul_f32 v33, v33, v9
    v_mul_f32 v94, v94, v8
    v_mul_f32 v34, v34, v9
    v_mul_f32 v95, v95, v8
    v_mul_f32 v35, v35, v9
    v_mul_f32 v96, v96, v8
    v_mul_f32 v36, v36, v9
    v_mul_f32 v97, v97, v8
    v_mul_f32 v37, v37, v9
    v_mul_f32 v98, v98, v8
    v_mul_f32 v38, v38, v9
    v_mul_f32 v99, v99, v8
    v_mul_f32 v39, v39, v9
    v_mul_f32 v100, v100, v8
    v_mul_f32 v40, v40, v9
    v_mul_f32 v101, v101, v8
    v_mul_f32 v41, v41, v9
    v_mul_f32 v102, v102, v8
    v_mul_f32 v42, v42, v9
    v_mul_f32 v103, v103, v8
    v_mul_f32 v43, v43, v9
    v_mul_f32 v104, v104, v8
    v_mul_f32 v44, v44, v9
    v_mul_f32 v105, v105, v8
    v_mul_f32 v45, v45, v9
    v_mul_f32 v106, v106, v8
    v_mul_f32 v46, v46, v9
    v_mul_f32 v107, v107, v8
    v_mul_f32 v47, v47, v9
    v_mul_f32 v108, v108, v8
    v_mul_f32 v48, v48, v9
    v_mul_f32 v109, v109, v8
    v_mul_f32 v49, v49, v9
    v_mul_f32 v110, v110, v8
    v_mul_f32 v50, v50, v9
    v_mul_f32 v111, v111, v8
    v_mul_f32 v51, v51, v9
    v_cvt_pk_bf16_f32 v182, v92, v93
    v_cvt_pk_bf16_f32 v192, v32, v33
    v_cvt_pk_bf16_f32 v183, v94, v95
    v_cvt_pk_bf16_f32 v193, v34, v35
    v_cvt_pk_bf16_f32 v184, v96, v97
    v_cvt_pk_bf16_f32 v194, v36, v37
    v_cvt_pk_bf16_f32 v185, v98, v99
    v_cvt_pk_bf16_f32 v195, v38, v39
    v_cvt_pk_bf16_f32 v186, v100, v101
    v_cvt_pk_bf16_f32 v196, v40, v41
    v_cvt_pk_bf16_f32 v187, v102, v103
    v_cvt_pk_bf16_f32 v197, v42, v43
    v_cvt_pk_bf16_f32 v188, v104, v105
    v_cvt_pk_bf16_f32 v198, v44, v45
    v_cvt_pk_bf16_f32 v189, v106, v107
    v_cvt_pk_bf16_f32 v199, v46, v47
    v_cvt_pk_bf16_f32 v190, v108, v109
    v_cvt_pk_bf16_f32 v200, v48, v49
    v_cvt_pk_bf16_f32 v191, v110, v111
    v_cvt_pk_bf16_f32 v201, v50, v51
    s_waitcnt vmcnt(14)
    s_barrier
    s_add_u32 s28, s33, 1845760
    s_mul_i32 s24, s9, 7168
    s_add_u32 m0, s24, 86016
    s_nop 0
    buffer_load_dwordx4 v0, s[20:23], s28 offen lds
    s_add_u32 m0, s24, 87040
    s_nop 0
    buffer_load_dwordx4 v1, s[20:23], s28 offen lds
    s_add_u32 m0, s24, 88064
    s_nop 0
    buffer_load_dwordx4 v2, s[20:23], s28 offen lds
    s_add_u32 m0, s24, 89088
    s_nop 0
    buffer_load_dwordx4 v3, s[20:23], s28 offen lds
    s_add_u32 m0, s24, 90112
    s_nop 0
    buffer_load_dwordx4 v4, s[20:23], s28 offen lds
    s_add_u32 m0, s24, 91136
    s_nop 0
    buffer_load_dwordx4 v5, s[20:23], s28 offen lds
    s_add_u32 m0, s24, 92160
    s_nop 0
    buffer_load_dwordx4 v6, s[20:23], s28 offen lds
    v_add_u32 v21, 0, v17
    v_add_u32 v22, 0, v16
    ds_read_b64_tr_b16 v[72:73], v21 offset:0
    ds_read_b64_tr_b16 v[74:75], v21 offset:640
    ds_read_b64_tr_b16 v[76:77], v21 offset:40
    ds_read_b64_tr_b16 v[78:79], v21 offset:680
    ds_read_b64_tr_b16 v[80:81], v21 offset:80
    ds_read_b64_tr_b16 v[82:83], v21 offset:720
    ds_read_b64_tr_b16 v[84:85], v21 offset:120
    ds_read_b64_tr_b16 v[86:87], v21 offset:760
    ds_read_b64_tr_b16 v[88:89], v22 offset:32
    ds_read_b64_tr_b16 v[90:91], v22 offset:672
    s_waitcnt lgkmcnt(0)
    v_mfma_f32_16x16x32_bf16 v[32:35], a[0:3], v[72:75], 0
    ds_read_b64_tr_b16 v[92:93], v21 offset:5120
    v_mfma_f32_16x16x32_bf16 v[36:39], a[80:83], v[72:75], 0
    ds_read_b64_tr_b16 v[94:95], v21 offset:5760
    v_mfma_f32_16x16x32_bf16 v[40:43], a[0:3], v[76:79], 0
    ds_read_b64_tr_b16 v[96:97], v21 offset:5160
    v_mfma_f32_16x16x32_bf16 v[44:47], a[80:83], v[76:79], 0
    ds_read_b64_tr_b16 v[98:99], v21 offset:5800
    v_mfma_f32_16x16x32_bf16 v[48:51], a[0:3], v[80:83], 0
    ds_read_b64_tr_b16 v[100:101], v21 offset:5200
    v_mfma_f32_16x16x32_bf16 v[52:55], a[80:83], v[80:83], 0
    ds_read_b64_tr_b16 v[102:103], v21 offset:5840
    v_mfma_f32_16x16x32_bf16 v[56:59], a[0:3], v[84:87], 0
    ds_read_b64_tr_b16 v[104:105], v21 offset:5240
    v_mfma_f32_16x16x32_bf16 v[60:63], a[80:83], v[84:87], 0
    ds_read_b64_tr_b16 v[106:107], v21 offset:5880
    v_mfma_f32_16x16x32_bf16 v[64:67], a[0:3], v[88:91], 0
    ds_read_b64_tr_b16 v[108:109], v22 offset:5152
    v_mfma_f32_16x16x32_bf16 v[68:71], a[80:83], v[88:91], 0
    ds_read_b64_tr_b16 v[110:111], v22 offset:5792
    s_waitcnt lgkmcnt(0)
    v_mfma_f32_16x16x32_bf16 v[32:35], a[4:7], v[92:95], v[32:35]
    ds_read_b64_tr_b16 v[72:73], v21 offset:10240
    v_mfma_f32_16x16x32_bf16 v[36:39], a[84:87], v[92:95], v[36:39]
    ds_read_b64_tr_b16 v[74:75], v21 offset:10880
    v_mfma_f32_16x16x32_bf16 v[40:43], a[4:7], v[96:99], v[40:43]
    ds_read_b64_tr_b16 v[76:77], v21 offset:10280
    v_mfma_f32_16x16x32_bf16 v[44:47], a[84:87], v[96:99], v[44:47]
    ds_read_b64_tr_b16 v[78:79], v21 offset:10920
    v_mfma_f32_16x16x32_bf16 v[48:51], a[4:7], v[100:103], v[48:51]
    ds_read_b64_tr_b16 v[80:81], v21 offset:10320
    v_mfma_f32_16x16x32_bf16 v[52:55], a[84:87], v[100:103], v[52:55]
    ds_read_b64_tr_b16 v[82:83], v21 offset:10960
    v_mfma_f32_16x16x32_bf16 v[56:59], a[4:7], v[104:107], v[56:59]
    ds_read_b64_tr_b16 v[84:85], v21 offset:10360
    v_mfma_f32_16x16x32_bf16 v[60:63], a[84:87], v[104:107], v[60:63]
    ds_read_b64_tr_b16 v[86:87], v21 offset:11000
    v_mfma_f32_16x16x32_bf16 v[64:67], a[4:7], v[108:111], v[64:67]
    ds_read_b64_tr_b16 v[88:89], v22 offset:10272
    v_mfma_f32_16x16x32_bf16 v[68:71], a[84:87], v[108:111], v[68:71]
    ds_read_b64_tr_b16 v[90:91], v22 offset:10912
    s_waitcnt lgkmcnt(0)
    v_mfma_f32_16x16x32_bf16 v[32:35], a[8:11], v[72:75], v[32:35]
    ds_read_b64_tr_b16 v[92:93], v21 offset:15360
    v_mfma_f32_16x16x32_bf16 v[36:39], a[88:91], v[72:75], v[36:39]
    ds_read_b64_tr_b16 v[94:95], v21 offset:16000
    v_mfma_f32_16x16x32_bf16 v[40:43], a[8:11], v[76:79], v[40:43]
    ds_read_b64_tr_b16 v[96:97], v21 offset:15400
    v_mfma_f32_16x16x32_bf16 v[44:47], a[88:91], v[76:79], v[44:47]
    ds_read_b64_tr_b16 v[98:99], v21 offset:16040
    v_mfma_f32_16x16x32_bf16 v[48:51], a[8:11], v[80:83], v[48:51]
    ds_read_b64_tr_b16 v[100:101], v21 offset:15440
    v_mfma_f32_16x16x32_bf16 v[52:55], a[88:91], v[80:83], v[52:55]
    ds_read_b64_tr_b16 v[102:103], v21 offset:16080
    v_mfma_f32_16x16x32_bf16 v[56:59], a[8:11], v[84:87], v[56:59]
    ds_read_b64_tr_b16 v[104:105], v21 offset:15480
    v_mfma_f32_16x16x32_bf16 v[60:63], a[88:91], v[84:87], v[60:63]
    ds_read_b64_tr_b16 v[106:107], v21 offset:16120
    v_mfma_f32_16x16x32_bf16 v[64:67], a[8:11], v[88:91], v[64:67]
    ds_read_b64_tr_b16 v[108:109], v22 offset:15392
    v_mfma_f32_16x16x32_bf16 v[68:71], a[88:91], v[88:91], v[68:71]
    ds_read_b64_tr_b16 v[110:111], v22 offset:16032
    s_waitcnt lgkmcnt(0)
    v_mfma_f32_16x16x32_bf16 v[32:35], a[12:15], v[92:95], v[32:35]
    ds_read_b64_tr_b16 v[72:73], v21 offset:20480
    v_mfma_f32_16x16x32_bf16 v[36:39], a[92:95], v[92:95], v[36:39]
    ds_read_b64_tr_b16 v[74:75], v21 offset:21120
    v_mfma_f32_16x16x32_bf16 v[40:43], a[12:15], v[96:99], v[40:43]
    ds_read_b64_tr_b16 v[76:77], v21 offset:20520
    v_mfma_f32_16x16x32_bf16 v[44:47], a[92:95], v[96:99], v[44:47]
    ds_read_b64_tr_b16 v[78:79], v21 offset:21160
    v_mfma_f32_16x16x32_bf16 v[48:51], a[12:15], v[100:103], v[48:51]
    ds_read_b64_tr_b16 v[80:81], v21 offset:20560
    v_mfma_f32_16x16x32_bf16 v[52:55], a[92:95], v[100:103], v[52:55]
    ds_read_b64_tr_b16 v[82:83], v21 offset:21200
    v_mfma_f32_16x16x32_bf16 v[56:59], a[12:15], v[104:107], v[56:59]
    ds_read_b64_tr_b16 v[84:85], v21 offset:20600
    v_mfma_f32_16x16x32_bf16 v[60:63], a[92:95], v[104:107], v[60:63]
    ds_read_b64_tr_b16 v[86:87], v21 offset:21240
    v_mfma_f32_16x16x32_bf16 v[64:67], a[12:15], v[108:111], v[64:67]
    ds_read_b64_tr_b16 v[88:89], v22 offset:20512
    v_mfma_f32_16x16x32_bf16 v[68:71], a[92:95], v[108:111], v[68:71]
    ds_read_b64_tr_b16 v[90:91], v22 offset:21152
    s_waitcnt lgkmcnt(0)
    v_mfma_f32_16x16x32_bf16 v[32:35], a[16:19], v[72:75], v[32:35]
    v_mfma_f32_16x16x32_bf16 v[36:39], a[96:99], v[72:75], v[36:39]
    v_mfma_f32_16x16x32_bf16 v[40:43], a[16:19], v[76:79], v[40:43]
    v_mfma_f32_16x16x32_bf16 v[44:47], a[96:99], v[76:79], v[44:47]
    v_mfma_f32_16x16x32_bf16 v[48:51], a[16:19], v[80:83], v[48:51]
    v_mfma_f32_16x16x32_bf16 v[52:55], a[96:99], v[80:83], v[52:55]
    v_mfma_f32_16x16x32_bf16 v[56:59], a[16:19], v[84:87], v[56:59]
    v_mfma_f32_16x16x32_bf16 v[60:63], a[96:99], v[84:87], v[60:63]
    v_mfma_f32_16x16x32_bf16 v[64:67], a[16:19], v[88:91], v[64:67]
    v_mfma_f32_16x16x32_bf16 v[68:71], a[96:99], v[88:91], v[68:71]
    s_waitcnt vmcnt(14)
    s_barrier
    s_add_u32 s28, s33, 1440
    s_mul_i32 s24, s9, 7168
    s_add_u32 m0, s24, 0
    s_nop 0
    buffer_load_dwordx4 v0, s[20:23], s28 offen lds
    s_add_u32 m0, s24, 1024
    s_nop 0
    buffer_load_dwordx4 v1, s[20:23], s28 offen lds
    s_add_u32 m0, s24, 2048
    s_nop 0
    buffer_load_dwordx4 v2, s[20:23], s28 offen lds
    s_add_u32 m0, s24, 3072
    s_nop 0
    buffer_load_dwordx4 v3, s[20:23], s28 offen lds
    s_add_u32 m0, s24, 4096
    s_nop 0
    buffer_load_dwordx4 v4, s[20:23], s28 offen lds
    s_add_u32 m0, s24, 5120
    s_nop 0
    buffer_load_dwordx4 v5, s[20:23], s28 offen lds
    s_add_u32 m0, s24, 6144
    s_nop 0
    buffer_load_dwordx4 v6, s[20:23], s28 offen lds
    v_add_u32 v21, 28672, v17
    v_add_u32 v22, 28672, v16
    ds_read_b64_tr_b16 v[72:73], v21 offset:0
    ds_read_b64_tr_b16 v[74:75], v21 offset:640
    ds_read_b64_tr_b16 v[76:77], v21 offset:40
    ds_read_b64_tr_b16 v[78:79], v21 offset:680
    ds_read_b64_tr_b16 v[80:81], v21 offset:80
    ds_read_b64_tr_b16 v[82:83], v21 offset:720
    ds_read_b64_tr_b16 v[84:85], v21 offset:120
    ds_read_b64_tr_b16 v[86:87], v21 offset:760
    ds_read_b64_tr_b16 v[88:89], v22 offset:32
    ds_read_b64_tr_b16 v[90:91], v22 offset:672
    s_waitcnt lgkmcnt(0)
    v_mfma_f32_16x16x32_bf16 v[32:35], a[20:23], v[72:75], v[32:35]
    ds_read_b64_tr_b16 v[92:93], v21 offset:5120
    v_mfma_f32_16x16x32_bf16 v[36:39], a[100:103], v[72:75], v[36:39]
    ds_read_b64_tr_b16 v[94:95], v21 offset:5760
    v_mfma_f32_16x16x32_bf16 v[40:43], a[20:23], v[76:79], v[40:43]
    ds_read_b64_tr_b16 v[96:97], v21 offset:5160
    v_mfma_f32_16x16x32_bf16 v[44:47], a[100:103], v[76:79], v[44:47]
    ds_read_b64_tr_b16 v[98:99], v21 offset:5800
    v_mfma_f32_16x16x32_bf16 v[48:51], a[20:23], v[80:83], v[48:51]
    ds_read_b64_tr_b16 v[100:101], v21 offset:5200
    v_mfma_f32_16x16x32_bf16 v[52:55], a[100:103], v[80:83], v[52:55]
    ds_read_b64_tr_b16 v[102:103], v21 offset:5840
    v_mfma_f32_16x16x32_bf16 v[56:59], a[20:23], v[84:87], v[56:59]
    ds_read_b64_tr_b16 v[104:105], v21 offset:5240
    v_mfma_f32_16x16x32_bf16 v[60:63], a[100:103], v[84:87], v[60:63]
    ds_read_b64_tr_b16 v[106:107], v21 offset:5880
    v_mfma_f32_16x16x32_bf16 v[64:67], a[20:23], v[88:91], v[64:67]
    ds_read_b64_tr_b16 v[108:109], v22 offset:5152
    v_mfma_f32_16x16x32_bf16 v[68:71], a[100:103], v[88:91], v[68:71]
    ds_read_b64_tr_b16 v[110:111], v22 offset:5792
    s_waitcnt lgkmcnt(0)
    v_mfma_f32_16x16x32_bf16 v[32:35], a[24:27], v[92:95], v[32:35]
    ds_read_b64_tr_b16 v[72:73], v21 offset:10240
    v_mfma_f32_16x16x32_bf16 v[36:39], a[104:107], v[92:95], v[36:39]
    ds_read_b64_tr_b16 v[74:75], v21 offset:10880
    v_mfma_f32_16x16x32_bf16 v[40:43], a[24:27], v[96:99], v[40:43]
    ds_read_b64_tr_b16 v[76:77], v21 offset:10280
    v_mfma_f32_16x16x32_bf16 v[44:47], a[104:107], v[96:99], v[44:47]
    ds_read_b64_tr_b16 v[78:79], v21 offset:10920
    v_mfma_f32_16x16x32_bf16 v[48:51], a[24:27], v[100:103], v[48:51]
    ds_read_b64_tr_b16 v[80:81], v21 offset:10320
    v_mfma_f32_16x16x32_bf16 v[52:55], a[104:107], v[100:103], v[52:55]
    ds_read_b64_tr_b16 v[82:83], v21 offset:10960
    v_mfma_f32_16x16x32_bf16 v[56:59], a[24:27], v[104:107], v[56:59]
    ds_read_b64_tr_b16 v[84:85], v21 offset:10360
    v_mfma_f32_16x16x32_bf16 v[60:63], a[104:107], v[104:107], v[60:63]
    ds_read_b64_tr_b16 v[86:87], v21 offset:11000
    v_mfma_f32_16x16x32_bf16 v[64:67], a[24:27], v[108:111], v[64:67]
    ds_read_b64_tr_b16 v[88:89], v22 offset:10272
    v_mfma_f32_16x16x32_bf16 v[68:71], a[104:107], v[108:111], v[68:71]
    ds_read_b64_tr_b16 v[90:91], v22 offset:10912
    s_waitcnt lgkmcnt(0)
    v_mfma_f32_16x16x32_bf16 v[32:35], a[28:31], v[72:75], v[32:35]
    ds_read_b64_tr_b16 v[92:93], v21 offset:15360
    v_mfma_f32_16x16x32_bf16 v[36:39], a[108:111], v[72:75], v[36:39]
    ds_read_b64_tr_b16 v[94:95], v21 offset:16000
    v_mfma_f32_16x16x32_bf16 v[40:43], a[28:31], v[76:79], v[40:43]
    ds_read_b64_tr_b16 v[96:97], v21 offset:15400
    v_mfma_f32_16x16x32_bf16 v[44:47], a[108:111], v[76:79], v[44:47]
    ds_read_b64_tr_b16 v[98:99], v21 offset:16040
    v_mfma_f32_16x16x32_bf16 v[48:51], a[28:31], v[80:83], v[48:51]
    ds_read_b64_tr_b16 v[100:101], v21 offset:15440
    v_mfma_f32_16x16x32_bf16 v[52:55], a[108:111], v[80:83], v[52:55]
    ds_read_b64_tr_b16 v[102:103], v21 offset:16080
    v_mfma_f32_16x16x32_bf16 v[56:59], a[28:31], v[84:87], v[56:59]
    ds_read_b64_tr_b16 v[104:105], v21 offset:15480
    v_mfma_f32_16x16x32_bf16 v[60:63], a[108:111], v[84:87], v[60:63]
    ds_read_b64_tr_b16 v[106:107], v21 offset:16120
    v_mfma_f32_16x16x32_bf16 v[64:67], a[28:31], v[88:91], v[64:67]
    ds_read_b64_tr_b16 v[108:109], v22 offset:15392
    v_mfma_f32_16x16x32_bf16 v[68:71], a[108:111], v[88:91], v[68:71]
    ds_read_b64_tr_b16 v[110:111], v22 offset:16032
    s_waitcnt lgkmcnt(0)
    v_mfma_f32_16x16x32_bf16 v[32:35], a[32:35], v[92:95], v[32:35]
    ds_read_b64_tr_b16 v[72:73], v21 offset:20480
    v_mfma_f32_16x16x32_bf16 v[36:39], a[112:115], v[92:95], v[36:39]
    ds_read_b64_tr_b16 v[74:75], v21 offset:21120
    v_mfma_f32_16x16x32_bf16 v[40:43], a[32:35], v[96:99], v[40:43]
    ds_read_b64_tr_b16 v[76:77], v21 offset:20520
    v_mfma_f32_16x16x32_bf16 v[44:47], a[112:115], v[96:99], v[44:47]
    ds_read_b64_tr_b16 v[78:79], v21 offset:21160
    v_mfma_f32_16x16x32_bf16 v[48:51], a[32:35], v[100:103], v[48:51]
    ds_read_b64_tr_b16 v[80:81], v21 offset:20560
    v_mfma_f32_16x16x32_bf16 v[52:55], a[112:115], v[100:103], v[52:55]
    ds_read_b64_tr_b16 v[82:83], v21 offset:21200
    v_mfma_f32_16x16x32_bf16 v[56:59], a[32:35], v[104:107], v[56:59]
    ds_read_b64_tr_b16 v[84:85], v21 offset:20600
    v_mfma_f32_16x16x32_bf16 v[60:63], a[112:115], v[104:107], v[60:63]
    ds_read_b64_tr_b16 v[86:87], v21 offset:21240
    v_mfma_f32_16x16x32_bf16 v[64:67], a[32:35], v[108:111], v[64:67]
    ds_read_b64_tr_b16 v[88:89], v22 offset:20512
    v_mfma_f32_16x16x32_bf16 v[68:71], a[112:115], v[108:111], v[68:71]
    ds_read_b64_tr_b16 v[90:91], v22 offset:21152
    s_waitcnt lgkmcnt(0)
    v_mfma_f32_16x16x32_bf16 v[32:35], a[36:39], v[72:75], v[32:35]
    v_mfma_f32_16x16x32_bf16 v[36:39], a[116:119], v[72:75], v[36:39]
    v_mfma_f32_16x16x32_bf16 v[40:43], a[36:39], v[76:79], v[40:43]
    v_mfma_f32_16x16x32_bf16 v[44:47], a[116:119], v[76:79], v[44:47]
    v_mfma_f32_16x16x32_bf16 v[48:51], a[36:39], v[80:83], v[48:51]
    v_mfma_f32_16x16x32_bf16 v[52:55], a[116:119], v[80:83], v[52:55]
    v_mfma_f32_16x16x32_bf16 v[56:59], a[36:39], v[84:87], v[56:59]
    v_mfma_f32_16x16x32_bf16 v[60:63], a[116:119], v[84:87], v[60:63]
    v_mfma_f32_16x16x32_bf16 v[64:67], a[36:39], v[88:91], v[64:67]
    v_mfma_f32_16x16x32_bf16 v[68:71], a[116:119], v[88:91], v[68:71]
    s_waitcnt vmcnt(14)
    s_barrier
    s_add_u32 s28, s33, 615840
    s_mul_i32 s24, s9, 7168
    s_add_u32 m0, s24, 28672
    s_nop 0
    buffer_load_dwordx4 v0, s[20:23], s28 offen lds
    s_add_u32 m0, s24, 29696
    s_nop 0
    buffer_load_dwordx4 v1, s[20:23], s28 offen lds
    s_add_u32 m0, s24, 30720
    s_nop 0
    buffer_load_dwordx4 v2, s[20:23], s28 offen lds
    s_add_u32 m0, s24, 31744
    s_nop 0
    buffer_load_dwordx4 v3, s[20:23], s28 offen lds
    s_add_u32 m0, s24, 32768
    s_nop 0
    buffer_load_dwordx4 v4, s[20:23], s28 offen lds
    s_add_u32 m0, s24, 33792
    s_nop 0
    buffer_load_dwordx4 v5, s[20:23], s28 offen lds
    s_add_u32 m0, s24, 34816
    s_nop 0
    buffer_load_dwordx4 v6, s[20:23], s28 offen lds
    v_add_u32 v21, 57344, v17
    v_add_u32 v22, 57344, v16
    ds_read_b64_tr_b16 v[72:73], v21 offset:0
    ds_read_b64_tr_b16 v[74:75], v21 offset:640
    ds_read_b64_tr_b16 v[76:77], v21 offset:40
    ds_read_b64_tr_b16 v[78:79], v21 offset:680
    ds_read_b64_tr_b16 v[80:81], v21 offset:80
    ds_read_b64_tr_b16 v[82:83], v21 offset:720
    ds_read_b64_tr_b16 v[84:85], v21 offset:120
    ds_read_b64_tr_b16 v[86:87], v21 offset:760
    ds_read_b64_tr_b16 v[88:89], v22 offset:32
    ds_read_b64_tr_b16 v[90:91], v22 offset:672
    s_waitcnt lgkmcnt(0)
    v_mfma_f32_16x16x32_bf16 v[32:35], a[40:43], v[72:75], v[32:35]
    ds_read_b64_tr_b16 v[92:93], v21 offset:5120
    v_mfma_f32_16x16x32_bf16 v[36:39], a[120:123], v[72:75], v[36:39]
    ds_read_b64_tr_b16 v[94:95], v21 offset:5760
    v_mfma_f32_16x16x32_bf16 v[40:43], a[40:43], v[76:79], v[40:43]
    ds_read_b64_tr_b16 v[96:97], v21 offset:5160
    v_mfma_f32_16x16x32_bf16 v[44:47], a[120:123], v[76:79], v[44:47]
    ds_read_b64_tr_b16 v[98:99], v21 offset:5800
    v_mfma_f32_16x16x32_bf16 v[48:51], a[40:43], v[80:83], v[48:51]
    ds_read_b64_tr_b16 v[100:101], v21 offset:5200
    v_mfma_f32_16x16x32_bf16 v[52:55], a[120:123], v[80:83], v[52:55]
    ds_read_b64_tr_b16 v[102:103], v21 offset:5840
    v_mfma_f32_16x16x32_bf16 v[56:59], a[40:43], v[84:87], v[56:59]
    ds_read_b64_tr_b16 v[104:105], v21 offset:5240
    v_mfma_f32_16x16x32_bf16 v[60:63], a[120:123], v[84:87], v[60:63]
    ds_read_b64_tr_b16 v[106:107], v21 offset:5880
    v_mfma_f32_16x16x32_bf16 v[64:67], a[40:43], v[88:91], v[64:67]
    ds_read_b64_tr_b16 v[108:109], v22 offset:5152
    v_mfma_f32_16x16x32_bf16 v[68:71], a[120:123], v[88:91], v[68:71]
    ds_read_b64_tr_b16 v[110:111], v22 offset:5792
    s_waitcnt lgkmcnt(0)
    v_mfma_f32_16x16x32_bf16 v[32:35], a[44:47], v[92:95], v[32:35]
    ds_read_b64_tr_b16 v[72:73], v21 offset:10240
    v_mfma_f32_16x16x32_bf16 v[36:39], a[124:127], v[92:95], v[36:39]
    ds_read_b64_tr_b16 v[74:75], v21 offset:10880
    v_mfma_f32_16x16x32_bf16 v[40:43], a[44:47], v[96:99], v[40:43]
    ds_read_b64_tr_b16 v[76:77], v21 offset:10280
    v_mfma_f32_16x16x32_bf16 v[44:47], a[124:127], v[96:99], v[44:47]
    ds_read_b64_tr_b16 v[78:79], v21 offset:10920
    v_mfma_f32_16x16x32_bf16 v[48:51], a[44:47], v[100:103], v[48:51]
    ds_read_b64_tr_b16 v[80:81], v21 offset:10320
    v_mfma_f32_16x16x32_bf16 v[52:55], a[124:127], v[100:103], v[52:55]
    ds_read_b64_tr_b16 v[82:83], v21 offset:10960
    v_mfma_f32_16x16x32_bf16 v[56:59], a[44:47], v[104:107], v[56:59]
    ds_read_b64_tr_b16 v[84:85], v21 offset:10360
    v_mfma_f32_16x16x32_bf16 v[60:63], a[124:127], v[104:107], v[60:63]
    ds_read_b64_tr_b16 v[86:87], v21 offset:11000
    v_mfma_f32_16x16x32_bf16 v[64:67], a[44:47], v[108:111], v[64:67]
    ds_read_b64_tr_b16 v[88:89], v22 offset:10272
    v_mfma_f32_16x16x32_bf16 v[68:71], a[124:127], v[108:111], v[68:71]
    ds_read_b64_tr_b16 v[90:91], v22 offset:10912
    s_waitcnt lgkmcnt(0)
    v_mfma_f32_16x16x32_bf16 v[32:35], a[48:51], v[72:75], v[32:35]
    ds_read_b64_tr_b16 v[92:93], v21 offset:15360
    v_mfma_f32_16x16x32_bf16 v[36:39], a[128:131], v[72:75], v[36:39]
    ds_read_b64_tr_b16 v[94:95], v21 offset:16000
    v_mfma_f32_16x16x32_bf16 v[40:43], a[48:51], v[76:79], v[40:43]
    ds_read_b64_tr_b16 v[96:97], v21 offset:15400
    v_mfma_f32_16x16x32_bf16 v[44:47], a[128:131], v[76:79], v[44:47]
    ds_read_b64_tr_b16 v[98:99], v21 offset:16040
    v_mfma_f32_16x16x32_bf16 v[48:51], a[48:51], v[80:83], v[48:51]
    ds_read_b64_tr_b16 v[100:101], v21 offset:15440
    v_mfma_f32_16x16x32_bf16 v[52:55], a[128:131], v[80:83], v[52:55]
    ds_read_b64_tr_b16 v[102:103], v21 offset:16080
    v_mfma_f32_16x16x32_bf16 v[56:59], a[48:51], v[84:87], v[56:59]
    ds_read_b64_tr_b16 v[104:105], v21 offset:15480
    v_mfma_f32_16x16x32_bf16 v[60:63], a[128:131], v[84:87], v[60:63]
    ds_read_b64_tr_b16 v[106:107], v21 offset:16120
    v_mfma_f32_16x16x32_bf16 v[64:67], a[48:51], v[88:91], v[64:67]
    ds_read_b64_tr_b16 v[108:109], v22 offset:15392
    v_mfma_f32_16x16x32_bf16 v[68:71], a[128:131], v[88:91], v[68:71]
    ds_read_b64_tr_b16 v[110:111], v22 offset:16032
    s_waitcnt lgkmcnt(0)
    v_mfma_f32_16x16x32_bf16 v[32:35], a[52:55], v[92:95], v[32:35]
    ds_read_b64_tr_b16 v[72:73], v21 offset:20480
    v_mfma_f32_16x16x32_bf16 v[36:39], a[132:135], v[92:95], v[36:39]
    ds_read_b64_tr_b16 v[74:75], v21 offset:21120
    v_mfma_f32_16x16x32_bf16 v[40:43], a[52:55], v[96:99], v[40:43]
    ds_read_b64_tr_b16 v[76:77], v21 offset:20520
    v_mfma_f32_16x16x32_bf16 v[44:47], a[132:135], v[96:99], v[44:47]
    ds_read_b64_tr_b16 v[78:79], v21 offset:21160
    v_mfma_f32_16x16x32_bf16 v[48:51], a[52:55], v[100:103], v[48:51]
    ds_read_b64_tr_b16 v[80:81], v21 offset:20560
    v_mfma_f32_16x16x32_bf16 v[52:55], a[132:135], v[100:103], v[52:55]
    ds_read_b64_tr_b16 v[82:83], v21 offset:21200
    v_mfma_f32_16x16x32_bf16 v[56:59], a[52:55], v[104:107], v[56:59]
    ds_read_b64_tr_b16 v[84:85], v21 offset:20600
    v_mfma_f32_16x16x32_bf16 v[60:63], a[132:135], v[104:107], v[60:63]
    ds_read_b64_tr_b16 v[86:87], v21 offset:21240
    v_mfma_f32_16x16x32_bf16 v[64:67], a[52:55], v[108:111], v[64:67]
    ds_read_b64_tr_b16 v[88:89], v22 offset:20512
    v_mfma_f32_16x16x32_bf16 v[68:71], a[132:135], v[108:111], v[68:71]
    ds_read_b64_tr_b16 v[90:91], v22 offset:21152
    s_waitcnt lgkmcnt(0)
    v_mfma_f32_16x16x32_bf16 v[32:35], a[56:59], v[72:75], v[32:35]
    v_mfma_f32_16x16x32_bf16 v[36:39], a[136:139], v[72:75], v[36:39]
    v_mfma_f32_16x16x32_bf16 v[40:43], a[56:59], v[76:79], v[40:43]
    v_mfma_f32_16x16x32_bf16 v[44:47], a[136:139], v[76:79], v[44:47]
    v_mfma_f32_16x16x32_bf16 v[48:51], a[56:59], v[80:83], v[48:51]
    v_mfma_f32_16x16x32_bf16 v[52:55], a[136:139], v[80:83], v[52:55]
    v_mfma_f32_16x16x32_bf16 v[56:59], a[56:59], v[84:87], v[56:59]
    v_mfma_f32_16x16x32_bf16 v[60:63], a[136:139], v[84:87], v[60:63]
    v_mfma_f32_16x16x32_bf16 v[64:67], a[56:59], v[88:91], v[64:67]
    v_mfma_f32_16x16x32_bf16 v[68:71], a[136:139], v[88:91], v[68:71]
    s_waitcnt vmcnt(14)
    s_barrier
    s_add_u32 s28, s33, 1230240
    s_mul_i32 s24, s9, 7168
    s_add_u32 m0, s24, 57344
    s_nop 0
    buffer_load_dwordx4 v0, s[20:23], s28 offen lds
    s_add_u32 m0, s24, 58368
    s_nop 0
    buffer_load_dwordx4 v1, s[20:23], s28 offen lds
    s_add_u32 m0, s24, 59392
    s_nop 0
    buffer_load_dwordx4 v2, s[20:23], s28 offen lds
    s_add_u32 m0, s24, 60416
    s_nop 0
    buffer_load_dwordx4 v3, s[20:23], s28 offen lds
    s_add_u32 m0, s24, 61440
    s_nop 0
    buffer_load_dwordx4 v4, s[20:23], s28 offen lds
    s_add_u32 m0, s24, 62464
    s_nop 0
    buffer_load_dwordx4 v5, s[20:23], s28 offen lds
    s_add_u32 m0, s24, 63488
    s_nop 0
    buffer_load_dwordx4 v6, s[20:23], s28 offen lds
    v_add_u32 v21, 86016, v17
    v_add_u32 v22, 86016, v16
    ds_read_b64_tr_b16 v[72:73], v21 offset:0
    ds_read_b64_tr_b16 v[74:75], v21 offset:640
    ds_read_b64_tr_b16 v[76:77], v21 offset:40
    ds_read_b64_tr_b16 v[78:79], v21 offset:680
    ds_read_b64_tr_b16 v[80:81], v21 offset:80
    ds_read_b64_tr_b16 v[82:83], v21 offset:720
    ds_read_b64_tr_b16 v[84:85], v21 offset:120
    ds_read_b64_tr_b16 v[86:87], v21 offset:760
    ds_read_b64_tr_b16 v[88:89], v22 offset:32
    ds_read_b64_tr_b16 v[90:91], v22 offset:672
    s_waitcnt lgkmcnt(0)
    v_mfma_f32_16x16x32_bf16 v[32:35], a[60:63], v[72:75], v[32:35]
    ds_read_b64_tr_b16 v[92:93], v21 offset:5120
    v_mfma_f32_16x16x32_bf16 v[36:39], a[140:143], v[72:75], v[36:39]
    ds_read_b64_tr_b16 v[94:95], v21 offset:5760
    v_mfma_f32_16x16x32_bf16 v[40:43], a[60:63], v[76:79], v[40:43]
    ds_read_b64_tr_b16 v[96:97], v21 offset:5160
    v_mfma_f32_16x16x32_bf16 v[44:47], a[140:143], v[76:79], v[44:47]
    ds_read_b64_tr_b16 v[98:99], v21 offset:5800
    v_mfma_f32_16x16x32_bf16 v[48:51], a[60:63], v[80:83], v[48:51]
    ds_read_b64_tr_b16 v[100:101], v21 offset:5200
    v_mfma_f32_16x16x32_bf16 v[52:55], a[140:143], v[80:83], v[52:55]
    ds_read_b64_tr_b16 v[102:103], v21 offset:5840
    v_mfma_f32_16x16x32_bf16 v[56:59], a[60:63], v[84:87], v[56:59]
    ds_read_b64_tr_b16 v[104:105], v21 offset:5240
    v_mfma_f32_16x16x32_bf16 v[60:63], a[140:143], v[84:87], v[60:63]
    ds_read_b64_tr_b16 v[106:107], v21 offset:5880
    v_mfma_f32_16x16x32_bf16 v[64:67], a[60:63], v[88:91], v[64:67]
    ds_read_b64_tr_b16 v[108:109], v22 offset:5152
    v_mfma_f32_16x16x32_bf16 v[68:71], a[140:143], v[88:91], v[68:71]
    ds_read_b64_tr_b16 v[110:111], v22 offset:5792
    s_waitcnt lgkmcnt(0)
    v_mfma_f32_16x16x32_bf16 v[32:35], a[64:67], v[92:95], v[32:35]
    ds_read_b64_tr_b16 v[72:73], v21 offset:10240
    v_mfma_f32_16x16x32_bf16 v[36:39], a[144:147], v[92:95], v[36:39]
    ds_read_b64_tr_b16 v[74:75], v21 offset:10880
    v_mfma_f32_16x16x32_bf16 v[40:43], a[64:67], v[96:99], v[40:43]
    ds_read_b64_tr_b16 v[76:77], v21 offset:10280
    v_mfma_f32_16x16x32_bf16 v[44:47], a[144:147], v[96:99], v[44:47]
    ds_read_b64_tr_b16 v[78:79], v21 offset:10920
    v_mfma_f32_16x16x32_bf16 v[48:51], a[64:67], v[100:103], v[48:51]
    ds_read_b64_tr_b16 v[80:81], v21 offset:10320
    v_mfma_f32_16x16x32_bf16 v[52:55], a[144:147], v[100:103], v[52:55]
    ds_read_b64_tr_b16 v[82:83], v21 offset:10960
    v_mfma_f32_16x16x32_bf16 v[56:59], a[64:67], v[104:107], v[56:59]
    ds_read_b64_tr_b16 v[84:85], v21 offset:10360
    v_mfma_f32_16x16x32_bf16 v[60:63], a[144:147], v[104:107], v[60:63]
    ds_read_b64_tr_b16 v[86:87], v21 offset:11000
    v_mfma_f32_16x16x32_bf16 v[64:67], a[64:67], v[108:111], v[64:67]
    ds_read_b64_tr_b16 v[88:89], v22 offset:10272
    v_mfma_f32_16x16x32_bf16 v[68:71], a[144:147], v[108:111], v[68:71]
    ds_read_b64_tr_b16 v[90:91], v22 offset:10912
    s_waitcnt lgkmcnt(0)
    v_mfma_f32_16x16x32_bf16 v[32:35], a[68:71], v[72:75], v[32:35]
    ds_read_b64_tr_b16 v[92:93], v21 offset:15360
    v_mfma_f32_16x16x32_bf16 v[36:39], a[148:151], v[72:75], v[36:39]
    ds_read_b64_tr_b16 v[94:95], v21 offset:16000
    v_mfma_f32_16x16x32_bf16 v[40:43], a[68:71], v[76:79], v[40:43]
    ds_read_b64_tr_b16 v[96:97], v21 offset:15400
    v_mfma_f32_16x16x32_bf16 v[44:47], a[148:151], v[76:79], v[44:47]
    ds_read_b64_tr_b16 v[98:99], v21 offset:16040
    v_mfma_f32_16x16x32_bf16 v[48:51], a[68:71], v[80:83], v[48:51]
    ds_read_b64_tr_b16 v[100:101], v21 offset:15440
    v_mfma_f32_16x16x32_bf16 v[52:55], a[148:151], v[80:83], v[52:55]
    ds_read_b64_tr_b16 v[102:103], v21 offset:16080
    v_mfma_f32_16x16x32_bf16 v[56:59], a[68:71], v[84:87], v[56:59]
    ds_read_b64_tr_b16 v[104:105], v21 offset:15480
    v_mfma_f32_16x16x32_bf16 v[60:63], a[148:151], v[84:87], v[60:63]
    ds_read_b64_tr_b16 v[106:107], v21 offset:16120
    v_mfma_f32_16x16x32_bf16 v[64:67], a[68:71], v[88:91], v[64:67]
    ds_read_b64_tr_b16 v[108:109], v22 offset:15392
    v_mfma_f32_16x16x32_bf16 v[68:71], a[148:151], v[88:91], v[68:71]
    ds_read_b64_tr_b16 v[110:111], v22 offset:16032
    s_waitcnt lgkmcnt(0)
    v_mfma_f32_16x16x32_bf16 v[32:35], a[72:75], v[92:95], v[32:35]
    ds_read_b64_tr_b16 v[72:73], v21 offset:20480
    v_mfma_f32_16x16x32_bf16 v[36:39], a[152:155], v[92:95], v[36:39]
    ds_read_b64_tr_b16 v[74:75], v21 offset:21120
    v_mfma_f32_16x16x32_bf16 v[40:43], a[72:75], v[96:99], v[40:43]
    ds_read_b64_tr_b16 v[76:77], v21 offset:20520
    v_mfma_f32_16x16x32_bf16 v[44:47], a[152:155], v[96:99], v[44:47]
    ds_read_b64_tr_b16 v[78:79], v21 offset:21160
    v_mfma_f32_16x16x32_bf16 v[48:51], a[72:75], v[100:103], v[48:51]
    ds_read_b64_tr_b16 v[80:81], v21 offset:20560
    v_mfma_f32_16x16x32_bf16 v[52:55], a[152:155], v[100:103], v[52:55]
    ds_read_b64_tr_b16 v[82:83], v21 offset:21200
    v_mfma_f32_16x16x32_bf16 v[56:59], a[72:75], v[104:107], v[56:59]
    ds_read_b64_tr_b16 v[84:85], v21 offset:20600
    v_mfma_f32_16x16x32_bf16 v[60:63], a[152:155], v[104:107], v[60:63]
    ds_read_b64_tr_b16 v[86:87], v21 offset:21240
    v_mfma_f32_16x16x32_bf16 v[64:67], a[72:75], v[108:111], v[64:67]
    ds_read_b64_tr_b16 v[88:89], v22 offset:20512
    v_mfma_f32_16x16x32_bf16 v[68:71], a[152:155], v[108:111], v[68:71]
    ds_read_b64_tr_b16 v[90:91], v22 offset:21152
    s_waitcnt lgkmcnt(0)
    v_mfma_f32_16x16x32_bf16 v[32:35], a[76:79], v[72:75], v[32:35]
    v_mfma_f32_16x16x32_bf16 v[36:39], a[156:159], v[72:75], v[36:39]
    v_mfma_f32_16x16x32_bf16 v[40:43], a[76:79], v[76:79], v[40:43]
    v_mfma_f32_16x16x32_bf16 v[44:47], a[156:159], v[76:79], v[44:47]
    v_mfma_f32_16x16x32_bf16 v[48:51], a[76:79], v[80:83], v[48:51]
    v_mfma_f32_16x16x32_bf16 v[52:55], a[156:159], v[80:83], v[52:55]
    v_mfma_f32_16x16x32_bf16 v[56:59], a[76:79], v[84:87], v[56:59]
    v_mfma_f32_16x16x32_bf16 v[60:63], a[156:159], v[84:87], v[60:63]
    v_mfma_f32_16x16x32_bf16 v[64:67], a[76:79], v[88:91], v[64:67]
    v_mfma_f32_16x16x32_bf16 v[68:71], a[156:159], v[88:91], v[68:71]
    s_nop 7
    v_mov_b32 v8, 0
    v_mov_b32 v9, 0
    v_mov_b32 v10, 0
    v_mov_b32 v11, 0
    s_mul_i32 s24, s9, 6144
    s_add_u32 s24, s24, 114688
    v_add_u32 v23, s24, v26
    ds_write_b128 v23, v[8:11] offset:0
    ds_write_b128 v23, v[8:11] offset:1024
    ds_write_b128 v23, v[8:11] offset:2048
    ds_write_b128 v23, v[8:11] offset:3072
    ds_write_b128 v23, v[8:11] offset:4096
    ds_write_b128 v23, v[8:11] offset:5120
    v_cvt_pk_bf16_f32 v234, v32, v33
    v_cvt_pk_bf16_f32 v235, v34, v35
    v_cvt_pk_bf16_f32 v236, v36, v37
    v_cvt_pk_bf16_f32 v237, v38, v39
    v_cvt_pk_bf16_f32 v238, v40, v41
    v_cvt_pk_bf16_f32 v239, v42, v43
    v_cvt_pk_bf16_f32 v240, v44, v45
    v_cvt_pk_bf16_f32 v241, v46, v47
    v_cvt_pk_bf16_f32 v242, v48, v49
    v_cvt_pk_bf16_f32 v243, v50, v51
    v_cvt_pk_bf16_f32 v244, v52, v53
    v_cvt_pk_bf16_f32 v245, v54, v55
    v_cvt_pk_bf16_f32 v246, v56, v57
    v_cvt_pk_bf16_f32 v247, v58, v59
    v_cvt_pk_bf16_f32 v248, v60, v61
    v_cvt_pk_bf16_f32 v249, v62, v63
    v_cvt_pk_bf16_f32 v250, v64, v65
    v_cvt_pk_bf16_f32 v251, v66, v67
    v_cvt_pk_bf16_f32 v252, v68, v69
    v_cvt_pk_bf16_f32 v253, v70, v71
    v_add_u32 v24, 114688, v26
    v_mov_b32 v12, 0x3f803f80
    s_waitcnt lgkmcnt(0)
    s_barrier
    s_mov_b32 s36, 0
kvt_12:
    s_add_u32 s37, s9, s36
    s_and_b32 s37, s37, 3
    s_mul_i32 s24, s37, 6144
    v_add_u32 v23, s24, v24
    ds_read_b128 v[112:115], v23 offset:0
    ds_read_b128 v[116:119], v23 offset:1024
    ds_read_b128 v[120:123], v23 offset:2048
    ds_read_b128 v[124:127], v23 offset:3072
    ds_read_b128 v[128:131], v23 offset:4096
    ds_read_b128 v[132:135], v23 offset:5120
    s_cmp_eq_u32 s37, 1
    s_cbranch_scc1 kvh_14
    s_cmp_eq_u32 s37, 2
    s_cbranch_scc1 kvh_15
    s_cmp_eq_u32 s37, 3
    s_cbranch_scc1 kvh_16
kvh_13:
    v_mfma_f32_16x16x32_bf16 v[72:75], v[162:165], v[202:205], 0
    v_mfma_f32_16x16x32_bf16 v[76:79], v[182:185], v[202:205], 0
    v_mfma_f32_16x16x32_bf16 v[72:75], v[166:169], v[206:209], v[72:75]
    v_mfma_f32_16x16x32_bf16 v[76:79], v[186:189], v[206:209], v[76:79]
    v_mfma_f32_16x16x32_bf16 v[80:83], v[170:173], v[202:205], 0
    v_mfma_f32_16x16x32_bf16 v[84:87], v[190:193], v[202:205], 0
    v_mfma_f32_16x16x32_bf16 v[80:83], v[174:177], v[206:209], v[80:83]
    v_mfma_f32_16x16x32_bf16 v[84:87], v[194:197], v[206:209], v[84:87]
    v_mfma_f32_16x16x32_bf16 v[88:91], v[178:181], v[202:205], 0
    v_mfma_f32_16x16x32_bf16 v[92:95], v[198:201], v[202:205], 0
    v_cmp_eq_u32 vcc, 4, v30
    v_mov_b32 v136, v234
    v_mov_b32 v137, v235
    v_mov_b32 v138, v236
    v_mov_b32 v139, v237
    s_branch kvj_11
kvh_14:
    v_mfma_f32_16x16x32_bf16 v[72:75], v[162:165], v[210:213], 0
    v_mfma_f32_16x16x32_bf16 v[76:79], v[182:185], v[210:213], 0
    v_mfma_f32_16x16x32_bf16 v[72:75], v[166:169], v[214:217], v[72:75]
    v_mfma_f32_16x16x32_bf16 v[76:79], v[186:189], v[214:217], v[76:79]
    v_mfma_f32_16x16x32_bf16 v[80:83], v[170:173], v[210:213], 0
    v_mfma_f32_16x16x32_bf16 v[84:87], v[190:193], v[210:213], 0
    v_mfma_f32_16x16x32_bf16 v[80:83], v[174:177], v[214:217], v[80:83]
    v_mfma_f32_16x16x32_bf16 v[84:87], v[194:197], v[214:217], v[84:87]
    v_mfma_f32_16x16x32_bf16 v[88:91], v[178:181], v[210:213], 0
    v_mfma_f32_16x16x32_bf16 v[92:95], v[198:201], v[210:213], 0
    v_cmp_eq_u32 vcc, 8, v30
    v_mov_b32 v136, v238
    v_mov_b32 v137, v239
    v_mov_b32 v138, v240
    v_mov_b32 v139, v241
    s_branch kvj_11
kvh_15:
    v_mfma_f32_16x16x32_bf16 v[72:75], v[162:165], v[218:221], 0
    v_mfma_f32_16x16x32_bf16 v[76:79], v[182:185], v[218:221], 0
    v_mfma_f32_16x16x32_bf16 v[72:75], v[166:169], v[222:225], v[72:75]
    v_mfma_f32_16x16x32_bf16 v[76:79], v[186:189], v[222:225], v[76:79]
    v_mfma_f32_16x16x32_bf16 v[80:83], v[170:173], v[218:221], 0
    v_mfma_f32_16x16x32_bf16 v[84:87], v[190:193], v[218:221], 0
    v_mfma_f32_16x16x32_bf16 v[80:83], v[174:177], v[222:225], v[80:83]
    v_mfma_f32_16x16x32_bf16 v[84:87], v[194:197], v[222:225], v[84:87]
    v_mfma_f32_16x16x32_bf16 v[88:91], v[178:181], v[218:221], 0
    v_mfma_f32_16x16x32_bf16 v[92:95], v[198:201], v[218:221], 0
    v_cmp_eq_u32 vcc, 12, v30
    v_mov_b32 v136, v242
    v_mov_b32 v137, v243
    v_mov_b32 v138, v244
    v_mov_b32 v139, v245
    s_branch kvj_11
kvh_16:
    v_mfma_f32_16x16x32_bf16 v[72:75], v[162:165], v[226:229], 0
    v_mfma_f32_16x16x32_bf16 v[76:79], v[182:185], v[226:229], 0
    v_mfma_f32_16x16x32_bf16 v[72:75], v[166:169], v[230:233], v[72:75]
    v_mfma_f32_16x16x32_bf16 v[76:79], v[186:189], v[230:233], v[76:79]
    v_mfma_f32_16x16x32_bf16 v[80:83], v[170:173], v[226:229], 0
    v_mfma_f32_16x16x32_bf16 v[84:87], v[190:193], v[226:229], 0
    v_mfma_f32_16x16x32_bf16 v[80:83], v[174:177], v[230:233], v[80:83]
    v_mfma_f32_16x16x32_bf16 v[84:87], v[194:197], v[230:233], v[84:87]
    v_mfma_f32_16x16x32_bf16 v[88:91], v[178:181], v[226:229], 0
    v_mfma_f32_16x16x32_bf16 v[92:95], v[198:201], v[226:229], 0
    v_cmp_eq_u32 vcc, 0, v30
    v_mov_b32 v136, v246
    v_mov_b32 v137, v247
    v_mov_b32 v138, v248
    v_mov_b32 v139, v249
kvj_11:
    v_cndmask_b32 v108, v250, v12, vcc
    v_cndmask_b32 v109, v251, v12, vcc
    v_cndmask_b32 v110, v252, v12, vcc
    v_cndmask_b32 v111, v253, v12, vcc
    v_cvt_pk_bf16_f32 v96, v72, v73
    v_cvt_pk_bf16_f32 v97, v74, v75
    v_cvt_pk_bf16_f32 v98, v76, v77
    v_cvt_pk_bf16_f32 v99, v78, v79
    v_cvt_pk_bf16_f32 v100, v80, v81
    v_cvt_pk_bf16_f32 v101, v82, v83
    v_cvt_pk_bf16_f32 v102, v84, v85
    v_cvt_pk_bf16_f32 v103, v86, v87
    v_cvt_pk_bf16_f32 v104, v88, v89
    v_cvt_pk_bf16_f32 v105, v90, v91
    v_cvt_pk_bf16_f32 v106, v92, v93
    v_cvt_pk_bf16_f32 v107, v94, v95
    s_waitcnt lgkmcnt(0)
    s_nop 0
    v_mfma_f32_16x16x32_bf16 v[112:115], v[96:99], v[136:139], v[112:115]
    v_mfma_f32_16x16x32_bf16 v[116:119], v[96:99], v[108:111], v[116:119]
    v_mfma_f32_16x16x32_bf16 v[120:123], v[100:103], v[136:139], v[120:123]
    v_mfma_f32_16x16x32_bf16 v[124:127], v[100:103], v[108:111], v[124:127]
    v_mfma_f32_16x16x32_bf16 v[128:131], v[104:107], v[136:139], v[128:131]
    v_mfma_f32_16x16x32_bf16 v[132:135], v[104:107], v[108:111], v[132:135]
    s_nop 7
    ds_write_b128 v23, v[112:115] offset:0
    ds_write_b128 v23, v[116:119] offset:1024
    ds_write_b128 v23, v[120:123] offset:2048
    ds_write_b128 v23, v[124:127] offset:3072
    ds_write_b128 v23, v[128:131] offset:4096
    ds_write_b128 v23, v[132:135] offset:5120
    s_add_u32 s36, s36, 1
    s_cmp_lt_u32 s36, 4
    s_waitcnt lgkmcnt(0)
    s_barrier
    s_cbranch_scc1 kvt_12
    s_lshl_b32 s24, s31, 5
    s_lshl_b32 s25, s32, 3
    s_add_u32 s24, s24, s25
    s_add_u32 s24, s24, s37
    s_add_u32 s24, s24, 0
    s_mul_i32 s24, s24, 6144
    s_add_u32 s24, s24, 100663296
    s_add_u32 s25, s24, 4096
    buffer_store_dwordx4 v[112:115], v26, s[16:19], s24 offen offset:0 sc1
    buffer_store_dwordx4 v[116:119], v26, s[16:19], s24 offen offset:1024 sc1
    buffer_store_dwordx4 v[120:123], v26, s[16:19], s24 offen offset:2048 sc1
    buffer_store_dwordx4 v[124:127], v26, s[16:19], s24 offen offset:3072 sc1
    buffer_store_dwordx4 v[128:131], v26, s[16:19], s25 offen offset:0 sc1
    buffer_store_dwordx4 v[132:135], v26, s[16:19], s25 offen offset:1024 sc1
    s_waitcnt vmcnt(20)
    s_barrier
    s_add_u32 s28, s33, 1844640
    s_mul_i32 s24, s9, 7168
    s_add_u32 m0, s24, 86016
    s_nop 0
    buffer_load_dwordx4 v0, s[20:23], s28 offen lds
    s_add_u32 m0, s24, 87040
    s_nop 0
    buffer_load_dwordx4 v1, s[20:23], s28 offen lds
    s_add_u32 m0, s24, 88064
    s_nop 0
    buffer_load_dwordx4 v2, s[20:23], s28 offen lds
    s_add_u32 m0, s24, 89088
    s_nop 0
    buffer_load_dwordx4 v3, s[20:23], s28 offen lds
    s_add_u32 m0, s24, 90112
    s_nop 0
    buffer_load_dwordx4 v4, s[20:23], s28 offen lds
    s_add_u32 m0, s24, 91136
    s_nop 0
    buffer_load_dwordx4 v5, s[20:23], s28 offen lds
    s_add_u32 m0, s24, 92160
    s_nop 0
    buffer_load_dwordx4 v6, s[20:23], s28 offen lds
    v_add_u32 v21, 0, v16
    ds_read_b64_tr_b16 v[72:73], v21 offset:0
    ds_read_b64_tr_b16 v[74:75], v21 offset:640
    ds_read_b64_tr_b16 v[76:77], v21 offset:8
    ds_read_b64_tr_b16 v[78:79], v21 offset:648
    ds_read_b64_tr_b16 v[80:81], v21 offset:16
    ds_read_b64_tr_b16 v[82:83], v21 offset:656
    ds_read_b64_tr_b16 v[84:85], v21 offset:24
    ds_read_b64_tr_b16 v[86:87], v21 offset:664
    ds_read_b64_tr_b16 v[88:89], v21 offset:32
    ds_read_b64_tr_b16 v[90:91], v21 offset:672
    s_waitcnt lgkmcnt(0)
    v_mfma_f32_16x16x32_bf16 v[32:35], v[72:75], a[0:3], 0
    ds_read_b64_tr_b16 v[92:93], v21 offset:5120
    v_mfma_f32_16x16x32_bf16 v[36:39], v[72:75], a[80:83], 0
    ds_read_b64_tr_b16 v[94:95], v21 offset:5760
    v_mfma_f32_16x16x32_bf16 v[40:43], v[76:79], a[0:3], 0
    ds_read_b64_tr_b16 v[96:97], v21 offset:5128
    v_mfma_f32_16x16x32_bf16 v[44:47], v[76:79], a[80:83], 0
    ds_read_b64_tr_b16 v[98:99], v21 offset:5768
    v_mfma_f32_16x16x32_bf16 v[48:51], v[80:83], a[0:3], 0
    ds_read_b64_tr_b16 v[100:101], v21 offset:5136
    v_mfma_f32_16x16x32_bf16 v[52:55], v[80:83], a[80:83], 0
    ds_read_b64_tr_b16 v[102:103], v21 offset:5776
    v_mfma_f32_16x16x32_bf16 v[56:59], v[84:87], a[0:3], 0
    ds_read_b64_tr_b16 v[104:105], v21 offset:5144
    v_mfma_f32_16x16x32_bf16 v[60:63], v[84:87], a[80:83], 0
    ds_read_b64_tr_b16 v[106:107], v21 offset:5784
    v_mfma_f32_16x16x32_bf16 v[64:67], v[88:91], a[0:3], 0
    ds_read_b64_tr_b16 v[108:109], v21 offset:5152
    v_mfma_f32_16x16x32_bf16 v[68:71], v[88:91], a[80:83], 0
    ds_read_b64_tr_b16 v[110:111], v21 offset:5792
    s_waitcnt lgkmcnt(0)
    v_mfma_f32_16x16x32_bf16 v[32:35], v[92:95], a[4:7], v[32:35]
    ds_read_b64_tr_b16 v[72:73], v21 offset:10240
    v_mfma_f32_16x16x32_bf16 v[36:39], v[92:95], a[84:87], v[36:39]
    ds_read_b64_tr_b16 v[74:75], v21 offset:10880
    v_mfma_f32_16x16x32_bf16 v[40:43], v[96:99], a[4:7], v[40:43]
    ds_read_b64_tr_b16 v[76:77], v21 offset:10248
    v_mfma_f32_16x16x32_bf16 v[44:47], v[96:99], a[84:87], v[44:47]
    ds_read_b64_tr_b16 v[78:79], v21 offset:10888
    v_mfma_f32_16x16x32_bf16 v[48:51], v[100:103], a[4:7], v[48:51]
    ds_read_b64_tr_b16 v[80:81], v21 offset:10256
    v_mfma_f32_16x16x32_bf16 v[52:55], v[100:103], a[84:87], v[52:55]
    ds_read_b64_tr_b16 v[82:83], v21 offset:10896
    v_mfma_f32_16x16x32_bf16 v[56:59], v[104:107], a[4:7], v[56:59]
    ds_read_b64_tr_b16 v[84:85], v21 offset:10264
    v_mfma_f32_16x16x32_bf16 v[60:63], v[104:107], a[84:87], v[60:63]
    ds_read_b64_tr_b16 v[86:87], v21 offset:10904
    v_mfma_f32_16x16x32_bf16 v[64:67], v[108:111], a[4:7], v[64:67]
    ds_read_b64_tr_b16 v[88:89], v21 offset:10272
    v_mfma_f32_16x16x32_bf16 v[68:71], v[108:111], a[84:87], v[68:71]
    ds_read_b64_tr_b16 v[90:91], v21 offset:10912
    s_waitcnt lgkmcnt(0)
    v_mfma_f32_16x16x32_bf16 v[32:35], v[72:75], a[8:11], v[32:35]
    ds_read_b64_tr_b16 v[92:93], v21 offset:15360
    v_mfma_f32_16x16x32_bf16 v[36:39], v[72:75], a[88:91], v[36:39]
    ds_read_b64_tr_b16 v[94:95], v21 offset:16000
    v_mfma_f32_16x16x32_bf16 v[40:43], v[76:79], a[8:11], v[40:43]
    ds_read_b64_tr_b16 v[96:97], v21 offset:15368
    v_mfma_f32_16x16x32_bf16 v[44:47], v[76:79], a[88:91], v[44:47]
    ds_read_b64_tr_b16 v[98:99], v21 offset:16008
    v_mfma_f32_16x16x32_bf16 v[48:51], v[80:83], a[8:11], v[48:51]
    ds_read_b64_tr_b16 v[100:101], v21 offset:15376
    v_mfma_f32_16x16x32_bf16 v[52:55], v[80:83], a[88:91], v[52:55]
    ds_read_b64_tr_b16 v[102:103], v21 offset:16016
    v_mfma_f32_16x16x32_bf16 v[56:59], v[84:87], a[8:11], v[56:59]
    ds_read_b64_tr_b16 v[104:105], v21 offset:15384
    v_mfma_f32_16x16x32_bf16 v[60:63], v[84:87], a[88:91], v[60:63]
    ds_read_b64_tr_b16 v[106:107], v21 offset:16024
    v_mfma_f32_16x16x32_bf16 v[64:67], v[88:91], a[8:11], v[64:67]
    ds_read_b64_tr_b16 v[108:109], v21 offset:15392
    v_mfma_f32_16x16x32_bf16 v[68:71], v[88:91], a[88:91], v[68:71]
    ds_read_b64_tr_b16 v[110:111], v21 offset:16032
    s_waitcnt lgkmcnt(0)
    v_mfma_f32_16x16x32_bf16 v[32:35], v[92:95], a[12:15], v[32:35]
    ds_read_b64_tr_b16 v[72:73], v21 offset:20480
    v_mfma_f32_16x16x32_bf16 v[36:39], v[92:95], a[92:95], v[36:39]
    ds_read_b64_tr_b16 v[74:75], v21 offset:21120
    v_mfma_f32_16x16x32_bf16 v[40:43], v[96:99], a[12:15], v[40:43]
    ds_read_b64_tr_b16 v[76:77], v21 offset:20488
    v_mfma_f32_16x16x32_bf16 v[44:47], v[96:99], a[92:95], v[44:47]
    ds_read_b64_tr_b16 v[78:79], v21 offset:21128
    v_mfma_f32_16x16x32_bf16 v[48:51], v[100:103], a[12:15], v[48:51]
    ds_read_b64_tr_b16 v[80:81], v21 offset:20496
    v_mfma_f32_16x16x32_bf16 v[52:55], v[100:103], a[92:95], v[52:55]
    ds_read_b64_tr_b16 v[82:83], v21 offset:21136
    v_mfma_f32_16x16x32_bf16 v[56:59], v[104:107], a[12:15], v[56:59]
    ds_read_b64_tr_b16 v[84:85], v21 offset:20504
    v_mfma_f32_16x16x32_bf16 v[60:63], v[104:107], a[92:95], v[60:63]
    ds_read_b64_tr_b16 v[86:87], v21 offset:21144
    v_mfma_f32_16x16x32_bf16 v[64:67], v[108:111], a[12:15], v[64:67]
    ds_read_b64_tr_b16 v[88:89], v21 offset:20512
    v_mfma_f32_16x16x32_bf16 v[68:71], v[108:111], a[92:95], v[68:71]
    ds_read_b64_tr_b16 v[90:91], v21 offset:21152
    s_waitcnt lgkmcnt(0)
    v_mfma_f32_16x16x32_bf16 v[32:35], v[72:75], a[16:19], v[32:35]
    v_mfma_f32_16x16x32_bf16 v[36:39], v[72:75], a[96:99], v[36:39]
    v_mfma_f32_16x16x32_bf16 v[40:43], v[76:79], a[16:19], v[40:43]
    v_mfma_f32_16x16x32_bf16 v[44:47], v[76:79], a[96:99], v[44:47]
    v_mfma_f32_16x16x32_bf16 v[48:51], v[80:83], a[16:19], v[48:51]
    v_mfma_f32_16x16x32_bf16 v[52:55], v[80:83], a[96:99], v[52:55]
    v_mfma_f32_16x16x32_bf16 v[56:59], v[84:87], a[16:19], v[56:59]
    v_mfma_f32_16x16x32_bf16 v[60:63], v[84:87], a[96:99], v[60:63]
    v_mfma_f32_16x16x32_bf16 v[64:67], v[88:91], a[16:19], v[64:67]
    v_mfma_f32_16x16x32_bf16 v[68:71], v[88:91], a[96:99], v[68:71]
    s_waitcnt vmcnt(20)
    s_barrier
    s_add_u32 s28, s33, 2720
    s_mul_i32 s24, s9, 7168
    s_add_u32 m0, s24, 0
    s_nop 0
    buffer_load_dwordx4 v0, s[20:23], s28 offen lds
    s_add_u32 m0, s24, 1024
    s_nop 0
    buffer_load_dwordx4 v1, s[20:23], s28 offen lds
    s_add_u32 m0, s24, 2048
    s_nop 0
    buffer_load_dwordx4 v2, s[20:23], s28 offen lds
    s_add_u32 m0, s24, 3072
    s_nop 0
    buffer_load_dwordx4 v3, s[20:23], s28 offen lds
    s_add_u32 m0, s24, 4096
    s_nop 0
    buffer_load_dwordx4 v4, s[20:23], s28 offen lds
    s_add_u32 m0, s24, 5120
    s_nop 0
    buffer_load_dwordx4 v5, s[20:23], s28 offen lds
    s_add_u32 m0, s24, 6144
    s_nop 0
    buffer_load_dwordx4 v6, s[20:23], s28 offen lds
    v_add_u32 v21, 28672, v16
    ds_read_b64_tr_b16 v[72:73], v21 offset:0
    ds_read_b64_tr_b16 v[74:75], v21 offset:640
    ds_read_b64_tr_b16 v[76:77], v21 offset:8
    ds_read_b64_tr_b16 v[78:79], v21 offset:648
    ds_read_b64_tr_b16 v[80:81], v21 offset:16
    ds_read_b64_tr_b16 v[82:83], v21 offset:656
    ds_read_b64_tr_b16 v[84:85], v21 offset:24
    ds_read_b64_tr_b16 v[86:87], v21 offset:664
    ds_read_b64_tr_b16 v[88:89], v21 offset:32
    ds_read_b64_tr_b16 v[90:91], v21 offset:672
    s_waitcnt lgkmcnt(0)
    v_mfma_f32_16x16x32_bf16 v[32:35], v[72:75], a[20:23], v[32:35]
    ds_read_b64_tr_b16 v[92:93], v21 offset:5120
    v_mfma_f32_16x16x32_bf16 v[36:39], v[72:75], a[100:103], v[36:39]
    ds_read_b64_tr_b16 v[94:95], v21 offset:5760
    v_mfma_f32_16x16x32_bf16 v[40:43], v[76:79], a[20:23], v[40:43]
    ds_read_b64_tr_b16 v[96:97], v21 offset:5128
    v_mfma_f32_16x16x32_bf16 v[44:47], v[76:79], a[100:103], v[44:47]
    ds_read_b64_tr_b16 v[98:99], v21 offset:5768
    v_mfma_f32_16x16x32_bf16 v[48:51], v[80:83], a[20:23], v[48:51]
    ds_read_b64_tr_b16 v[100:101], v21 offset:5136
    v_mfma_f32_16x16x32_bf16 v[52:55], v[80:83], a[100:103], v[52:55]
    ds_read_b64_tr_b16 v[102:103], v21 offset:5776
    v_mfma_f32_16x16x32_bf16 v[56:59], v[84:87], a[20:23], v[56:59]
    ds_read_b64_tr_b16 v[104:105], v21 offset:5144
    v_mfma_f32_16x16x32_bf16 v[60:63], v[84:87], a[100:103], v[60:63]
    ds_read_b64_tr_b16 v[106:107], v21 offset:5784
    v_mfma_f32_16x16x32_bf16 v[64:67], v[88:91], a[20:23], v[64:67]
    ds_read_b64_tr_b16 v[108:109], v21 offset:5152
    v_mfma_f32_16x16x32_bf16 v[68:71], v[88:91], a[100:103], v[68:71]
    ds_read_b64_tr_b16 v[110:111], v21 offset:5792
    s_waitcnt lgkmcnt(0)
    v_mfma_f32_16x16x32_bf16 v[32:35], v[92:95], a[24:27], v[32:35]
    ds_read_b64_tr_b16 v[72:73], v21 offset:10240
    v_mfma_f32_16x16x32_bf16 v[36:39], v[92:95], a[104:107], v[36:39]
    ds_read_b64_tr_b16 v[74:75], v21 offset:10880
    v_mfma_f32_16x16x32_bf16 v[40:43], v[96:99], a[24:27], v[40:43]
    ds_read_b64_tr_b16 v[76:77], v21 offset:10248
    v_mfma_f32_16x16x32_bf16 v[44:47], v[96:99], a[104:107], v[44:47]
    ds_read_b64_tr_b16 v[78:79], v21 offset:10888
    v_mfma_f32_16x16x32_bf16 v[48:51], v[100:103], a[24:27], v[48:51]
    ds_read_b64_tr_b16 v[80:81], v21 offset:10256
    v_mfma_f32_16x16x32_bf16 v[52:55], v[100:103], a[104:107], v[52:55]
    ds_read_b64_tr_b16 v[82:83], v21 offset:10896
    v_mfma_f32_16x16x32_bf16 v[56:59], v[104:107], a[24:27], v[56:59]
    ds_read_b64_tr_b16 v[84:85], v21 offset:10264
    v_mfma_f32_16x16x32_bf16 v[60:63], v[104:107], a[104:107], v[60:63]
    ds_read_b64_tr_b16 v[86:87], v21 offset:10904
    v_mfma_f32_16x16x32_bf16 v[64:67], v[108:111], a[24:27], v[64:67]
    ds_read_b64_tr_b16 v[88:89], v21 offset:10272
    v_mfma_f32_16x16x32_bf16 v[68:71], v[108:111], a[104:107], v[68:71]
    ds_read_b64_tr_b16 v[90:91], v21 offset:10912
    s_waitcnt lgkmcnt(0)
    v_mfma_f32_16x16x32_bf16 v[32:35], v[72:75], a[28:31], v[32:35]
    ds_read_b64_tr_b16 v[92:93], v21 offset:15360
    v_mfma_f32_16x16x32_bf16 v[36:39], v[72:75], a[108:111], v[36:39]
    ds_read_b64_tr_b16 v[94:95], v21 offset:16000
    v_mfma_f32_16x16x32_bf16 v[40:43], v[76:79], a[28:31], v[40:43]
    ds_read_b64_tr_b16 v[96:97], v21 offset:15368
    v_mfma_f32_16x16x32_bf16 v[44:47], v[76:79], a[108:111], v[44:47]
    ds_read_b64_tr_b16 v[98:99], v21 offset:16008
    v_mfma_f32_16x16x32_bf16 v[48:51], v[80:83], a[28:31], v[48:51]
    ds_read_b64_tr_b16 v[100:101], v21 offset:15376
    v_mfma_f32_16x16x32_bf16 v[52:55], v[80:83], a[108:111], v[52:55]
    ds_read_b64_tr_b16 v[102:103], v21 offset:16016
    v_mfma_f32_16x16x32_bf16 v[56:59], v[84:87], a[28:31], v[56:59]
    ds_read_b64_tr_b16 v[104:105], v21 offset:15384
    v_mfma_f32_16x16x32_bf16 v[60:63], v[84:87], a[108:111], v[60:63]
    ds_read_b64_tr_b16 v[106:107], v21 offset:16024
    v_mfma_f32_16x16x32_bf16 v[64:67], v[88:91], a[28:31], v[64:67]
    ds_read_b64_tr_b16 v[108:109], v21 offset:15392
    v_mfma_f32_16x16x32_bf16 v[68:71], v[88:91], a[108:111], v[68:71]
    ds_read_b64_tr_b16 v[110:111], v21 offset:16032
    s_waitcnt lgkmcnt(0)
    v_mfma_f32_16x16x32_bf16 v[32:35], v[92:95], a[32:35], v[32:35]
    ds_read_b64_tr_b16 v[72:73], v21 offset:20480
    v_mfma_f32_16x16x32_bf16 v[36:39], v[92:95], a[112:115], v[36:39]
    ds_read_b64_tr_b16 v[74:75], v21 offset:21120
    v_mfma_f32_16x16x32_bf16 v[40:43], v[96:99], a[32:35], v[40:43]
    ds_read_b64_tr_b16 v[76:77], v21 offset:20488
    v_mfma_f32_16x16x32_bf16 v[44:47], v[96:99], a[112:115], v[44:47]
    ds_read_b64_tr_b16 v[78:79], v21 offset:21128
    v_mfma_f32_16x16x32_bf16 v[48:51], v[100:103], a[32:35], v[48:51]
    ds_read_b64_tr_b16 v[80:81], v21 offset:20496
    v_mfma_f32_16x16x32_bf16 v[52:55], v[100:103], a[112:115], v[52:55]
    ds_read_b64_tr_b16 v[82:83], v21 offset:21136
    v_mfma_f32_16x16x32_bf16 v[56:59], v[104:107], a[32:35], v[56:59]
    ds_read_b64_tr_b16 v[84:85], v21 offset:20504
    v_mfma_f32_16x16x32_bf16 v[60:63], v[104:107], a[112:115], v[60:63]
    ds_read_b64_tr_b16 v[86:87], v21 offset:21144
    v_mfma_f32_16x16x32_bf16 v[64:67], v[108:111], a[32:35], v[64:67]
    ds_read_b64_tr_b16 v[88:89], v21 offset:20512
    v_mfma_f32_16x16x32_bf16 v[68:71], v[108:111], a[112:115], v[68:71]
    ds_read_b64_tr_b16 v[90:91], v21 offset:21152
    s_waitcnt lgkmcnt(0)
    v_mfma_f32_16x16x32_bf16 v[32:35], v[72:75], a[36:39], v[32:35]
    v_mfma_f32_16x16x32_bf16 v[36:39], v[72:75], a[116:119], v[36:39]
    v_mfma_f32_16x16x32_bf16 v[40:43], v[76:79], a[36:39], v[40:43]
    v_mfma_f32_16x16x32_bf16 v[44:47], v[76:79], a[116:119], v[44:47]
    v_mfma_f32_16x16x32_bf16 v[48:51], v[80:83], a[36:39], v[48:51]
    v_mfma_f32_16x16x32_bf16 v[52:55], v[80:83], a[116:119], v[52:55]
    v_mfma_f32_16x16x32_bf16 v[56:59], v[84:87], a[36:39], v[56:59]
    v_mfma_f32_16x16x32_bf16 v[60:63], v[84:87], a[116:119], v[60:63]
    v_mfma_f32_16x16x32_bf16 v[64:67], v[88:91], a[36:39], v[64:67]
    v_mfma_f32_16x16x32_bf16 v[68:71], v[88:91], a[116:119], v[68:71]
    s_waitcnt vmcnt(20)
    s_barrier
    s_add_u32 s28, s33, 617120
    s_mul_i32 s24, s9, 7168
    s_add_u32 m0, s24, 28672
    s_nop 0
    buffer_load_dwordx4 v0, s[20:23], s28 offen lds
    s_add_u32 m0, s24, 29696
    s_nop 0
    buffer_load_dwordx4 v1, s[20:23], s28 offen lds
    s_add_u32 m0, s24, 30720
    s_nop 0
    buffer_load_dwordx4 v2, s[20:23], s28 offen lds
    s_add_u32 m0, s24, 31744
    s_nop 0
    buffer_load_dwordx4 v3, s[20:23], s28 offen lds
    s_add_u32 m0, s24, 32768
    s_nop 0
    buffer_load_dwordx4 v4, s[20:23], s28 offen lds
    s_add_u32 m0, s24, 33792
    s_nop 0
    buffer_load_dwordx4 v5, s[20:23], s28 offen lds
    s_add_u32 m0, s24, 34816
    s_nop 0
    buffer_load_dwordx4 v6, s[20:23], s28 offen lds
    v_add_u32 v21, 57344, v16
    ds_read_b64_tr_b16 v[72:73], v21 offset:0
    ds_read_b64_tr_b16 v[74:75], v21 offset:640
    ds_read_b64_tr_b16 v[76:77], v21 offset:8
    ds_read_b64_tr_b16 v[78:79], v21 offset:648
    ds_read_b64_tr_b16 v[80:81], v21 offset:16
    ds_read_b64_tr_b16 v[82:83], v21 offset:656
    ds_read_b64_tr_b16 v[84:85], v21 offset:24
    ds_read_b64_tr_b16 v[86:87], v21 offset:664
    ds_read_b64_tr_b16 v[88:89], v21 offset:32
    ds_read_b64_tr_b16 v[90:91], v21 offset:672
    s_waitcnt lgkmcnt(0)
    v_mfma_f32_16x16x32_bf16 v[32:35], v[72:75], a[40:43], v[32:35]
    ds_read_b64_tr_b16 v[92:93], v21 offset:5120
    v_mfma_f32_16x16x32_bf16 v[36:39], v[72:75], a[120:123], v[36:39]
    ds_read_b64_tr_b16 v[94:95], v21 offset:5760
    v_mfma_f32_16x16x32_bf16 v[40:43], v[76:79], a[40:43], v[40:43]
    ds_read_b64_tr_b16 v[96:97], v21 offset:5128
    v_mfma_f32_16x16x32_bf16 v[44:47], v[76:79], a[120:123], v[44:47]
    ds_read_b64_tr_b16 v[98:99], v21 offset:5768
    v_mfma_f32_16x16x32_bf16 v[48:51], v[80:83], a[40:43], v[48:51]
    ds_read_b64_tr_b16 v[100:101], v21 offset:5136
    v_mfma_f32_16x16x32_bf16 v[52:55], v[80:83], a[120:123], v[52:55]
    ds_read_b64_tr_b16 v[102:103], v21 offset:5776
    v_mfma_f32_16x16x32_bf16 v[56:59], v[84:87], a[40:43], v[56:59]
    ds_read_b64_tr_b16 v[104:105], v21 offset:5144
    v_mfma_f32_16x16x32_bf16 v[60:63], v[84:87], a[120:123], v[60:63]
    ds_read_b64_tr_b16 v[106:107], v21 offset:5784
    v_mfma_f32_16x16x32_bf16 v[64:67], v[88:91], a[40:43], v[64:67]
    ds_read_b64_tr_b16 v[108:109], v21 offset:5152
    v_mfma_f32_16x16x32_bf16 v[68:71], v[88:91], a[120:123], v[68:71]
    ds_read_b64_tr_b16 v[110:111], v21 offset:5792
    s_waitcnt lgkmcnt(0)
    v_mfma_f32_16x16x32_bf16 v[32:35], v[92:95], a[44:47], v[32:35]
    ds_read_b64_tr_b16 v[72:73], v21 offset:10240
    v_mfma_f32_16x16x32_bf16 v[36:39], v[92:95], a[124:127], v[36:39]
    ds_read_b64_tr_b16 v[74:75], v21 offset:10880
    v_mfma_f32_16x16x32_bf16 v[40:43], v[96:99], a[44:47], v[40:43]
    ds_read_b64_tr_b16 v[76:77], v21 offset:10248
    v_mfma_f32_16x16x32_bf16 v[44:47], v[96:99], a[124:127], v[44:47]
    ds_read_b64_tr_b16 v[78:79], v21 offset:10888
    v_mfma_f32_16x16x32_bf16 v[48:51], v[100:103], a[44:47], v[48:51]
    ds_read_b64_tr_b16 v[80:81], v21 offset:10256
    v_mfma_f32_16x16x32_bf16 v[52:55], v[100:103], a[124:127], v[52:55]
    ds_read_b64_tr_b16 v[82:83], v21 offset:10896
    v_mfma_f32_16x16x32_bf16 v[56:59], v[104:107], a[44:47], v[56:59]
    ds_read_b64_tr_b16 v[84:85], v21 offset:10264
    v_mfma_f32_16x16x32_bf16 v[60:63], v[104:107], a[124:127], v[60:63]
    ds_read_b64_tr_b16 v[86:87], v21 offset:10904
    v_mfma_f32_16x16x32_bf16 v[64:67], v[108:111], a[44:47], v[64:67]
    ds_read_b64_tr_b16 v[88:89], v21 offset:10272
    v_mfma_f32_16x16x32_bf16 v[68:71], v[108:111], a[124:127], v[68:71]
    ds_read_b64_tr_b16 v[90:91], v21 offset:10912
    s_waitcnt lgkmcnt(0)
    v_mfma_f32_16x16x32_bf16 v[32:35], v[72:75], a[48:51], v[32:35]
    ds_read_b64_tr_b16 v[92:93], v21 offset:15360
    v_mfma_f32_16x16x32_bf16 v[36:39], v[72:75], a[128:131], v[36:39]
    ds_read_b64_tr_b16 v[94:95], v21 offset:16000
    v_mfma_f32_16x16x32_bf16 v[40:43], v[76:79], a[48:51], v[40:43]
    ds_read_b64_tr_b16 v[96:97], v21 offset:15368
    v_mfma_f32_16x16x32_bf16 v[44:47], v[76:79], a[128:131], v[44:47]
    ds_read_b64_tr_b16 v[98:99], v21 offset:16008
    v_mfma_f32_16x16x32_bf16 v[48:51], v[80:83], a[48:51], v[48:51]
    ds_read_b64_tr_b16 v[100:101], v21 offset:15376
    v_mfma_f32_16x16x32_bf16 v[52:55], v[80:83], a[128:131], v[52:55]
    ds_read_b64_tr_b16 v[102:103], v21 offset:16016
    v_mfma_f32_16x16x32_bf16 v[56:59], v[84:87], a[48:51], v[56:59]
    ds_read_b64_tr_b16 v[104:105], v21 offset:15384
    v_mfma_f32_16x16x32_bf16 v[60:63], v[84:87], a[128:131], v[60:63]
    ds_read_b64_tr_b16 v[106:107], v21 offset:16024
    v_mfma_f32_16x16x32_bf16 v[64:67], v[88:91], a[48:51], v[64:67]
    ds_read_b64_tr_b16 v[108:109], v21 offset:15392
    v_mfma_f32_16x16x32_bf16 v[68:71], v[88:91], a[128:131], v[68:71]
    ds_read_b64_tr_b16 v[110:111], v21 offset:16032
    s_waitcnt lgkmcnt(0)
    v_mfma_f32_16x16x32_bf16 v[32:35], v[92:95], a[52:55], v[32:35]
    ds_read_b64_tr_b16 v[72:73], v21 offset:20480
    v_mfma_f32_16x16x32_bf16 v[36:39], v[92:95], a[132:135], v[36:39]
    ds_read_b64_tr_b16 v[74:75], v21 offset:21120
    v_mfma_f32_16x16x32_bf16 v[40:43], v[96:99], a[52:55], v[40:43]
    ds_read_b64_tr_b16 v[76:77], v21 offset:20488
    v_mfma_f32_16x16x32_bf16 v[44:47], v[96:99], a[132:135], v[44:47]
    ds_read_b64_tr_b16 v[78:79], v21 offset:21128
    v_mfma_f32_16x16x32_bf16 v[48:51], v[100:103], a[52:55], v[48:51]
    ds_read_b64_tr_b16 v[80:81], v21 offset:20496
    v_mfma_f32_16x16x32_bf16 v[52:55], v[100:103], a[132:135], v[52:55]
    ds_read_b64_tr_b16 v[82:83], v21 offset:21136
    v_mfma_f32_16x16x32_bf16 v[56:59], v[104:107], a[52:55], v[56:59]
    ds_read_b64_tr_b16 v[84:85], v21 offset:20504
    v_mfma_f32_16x16x32_bf16 v[60:63], v[104:107], a[132:135], v[60:63]
    ds_read_b64_tr_b16 v[86:87], v21 offset:21144
    v_mfma_f32_16x16x32_bf16 v[64:67], v[108:111], a[52:55], v[64:67]
    ds_read_b64_tr_b16 v[88:89], v21 offset:20512
    v_mfma_f32_16x16x32_bf16 v[68:71], v[108:111], a[132:135], v[68:71]
    ds_read_b64_tr_b16 v[90:91], v21 offset:21152
    s_waitcnt lgkmcnt(0)
    v_mfma_f32_16x16x32_bf16 v[32:35], v[72:75], a[56:59], v[32:35]
    v_mfma_f32_16x16x32_bf16 v[36:39], v[72:75], a[136:139], v[36:39]
    v_mfma_f32_16x16x32_bf16 v[40:43], v[76:79], a[56:59], v[40:43]
    v_mfma_f32_16x16x32_bf16 v[44:47], v[76:79], a[136:139], v[44:47]
    v_mfma_f32_16x16x32_bf16 v[48:51], v[80:83], a[56:59], v[48:51]
    v_mfma_f32_16x16x32_bf16 v[52:55], v[80:83], a[136:139], v[52:55]
    v_mfma_f32_16x16x32_bf16 v[56:59], v[84:87], a[56:59], v[56:59]
    v_mfma_f32_16x16x32_bf16 v[60:63], v[84:87], a[136:139], v[60:63]
    v_mfma_f32_16x16x32_bf16 v[64:67], v[88:91], a[56:59], v[64:67]
    v_mfma_f32_16x16x32_bf16 v[68:71], v[88:91], a[136:139], v[68:71]
    s_waitcnt vmcnt(14)
    s_barrier
    s_add_u32 s28, s33, 1231520
    s_mul_i32 s24, s9, 7168
    s_add_u32 m0, s24, 57344
    s_nop 0
    buffer_load_dwordx4 v0, s[20:23], s28 offen lds
    s_add_u32 m0, s24, 58368
    s_nop 0
    buffer_load_dwordx4 v1, s[20:23], s28 offen lds
    s_add_u32 m0, s24, 59392
    s_nop 0
    buffer_load_dwordx4 v2, s[20:23], s28 offen lds
    s_add_u32 m0, s24, 60416
    s_nop 0
    buffer_load_dwordx4 v3, s[20:23], s28 offen lds
    s_add_u32 m0, s24, 61440
    s_nop 0
    buffer_load_dwordx4 v4, s[20:23], s28 offen lds
    s_add_u32 m0, s24, 62464
    s_nop 0
    buffer_load_dwordx4 v5, s[20:23], s28 offen lds
    s_add_u32 m0, s24, 63488
    s_nop 0
    buffer_load_dwordx4 v6, s[20:23], s28 offen lds
    v_add_u32 v21, 86016, v16
    ds_read_b64_tr_b16 v[72:73], v21 offset:0
    ds_read_b64_tr_b16 v[74:75], v21 offset:640
    ds_read_b64_tr_b16 v[76:77], v21 offset:8
    ds_read_b64_tr_b16 v[78:79], v21 offset:648
    ds_read_b64_tr_b16 v[80:81], v21 offset:16
    ds_read_b64_tr_b16 v[82:83], v21 offset:656
    ds_read_b64_tr_b16 v[84:85], v21 offset:24
    ds_read_b64_tr_b16 v[86:87], v21 offset:664
    ds_read_b64_tr_b16 v[88:89], v21 offset:32
    ds_read_b64_tr_b16 v[90:91], v21 offset:672
    s_waitcnt lgkmcnt(0)
    v_mfma_f32_16x16x32_bf16 v[32:35], v[72:75], a[60:63], v[32:35]
    ds_read_b64_tr_b16 v[92:93], v21 offset:5120
    v_mfma_f32_16x16x32_bf16 v[36:39], v[72:75], a[140:143], v[36:39]
    ds_read_b64_tr_b16 v[94:95], v21 offset:5760
    v_mfma_f32_16x16x32_bf16 v[40:43], v[76:79], a[60:63], v[40:43]
    ds_read_b64_tr_b16 v[96:97], v21 offset:5128
    v_mfma_f32_16x16x32_bf16 v[44:47], v[76:79], a[140:143], v[44:47]
    ds_read_b64_tr_b16 v[98:99], v21 offset:5768
    v_mfma_f32_16x16x32_bf16 v[48:51], v[80:83], a[60:63], v[48:51]
    ds_read_b64_tr_b16 v[100:101], v21 offset:5136
    v_mfma_f32_16x16x32_bf16 v[52:55], v[80:83], a[140:143], v[52:55]
    ds_read_b64_tr_b16 v[102:103], v21 offset:5776
    v_mfma_f32_16x16x32_bf16 v[56:59], v[84:87], a[60:63], v[56:59]
    ds_read_b64_tr_b16 v[104:105], v21 offset:5144
    v_mfma_f32_16x16x32_bf16 v[60:63], v[84:87], a[140:143], v[60:63]
    ds_read_b64_tr_b16 v[106:107], v21 offset:5784
    v_mfma_f32_16x16x32_bf16 v[64:67], v[88:91], a[60:63], v[64:67]
    ds_read_b64_tr_b16 v[108:109], v21 offset:5152
    v_mfma_f32_16x16x32_bf16 v[68:71], v[88:91], a[140:143], v[68:71]
    ds_read_b64_tr_b16 v[110:111], v21 offset:5792
    s_waitcnt lgkmcnt(0)
    v_mfma_f32_16x16x32_bf16 v[32:35], v[92:95], a[64:67], v[32:35]
    ds_read_b64_tr_b16 v[72:73], v21 offset:10240
    v_mfma_f32_16x16x32_bf16 v[36:39], v[92:95], a[144:147], v[36:39]
    ds_read_b64_tr_b16 v[74:75], v21 offset:10880
    v_mfma_f32_16x16x32_bf16 v[40:43], v[96:99], a[64:67], v[40:43]
    ds_read_b64_tr_b16 v[76:77], v21 offset:10248
    v_mfma_f32_16x16x32_bf16 v[44:47], v[96:99], a[144:147], v[44:47]
    ds_read_b64_tr_b16 v[78:79], v21 offset:10888
    v_mfma_f32_16x16x32_bf16 v[48:51], v[100:103], a[64:67], v[48:51]
    ds_read_b64_tr_b16 v[80:81], v21 offset:10256
    v_mfma_f32_16x16x32_bf16 v[52:55], v[100:103], a[144:147], v[52:55]
    ds_read_b64_tr_b16 v[82:83], v21 offset:10896
    v_mfma_f32_16x16x32_bf16 v[56:59], v[104:107], a[64:67], v[56:59]
    ds_read_b64_tr_b16 v[84:85], v21 offset:10264
    v_mfma_f32_16x16x32_bf16 v[60:63], v[104:107], a[144:147], v[60:63]
    ds_read_b64_tr_b16 v[86:87], v21 offset:10904
    v_mfma_f32_16x16x32_bf16 v[64:67], v[108:111], a[64:67], v[64:67]
    ds_read_b64_tr_b16 v[88:89], v21 offset:10272
    v_mfma_f32_16x16x32_bf16 v[68:71], v[108:111], a[144:147], v[68:71]
    ds_read_b64_tr_b16 v[90:91], v21 offset:10912
    s_waitcnt lgkmcnt(0)
    v_mfma_f32_16x16x32_bf16 v[32:35], v[72:75], a[68:71], v[32:35]
    ds_read_b64_tr_b16 v[92:93], v21 offset:15360
    v_mfma_f32_16x16x32_bf16 v[36:39], v[72:75], a[148:151], v[36:39]
    ds_read_b64_tr_b16 v[94:95], v21 offset:16000
    v_mfma_f32_16x16x32_bf16 v[40:43], v[76:79], a[68:71], v[40:43]
    ds_read_b64_tr_b16 v[96:97], v21 offset:15368
    v_mfma_f32_16x16x32_bf16 v[44:47], v[76:79], a[148:151], v[44:47]
    ds_read_b64_tr_b16 v[98:99], v21 offset:16008
    v_mfma_f32_16x16x32_bf16 v[48:51], v[80:83], a[68:71], v[48:51]
    ds_read_b64_tr_b16 v[100:101], v21 offset:15376
    v_mfma_f32_16x16x32_bf16 v[52:55], v[80:83], a[148:151], v[52:55]
    ds_read_b64_tr_b16 v[102:103], v21 offset:16016
    v_mfma_f32_16x16x32_bf16 v[56:59], v[84:87], a[68:71], v[56:59]
    ds_read_b64_tr_b16 v[104:105], v21 offset:15384
    v_mfma_f32_16x16x32_bf16 v[60:63], v[84:87], a[148:151], v[60:63]
    ds_read_b64_tr_b16 v[106:107], v21 offset:16024
    v_mfma_f32_16x16x32_bf16 v[64:67], v[88:91], a[68:71], v[64:67]
    ds_read_b64_tr_b16 v[108:109], v21 offset:15392
    v_mfma_f32_16x16x32_bf16 v[68:71], v[88:91], a[148:151], v[68:71]
    ds_read_b64_tr_b16 v[110:111], v21 offset:16032
    s_waitcnt lgkmcnt(0)
    v_mfma_f32_16x16x32_bf16 v[32:35], v[92:95], a[72:75], v[32:35]
    ds_read_b64_tr_b16 v[72:73], v21 offset:20480
    v_mfma_f32_16x16x32_bf16 v[36:39], v[92:95], a[152:155], v[36:39]
    ds_read_b64_tr_b16 v[74:75], v21 offset:21120
    v_mfma_f32_16x16x32_bf16 v[40:43], v[96:99], a[72:75], v[40:43]
    ds_read_b64_tr_b16 v[76:77], v21 offset:20488
    v_mfma_f32_16x16x32_bf16 v[44:47], v[96:99], a[152:155], v[44:47]
    ds_read_b64_tr_b16 v[78:79], v21 offset:21128
    v_mfma_f32_16x16x32_bf16 v[48:51], v[100:103], a[72:75], v[48:51]
    ds_read_b64_tr_b16 v[80:81], v21 offset:20496
    v_mfma_f32_16x16x32_bf16 v[52:55], v[100:103], a[152:155], v[52:55]
    ds_read_b64_tr_b16 v[82:83], v21 offset:21136
    v_mfma_f32_16x16x32_bf16 v[56:59], v[104:107], a[72:75], v[56:59]
    ds_read_b64_tr_b16 v[84:85], v21 offset:20504
    v_mfma_f32_16x16x32_bf16 v[60:63], v[104:107], a[152:155], v[60:63]
    ds_read_b64_tr_b16 v[86:87], v21 offset:21144
    v_mfma_f32_16x16x32_bf16 v[64:67], v[108:111], a[72:75], v[64:67]
    ds_read_b64_tr_b16 v[88:89], v21 offset:20512
    v_mfma_f32_16x16x32_bf16 v[68:71], v[108:111], a[152:155], v[68:71]
    ds_read_b64_tr_b16 v[90:91], v21 offset:21152
    s_waitcnt lgkmcnt(0)
    v_mfma_f32_16x16x32_bf16 v[32:35], v[72:75], a[76:79], v[32:35]
    v_mfma_f32_16x16x32_bf16 v[36:39], v[72:75], a[156:159], v[36:39]
    v_mfma_f32_16x16x32_bf16 v[40:43], v[76:79], a[76:79], v[40:43]
    v_mfma_f32_16x16x32_bf16 v[44:47], v[76:79], a[156:159], v[44:47]
    v_mfma_f32_16x16x32_bf16 v[48:51], v[80:83], a[76:79], v[48:51]
    v_mfma_f32_16x16x32_bf16 v[52:55], v[80:83], a[156:159], v[52:55]
    v_mfma_f32_16x16x32_bf16 v[56:59], v[84:87], a[76:79], v[56:59]
    v_mfma_f32_16x16x32_bf16 v[60:63], v[84:87], a[156:159], v[60:63]
    v_mfma_f32_16x16x32_bf16 v[64:67], v[88:91], a[76:79], v[64:67]
    v_mfma_f32_16x16x32_bf16 v[68:71], v[88:91], a[156:159], v[68:71]
    s_nop 7
    v_add_u32 v21, 3200, v19
    v_cndmask_b32 v21, v19, v21, s[40:41]
    ds_read_b64_tr_b16 v[112:113], v21 offset:0
    ds_read_b64_tr_b16 v[114:115], v21 offset:160
    ds_read_b64_tr_b16 v[116:117], v21 offset:320
    ds_read_b64_tr_b16 v[118:119], v21 offset:480
    ds_read_b64_tr_b16 v[120:121], v21 offset:640
    ds_read_b64_tr_b16 v[122:123], v21 offset:8
    ds_read_b64_tr_b16 v[124:125], v21 offset:168
    ds_read_b64_tr_b16 v[126:127], v21 offset:328
    ds_read_b64_tr_b16 v[128:129], v21 offset:488
    ds_read_b64_tr_b16 v[130:131], v21 offset:648
    s_waitcnt lgkmcnt(0)
    ds_read_b64_tr_b16 v[132:133], v21 offset:16
    ds_read_b64_tr_b16 v[134:135], v21 offset:176
    ds_read_b64_tr_b16 v[136:137], v21 offset:336
    ds_read_b64_tr_b16 v[138:139], v21 offset:496
    ds_read_b64_tr_b16 v[140:141], v21 offset:656
    ds_read_b64_tr_b16 v[142:143], v21 offset:24
    ds_read_b64_tr_b16 v[144:145], v21 offset:184
    ds_read_b64_tr_b16 v[146:147], v21 offset:344
    ds_read_b64_tr_b16 v[148:149], v21 offset:504
    ds_read_b64_tr_b16 v[150:151], v21 offset:664
    s_waitcnt lgkmcnt(0)
    ds_read_b64_tr_b16 v[152:153], v21 offset:32
    ds_read_b64_tr_b16 v[154:155], v21 offset:192
    ds_read_b64_tr_b16 v[156:157], v21 offset:352
    ds_read_b64_tr_b16 v[158:159], v21 offset:512
    ds_read_b64_tr_b16 v[160:161], v21 offset:672
    v_cvt_pk_bf16_f32 v234, v32, v33
    v_cvt_pk_bf16_f32 v235, v34, v35
    v_cvt_pk_bf16_f32 v236, v40, v41
    v_cvt_pk_bf16_f32 v237, v42, v43
    v_cvt_pk_bf16_f32 v238, v48, v49
    v_cvt_pk_bf16_f32 v239, v50, v51
    v_cvt_pk_bf16_f32 v240, v56, v57
    v_cvt_pk_bf16_f32 v241, v58, v59
    v_cvt_pk_bf16_f32 v242, v64, v65
    v_cvt_pk_bf16_f32 v243, v66, v67
    v_cvt_pk_bf16_f32 v244, v36, v37
    v_cvt_pk_bf16_f32 v245, v38, v39
    v_cvt_pk_bf16_f32 v246, v44, v45
    v_cvt_pk_bf16_f32 v247, v46, v47
    v_cvt_pk_bf16_f32 v248, v52, v53
    v_cvt_pk_bf16_f32 v249, v54, v55
    v_cvt_pk_bf16_f32 v250, v60, v61
    v_cvt_pk_bf16_f32 v251, v62, v63
    v_cvt_pk_bf16_f32 v252, v68, v69
    v_cvt_pk_bf16_f32 v253, v70, v71
    s_waitcnt lgkmcnt(0)
    s_nop 1
    v_mfma_f32_16x16x32_bf16 v[72:75], v[112:115], v[234:237], 0
    v_mfma_f32_16x16x32_bf16 v[92:95], v[112:115], v[244:247], 0
    v_mfma_f32_16x16x32_bf16 v[76:79], v[122:125], v[234:237], 0
    v_mfma_f32_16x16x32_bf16 v[96:99], v[122:125], v[244:247], 0
    v_mfma_f32_16x16x32_bf16 v[80:83], v[132:135], v[234:237], 0
    v_mfma_f32_16x16x32_bf16 v[100:103], v[132:135], v[244:247], 0
    v_mfma_f32_16x16x32_bf16 v[84:87], v[142:145], v[234:237], 0
    v_mfma_f32_16x16x32_bf16 v[104:107], v[142:145], v[244:247], 0
    v_mfma_f32_16x16x32_bf16 v[88:91], v[152:155], v[234:237], 0
    v_mfma_f32_16x16x32_bf16 v[108:111], v[152:155], v[244:247], 0
    v_mfma_f32_16x16x32_bf16 v[72:75], v[116:119], v[238:241], v[72:75]
    v_mfma_f32_16x16x32_bf16 v[92:95], v[116:119], v[248:251], v[92:95]
    v_mfma_f32_16x16x32_bf16 v[76:79], v[126:129], v[238:241], v[76:79]
    v_mfma_f32_16x16x32_bf16 v[96:99], v[126:129], v[248:251], v[96:99]
    v_mfma_f32_16x16x32_bf16 v[80:83], v[136:139], v[238:241], v[80:83]
    v_mfma_f32_16x16x32_bf16 v[100:103], v[136:139], v[248:251], v[100:103]
    v_mfma_f32_16x16x32_bf16 v[84:87], v[146:149], v[238:241], v[84:87]
    v_mfma_f32_16x16x32_bf16 v[104:107], v[146:149], v[248:251], v[104:107]
    v_mfma_f32_16x16x32_bf16 v[88:91], v[156:159], v[238:241], v[88:91]
    v_mfma_f32_16x16x32_bf16 v[108:111], v[156:159], v[248:251], v[108:111]
    v_mfma_f32_16x16x16_bf16 v[72:75], v[120:121], v[242:243], v[72:75]
    v_mfma_f32_16x16x16_bf16 v[92:95], v[120:121], v[252:253], v[92:95]
    v_mfma_f32_16x16x16_bf16 v[76:79], v[130:131], v[242:243], v[76:79]
    v_mfma_f32_16x16x16_bf16 v[96:99], v[130:131], v[252:253], v[96:99]
    v_mfma_f32_16x16x16_bf16 v[80:83], v[140:141], v[242:243], v[80:83]
    v_mfma_f32_16x16x16_bf16 v[100:103], v[140:141], v[252:253], v[100:103]
    v_mfma_f32_16x16x16_bf16 v[84:87], v[150:151], v[242:243], v[84:87]
    v_mfma_f32_16x16x16_bf16 v[104:107], v[150:151], v[252:253], v[104:107]
    v_mfma_f32_16x16x16_bf16 v[88:91], v[160:161], v[242:243], v[88:91]
    v_mfma_f32_16x16x16_bf16 v[108:111], v[160:161], v[252:253], v[108:111]
    s_mov_b32 s24, 0x3fb8aa3b
    s_nop 7
    v_cvt_pk_bf16_f32 v8, v72, v73
    v_lshlrev_b32 v72, 16, v8
    v_and_b32 v73, 0xffff0000, v8
    v_cvt_pk_bf16_f32 v8, v74, v75
    v_lshlrev_b32 v74, 16, v8
    v_and_b32 v75, 0xffff0000, v8
    v_cvt_pk_bf16_f32 v8, v76, v77
    v_lshlrev_b32 v76, 16, v8
    v_and_b32 v77, 0xffff0000, v8
    v_cvt_pk_bf16_f32 v8, v78, v79
    v_lshlrev_b32 v78, 16, v8
    v_and_b32 v79, 0xffff0000, v8
    v_cvt_pk_bf16_f32 v8, v80, v81
    v_lshlrev_b32 v80, 16, v8
    v_and_b32 v81, 0xffff0000, v8
    v_cvt_pk_bf16_f32 v8, v82, v83
    v_lshlrev_b32 v82, 16, v8
    v_and_b32 v83, 0xffff0000, v8
    v_cvt_pk_bf16_f32 v8, v84, v85
    v_lshlrev_b32 v84, 16, v8
    v_and_b32 v85, 0xffff0000, v8
    v_cvt_pk_bf16_f32 v8, v86, v87
    v_lshlrev_b32 v86, 16, v8
    v_and_b32 v87, 0xffff0000, v8
    v_cvt_pk_bf16_f32 v8, v88, v89
    v_lshlrev_b32 v88, 16, v8
    v_and_b32 v89, 0xffff0000, v8
    v_cvt_pk_bf16_f32 v8, v90, v91
    v_lshlrev_b32 v90, 16, v8
    v_and_b32 v91, 0xffff0000, v8
    v_max3_f32 v8, v72, v73, v74
    v_max3_f32 v8, v8, v75, v76
    v_max3_f32 v8, v8, v77, v78
    v_max3_f32 v8, v8, v79, v80
    v_max3_f32 v8, v8, v81, v82
    v_max3_f32 v8, v8, v83, v84
    v_max3_f32 v8, v8, v85, v86
    v_max3_f32 v8, v8, v87, v88
    v_max3_f32 v8, v8, v89, v90
    v_max_f32 v8, v8, v91
    v_min3_f32 v9, v72, v73, v74
    v_min3_f32 v9, v9, v75, v76
    v_min3_f32 v9, v9, v77, v78
    v_min3_f32 v9, v9, v79, v80
    v_min3_f32 v9, v9, v81, v82
    v_min3_f32 v9, v9, v83, v84
    v_min3_f32 v9, v9, v85, v86
    v_min3_f32 v9, v9, v87, v88
    v_min3_f32 v9, v9, v89, v90
    v_min_f32 v9, v9, v91
    v_mul_f32 v8, s24, v8
    v_mul_f32 v9, s24, v9
    v_fma_f32 v32, -v72, s24, v9
    v_fma_f32 v72, v72, s24, -v8
    v_fma_f32 v33, -v73, s24, v9
    v_fma_f32 v73, v73, s24, -v8
    v_fma_f32 v34, -v74, s24, v9
    v_fma_f32 v74, v74, s24, -v8
    v_fma_f32 v35, -v75, s24, v9
    v_fma_f32 v75, v75, s24, -v8
    v_fma_f32 v36, -v76, s24, v9
    v_fma_f32 v76, v76, s24, -v8
    v_fma_f32 v37, -v77, s24, v9
    v_fma_f32 v77, v77, s24, -v8
    v_fma_f32 v38, -v78, s24, v9
    v_fma_f32 v78, v78, s24, -v8
    v_fma_f32 v39, -v79, s24, v9
    v_fma_f32 v79, v79, s24, -v8
    v_fma_f32 v40, -v80, s24, v9
    v_fma_f32 v80, v80, s24, -v8
    v_fma_f32 v41, -v81, s24, v9
    v_fma_f32 v81, v81, s24, -v8
    v_fma_f32 v42, -v82, s24, v9
    v_fma_f32 v82, v82, s24, -v8
    v_fma_f32 v43, -v83, s24, v9
    v_fma_f32 v83, v83, s24, -v8
    v_fma_f32 v44, -v84, s24, v9
    v_fma_f32 v84, v84, s24, -v8
    v_fma_f32 v45, -v85, s24, v9
    v_fma_f32 v85, v85, s24, -v8
    v_fma_f32 v46, -v86, s24, v9
    v_fma_f32 v86, v86, s24, -v8
    v_fma_f32 v47, -v87, s24, v9
    v_fma_f32 v87, v87, s24, -v8
    v_fma_f32 v48, -v88, s24, v9
    v_fma_f32 v88, v88, s24, -v8
    v_fma_f32 v49, -v89, s24, v9
    v_fma_f32 v89, v89, s24, -v8
    v_fma_f32 v50, -v90, s24, v9
    v_fma_f32 v90, v90, s24, -v8
    v_fma_f32 v51, -v91, s24, v9
    v_fma_f32 v91, v91, s24, -v8
    v_exp_f32 v32, v32
    v_exp_f32 v72, v72
    v_exp_f32 v33, v33
    v_exp_f32 v73, v73
    v_exp_f32 v34, v34
    v_exp_f32 v74, v74
    v_exp_f32 v35, v35
    v_exp_f32 v75, v75
    v_exp_f32 v36, v36
    v_exp_f32 v76, v76
    v_exp_f32 v37, v37
    v_exp_f32 v77, v77
    v_exp_f32 v38, v38
    v_exp_f32 v78, v78
    v_exp_f32 v39, v39
    v_exp_f32 v79, v79
    v_exp_f32 v40, v40
    v_exp_f32 v80, v80
    v_exp_f32 v41, v41
    v_exp_f32 v81, v81
    v_exp_f32 v42, v42
    v_exp_f32 v82, v82
    v_exp_f32 v43, v43
    v_exp_f32 v83, v83
    v_exp_f32 v44, v44
    v_exp_f32 v84, v84
    v_exp_f32 v45, v45
    v_exp_f32 v85, v85
    v_exp_f32 v46, v46
    v_exp_f32 v86, v86
    v_exp_f32 v47, v47
    v_exp_f32 v87, v87
    v_exp_f32 v48, v48
    v_exp_f32 v88, v88
    v_exp_f32 v49, v49
    v_exp_f32 v89, v89
    v_exp_f32 v50, v50
    v_exp_f32 v90, v90
    v_exp_f32 v51, v51
    v_exp_f32 v91, v91
    v_add_f32 v9, v32, v33
    v_add_f32 v9, v9, v34
    v_add_f32 v9, v9, v35
    v_add_f32 v9, v9, v36
    v_add_f32 v9, v9, v37
    v_add_f32 v9, v9, v38
    v_add_f32 v9, v9, v39
    v_add_f32 v9, v9, v40
    v_add_f32 v9, v9, v41
    v_add_f32 v9, v9, v42
    v_add_f32 v9, v9, v43
    v_add_f32 v9, v9, v44
    v_add_f32 v9, v9, v45
    v_add_f32 v9, v9, v46
    v_add_f32 v9, v9, v47
    v_add_f32 v9, v9, v48
    v_add_f32 v9, v9, v49
    v_add_f32 v9, v9, v50
    v_add_f32 v9, v9, v51
    v_add_f32 v8, v72, v73
    v_add_f32 v8, v8, v74
    v_add_f32 v8, v8, v75
    v_add_f32 v8, v8, v76
    v_add_f32 v8, v8, v77
    v_add_f32 v8, v8, v78
    v_add_f32 v8, v8, v79
    v_add_f32 v8, v8, v80
    v_add_f32 v8, v8, v81
    v_add_f32 v8, v8, v82
    v_add_f32 v8, v8, v83
    v_add_f32 v8, v8, v84
    v_add_f32 v8, v8, v85
    v_add_f32 v8, v8, v86
    v_add_f32 v8, v8, v87
    v_add_f32 v8, v8, v88
    v_add_f32 v8, v8, v89
    v_add_f32 v8, v8, v90
    v_add_f32 v8, v8, v91
    v_rcp_f32 v8, v8
    v_rcp_f32 v9, v9
    s_nop 0
    v_mul_f32 v72, v72, v8
    v_mul_f32 v32, v32, v9
    v_mul_f32 v73, v73, v8
    v_mul_f32 v33, v33, v9
    v_mul_f32 v74, v74, v8
    v_mul_f32 v34, v34, v9
    v_mul_f32 v75, v75, v8
    v_mul_f32 v35, v35, v9
    v_mul_f32 v76, v76, v8
    v_mul_f32 v36, v36, v9
    v_mul_f32 v77, v77, v8
    v_mul_f32 v37, v37, v9
    v_mul_f32 v78, v78, v8
    v_mul_f32 v38, v38, v9
    v_mul_f32 v79, v79, v8
    v_mul_f32 v39, v39, v9
    v_mul_f32 v80, v80, v8
    v_mul_f32 v40, v40, v9
    v_mul_f32 v81, v81, v8
    v_mul_f32 v41, v41, v9
    v_mul_f32 v82, v82, v8
    v_mul_f32 v42, v42, v9
    v_mul_f32 v83, v83, v8
    v_mul_f32 v43, v43, v9
    v_mul_f32 v84, v84, v8
    v_mul_f32 v44, v44, v9
    v_mul_f32 v85, v85, v8
    v_mul_f32 v45, v45, v9
    v_mul_f32 v86, v86, v8
    v_mul_f32 v46, v46, v9
    v_mul_f32 v87, v87, v8
    v_mul_f32 v47, v47, v9
    v_mul_f32 v88, v88, v8
    v_mul_f32 v48, v48, v9
    v_mul_f32 v89, v89, v8
    v_mul_f32 v49, v49, v9
    v_mul_f32 v90, v90, v8
    v_mul_f32 v50, v50, v9
    v_mul_f32 v91, v91, v8
    v_mul_f32 v51, v51, v9
    v_cvt_pk_bf16_f32 v162, v72, v73
    v_cvt_pk_bf16_f32 v172, v32, v33
    v_cvt_pk_bf16_f32 v163, v74, v75
    v_cvt_pk_bf16_f32 v173, v34, v35
    v_cvt_pk_bf16_f32 v164, v76, v77
    v_cvt_pk_bf16_f32 v174, v36, v37
    v_cvt_pk_bf16_f32 v165, v78, v79
    v_cvt_pk_bf16_f32 v175, v38, v39
    v_cvt_pk_bf16_f32 v166, v80, v81
    v_cvt_pk_bf16_f32 v176, v40, v41
    v_cvt_pk_bf16_f32 v167, v82, v83
    v_cvt_pk_bf16_f32 v177, v42, v43
    v_cvt_pk_bf16_f32 v168, v84, v85
    v_cvt_pk_bf16_f32 v178, v44, v45
    v_cvt_pk_bf16_f32 v169, v86, v87
    v_cvt_pk_bf16_f32 v179, v46, v47
    v_cvt_pk_bf16_f32 v170, v88, v89
    v_cvt_pk_bf16_f32 v180, v48, v49
    v_cvt_pk_bf16_f32 v171, v90, v91
    v_cvt_pk_bf16_f32 v181, v50, v51
    v_cvt_pk_bf16_f32 v8, v92, v93
    v_lshlrev_b32 v92, 16, v8
    v_and_b32 v93, 0xffff0000, v8
    v_cvt_pk_bf16_f32 v8, v94, v95
    v_lshlrev_b32 v94, 16, v8
    v_and_b32 v95, 0xffff0000, v8
    v_cvt_pk_bf16_f32 v8, v96, v97
    v_lshlrev_b32 v96, 16, v8
    v_and_b32 v97, 0xffff0000, v8
    v_cvt_pk_bf16_f32 v8, v98, v99
    v_lshlrev_b32 v98, 16, v8
    v_and_b32 v99, 0xffff0000, v8
    v_cvt_pk_bf16_f32 v8, v100, v101
    v_lshlrev_b32 v100, 16, v8
    v_and_b32 v101, 0xffff0000, v8
    v_cvt_pk_bf16_f32 v8, v102, v103
    v_lshlrev_b32 v102, 16, v8
    v_and_b32 v103, 0xffff0000, v8
    v_cvt_pk_bf16_f32 v8, v104, v105
    v_lshlrev_b32 v104, 16, v8
    v_and_b32 v105, 0xffff0000, v8
    v_cvt_pk_bf16_f32 v8, v106, v107
    v_lshlrev_b32 v106, 16, v8
    v_and_b32 v107, 0xffff0000, v8
    v_cvt_pk_bf16_f32 v8, v108, v109
    v_lshlrev_b32 v108, 16, v8
    v_and_b32 v109, 0xffff0000, v8
    v_cvt_pk_bf16_f32 v8, v110, v111
    v_lshlrev_b32 v110, 16, v8
    v_and_b32 v111, 0xffff0000, v8
    v_max3_f32 v8, v92, v93, v94
    v_max3_f32 v8, v8, v95, v96
    v_max3_f32 v8, v8, v97, v98
    v_max3_f32 v8, v8, v99, v100
    v_max3_f32 v8, v8, v101, v102
    v_max3_f32 v8, v8, v103, v104
    v_max3_f32 v8, v8, v105, v106
    v_max3_f32 v8, v8, v107, v108
    v_max3_f32 v8, v8, v109, v110
    v_max_f32 v8, v8, v111
    v_min3_f32 v9, v92, v93, v94
    v_min3_f32 v9, v9, v95, v96
    v_min3_f32 v9, v9, v97, v98
    v_min3_f32 v9, v9, v99, v100
    v_min3_f32 v9, v9, v101, v102
    v_min3_f32 v9, v9, v103, v104
    v_min3_f32 v9, v9, v105, v106
    v_min3_f32 v9, v9, v107, v108
    v_min3_f32 v9, v9, v109, v110
    v_min_f32 v9, v9, v111
    v_mul_f32 v8, s24, v8
    v_mul_f32 v9, s24, v9
    v_fma_f32 v32, -v92, s24, v9
    v_fma_f32 v92, v92, s24, -v8
    v_fma_f32 v33, -v93, s24, v9
    v_fma_f32 v93, v93, s24, -v8
    v_fma_f32 v34, -v94, s24, v9
    v_fma_f32 v94, v94, s24, -v8
    v_fma_f32 v35, -v95, s24, v9
    v_fma_f32 v95, v95, s24, -v8
    v_fma_f32 v36, -v96, s24, v9
    v_fma_f32 v96, v96, s24, -v8
    v_fma_f32 v37, -v97, s24, v9
    v_fma_f32 v97, v97, s24, -v8
    v_fma_f32 v38, -v98, s24, v9
    v_fma_f32 v98, v98, s24, -v8
    v_fma_f32 v39, -v99, s24, v9
    v_fma_f32 v99, v99, s24, -v8
    v_fma_f32 v40, -v100, s24, v9
    v_fma_f32 v100, v100, s24, -v8
    v_fma_f32 v41, -v101, s24, v9
    v_fma_f32 v101, v101, s24, -v8
    v_fma_f32 v42, -v102, s24, v9
    v_fma_f32 v102, v102, s24, -v8
    v_fma_f32 v43, -v103, s24, v9
    v_fma_f32 v103, v103, s24, -v8
    v_fma_f32 v44, -v104, s24, v9
    v_fma_f32 v104, v104, s24, -v8
    v_fma_f32 v45, -v105, s24, v9
    v_fma_f32 v105, v105, s24, -v8
    v_fma_f32 v46, -v106, s24, v9
    v_fma_f32 v106, v106, s24, -v8
    v_fma_f32 v47, -v107, s24, v9
    v_fma_f32 v107, v107, s24, -v8
    v_fma_f32 v48, -v108, s24, v9
    v_fma_f32 v108, v108, s24, -v8
    v_fma_f32 v49, -v109, s24, v9
    v_fma_f32 v109, v109, s24, -v8
    v_fma_f32 v50, -v110, s24, v9
    v_fma_f32 v110, v110, s24, -v8
    v_fma_f32 v51, -v111, s24, v9
    v_fma_f32 v111, v111, s24, -v8
    v_exp_f32 v32, v32
    v_exp_f32 v92, v92
    v_exp_f32 v33, v33
    v_exp_f32 v93, v93
    v_exp_f32 v34, v34
    v_exp_f32 v94, v94
    v_exp_f32 v35, v35
    v_exp_f32 v95, v95
    v_exp_f32 v36, v36
    v_exp_f32 v96, v96
    v_exp_f32 v37, v37
    v_exp_f32 v97, v97
    v_exp_f32 v38, v38
    v_exp_f32 v98, v98
    v_exp_f32 v39, v39
    v_exp_f32 v99, v99
    v_exp_f32 v40, v40
    v_exp_f32 v100, v100
    v_exp_f32 v41, v41
    v_exp_f32 v101, v101
    v_exp_f32 v42, v42
    v_exp_f32 v102, v102
    v_exp_f32 v43, v43
    v_exp_f32 v103, v103
    v_exp_f32 v44, v44
    v_exp_f32 v104, v104
    v_exp_f32 v45, v45
    v_exp_f32 v105, v105
    v_exp_f32 v46, v46
    v_exp_f32 v106, v106
    v_exp_f32 v47, v47
    v_exp_f32 v107, v107
    v_exp_f32 v48, v48
    v_exp_f32 v108, v108
    v_exp_f32 v49, v49
    v_exp_f32 v109, v109
    v_exp_f32 v50, v50
    v_exp_f32 v110, v110
    v_exp_f32 v51, v51
    v_exp_f32 v111, v111
    v_add_f32 v9, v32, v33
    v_add_f32 v9, v9, v34
    v_add_f32 v9, v9, v35
    v_add_f32 v9, v9, v36
    v_add_f32 v9, v9, v37
    v_add_f32 v9, v9, v38
    v_add_f32 v9, v9, v39
    v_add_f32 v9, v9, v40
    v_add_f32 v9, v9, v41
    v_add_f32 v9, v9, v42
    v_add_f32 v9, v9, v43
    v_add_f32 v9, v9, v44
    v_add_f32 v9, v9, v45
    v_add_f32 v9, v9, v46
    v_add_f32 v9, v9, v47
    v_add_f32 v9, v9, v48
    v_add_f32 v9, v9, v49
    v_add_f32 v9, v9, v50
    v_add_f32 v9, v9, v51
    v_add_f32 v8, v92, v93
    v_add_f32 v8, v8, v94
    v_add_f32 v8, v8, v95
    v_add_f32 v8, v8, v96
    v_add_f32 v8, v8, v97
    v_add_f32 v8, v8, v98
    v_add_f32 v8, v8, v99
    v_add_f32 v8, v8, v100
    v_add_f32 v8, v8, v101
    v_add_f32 v8, v8, v102
    v_add_f32 v8, v8, v103
    v_add_f32 v8, v8, v104
    v_add_f32 v8, v8, v105
    v_add_f32 v8, v8, v106
    v_add_f32 v8, v8, v107
    v_add_f32 v8, v8, v108
    v_add_f32 v8, v8, v109
    v_add_f32 v8, v8, v110
    v_add_f32 v8, v8, v111
    v_rcp_f32 v8, v8
    v_rcp_f32 v9, v9
    s_nop 0
    v_mul_f32 v92, v92, v8
    v_mul_f32 v32, v32, v9
    v_mul_f32 v93, v93, v8
    v_mul_f32 v33, v33, v9
    v_mul_f32 v94, v94, v8
    v_mul_f32 v34, v34, v9
    v_mul_f32 v95, v95, v8
    v_mul_f32 v35, v35, v9
    v_mul_f32 v96, v96, v8
    v_mul_f32 v36, v36, v9
    v_mul_f32 v97, v97, v8
    v_mul_f32 v37, v37, v9
    v_mul_f32 v98, v98, v8
    v_mul_f32 v38, v38, v9
    v_mul_f32 v99, v99, v8
    v_mul_f32 v39, v39, v9
    v_mul_f32 v100, v100, v8
    v_mul_f32 v40, v40, v9
    v_mul_f32 v101, v101, v8
    v_mul_f32 v41, v41, v9
    v_mul_f32 v102, v102, v8
    v_mul_f32 v42, v42, v9
    v_mul_f32 v103, v103, v8
    v_mul_f32 v43, v43, v9
    v_mul_f32 v104, v104, v8
    v_mul_f32 v44, v44, v9
    v_mul_f32 v105, v105, v8
    v_mul_f32 v45, v45, v9
    v_mul_f32 v106, v106, v8
    v_mul_f32 v46, v46, v9
    v_mul_f32 v107, v107, v8
    v_mul_f32 v47, v47, v9
    v_mul_f32 v108, v108, v8
    v_mul_f32 v48, v48, v9
    v_mul_f32 v109, v109, v8
    v_mul_f32 v49, v49, v9
    v_mul_f32 v110, v110, v8
    v_mul_f32 v50, v50, v9
    v_mul_f32 v111, v111, v8
    v_mul_f32 v51, v51, v9
    v_cvt_pk_bf16_f32 v182, v92, v93
    v_cvt_pk_bf16_f32 v192, v32, v33
    v_cvt_pk_bf16_f32 v183, v94, v95
    v_cvt_pk_bf16_f32 v193, v34, v35
    v_cvt_pk_bf16_f32 v184, v96, v97
    v_cvt_pk_bf16_f32 v194, v36, v37
    v_cvt_pk_bf16_f32 v185, v98, v99
    v_cvt_pk_bf16_f32 v195, v38, v39
    v_cvt_pk_bf16_f32 v186, v100, v101
    v_cvt_pk_bf16_f32 v196, v40, v41
    v_cvt_pk_bf16_f32 v187, v102, v103
    v_cvt_pk_bf16_f32 v197, v42, v43
    v_cvt_pk_bf16_f32 v188, v104, v105
    v_cvt_pk_bf16_f32 v198, v44, v45
    v_cvt_pk_bf16_f32 v189, v106, v107
    v_cvt_pk_bf16_f32 v199, v46, v47
    v_cvt_pk_bf16_f32 v190, v108, v109
    v_cvt_pk_bf16_f32 v200, v48, v49
    v_cvt_pk_bf16_f32 v191, v110, v111
    v_cvt_pk_bf16_f32 v201, v50, v51
    s_waitcnt vmcnt(14)
    s_barrier
    s_add_u32 s28, s33, 1845920
    s_mul_i32 s24, s9, 7168
    s_add_u32 m0, s24, 86016
    s_nop 0
    buffer_load_dwordx4 v0, s[20:23], s28 offen lds
    s_add_u32 m0, s24, 87040
    s_nop 0
    buffer_load_dwordx4 v1, s[20:23], s28 offen lds
    s_add_u32 m0, s24, 88064
    s_nop 0
    buffer_load_dwordx4 v2, s[20:23], s28 offen lds
    s_add_u32 m0, s24, 89088
    s_nop 0
    buffer_load_dwordx4 v3, s[20:23], s28 offen lds
    s_add_u32 m0, s24, 90112
    s_nop 0
    buffer_load_dwordx4 v4, s[20:23], s28 offen lds
    s_add_u32 m0, s24, 91136
    s_nop 0
    buffer_load_dwordx4 v5, s[20:23], s28 offen lds
    s_add_u32 m0, s24, 92160
    s_nop 0
    buffer_load_dwordx4 v6, s[20:23], s28 offen lds
    v_add_u32 v21, 0, v17
    v_add_u32 v22, 0, v16
    ds_read_b64_tr_b16 v[72:73], v21 offset:0
    ds_read_b64_tr_b16 v[74:75], v21 offset:640
    ds_read_b64_tr_b16 v[76:77], v21 offset:40
    ds_read_b64_tr_b16 v[78:79], v21 offset:680
    ds_read_b64_tr_b16 v[80:81], v21 offset:80
    ds_read_b64_tr_b16 v[82:83], v21 offset:720
    ds_read_b64_tr_b16 v[84:85], v21 offset:120
    ds_read_b64_tr_b16 v[86:87], v21 offset:760
    ds_read_b64_tr_b16 v[88:89], v22 offset:32
    ds_read_b64_tr_b16 v[90:91], v22 offset:672
    s_waitcnt lgkmcnt(0)
    v_mfma_f32_16x16x32_bf16 v[32:35], a[0:3], v[72:75], 0
    ds_read_b64_tr_b16 v[92:93], v21 offset:5120
    v_mfma_f32_16x16x32_bf16 v[36:39], a[80:83], v[72:75], 0
    ds_read_b64_tr_b16 v[94:95], v21 offset:5760
    v_mfma_f32_16x16x32_bf16 v[40:43], a[0:3], v[76:79], 0
    ds_read_b64_tr_b16 v[96:97], v21 offset:5160
    v_mfma_f32_16x16x32_bf16 v[44:47], a[80:83], v[76:79], 0
    ds_read_b64_tr_b16 v[98:99], v21 offset:5800
    v_mfma_f32_16x16x32_bf16 v[48:51], a[0:3], v[80:83], 0
    ds_read_b64_tr_b16 v[100:101], v21 offset:5200
    v_mfma_f32_16x16x32_bf16 v[52:55], a[80:83], v[80:83], 0
    ds_read_b64_tr_b16 v[102:103], v21 offset:5840
    v_mfma_f32_16x16x32_bf16 v[56:59], a[0:3], v[84:87], 0
    ds_read_b64_tr_b16 v[104:105], v21 offset:5240
    v_mfma_f32_16x16x32_bf16 v[60:63], a[80:83], v[84:87], 0
    ds_read_b64_tr_b16 v[106:107], v21 offset:5880
    v_mfma_f32_16x16x32_bf16 v[64:67], a[0:3], v[88:91], 0
    ds_read_b64_tr_b16 v[108:109], v22 offset:5152
    v_mfma_f32_16x16x32_bf16 v[68:71], a[80:83], v[88:91], 0
    ds_read_b64_tr_b16 v[110:111], v22 offset:5792
    s_waitcnt lgkmcnt(0)
    v_mfma_f32_16x16x32_bf16 v[32:35], a[4:7], v[92:95], v[32:35]
    ds_read_b64_tr_b16 v[72:73], v21 offset:10240
    v_mfma_f32_16x16x32_bf16 v[36:39], a[84:87], v[92:95], v[36:39]
    ds_read_b64_tr_b16 v[74:75], v21 offset:10880
    v_mfma_f32_16x16x32_bf16 v[40:43], a[4:7], v[96:99], v[40:43]
    ds_read_b64_tr_b16 v[76:77], v21 offset:10280
    v_mfma_f32_16x16x32_bf16 v[44:47], a[84:87], v[96:99], v[44:47]
    ds_read_b64_tr_b16 v[78:79], v21 offset:10920
    v_mfma_f32_16x16x32_bf16 v[48:51], a[4:7], v[100:103], v[48:51]
    ds_read_b64_tr_b16 v[80:81], v21 offset:10320
    v_mfma_f32_16x16x32_bf16 v[52:55], a[84:87], v[100:103], v[52:55]
    ds_read_b64_tr_b16 v[82:83], v21 offset:10960
    v_mfma_f32_16x16x32_bf16 v[56:59], a[4:7], v[104:107], v[56:59]
    ds_read_b64_tr_b16 v[84:85], v21 offset:10360
    v_mfma_f32_16x16x32_bf16 v[60:63], a[84:87], v[104:107], v[60:63]
    ds_read_b64_tr_b16 v[86:87], v21 offset:11000
    v_mfma_f32_16x16x32_bf16 v[64:67], a[4:7], v[108:111], v[64:67]
    ds_read_b64_tr_b16 v[88:89], v22 offset:10272
    v_mfma_f32_16x16x32_bf16 v[68:71], a[84:87], v[108:111], v[68:71]
    ds_read_b64_tr_b16 v[90:91], v22 offset:10912
    s_waitcnt lgkmcnt(0)
    v_mfma_f32_16x16x32_bf16 v[32:35], a[8:11], v[72:75], v[32:35]
    ds_read_b64_tr_b16 v[92:93], v21 offset:15360
    v_mfma_f32_16x16x32_bf16 v[36:39], a[88:91], v[72:75], v[36:39]
    ds_read_b64_tr_b16 v[94:95], v21 offset:16000
    v_mfma_f32_16x16x32_bf16 v[40:43], a[8:11], v[76:79], v[40:43]
    ds_read_b64_tr_b16 v[96:97], v21 offset:15400
    v_mfma_f32_16x16x32_bf16 v[44:47], a[88:91], v[76:79], v[44:47]
    ds_read_b64_tr_b16 v[98:99], v21 offset:16040
    v_mfma_f32_16x16x32_bf16 v[48:51], a[8:11], v[80:83], v[48:51]
    ds_read_b64_tr_b16 v[100:101], v21 offset:15440
    v_mfma_f32_16x16x32_bf16 v[52:55], a[88:91], v[80:83], v[52:55]
    ds_read_b64_tr_b16 v[102:103], v21 offset:16080
    v_mfma_f32_16x16x32_bf16 v[56:59], a[8:11], v[84:87], v[56:59]
    ds_read_b64_tr_b16 v[104:105], v21 offset:15480
    v_mfma_f32_16x16x32_bf16 v[60:63], a[88:91], v[84:87], v[60:63]
    ds_read_b64_tr_b16 v[106:107], v21 offset:16120
    v_mfma_f32_16x16x32_bf16 v[64:67], a[8:11], v[88:91], v[64:67]
    ds_read_b64_tr_b16 v[108:109], v22 offset:15392
    v_mfma_f32_16x16x32_bf16 v[68:71], a[88:91], v[88:91], v[68:71]
    ds_read_b64_tr_b16 v[110:111], v22 offset:16032
    s_waitcnt lgkmcnt(0)
    v_mfma_f32_16x16x32_bf16 v[32:35], a[12:15], v[92:95], v[32:35]
    ds_read_b64_tr_b16 v[72:73], v21 offset:20480
    v_mfma_f32_16x16x32_bf16 v[36:39], a[92:95], v[92:95], v[36:39]
    ds_read_b64_tr_b16 v[74:75], v21 offset:21120
    v_mfma_f32_16x16x32_bf16 v[40:43], a[12:15], v[96:99], v[40:43]
    ds_read_b64_tr_b16 v[76:77], v21 offset:20520
    v_mfma_f32_16x16x32_bf16 v[44:47], a[92:95], v[96:99], v[44:47]
    ds_read_b64_tr_b16 v[78:79], v21 offset:21160
    v_mfma_f32_16x16x32_bf16 v[48:51], a[12:15], v[100:103], v[48:51]
    ds_read_b64_tr_b16 v[80:81], v21 offset:20560
    v_mfma_f32_16x16x32_bf16 v[52:55], a[92:95], v[100:103], v[52:55]
    ds_read_b64_tr_b16 v[82:83], v21 offset:21200
    v_mfma_f32_16x16x32_bf16 v[56:59], a[12:15], v[104:107], v[56:59]
    ds_read_b64_tr_b16 v[84:85], v21 offset:20600
    v_mfma_f32_16x16x32_bf16 v[60:63], a[92:95], v[104:107], v[60:63]
    ds_read_b64_tr_b16 v[86:87], v21 offset:21240
    v_mfma_f32_16x16x32_bf16 v[64:67], a[12:15], v[108:111], v[64:67]
    ds_read_b64_tr_b16 v[88:89], v22 offset:20512
    v_mfma_f32_16x16x32_bf16 v[68:71], a[92:95], v[108:111], v[68:71]
    ds_read_b64_tr_b16 v[90:91], v22 offset:21152
    s_waitcnt lgkmcnt(0)
    v_mfma_f32_16x16x32_bf16 v[32:35], a[16:19], v[72:75], v[32:35]
    v_mfma_f32_16x16x32_bf16 v[36:39], a[96:99], v[72:75], v[36:39]
    v_mfma_f32_16x16x32_bf16 v[40:43], a[16:19], v[76:79], v[40:43]
    v_mfma_f32_16x16x32_bf16 v[44:47], a[96:99], v[76:79], v[44:47]
    v_mfma_f32_16x16x32_bf16 v[48:51], a[16:19], v[80:83], v[48:51]
    v_mfma_f32_16x16x32_bf16 v[52:55], a[96:99], v[80:83], v[52:55]
    v_mfma_f32_16x16x32_bf16 v[56:59], a[16:19], v[84:87], v[56:59]
    v_mfma_f32_16x16x32_bf16 v[60:63], a[96:99], v[84:87], v[60:63]
    v_mfma_f32_16x16x32_bf16 v[64:67], a[16:19], v[88:91], v[64:67]
    v_mfma_f32_16x16x32_bf16 v[68:71], a[96:99], v[88:91], v[68:71]
    s_waitcnt vmcnt(14)
    s_barrier
    s_add_u32 s28, s33, 0
    s_mul_i32 s24, s9, 7168
    s_add_u32 m0, s24, 0
    s_nop 0
    buffer_load_dwordx4 v0, s[20:23], s28 offen lds
    s_add_u32 m0, s24, 1024
    s_nop 0
    buffer_load_dwordx4 v1, s[20:23], s28 offen lds
    s_add_u32 m0, s24, 2048
    s_nop 0
    buffer_load_dwordx4 v2, s[20:23], s28 offen lds
    s_add_u32 m0, s24, 3072
    s_nop 0
    buffer_load_dwordx4 v3, s[20:23], s28 offen lds
    s_add_u32 m0, s24, 4096
    s_nop 0
    buffer_load_dwordx4 v4, s[20:23], s28 offen lds
    s_add_u32 m0, s24, 5120
    s_nop 0
    buffer_load_dwordx4 v5, s[20:23], s28 offen lds
    s_add_u32 m0, s24, 6144
    s_nop 0
    buffer_load_dwordx4 v6, s[20:23], s28 offen lds
    v_add_u32 v21, 28672, v17
    v_add_u32 v22, 28672, v16
    ds_read_b64_tr_b16 v[72:73], v21 offset:0
    ds_read_b64_tr_b16 v[74:75], v21 offset:640
    ds_read_b64_tr_b16 v[76:77], v21 offset:40
    ds_read_b64_tr_b16 v[78:79], v21 offset:680
    ds_read_b64_tr_b16 v[80:81], v21 offset:80
    ds_read_b64_tr_b16 v[82:83], v21 offset:720
    ds_read_b64_tr_b16 v[84:85], v21 offset:120
    ds_read_b64_tr_b16 v[86:87], v21 offset:760
    ds_read_b64_tr_b16 v[88:89], v22 offset:32
    ds_read_b64_tr_b16 v[90:91], v22 offset:672
    s_waitcnt lgkmcnt(0)
    v_mfma_f32_16x16x32_bf16 v[32:35], a[20:23], v[72:75], v[32:35]
    ds_read_b64_tr_b16 v[92:93], v21 offset:5120
    v_mfma_f32_16x16x32_bf16 v[36:39], a[100:103], v[72:75], v[36:39]
    ds_read_b64_tr_b16 v[94:95], v21 offset:5760
    v_mfma_f32_16x16x32_bf16 v[40:43], a[20:23], v[76:79], v[40:43]
    ds_read_b64_tr_b16 v[96:97], v21 offset:5160
    v_mfma_f32_16x16x32_bf16 v[44:47], a[100:103], v[76:79], v[44:47]
    ds_read_b64_tr_b16 v[98:99], v21 offset:5800
    v_mfma_f32_16x16x32_bf16 v[48:51], a[20:23], v[80:83], v[48:51]
    ds_read_b64_tr_b16 v[100:101], v21 offset:5200
    v_mfma_f32_16x16x32_bf16 v[52:55], a[100:103], v[80:83], v[52:55]
    ds_read_b64_tr_b16 v[102:103], v21 offset:5840
    v_mfma_f32_16x16x32_bf16 v[56:59], a[20:23], v[84:87], v[56:59]
    ds_read_b64_tr_b16 v[104:105], v21 offset:5240
    v_mfma_f32_16x16x32_bf16 v[60:63], a[100:103], v[84:87], v[60:63]
    ds_read_b64_tr_b16 v[106:107], v21 offset:5880
    v_mfma_f32_16x16x32_bf16 v[64:67], a[20:23], v[88:91], v[64:67]
    ds_read_b64_tr_b16 v[108:109], v22 offset:5152
    v_mfma_f32_16x16x32_bf16 v[68:71], a[100:103], v[88:91], v[68:71]
    ds_read_b64_tr_b16 v[110:111], v22 offset:5792
    s_waitcnt lgkmcnt(0)
    v_mfma_f32_16x16x32_bf16 v[32:35], a[24:27], v[92:95], v[32:35]
    ds_read_b64_tr_b16 v[72:73], v21 offset:10240
    v_mfma_f32_16x16x32_bf16 v[36:39], a[104:107], v[92:95], v[36:39]
    ds_read_b64_tr_b16 v[74:75], v21 offset:10880
    v_mfma_f32_16x16x32_bf16 v[40:43], a[24:27], v[96:99], v[40:43]
    ds_read_b64_tr_b16 v[76:77], v21 offset:10280
    v_mfma_f32_16x16x32_bf16 v[44:47], a[104:107], v[96:99], v[44:47]
    ds_read_b64_tr_b16 v[78:79], v21 offset:10920
    v_mfma_f32_16x16x32_bf16 v[48:51], a[24:27], v[100:103], v[48:51]
    ds_read_b64_tr_b16 v[80:81], v21 offset:10320
    v_mfma_f32_16x16x32_bf16 v[52:55], a[104:107], v[100:103], v[52:55]
    ds_read_b64_tr_b16 v[82:83], v21 offset:10960
    v_mfma_f32_16x16x32_bf16 v[56:59], a[24:27], v[104:107], v[56:59]
    ds_read_b64_tr_b16 v[84:85], v21 offset:10360
    v_mfma_f32_16x16x32_bf16 v[60:63], a[104:107], v[104:107], v[60:63]
    ds_read_b64_tr_b16 v[86:87], v21 offset:11000
    v_mfma_f32_16x16x32_bf16 v[64:67], a[24:27], v[108:111], v[64:67]
    ds_read_b64_tr_b16 v[88:89], v22 offset:10272
    v_mfma_f32_16x16x32_bf16 v[68:71], a[104:107], v[108:111], v[68:71]
    ds_read_b64_tr_b16 v[90:91], v22 offset:10912
    s_waitcnt lgkmcnt(0)
    v_mfma_f32_16x16x32_bf16 v[32:35], a[28:31], v[72:75], v[32:35]
    ds_read_b64_tr_b16 v[92:93], v21 offset:15360
    v_mfma_f32_16x16x32_bf16 v[36:39], a[108:111], v[72:75], v[36:39]
    ds_read_b64_tr_b16 v[94:95], v21 offset:16000
    v_mfma_f32_16x16x32_bf16 v[40:43], a[28:31], v[76:79], v[40:43]
    ds_read_b64_tr_b16 v[96:97], v21 offset:15400
    v_mfma_f32_16x16x32_bf16 v[44:47], a[108:111], v[76:79], v[44:47]
    ds_read_b64_tr_b16 v[98:99], v21 offset:16040
    v_mfma_f32_16x16x32_bf16 v[48:51], a[28:31], v[80:83], v[48:51]
    ds_read_b64_tr_b16 v[100:101], v21 offset:15440
    v_mfma_f32_16x16x32_bf16 v[52:55], a[108:111], v[80:83], v[52:55]
    ds_read_b64_tr_b16 v[102:103], v21 offset:16080
    v_mfma_f32_16x16x32_bf16 v[56:59], a[28:31], v[84:87], v[56:59]
    ds_read_b64_tr_b16 v[104:105], v21 offset:15480
    v_mfma_f32_16x16x32_bf16 v[60:63], a[108:111], v[84:87], v[60:63]
    ds_read_b64_tr_b16 v[106:107], v21 offset:16120
    v_mfma_f32_16x16x32_bf16 v[64:67], a[28:31], v[88:91], v[64:67]
    ds_read_b64_tr_b16 v[108:109], v22 offset:15392
    v_mfma_f32_16x16x32_bf16 v[68:71], a[108:111], v[88:91], v[68:71]
    ds_read_b64_tr_b16 v[110:111], v22 offset:16032
    s_waitcnt lgkmcnt(0)
    v_mfma_f32_16x16x32_bf16 v[32:35], a[32:35], v[92:95], v[32:35]
    ds_read_b64_tr_b16 v[72:73], v21 offset:20480
    v_mfma_f32_16x16x32_bf16 v[36:39], a[112:115], v[92:95], v[36:39]
    ds_read_b64_tr_b16 v[74:75], v21 offset:21120
    v_mfma_f32_16x16x32_bf16 v[40:43], a[32:35], v[96:99], v[40:43]
    ds_read_b64_tr_b16 v[76:77], v21 offset:20520
    v_mfma_f32_16x16x32_bf16 v[44:47], a[112:115], v[96:99], v[44:47]
    ds_read_b64_tr_b16 v[78:79], v21 offset:21160
    v_mfma_f32_16x16x32_bf16 v[48:51], a[32:35], v[100:103], v[48:51]
    ds_read_b64_tr_b16 v[80:81], v21 offset:20560
    v_mfma_f32_16x16x32_bf16 v[52:55], a[112:115], v[100:103], v[52:55]
    ds_read_b64_tr_b16 v[82:83], v21 offset:21200
    v_mfma_f32_16x16x32_bf16 v[56:59], a[32:35], v[104:107], v[56:59]
    ds_read_b64_tr_b16 v[84:85], v21 offset:20600
    v_mfma_f32_16x16x32_bf16 v[60:63], a[112:115], v[104:107], v[60:63]
    ds_read_b64_tr_b16 v[86:87], v21 offset:21240
    v_mfma_f32_16x16x32_bf16 v[64:67], a[32:35], v[108:111], v[64:67]
    ds_read_b64_tr_b16 v[88:89], v22 offset:20512
    v_mfma_f32_16x16x32_bf16 v[68:71], a[112:115], v[108:111], v[68:71]
    ds_read_b64_tr_b16 v[90:91], v22 offset:21152
    s_waitcnt lgkmcnt(0)
    v_mfma_f32_16x16x32_bf16 v[32:35], a[36:39], v[72:75], v[32:35]
    v_mfma_f32_16x16x32_bf16 v[36:39], a[116:119], v[72:75], v[36:39]
    v_mfma_f32_16x16x32_bf16 v[40:43], a[36:39], v[76:79], v[40:43]
    v_mfma_f32_16x16x32_bf16 v[44:47], a[116:119], v[76:79], v[44:47]
    v_mfma_f32_16x16x32_bf16 v[48:51], a[36:39], v[80:83], v[48:51]
    v_mfma_f32_16x16x32_bf16 v[52:55], a[116:119], v[80:83], v[52:55]
    v_mfma_f32_16x16x32_bf16 v[56:59], a[36:39], v[84:87], v[56:59]
    v_mfma_f32_16x16x32_bf16 v[60:63], a[116:119], v[84:87], v[60:63]
    v_mfma_f32_16x16x32_bf16 v[64:67], a[36:39], v[88:91], v[64:67]
    v_mfma_f32_16x16x32_bf16 v[68:71], a[116:119], v[88:91], v[68:71]
    s_waitcnt vmcnt(14)
    s_barrier
    s_add_u32 s28, s33, 614400
    s_mul_i32 s24, s9, 7168
    s_add_u32 m0, s24, 28672
    s_nop 0
    buffer_load_dwordx4 v0, s[20:23], s28 offen lds
    s_add_u32 m0, s24, 29696
    s_nop 0
    buffer_load_dwordx4 v1, s[20:23], s28 offen lds
    s_add_u32 m0, s24, 30720
    s_nop 0
    buffer_load_dwordx4 v2, s[20:23], s28 offen lds
    s_add_u32 m0, s24, 31744
    s_nop 0
    buffer_load_dwordx4 v3, s[20:23], s28 offen lds
    s_add_u32 m0, s24, 32768
    s_nop 0
    buffer_load_dwordx4 v4, s[20:23], s28 offen lds
    s_add_u32 m0, s24, 33792
    s_nop 0
    buffer_load_dwordx4 v5, s[20:23], s28 offen lds
    s_add_u32 m0, s24, 34816
    s_nop 0
    buffer_load_dwordx4 v6, s[20:23], s28 offen lds
    v_add_u32 v21, 57344, v17
    v_add_u32 v22, 57344, v16
    ds_read_b64_tr_b16 v[72:73], v21 offset:0
    ds_read_b64_tr_b16 v[74:75], v21 offset:640
    ds_read_b64_tr_b16 v[76:77], v21 offset:40
    ds_read_b64_tr_b16 v[78:79], v21 offset:680
    ds_read_b64_tr_b16 v[80:81], v21 offset:80
    ds_read_b64_tr_b16 v[82:83], v21 offset:720
    ds_read_b64_tr_b16 v[84:85], v21 offset:120
    ds_read_b64_tr_b16 v[86:87], v21 offset:760
    ds_read_b64_tr_b16 v[88:89], v22 offset:32
    ds_read_b64_tr_b16 v[90:91], v22 offset:672
    s_waitcnt lgkmcnt(0)
    v_mfma_f32_16x16x32_bf16 v[32:35], a[40:43], v[72:75], v[32:35]
    ds_read_b64_tr_b16 v[92:93], v21 offset:5120
    v_mfma_f32_16x16x32_bf16 v[36:39], a[120:123], v[72:75], v[36:39]
    ds_read_b64_tr_b16 v[94:95], v21 offset:5760
    v_mfma_f32_16x16x32_bf16 v[40:43], a[40:43], v[76:79], v[40:43]
    ds_read_b64_tr_b16 v[96:97], v21 offset:5160
    v_mfma_f32_16x16x32_bf16 v[44:47], a[120:123], v[76:79], v[44:47]
    ds_read_b64_tr_b16 v[98:99], v21 offset:5800
    v_mfma_f32_16x16x32_bf16 v[48:51], a[40:43], v[80:83], v[48:51]
    ds_read_b64_tr_b16 v[100:101], v21 offset:5200
    v_mfma_f32_16x16x32_bf16 v[52:55], a[120:123], v[80:83], v[52:55]
    ds_read_b64_tr_b16 v[102:103], v21 offset:5840
    v_mfma_f32_16x16x32_bf16 v[56:59], a[40:43], v[84:87], v[56:59]
    ds_read_b64_tr_b16 v[104:105], v21 offset:5240
    v_mfma_f32_16x16x32_bf16 v[60:63], a[120:123], v[84:87], v[60:63]
    ds_read_b64_tr_b16 v[106:107], v21 offset:5880
    v_mfma_f32_16x16x32_bf16 v[64:67], a[40:43], v[88:91], v[64:67]
    ds_read_b64_tr_b16 v[108:109], v22 offset:5152
    v_mfma_f32_16x16x32_bf16 v[68:71], a[120:123], v[88:91], v[68:71]
    ds_read_b64_tr_b16 v[110:111], v22 offset:5792
    s_waitcnt lgkmcnt(0)
    v_mfma_f32_16x16x32_bf16 v[32:35], a[44:47], v[92:95], v[32:35]
    ds_read_b64_tr_b16 v[72:73], v21 offset:10240
    v_mfma_f32_16x16x32_bf16 v[36:39], a[124:127], v[92:95], v[36:39]
    ds_read_b64_tr_b16 v[74:75], v21 offset:10880
    v_mfma_f32_16x16x32_bf16 v[40:43], a[44:47], v[96:99], v[40:43]
    ds_read_b64_tr_b16 v[76:77], v21 offset:10280
    v_mfma_f32_16x16x32_bf16 v[44:47], a[124:127], v[96:99], v[44:47]
    ds_read_b64_tr_b16 v[78:79], v21 offset:10920
    v_mfma_f32_16x16x32_bf16 v[48:51], a[44:47], v[100:103], v[48:51]
    ds_read_b64_tr_b16 v[80:81], v21 offset:10320
    v_mfma_f32_16x16x32_bf16 v[52:55], a[124:127], v[100:103], v[52:55]
    ds_read_b64_tr_b16 v[82:83], v21 offset:10960
    v_mfma_f32_16x16x32_bf16 v[56:59], a[44:47], v[104:107], v[56:59]
    ds_read_b64_tr_b16 v[84:85], v21 offset:10360
    v_mfma_f32_16x16x32_bf16 v[60:63], a[124:127], v[104:107], v[60:63]
    ds_read_b64_tr_b16 v[86:87], v21 offset:11000
    v_mfma_f32_16x16x32_bf16 v[64:67], a[44:47], v[108:111], v[64:67]
    ds_read_b64_tr_b16 v[88:89], v22 offset:10272
    v_mfma_f32_16x16x32_bf16 v[68:71], a[124:127], v[108:111], v[68:71]
    ds_read_b64_tr_b16 v[90:91], v22 offset:10912
    s_waitcnt lgkmcnt(0)
    v_mfma_f32_16x16x32_bf16 v[32:35], a[48:51], v[72:75], v[32:35]
    ds_read_b64_tr_b16 v[92:93], v21 offset:15360
    v_mfma_f32_16x16x32_bf16 v[36:39], a[128:131], v[72:75], v[36:39]
    ds_read_b64_tr_b16 v[94:95], v21 offset:16000
    v_mfma_f32_16x16x32_bf16 v[40:43], a[48:51], v[76:79], v[40:43]
    ds_read_b64_tr_b16 v[96:97], v21 offset:15400
    v_mfma_f32_16x16x32_bf16 v[44:47], a[128:131], v[76:79], v[44:47]
    ds_read_b64_tr_b16 v[98:99], v21 offset:16040
    v_mfma_f32_16x16x32_bf16 v[48:51], a[48:51], v[80:83], v[48:51]
    ds_read_b64_tr_b16 v[100:101], v21 offset:15440
    v_mfma_f32_16x16x32_bf16 v[52:55], a[128:131], v[80:83], v[52:55]
    ds_read_b64_tr_b16 v[102:103], v21 offset:16080
    v_mfma_f32_16x16x32_bf16 v[56:59], a[48:51], v[84:87], v[56:59]
    ds_read_b64_tr_b16 v[104:105], v21 offset:15480
    v_mfma_f32_16x16x32_bf16 v[60:63], a[128:131], v[84:87], v[60:63]
    ds_read_b64_tr_b16 v[106:107], v21 offset:16120
    v_mfma_f32_16x16x32_bf16 v[64:67], a[48:51], v[88:91], v[64:67]
    ds_read_b64_tr_b16 v[108:109], v22 offset:15392
    v_mfma_f32_16x16x32_bf16 v[68:71], a[128:131], v[88:91], v[68:71]
    ds_read_b64_tr_b16 v[110:111], v22 offset:16032
    s_waitcnt lgkmcnt(0)
    v_mfma_f32_16x16x32_bf16 v[32:35], a[52:55], v[92:95], v[32:35]
    ds_read_b64_tr_b16 v[72:73], v21 offset:20480
    v_mfma_f32_16x16x32_bf16 v[36:39], a[132:135], v[92:95], v[36:39]
    ds_read_b64_tr_b16 v[74:75], v21 offset:21120
    v_mfma_f32_16x16x32_bf16 v[40:43], a[52:55], v[96:99], v[40:43]
    ds_read_b64_tr_b16 v[76:77], v21 offset:20520
    v_mfma_f32_16x16x32_bf16 v[44:47], a[132:135], v[96:99], v[44:47]
    ds_read_b64_tr_b16 v[78:79], v21 offset:21160
    v_mfma_f32_16x16x32_bf16 v[48:51], a[52:55], v[100:103], v[48:51]
    ds_read_b64_tr_b16 v[80:81], v21 offset:20560
    v_mfma_f32_16x16x32_bf16 v[52:55], a[132:135], v[100:103], v[52:55]
    ds_read_b64_tr_b16 v[82:83], v21 offset:21200
    v_mfma_f32_16x16x32_bf16 v[56:59], a[52:55], v[104:107], v[56:59]
    ds_read_b64_tr_b16 v[84:85], v21 offset:20600
    v_mfma_f32_16x16x32_bf16 v[60:63], a[132:135], v[104:107], v[60:63]
    ds_read_b64_tr_b16 v[86:87], v21 offset:21240
    v_mfma_f32_16x16x32_bf16 v[64:67], a[52:55], v[108:111], v[64:67]
    ds_read_b64_tr_b16 v[88:89], v22 offset:20512
    v_mfma_f32_16x16x32_bf16 v[68:71], a[132:135], v[108:111], v[68:71]
    ds_read_b64_tr_b16 v[90:91], v22 offset:21152
    s_waitcnt lgkmcnt(0)
    v_mfma_f32_16x16x32_bf16 v[32:35], a[56:59], v[72:75], v[32:35]
    v_mfma_f32_16x16x32_bf16 v[36:39], a[136:139], v[72:75], v[36:39]
    v_mfma_f32_16x16x32_bf16 v[40:43], a[56:59], v[76:79], v[40:43]
    v_mfma_f32_16x16x32_bf16 v[44:47], a[136:139], v[76:79], v[44:47]
    v_mfma_f32_16x16x32_bf16 v[48:51], a[56:59], v[80:83], v[48:51]
    v_mfma_f32_16x16x32_bf16 v[52:55], a[136:139], v[80:83], v[52:55]
    v_mfma_f32_16x16x32_bf16 v[56:59], a[56:59], v[84:87], v[56:59]
    v_mfma_f32_16x16x32_bf16 v[60:63], a[136:139], v[84:87], v[60:63]
    v_mfma_f32_16x16x32_bf16 v[64:67], a[56:59], v[88:91], v[64:67]
    v_mfma_f32_16x16x32_bf16 v[68:71], a[136:139], v[88:91], v[68:71]
    s_waitcnt vmcnt(14)
    s_barrier
    s_add_u32 s28, s33, 1228800
    s_mul_i32 s24, s9, 7168
    s_add_u32 m0, s24, 57344
    s_nop 0
    buffer_load_dwordx4 v0, s[20:23], s28 offen lds
    s_add_u32 m0, s24, 58368
    s_nop 0
    buffer_load_dwordx4 v1, s[20:23], s28 offen lds
    s_add_u32 m0, s24, 59392
    s_nop 0
    buffer_load_dwordx4 v2, s[20:23], s28 offen lds
    s_add_u32 m0, s24, 60416
    s_nop 0
    buffer_load_dwordx4 v3, s[20:23], s28 offen lds
    s_add_u32 m0, s24, 61440
    s_nop 0
    buffer_load_dwordx4 v4, s[20:23], s28 offen lds
    s_add_u32 m0, s24, 62464
    s_nop 0
    buffer_load_dwordx4 v5, s[20:23], s28 offen lds
    s_add_u32 m0, s24, 63488
    s_nop 0
    buffer_load_dwordx4 v6, s[20:23], s28 offen lds
    v_add_u32 v21, 86016, v17
    v_add_u32 v22, 86016, v16
    ds_read_b64_tr_b16 v[72:73], v21 offset:0
    ds_read_b64_tr_b16 v[74:75], v21 offset:640
    ds_read_b64_tr_b16 v[76:77], v21 offset:40
    ds_read_b64_tr_b16 v[78:79], v21 offset:680
    ds_read_b64_tr_b16 v[80:81], v21 offset:80
    ds_read_b64_tr_b16 v[82:83], v21 offset:720
    ds_read_b64_tr_b16 v[84:85], v21 offset:120
    ds_read_b64_tr_b16 v[86:87], v21 offset:760
    ds_read_b64_tr_b16 v[88:89], v22 offset:32
    ds_read_b64_tr_b16 v[90:91], v22 offset:672
    s_waitcnt lgkmcnt(0)
    v_mfma_f32_16x16x32_bf16 v[32:35], a[60:63], v[72:75], v[32:35]
    ds_read_b64_tr_b16 v[92:93], v21 offset:5120
    v_mfma_f32_16x16x32_bf16 v[36:39], a[140:143], v[72:75], v[36:39]
    ds_read_b64_tr_b16 v[94:95], v21 offset:5760
    v_mfma_f32_16x16x32_bf16 v[40:43], a[60:63], v[76:79], v[40:43]
    ds_read_b64_tr_b16 v[96:97], v21 offset:5160
    v_mfma_f32_16x16x32_bf16 v[44:47], a[140:143], v[76:79], v[44:47]
    ds_read_b64_tr_b16 v[98:99], v21 offset:5800
    v_mfma_f32_16x16x32_bf16 v[48:51], a[60:63], v[80:83], v[48:51]
    ds_read_b64_tr_b16 v[100:101], v21 offset:5200
    v_mfma_f32_16x16x32_bf16 v[52:55], a[140:143], v[80:83], v[52:55]
    ds_read_b64_tr_b16 v[102:103], v21 offset:5840
    v_mfma_f32_16x16x32_bf16 v[56:59], a[60:63], v[84:87], v[56:59]
    ds_read_b64_tr_b16 v[104:105], v21 offset:5240
    v_mfma_f32_16x16x32_bf16 v[60:63], a[140:143], v[84:87], v[60:63]
    ds_read_b64_tr_b16 v[106:107], v21 offset:5880
    v_mfma_f32_16x16x32_bf16 v[64:67], a[60:63], v[88:91], v[64:67]
    ds_read_b64_tr_b16 v[108:109], v22 offset:5152
    v_mfma_f32_16x16x32_bf16 v[68:71], a[140:143], v[88:91], v[68:71]
    ds_read_b64_tr_b16 v[110:111], v22 offset:5792
    s_waitcnt lgkmcnt(0)
    v_mfma_f32_16x16x32_bf16 v[32:35], a[64:67], v[92:95], v[32:35]
    ds_read_b64_tr_b16 v[72:73], v21 offset:10240
    v_mfma_f32_16x16x32_bf16 v[36:39], a[144:147], v[92:95], v[36:39]
    ds_read_b64_tr_b16 v[74:75], v21 offset:10880
    v_mfma_f32_16x16x32_bf16 v[40:43], a[64:67], v[96:99], v[40:43]
    ds_read_b64_tr_b16 v[76:77], v21 offset:10280
    v_mfma_f32_16x16x32_bf16 v[44:47], a[144:147], v[96:99], v[44:47]
    ds_read_b64_tr_b16 v[78:79], v21 offset:10920
    v_mfma_f32_16x16x32_bf16 v[48:51], a[64:67], v[100:103], v[48:51]
    ds_read_b64_tr_b16 v[80:81], v21 offset:10320
    v_mfma_f32_16x16x32_bf16 v[52:55], a[144:147], v[100:103], v[52:55]
    ds_read_b64_tr_b16 v[82:83], v21 offset:10960
    v_mfma_f32_16x16x32_bf16 v[56:59], a[64:67], v[104:107], v[56:59]
    ds_read_b64_tr_b16 v[84:85], v21 offset:10360
    v_mfma_f32_16x16x32_bf16 v[60:63], a[144:147], v[104:107], v[60:63]
    ds_read_b64_tr_b16 v[86:87], v21 offset:11000
    v_mfma_f32_16x16x32_bf16 v[64:67], a[64:67], v[108:111], v[64:67]
    ds_read_b64_tr_b16 v[88:89], v22 offset:10272
    v_mfma_f32_16x16x32_bf16 v[68:71], a[144:147], v[108:111], v[68:71]
    ds_read_b64_tr_b16 v[90:91], v22 offset:10912
    s_waitcnt lgkmcnt(0)
    v_mfma_f32_16x16x32_bf16 v[32:35], a[68:71], v[72:75], v[32:35]
    ds_read_b64_tr_b16 v[92:93], v21 offset:15360
    v_mfma_f32_16x16x32_bf16 v[36:39], a[148:151], v[72:75], v[36:39]
    ds_read_b64_tr_b16 v[94:95], v21 offset:16000
    v_mfma_f32_16x16x32_bf16 v[40:43], a[68:71], v[76:79], v[40:43]
    ds_read_b64_tr_b16 v[96:97], v21 offset:15400
    v_mfma_f32_16x16x32_bf16 v[44:47], a[148:151], v[76:79], v[44:47]
    ds_read_b64_tr_b16 v[98:99], v21 offset:16040
    v_mfma_f32_16x16x32_bf16 v[48:51], a[68:71], v[80:83], v[48:51]
    ds_read_b64_tr_b16 v[100:101], v21 offset:15440
    v_mfma_f32_16x16x32_bf16 v[52:55], a[148:151], v[80:83], v[52:55]
    ds_read_b64_tr_b16 v[102:103], v21 offset:16080
    v_mfma_f32_16x16x32_bf16 v[56:59], a[68:71], v[84:87], v[56:59]
    ds_read_b64_tr_b16 v[104:105], v21 offset:15480
    v_mfma_f32_16x16x32_bf16 v[60:63], a[148:151], v[84:87], v[60:63]
    ds_read_b64_tr_b16 v[106:107], v21 offset:16120
    v_mfma_f32_16x16x32_bf16 v[64:67], a[68:71], v[88:91], v[64:67]
    ds_read_b64_tr_b16 v[108:109], v22 offset:15392
    v_mfma_f32_16x16x32_bf16 v[68:71], a[148:151], v[88:91], v[68:71]
    ds_read_b64_tr_b16 v[110:111], v22 offset:16032
    s_waitcnt lgkmcnt(0)
    v_mfma_f32_16x16x32_bf16 v[32:35], a[72:75], v[92:95], v[32:35]
    ds_read_b64_tr_b16 v[72:73], v21 offset:20480
    v_mfma_f32_16x16x32_bf16 v[36:39], a[152:155], v[92:95], v[36:39]
    ds_read_b64_tr_b16 v[74:75], v21 offset:21120
    v_mfma_f32_16x16x32_bf16 v[40:43], a[72:75], v[96:99], v[40:43]
    ds_read_b64_tr_b16 v[76:77], v21 offset:20520
    v_mfma_f32_16x16x32_bf16 v[44:47], a[152:155], v[96:99], v[44:47]
    ds_read_b64_tr_b16 v[78:79], v21 offset:21160
    v_mfma_f32_16x16x32_bf16 v[48:51], a[72:75], v[100:103], v[48:51]
    ds_read_b64_tr_b16 v[80:81], v21 offset:20560
    v_mfma_f32_16x16x32_bf16 v[52:55], a[152:155], v[100:103], v[52:55]
    ds_read_b64_tr_b16 v[82:83], v21 offset:21200
    v_mfma_f32_16x16x32_bf16 v[56:59], a[72:75], v[104:107], v[56:59]
    ds_read_b64_tr_b16 v[84:85], v21 offset:20600
    v_mfma_f32_16x16x32_bf16 v[60:63], a[152:155], v[104:107], v[60:63]
    ds_read_b64_tr_b16 v[86:87], v21 offset:21240
    v_mfma_f32_16x16x32_bf16 v[64:67], a[72:75], v[108:111], v[64:67]
    ds_read_b64_tr_b16 v[88:89], v22 offset:20512
    v_mfma_f32_16x16x32_bf16 v[68:71], a[152:155], v[108:111], v[68:71]
    ds_read_b64_tr_b16 v[90:91], v22 offset:21152
    s_waitcnt lgkmcnt(0)
    v_mfma_f32_16x16x32_bf16 v[32:35], a[76:79], v[72:75], v[32:35]
    v_mfma_f32_16x16x32_bf16 v[36:39], a[156:159], v[72:75], v[36:39]
    v_mfma_f32_16x16x32_bf16 v[40:43], a[76:79], v[76:79], v[40:43]
    v_mfma_f32_16x16x32_bf16 v[44:47], a[156:159], v[76:79], v[44:47]
    v_mfma_f32_16x16x32_bf16 v[48:51], a[76:79], v[80:83], v[48:51]
    v_mfma_f32_16x16x32_bf16 v[52:55], a[156:159], v[80:83], v[52:55]
    v_mfma_f32_16x16x32_bf16 v[56:59], a[76:79], v[84:87], v[56:59]
    v_mfma_f32_16x16x32_bf16 v[60:63], a[156:159], v[84:87], v[60:63]
    v_mfma_f32_16x16x32_bf16 v[64:67], a[76:79], v[88:91], v[64:67]
    v_mfma_f32_16x16x32_bf16 v[68:71], a[156:159], v[88:91], v[68:71]
    s_nop 7
    v_mov_b32 v8, 0
    v_mov_b32 v9, 0
    v_mov_b32 v10, 0
    v_mov_b32 v11, 0
    s_mul_i32 s24, s9, 6144
    s_add_u32 s24, s24, 114688
    v_add_u32 v23, s24, v26
    ds_write_b128 v23, v[8:11] offset:0
    ds_write_b128 v23, v[8:11] offset:1024
    ds_write_b128 v23, v[8:11] offset:2048
    ds_write_b128 v23, v[8:11] offset:3072
    ds_write_b128 v23, v[8:11] offset:4096
    ds_write_b128 v23, v[8:11] offset:5120
    v_cvt_pk_bf16_f32 v234, v32, v33
    v_cvt_pk_bf16_f32 v235, v34, v35
    v_cvt_pk_bf16_f32 v236, v36, v37
    v_cvt_pk_bf16_f32 v237, v38, v39
    v_cvt_pk_bf16_f32 v238, v40, v41
    v_cvt_pk_bf16_f32 v239, v42, v43
    v_cvt_pk_bf16_f32 v240, v44, v45
    v_cvt_pk_bf16_f32 v241, v46, v47
    v_cvt_pk_bf16_f32 v242, v48, v49
    v_cvt_pk_bf16_f32 v243, v50, v51
    v_cvt_pk_bf16_f32 v244, v52, v53
    v_cvt_pk_bf16_f32 v245, v54, v55
    v_cvt_pk_bf16_f32 v246, v56, v57
    v_cvt_pk_bf16_f32 v247, v58, v59
    v_cvt_pk_bf16_f32 v248, v60, v61
    v_cvt_pk_bf16_f32 v249, v62, v63
    v_cvt_pk_bf16_f32 v250, v64, v65
    v_cvt_pk_bf16_f32 v251, v66, v67
    v_cvt_pk_bf16_f32 v252, v68, v69
    v_cvt_pk_bf16_f32 v253, v70, v71
    v_add_u32 v24, 114688, v26
    v_mov_b32 v12, 0x3f803f80
    s_waitcnt lgkmcnt(0)
    s_barrier
    s_mov_b32 s36, 0
kvt_18:
    s_add_u32 s37, s9, s36
    s_and_b32 s37, s37, 3
    s_mul_i32 s24, s37, 6144
    v_add_u32 v23, s24, v24
    ds_read_b128 v[112:115], v23 offset:0
    ds_read_b128 v[116:119], v23 offset:1024
    ds_read_b128 v[120:123], v23 offset:2048
    ds_read_b128 v[124:127], v23 offset:3072
    ds_read_b128 v[128:131], v23 offset:4096
    ds_read_b128 v[132:135], v23 offset:5120
    s_cmp_eq_u32 s37, 1
    s_cbranch_scc1 kvh_20
    s_cmp_eq_u32 s37, 2
    s_cbranch_scc1 kvh_21
    s_cmp_eq_u32 s37, 3
    s_cbranch_scc1 kvh_22
kvh_19:
    v_mfma_f32_16x16x32_bf16 v[72:75], v[162:165], v[202:205], 0
    v_mfma_f32_16x16x32_bf16 v[76:79], v[182:185], v[202:205], 0
    v_mfma_f32_16x16x32_bf16 v[72:75], v[166:169], v[206:209], v[72:75]
    v_mfma_f32_16x16x32_bf16 v[76:79], v[186:189], v[206:209], v[76:79]
    v_mfma_f32_16x16x32_bf16 v[80:83], v[170:173], v[202:205], 0
    v_mfma_f32_16x16x32_bf16 v[84:87], v[190:193], v[202:205], 0
    v_mfma_f32_16x16x32_bf16 v[80:83], v[174:177], v[206:209], v[80:83]
    v_mfma_f32_16x16x32_bf16 v[84:87], v[194:197], v[206:209], v[84:87]
    v_mfma_f32_16x16x32_bf16 v[88:91], v[178:181], v[202:205], 0
    v_mfma_f32_16x16x32_bf16 v[92:95], v[198:201], v[202:205], 0
    v_cmp_eq_u32 vcc, 4, v30
    v_mov_b32 v136, v234
    v_mov_b32 v137, v235
    v_mov_b32 v138, v236
    v_mov_b32 v139, v237
    s_branch kvj_17
kvh_20:
    v_mfma_f32_16x16x32_bf16 v[72:75], v[162:165], v[210:213], 0
    v_mfma_f32_16x16x32_bf16 v[76:79], v[182:185], v[210:213], 0
    v_mfma_f32_16x16x32_bf16 v[72:75], v[166:169], v[214:217], v[72:75]
    v_mfma_f32_16x16x32_bf16 v[76:79], v[186:189], v[214:217], v[76:79]
    v_mfma_f32_16x16x32_bf16 v[80:83], v[170:173], v[210:213], 0
    v_mfma_f32_16x16x32_bf16 v[84:87], v[190:193], v[210:213], 0
    v_mfma_f32_16x16x32_bf16 v[80:83], v[174:177], v[214:217], v[80:83]
    v_mfma_f32_16x16x32_bf16 v[84:87], v[194:197], v[214:217], v[84:87]
    v_mfma_f32_16x16x32_bf16 v[88:91], v[178:181], v[210:213], 0
    v_mfma_f32_16x16x32_bf16 v[92:95], v[198:201], v[210:213], 0
    v_cmp_eq_u32 vcc, 8, v30
    v_mov_b32 v136, v238
    v_mov_b32 v137, v239
    v_mov_b32 v138, v240
    v_mov_b32 v139, v241
    s_branch kvj_17
kvh_21:
    v_mfma_f32_16x16x32_bf16 v[72:75], v[162:165], v[218:221], 0
    v_mfma_f32_16x16x32_bf16 v[76:79], v[182:185], v[218:221], 0
    v_mfma_f32_16x16x32_bf16 v[72:75], v[166:169], v[222:225], v[72:75]
    v_mfma_f32_16x16x32_bf16 v[76:79], v[186:189], v[222:225], v[76:79]
    v_mfma_f32_16x16x32_bf16 v[80:83], v[170:173], v[218:221], 0
    v_mfma_f32_16x16x32_bf16 v[84:87], v[190:193], v[218:221], 0
    v_mfma_f32_16x16x32_bf16 v[80:83], v[174:177], v[222:225], v[80:83]
    v_mfma_f32_16x16x32_bf16 v[84:87], v[194:197], v[222:225], v[84:87]
    v_mfma_f32_16x16x32_bf16 v[88:91], v[178:181], v[218:221], 0
    v_mfma_f32_16x16x32_bf16 v[92:95], v[198:201], v[218:221], 0
    v_cmp_eq_u32 vcc, 12, v30
    v_mov_b32 v136, v242
    v_mov_b32 v137, v243
    v_mov_b32 v138, v244
    v_mov_b32 v139, v245
    s_branch kvj_17
kvh_22:
    v_mfma_f32_16x16x32_bf16 v[72:75], v[162:165], v[226:229], 0
    v_mfma_f32_16x16x32_bf16 v[76:79], v[182:185], v[226:229], 0
    v_mfma_f32_16x16x32_bf16 v[72:75], v[166:169], v[230:233], v[72:75]
    v_mfma_f32_16x16x32_bf16 v[76:79], v[186:189], v[230:233], v[76:79]
    v_mfma_f32_16x16x32_bf16 v[80:83], v[170:173], v[226:229], 0
    v_mfma_f32_16x16x32_bf16 v[84:87], v[190:193], v[226:229], 0
    v_mfma_f32_16x16x32_bf16 v[80:83], v[174:177], v[230:233], v[80:83]
    v_mfma_f32_16x16x32_bf16 v[84:87], v[194:197], v[230:233], v[84:87]
    v_mfma_f32_16x16x32_bf16 v[88:91], v[178:181], v[226:229], 0
    v_mfma_f32_16x16x32_bf16 v[92:95], v[198:201], v[226:229], 0
    v_cmp_eq_u32 vcc, 0, v30
    v_mov_b32 v136, v246
    v_mov_b32 v137, v247
    v_mov_b32 v138, v248
    v_mov_b32 v139, v249
kvj_17:
    v_cndmask_b32 v108, v250, v12, vcc
    v_cndmask_b32 v109, v251, v12, vcc
    v_cndmask_b32 v110, v252, v12, vcc
    v_cndmask_b32 v111, v253, v12, vcc
    v_cvt_pk_bf16_f32 v96, v72, v73
    v_cvt_pk_bf16_f32 v97, v74, v75
    v_cvt_pk_bf16_f32 v98, v76, v77
    v_cvt_pk_bf16_f32 v99, v78, v79
    v_cvt_pk_bf16_f32 v100, v80, v81
    v_cvt_pk_bf16_f32 v101, v82, v83
    v_cvt_pk_bf16_f32 v102, v84, v85
    v_cvt_pk_bf16_f32 v103, v86, v87
    v_cvt_pk_bf16_f32 v104, v88, v89
    v_cvt_pk_bf16_f32 v105, v90, v91
    v_cvt_pk_bf16_f32 v106, v92, v93
    v_cvt_pk_bf16_f32 v107, v94, v95
    s_waitcnt lgkmcnt(0)
    s_nop 0
    v_mfma_f32_16x16x32_bf16 v[112:115], v[96:99], v[136:139], v[112:115]
    v_mfma_f32_16x16x32_bf16 v[116:119], v[96:99], v[108:111], v[116:119]
    v_mfma_f32_16x16x32_bf16 v[120:123], v[100:103], v[136:139], v[120:123]
    v_mfma_f32_16x16x32_bf16 v[124:127], v[100:103], v[108:111], v[124:127]
    v_mfma_f32_16x16x32_bf16 v[128:131], v[104:107], v[136:139], v[128:131]
    v_mfma_f32_16x16x32_bf16 v[132:135], v[104:107], v[108:111], v[132:135]
    s_nop 7
    ds_write_b128 v23, v[112:115] offset:0
    ds_write_b128 v23, v[116:119] offset:1024
    ds_write_b128 v23, v[120:123] offset:2048
    ds_write_b128 v23, v[124:127] offset:3072
    ds_write_b128 v23, v[128:131] offset:4096
    ds_write_b128 v23, v[132:135] offset:5120
    s_add_u32 s36, s36, 1
    s_cmp_lt_u32 s36, 4
    s_waitcnt lgkmcnt(0)
    s_barrier
    s_cbranch_scc1 kvt_18
    s_lshl_b32 s24, s31, 5
    s_lshl_b32 s25, s32, 3
    s_add_u32 s24, s24, s25
    s_add_u32 s24, s24, s37
    s_add_u32 s24, s24, 4
    s_mul_i32 s24, s24, 6144
    s_add_u32 s24, s24, 100663296
    s_add_u32 s25, s24, 4096
    buffer_store_dwordx4 v[112:115], v26, s[16:19], s24 offen offset:0 sc1
    buffer_store_dwordx4 v[116:119], v26, s[16:19], s24 offen offset:1024 sc1
    buffer_store_dwordx4 v[120:123], v26, s[16:19], s24 offen offset:2048 sc1
    buffer_store_dwordx4 v[124:127], v26, s[16:19], s24 offen offset:3072 sc1
    buffer_store_dwordx4 v[128:131], v26, s[16:19], s25 offen offset:0 sc1
    buffer_store_dwordx4 v[132:135], v26, s[16:19], s25 offen offset:1024 sc1
    v_mov_b32 v8, 1
    s_waitcnt vmcnt(0)
    s_mov_b64 exec, 1
    buffer_store_dword v8, v25, s[16:19], s11 offen sc1
    s_mov_b64 exec, -1
    s_barrier
    s_add_u32 s28, s33, 1843200
    s_mul_i32 s24, s9, 7168
    s_add_u32 m0, s24, 86016
    s_nop 0
    buffer_load_dwordx4 v0, s[20:23], s28 offen lds
    s_add_u32 m0, s24, 87040
    s_nop 0
    buffer_load_dwordx4 v1, s[20:23], s28 offen lds
    s_add_u32 m0, s24, 88064
    s_nop 0
    buffer_load_dwordx4 v2, s[20:23], s28 offen lds
    s_add_u32 m0, s24, 89088
    s_nop 0
    buffer_load_dwordx4 v3, s[20:23], s28 offen lds
    s_add_u32 m0, s24, 90112
    s_nop 0
    buffer_load_dwordx4 v4, s[20:23], s28 offen lds
    s_add_u32 m0, s24, 91136
    s_nop 0
    buffer_load_dwordx4 v5, s[20:23], s28 offen lds
    s_add_u32 m0, s24, 92160
    s_nop 0
    buffer_load_dwordx4 v6, s[20:23], s28 offen lds
    v_add_u32 v21, 0, v16
    ds_read_b64_tr_b16 v[72:73], v21 offset:0
    ds_read_b64_tr_b16 v[74:75], v21 offset:640
    ds_read_b64_tr_b16 v[76:77], v21 offset:8
    ds_read_b64_tr_b16 v[78:79], v21 offset:648
    ds_read_b64_tr_b16 v[80:81], v21 offset:16
    ds_read_b64_tr_b16 v[82:83], v21 offset:656
    ds_read_b64_tr_b16 v[84:85], v21 offset:24
    ds_read_b64_tr_b16 v[86:87], v21 offset:664
    ds_read_b64_tr_b16 v[88:89], v21 offset:32
    ds_read_b64_tr_b16 v[90:91], v21 offset:672
    s_waitcnt lgkmcnt(0)
    v_mfma_f32_16x16x32_bf16 v[32:35], v[72:75], a[0:3], 0
    ds_read_b64_tr_b16 v[92:93], v21 offset:5120
    v_mfma_f32_16x16x32_bf16 v[36:39], v[72:75], a[80:83], 0
    ds_read_b64_tr_b16 v[94:95], v21 offset:5760
    v_mfma_f32_16x16x32_bf16 v[40:43], v[76:79], a[0:3], 0
    ds_read_b64_tr_b16 v[96:97], v21 offset:5128
    v_mfma_f32_16x16x32_bf16 v[44:47], v[76:79], a[80:83], 0
    ds_read_b64_tr_b16 v[98:99], v21 offset:5768
    v_mfma_f32_16x16x32_bf16 v[48:51], v[80:83], a[0:3], 0
    ds_read_b64_tr_b16 v[100:101], v21 offset:5136
    v_mfma_f32_16x16x32_bf16 v[52:55], v[80:83], a[80:83], 0
    ds_read_b64_tr_b16 v[102:103], v21 offset:5776
    v_mfma_f32_16x16x32_bf16 v[56:59], v[84:87], a[0:3], 0
    ds_read_b64_tr_b16 v[104:105], v21 offset:5144
    v_mfma_f32_16x16x32_bf16 v[60:63], v[84:87], a[80:83], 0
    ds_read_b64_tr_b16 v[106:107], v21 offset:5784
    v_mfma_f32_16x16x32_bf16 v[64:67], v[88:91], a[0:3], 0
    ds_read_b64_tr_b16 v[108:109], v21 offset:5152
    v_mfma_f32_16x16x32_bf16 v[68:71], v[88:91], a[80:83], 0
    ds_read_b64_tr_b16 v[110:111], v21 offset:5792
    s_waitcnt lgkmcnt(0)
    v_mfma_f32_16x16x32_bf16 v[32:35], v[92:95], a[4:7], v[32:35]
    ds_read_b64_tr_b16 v[72:73], v21 offset:10240
    v_mfma_f32_16x16x32_bf16 v[36:39], v[92:95], a[84:87], v[36:39]
    ds_read_b64_tr_b16 v[74:75], v21 offset:10880
    v_mfma_f32_16x16x32_bf16 v[40:43], v[96:99], a[4:7], v[40:43]
    ds_read_b64_tr_b16 v[76:77], v21 offset:10248
    v_mfma_f32_16x16x32_bf16 v[44:47], v[96:99], a[84:87], v[44:47]
    ds_read_b64_tr_b16 v[78:79], v21 offset:10888
    v_mfma_f32_16x16x32_bf16 v[48:51], v[100:103], a[4:7], v[48:51]
    ds_read_b64_tr_b16 v[80:81], v21 offset:10256
    v_mfma_f32_16x16x32_bf16 v[52:55], v[100:103], a[84:87], v[52:55]
    ds_read_b64_tr_b16 v[82:83], v21 offset:10896
    v_mfma_f32_16x16x32_bf16 v[56:59], v[104:107], a[4:7], v[56:59]
    ds_read_b64_tr_b16 v[84:85], v21 offset:10264
    v_mfma_f32_16x16x32_bf16 v[60:63], v[104:107], a[84:87], v[60:63]
    ds_read_b64_tr_b16 v[86:87], v21 offset:10904
    v_mfma_f32_16x16x32_bf16 v[64:67], v[108:111], a[4:7], v[64:67]
    ds_read_b64_tr_b16 v[88:89], v21 offset:10272
    v_mfma_f32_16x16x32_bf16 v[68:71], v[108:111], a[84:87], v[68:71]
    ds_read_b64_tr_b16 v[90:91], v21 offset:10912
    s_waitcnt lgkmcnt(0)
    v_mfma_f32_16x16x32_bf16 v[32:35], v[72:75], a[8:11], v[32:35]
    ds_read_b64_tr_b16 v[92:93], v21 offset:15360
    v_mfma_f32_16x16x32_bf16 v[36:39], v[72:75], a[88:91], v[36:39]
    ds_read_b64_tr_b16 v[94:95], v21 offset:16000
    v_mfma_f32_16x16x32_bf16 v[40:43], v[76:79], a[8:11], v[40:43]
    ds_read_b64_tr_b16 v[96:97], v21 offset:15368
    v_mfma_f32_16x16x32_bf16 v[44:47], v[76:79], a[88:91], v[44:47]
    ds_read_b64_tr_b16 v[98:99], v21 offset:16008
    v_mfma_f32_16x16x32_bf16 v[48:51], v[80:83], a[8:11], v[48:51]
    ds_read_b64_tr_b16 v[100:101], v21 offset:15376
    v_mfma_f32_16x16x32_bf16 v[52:55], v[80:83], a[88:91], v[52:55]
    ds_read_b64_tr_b16 v[102:103], v21 offset:16016
    v_mfma_f32_16x16x32_bf16 v[56:59], v[84:87], a[8:11], v[56:59]
    ds_read_b64_tr_b16 v[104:105], v21 offset:15384
    v_mfma_f32_16x16x32_bf16 v[60:63], v[84:87], a[88:91], v[60:63]
    ds_read_b64_tr_b16 v[106:107], v21 offset:16024
    v_mfma_f32_16x16x32_bf16 v[64:67], v[88:91], a[8:11], v[64:67]
    ds_read_b64_tr_b16 v[108:109], v21 offset:15392
    v_mfma_f32_16x16x32_bf16 v[68:71], v[88:91], a[88:91], v[68:71]
    ds_read_b64_tr_b16 v[110:111], v21 offset:16032
    s_waitcnt lgkmcnt(0)
    v_mfma_f32_16x16x32_bf16 v[32:35], v[92:95], a[12:15], v[32:35]
    ds_read_b64_tr_b16 v[72:73], v21 offset:20480
    v_mfma_f32_16x16x32_bf16 v[36:39], v[92:95], a[92:95], v[36:39]
    ds_read_b64_tr_b16 v[74:75], v21 offset:21120
    v_mfma_f32_16x16x32_bf16 v[40:43], v[96:99], a[12:15], v[40:43]
    ds_read_b64_tr_b16 v[76:77], v21 offset:20488
    v_mfma_f32_16x16x32_bf16 v[44:47], v[96:99], a[92:95], v[44:47]
    ds_read_b64_tr_b16 v[78:79], v21 offset:21128
    v_mfma_f32_16x16x32_bf16 v[48:51], v[100:103], a[12:15], v[48:51]
    ds_read_b64_tr_b16 v[80:81], v21 offset:20496
    v_mfma_f32_16x16x32_bf16 v[52:55], v[100:103], a[92:95], v[52:55]
    ds_read_b64_tr_b16 v[82:83], v21 offset:21136
    v_mfma_f32_16x16x32_bf16 v[56:59], v[104:107], a[12:15], v[56:59]
    ds_read_b64_tr_b16 v[84:85], v21 offset:20504
    v_mfma_f32_16x16x32_bf16 v[60:63], v[104:107], a[92:95], v[60:63]
    ds_read_b64_tr_b16 v[86:87], v21 offset:21144
    v_mfma_f32_16x16x32_bf16 v[64:67], v[108:111], a[12:15], v[64:67]
    ds_read_b64_tr_b16 v[88:89], v21 offset:20512
    v_mfma_f32_16x16x32_bf16 v[68:71], v[108:111], a[92:95], v[68:71]
    ds_read_b64_tr_b16 v[90:91], v21 offset:21152
    s_waitcnt lgkmcnt(0)
    v_mfma_f32_16x16x32_bf16 v[32:35], v[72:75], a[16:19], v[32:35]
    v_mfma_f32_16x16x32_bf16 v[36:39], v[72:75], a[96:99], v[36:39]
    v_mfma_f32_16x16x32_bf16 v[40:43], v[76:79], a[16:19], v[40:43]
    v_mfma_f32_16x16x32_bf16 v[44:47], v[76:79], a[96:99], v[44:47]
    v_mfma_f32_16x16x32_bf16 v[48:51], v[80:83], a[16:19], v[48:51]
    v_mfma_f32_16x16x32_bf16 v[52:55], v[80:83], a[96:99], v[52:55]
    v_mfma_f32_16x16x32_bf16 v[56:59], v[84:87], a[16:19], v[56:59]
    v_mfma_f32_16x16x32_bf16 v[60:63], v[84:87], a[96:99], v[60:63]
    v_mfma_f32_16x16x32_bf16 v[64:67], v[88:91], a[16:19], v[64:67]
    v_mfma_f32_16x16x32_bf16 v[68:71], v[88:91], a[96:99], v[68:71]
    s_barrier
    s_add_u32 s28, s33, 160
    s_mul_i32 s24, s9, 7168
    s_add_u32 m0, s24, 0
    s_nop 0
    buffer_load_dwordx4 v0, s[20:23], s28 offen lds
    s_add_u32 m0, s24, 1024
    s_nop 0
    buffer_load_dwordx4 v1, s[20:23], s28 offen lds
    s_add_u32 m0, s24, 2048
    s_nop 0
    buffer_load_dwordx4 v2, s[20:23], s28 offen lds
    s_add_u32 m0, s24, 3072
    s_nop 0
    buffer_load_dwordx4 v3, s[20:23], s28 offen lds
    s_add_u32 m0, s24, 4096
    s_nop 0
    buffer_load_dwordx4 v4, s[20:23], s28 offen lds
    s_add_u32 m0, s24, 5120
    s_nop 0
    buffer_load_dwordx4 v5, s[20:23], s28 offen lds
    s_add_u32 m0, s24, 6144
    s_nop 0
    buffer_load_dwordx4 v6, s[20:23], s28 offen lds
    v_add_u32 v21, 28672, v16
    ds_read_b64_tr_b16 v[72:73], v21 offset:0
    ds_read_b64_tr_b16 v[74:75], v21 offset:640
    ds_read_b64_tr_b16 v[76:77], v21 offset:8
    ds_read_b64_tr_b16 v[78:79], v21 offset:648
    ds_read_b64_tr_b16 v[80:81], v21 offset:16
    ds_read_b64_tr_b16 v[82:83], v21 offset:656
    ds_read_b64_tr_b16 v[84:85], v21 offset:24
    ds_read_b64_tr_b16 v[86:87], v21 offset:664
    ds_read_b64_tr_b16 v[88:89], v21 offset:32
    ds_read_b64_tr_b16 v[90:91], v21 offset:672
    s_waitcnt lgkmcnt(0)
    v_mfma_f32_16x16x32_bf16 v[32:35], v[72:75], a[20:23], v[32:35]
    ds_read_b64_tr_b16 v[92:93], v21 offset:5120
    v_mfma_f32_16x16x32_bf16 v[36:39], v[72:75], a[100:103], v[36:39]
    ds_read_b64_tr_b16 v[94:95], v21 offset:5760
    v_mfma_f32_16x16x32_bf16 v[40:43], v[76:79], a[20:23], v[40:43]
    ds_read_b64_tr_b16 v[96:97], v21 offset:5128
    v_mfma_f32_16x16x32_bf16 v[44:47], v[76:79], a[100:103], v[44:47]
    ds_read_b64_tr_b16 v[98:99], v21 offset:5768
    v_mfma_f32_16x16x32_bf16 v[48:51], v[80:83], a[20:23], v[48:51]
    ds_read_b64_tr_b16 v[100:101], v21 offset:5136
    v_mfma_f32_16x16x32_bf16 v[52:55], v[80:83], a[100:103], v[52:55]
    ds_read_b64_tr_b16 v[102:103], v21 offset:5776
    v_mfma_f32_16x16x32_bf16 v[56:59], v[84:87], a[20:23], v[56:59]
    ds_read_b64_tr_b16 v[104:105], v21 offset:5144
    v_mfma_f32_16x16x32_bf16 v[60:63], v[84:87], a[100:103], v[60:63]
    ds_read_b64_tr_b16 v[106:107], v21 offset:5784
    v_mfma_f32_16x16x32_bf16 v[64:67], v[88:91], a[20:23], v[64:67]
    ds_read_b64_tr_b16 v[108:109], v21 offset:5152
    v_mfma_f32_16x16x32_bf16 v[68:71], v[88:91], a[100:103], v[68:71]
    ds_read_b64_tr_b16 v[110:111], v21 offset:5792
    s_waitcnt lgkmcnt(0)
    v_mfma_f32_16x16x32_bf16 v[32:35], v[92:95], a[24:27], v[32:35]
    ds_read_b64_tr_b16 v[72:73], v21 offset:10240
    v_mfma_f32_16x16x32_bf16 v[36:39], v[92:95], a[104:107], v[36:39]
    ds_read_b64_tr_b16 v[74:75], v21 offset:10880
    v_mfma_f32_16x16x32_bf16 v[40:43], v[96:99], a[24:27], v[40:43]
    ds_read_b64_tr_b16 v[76:77], v21 offset:10248
    v_mfma_f32_16x16x32_bf16 v[44:47], v[96:99], a[104:107], v[44:47]
    ds_read_b64_tr_b16 v[78:79], v21 offset:10888
    v_mfma_f32_16x16x32_bf16 v[48:51], v[100:103], a[24:27], v[48:51]
    ds_read_b64_tr_b16 v[80:81], v21 offset:10256
    v_mfma_f32_16x16x32_bf16 v[52:55], v[100:103], a[104:107], v[52:55]
    ds_read_b64_tr_b16 v[82:83], v21 offset:10896
    v_mfma_f32_16x16x32_bf16 v[56:59], v[104:107], a[24:27], v[56:59]
    ds_read_b64_tr_b16 v[84:85], v21 offset:10264
    v_mfma_f32_16x16x32_bf16 v[60:63], v[104:107], a[104:107], v[60:63]
    ds_read_b64_tr_b16 v[86:87], v21 offset:10904
    v_mfma_f32_16x16x32_bf16 v[64:67], v[108:111], a[24:27], v[64:67]
    ds_read_b64_tr_b16 v[88:89], v21 offset:10272
    v_mfma_f32_16x16x32_bf16 v[68:71], v[108:111], a[104:107], v[68:71]
    ds_read_b64_tr_b16 v[90:91], v21 offset:10912
    s_waitcnt lgkmcnt(0)
    v_mfma_f32_16x16x32_bf16 v[32:35], v[72:75], a[28:31], v[32:35]
    ds_read_b64_tr_b16 v[92:93], v21 offset:15360
    v_mfma_f32_16x16x32_bf16 v[36:39], v[72:75], a[108:111], v[36:39]
    ds_read_b64_tr_b16 v[94:95], v21 offset:16000
    v_mfma_f32_16x16x32_bf16 v[40:43], v[76:79], a[28:31], v[40:43]
    ds_read_b64_tr_b16 v[96:97], v21 offset:15368
    v_mfma_f32_16x16x32_bf16 v[44:47], v[76:79], a[108:111], v[44:47]
    ds_read_b64_tr_b16 v[98:99], v21 offset:16008
    v_mfma_f32_16x16x32_bf16 v[48:51], v[80:83], a[28:31], v[48:51]
    ds_read_b64_tr_b16 v[100:101], v21 offset:15376
    v_mfma_f32_16x16x32_bf16 v[52:55], v[80:83], a[108:111], v[52:55]
    ds_read_b64_tr_b16 v[102:103], v21 offset:16016
    v_mfma_f32_16x16x32_bf16 v[56:59], v[84:87], a[28:31], v[56:59]
    ds_read_b64_tr_b16 v[104:105], v21 offset:15384
    v_mfma_f32_16x16x32_bf16 v[60:63], v[84:87], a[108:111], v[60:63]
    ds_read_b64_tr_b16 v[106:107], v21 offset:16024
    v_mfma_f32_16x16x32_bf16 v[64:67], v[88:91], a[28:31], v[64:67]
    ds_read_b64_tr_b16 v[108:109], v21 offset:15392
    v_mfma_f32_16x16x32_bf16 v[68:71], v[88:91], a[108:111], v[68:71]
    ds_read_b64_tr_b16 v[110:111], v21 offset:16032
    s_waitcnt lgkmcnt(0)
    v_mfma_f32_16x16x32_bf16 v[32:35], v[92:95], a[32:35], v[32:35]
    ds_read_b64_tr_b16 v[72:73], v21 offset:20480
    v_mfma_f32_16x16x32_bf16 v[36:39], v[92:95], a[112:115], v[36:39]
    ds_read_b64_tr_b16 v[74:75], v21 offset:21120
    v_mfma_f32_16x16x32_bf16 v[40:43], v[96:99], a[32:35], v[40:43]
    ds_read_b64_tr_b16 v[76:77], v21 offset:20488
    v_mfma_f32_16x16x32_bf16 v[44:47], v[96:99], a[112:115], v[44:47]
    ds_read_b64_tr_b16 v[78:79], v21 offset:21128
    v_mfma_f32_16x16x32_bf16 v[48:51], v[100:103], a[32:35], v[48:51]
    ds_read_b64_tr_b16 v[80:81], v21 offset:20496
    v_mfma_f32_16x16x32_bf16 v[52:55], v[100:103], a[112:115], v[52:55]
    ds_read_b64_tr_b16 v[82:83], v21 offset:21136
    v_mfma_f32_16x16x32_bf16 v[56:59], v[104:107], a[32:35], v[56:59]
    ds_read_b64_tr_b16 v[84:85], v21 offset:20504
    v_mfma_f32_16x16x32_bf16 v[60:63], v[104:107], a[112:115], v[60:63]
    ds_read_b64_tr_b16 v[86:87], v21 offset:21144
    v_mfma_f32_16x16x32_bf16 v[64:67], v[108:111], a[32:35], v[64:67]
    ds_read_b64_tr_b16 v[88:89], v21 offset:20512
    v_mfma_f32_16x16x32_bf16 v[68:71], v[108:111], a[112:115], v[68:71]
    ds_read_b64_tr_b16 v[90:91], v21 offset:21152
    s_waitcnt lgkmcnt(0)
    v_mfma_f32_16x16x32_bf16 v[32:35], v[72:75], a[36:39], v[32:35]
    v_mfma_f32_16x16x32_bf16 v[36:39], v[72:75], a[116:119], v[36:39]
    v_mfma_f32_16x16x32_bf16 v[40:43], v[76:79], a[36:39], v[40:43]
    v_mfma_f32_16x16x32_bf16 v[44:47], v[76:79], a[116:119], v[44:47]
    v_mfma_f32_16x16x32_bf16 v[48:51], v[80:83], a[36:39], v[48:51]
    v_mfma_f32_16x16x32_bf16 v[52:55], v[80:83], a[116:119], v[52:55]
    v_mfma_f32_16x16x32_bf16 v[56:59], v[84:87], a[36:39], v[56:59]
    v_mfma_f32_16x16x32_bf16 v[60:63], v[84:87], a[116:119], v[60:63]
    v_mfma_f32_16x16x32_bf16 v[64:67], v[88:91], a[36:39], v[64:67]
    v_mfma_f32_16x16x32_bf16 v[68:71], v[88:91], a[116:119], v[68:71]
    s_barrier
    s_add_u32 s28, s33, 614560
    s_mul_i32 s24, s9, 7168
    s_add_u32 m0, s24, 28672
    s_nop 0
    buffer_load_dwordx4 v0, s[20:23], s28 offen lds
    s_add_u32 m0, s24, 29696
    s_nop 0
    buffer_load_dwordx4 v1, s[20:23], s28 offen lds
    s_add_u32 m0, s24, 30720
    s_nop 0
    buffer_load_dwordx4 v2, s[20:23], s28 offen lds
    s_add_u32 m0, s24, 31744
    s_nop 0
    buffer_load_dwordx4 v3, s[20:23], s28 offen lds
    s_add_u32 m0, s24, 32768
    s_nop 0
    buffer_load_dwordx4 v4, s[20:23], s28 offen lds
    s_add_u32 m0, s24, 33792
    s_nop 0
    buffer_load_dwordx4 v5, s[20:23], s28 offen lds
    s_add_u32 m0, s24, 34816
    s_nop 0
    buffer_load_dwordx4 v6, s[20:23], s28 offen lds
    v_add_u32 v21, 57344, v16
    ds_read_b64_tr_b16 v[72:73], v21 offset:0
    ds_read_b64_tr_b16 v[74:75], v21 offset:640
    ds_read_b64_tr_b16 v[76:77], v21 offset:8
    ds_read_b64_tr_b16 v[78:79], v21 offset:648
    ds_read_b64_tr_b16 v[80:81], v21 offset:16
    ds_read_b64_tr_b16 v[82:83], v21 offset:656
    ds_read_b64_tr_b16 v[84:85], v21 offset:24
    ds_read_b64_tr_b16 v[86:87], v21 offset:664
    ds_read_b64_tr_b16 v[88:89], v21 offset:32
    ds_read_b64_tr_b16 v[90:91], v21 offset:672
    s_waitcnt lgkmcnt(0)
    v_mfma_f32_16x16x32_bf16 v[32:35], v[72:75], a[40:43], v[32:35]
    ds_read_b64_tr_b16 v[92:93], v21 offset:5120
    v_mfma_f32_16x16x32_bf16 v[36:39], v[72:75], a[120:123], v[36:39]
    ds_read_b64_tr_b16 v[94:95], v21 offset:5760
    v_mfma_f32_16x16x32_bf16 v[40:43], v[76:79], a[40:43], v[40:43]
    ds_read_b64_tr_b16 v[96:97], v21 offset:5128
    v_mfma_f32_16x16x32_bf16 v[44:47], v[76:79], a[120:123], v[44:47]
    ds_read_b64_tr_b16 v[98:99], v21 offset:5768
    v_mfma_f32_16x16x32_bf16 v[48:51], v[80:83], a[40:43], v[48:51]
    ds_read_b64_tr_b16 v[100:101], v21 offset:5136
    v_mfma_f32_16x16x32_bf16 v[52:55], v[80:83], a[120:123], v[52:55]
    ds_read_b64_tr_b16 v[102:103], v21 offset:5776
    v_mfma_f32_16x16x32_bf16 v[56:59], v[84:87], a[40:43], v[56:59]
    ds_read_b64_tr_b16 v[104:105], v21 offset:5144
    v_mfma_f32_16x16x32_bf16 v[60:63], v[84:87], a[120:123], v[60:63]
    ds_read_b64_tr_b16 v[106:107], v21 offset:5784
    v_mfma_f32_16x16x32_bf16 v[64:67], v[88:91], a[40:43], v[64:67]
    ds_read_b64_tr_b16 v[108:109], v21 offset:5152
    v_mfma_f32_16x16x32_bf16 v[68:71], v[88:91], a[120:123], v[68:71]
    ds_read_b64_tr_b16 v[110:111], v21 offset:5792
    s_waitcnt lgkmcnt(0)
    v_mfma_f32_16x16x32_bf16 v[32:35], v[92:95], a[44:47], v[32:35]
    ds_read_b64_tr_b16 v[72:73], v21 offset:10240
    v_mfma_f32_16x16x32_bf16 v[36:39], v[92:95], a[124:127], v[36:39]
    ds_read_b64_tr_b16 v[74:75], v21 offset:10880
    v_mfma_f32_16x16x32_bf16 v[40:43], v[96:99], a[44:47], v[40:43]
    ds_read_b64_tr_b16 v[76:77], v21 offset:10248
    v_mfma_f32_16x16x32_bf16 v[44:47], v[96:99], a[124:127], v[44:47]
    ds_read_b64_tr_b16 v[78:79], v21 offset:10888
    v_mfma_f32_16x16x32_bf16 v[48:51], v[100:103], a[44:47], v[48:51]
    ds_read_b64_tr_b16 v[80:81], v21 offset:10256
    v_mfma_f32_16x16x32_bf16 v[52:55], v[100:103], a[124:127], v[52:55]
    ds_read_b64_tr_b16 v[82:83], v21 offset:10896
    v_mfma_f32_16x16x32_bf16 v[56:59], v[104:107], a[44:47], v[56:59]
    ds_read_b64_tr_b16 v[84:85], v21 offset:10264
    v_mfma_f32_16x16x32_bf16 v[60:63], v[104:107], a[124:127], v[60:63]
    ds_read_b64_tr_b16 v[86:87], v21 offset:10904
    v_mfma_f32_16x16x32_bf16 v[64:67], v[108:111], a[44:47], v[64:67]
    ds_read_b64_tr_b16 v[88:89], v21 offset:10272
    v_mfma_f32_16x16x32_bf16 v[68:71], v[108:111], a[124:127], v[68:71]
    ds_read_b64_tr_b16 v[90:91], v21 offset:10912
    s_waitcnt lgkmcnt(0)
    v_mfma_f32_16x16x32_bf16 v[32:35], v[72:75], a[48:51], v[32:35]
    ds_read_b64_tr_b16 v[92:93], v21 offset:15360
    v_mfma_f32_16x16x32_bf16 v[36:39], v[72:75], a[128:131], v[36:39]
    ds_read_b64_tr_b16 v[94:95], v21 offset:16000
    v_mfma_f32_16x16x32_bf16 v[40:43], v[76:79], a[48:51], v[40:43]
    ds_read_b64_tr_b16 v[96:97], v21 offset:15368
    v_mfma_f32_16x16x32_bf16 v[44:47], v[76:79], a[128:131], v[44:47]
    ds_read_b64_tr_b16 v[98:99], v21 offset:16008
    v_mfma_f32_16x16x32_bf16 v[48:51], v[80:83], a[48:51], v[48:51]
    ds_read_b64_tr_b16 v[100:101], v21 offset:15376
    v_mfma_f32_16x16x32_bf16 v[52:55], v[80:83], a[128:131], v[52:55]
    ds_read_b64_tr_b16 v[102:103], v21 offset:16016
    v_mfma_f32_16x16x32_bf16 v[56:59], v[84:87], a[48:51], v[56:59]
    ds_read_b64_tr_b16 v[104:105], v21 offset:15384
    v_mfma_f32_16x16x32_bf16 v[60:63], v[84:87], a[128:131], v[60:63]
    ds_read_b64_tr_b16 v[106:107], v21 offset:16024
    v_mfma_f32_16x16x32_bf16 v[64:67], v[88:91], a[48:51], v[64:67]
    ds_read_b64_tr_b16 v[108:109], v21 offset:15392
    v_mfma_f32_16x16x32_bf16 v[68:71], v[88:91], a[128:131], v[68:71]
    ds_read_b64_tr_b16 v[110:111], v21 offset:16032
    s_waitcnt lgkmcnt(0)
    v_mfma_f32_16x16x32_bf16 v[32:35], v[92:95], a[52:55], v[32:35]
    ds_read_b64_tr_b16 v[72:73], v21 offset:20480
    v_mfma_f32_16x16x32_bf16 v[36:39], v[92:95], a[132:135], v[36:39]
    ds_read_b64_tr_b16 v[74:75], v21 offset:21120
    v_mfma_f32_16x16x32_bf16 v[40:43], v[96:99], a[52:55], v[40:43]
    ds_read_b64_tr_b16 v[76:77], v21 offset:20488
    v_mfma_f32_16x16x32_bf16 v[44:47], v[96:99], a[132:135], v[44:47]
    ds_read_b64_tr_b16 v[78:79], v21 offset:21128
    v_mfma_f32_16x16x32_bf16 v[48:51], v[100:103], a[52:55], v[48:51]
    ds_read_b64_tr_b16 v[80:81], v21 offset:20496
    v_mfma_f32_16x16x32_bf16 v[52:55], v[100:103], a[132:135], v[52:55]
    ds_read_b64_tr_b16 v[82:83], v21 offset:21136
    v_mfma_f32_16x16x32_bf16 v[56:59], v[104:107], a[52:55], v[56:59]
    ds_read_b64_tr_b16 v[84:85], v21 offset:20504
    v_mfma_f32_16x16x32_bf16 v[60:63], v[104:107], a[132:135], v[60:63]
    ds_read_b64_tr_b16 v[86:87], v21 offset:21144
    v_mfma_f32_16x16x32_bf16 v[64:67], v[108:111], a[52:55], v[64:67]
    ds_read_b64_tr_b16 v[88:89], v21 offset:20512
    v_mfma_f32_16x16x32_bf16 v[68:71], v[108:111], a[132:135], v[68:71]
    ds_read_b64_tr_b16 v[90:91], v21 offset:21152
    s_waitcnt lgkmcnt(0)
    v_mfma_f32_16x16x32_bf16 v[32:35], v[72:75], a[56:59], v[32:35]
    v_mfma_f32_16x16x32_bf16 v[36:39], v[72:75], a[136:139], v[36:39]
    v_mfma_f32_16x16x32_bf16 v[40:43], v[76:79], a[56:59], v[40:43]
    v_mfma_f32_16x16x32_bf16 v[44:47], v[76:79], a[136:139], v[44:47]
    v_mfma_f32_16x16x32_bf16 v[48:51], v[80:83], a[56:59], v[48:51]
    v_mfma_f32_16x16x32_bf16 v[52:55], v[80:83], a[136:139], v[52:55]
    v_mfma_f32_16x16x32_bf16 v[56:59], v[84:87], a[56:59], v[56:59]
    v_mfma_f32_16x16x32_bf16 v[60:63], v[84:87], a[136:139], v[60:63]
    v_mfma_f32_16x16x32_bf16 v[64:67], v[88:91], a[56:59], v[64:67]
    v_mfma_f32_16x16x32_bf16 v[68:71], v[88:91], a[136:139], v[68:71]
    s_waitcnt vmcnt(14)
    s_barrier
    s_add_u32 s28, s33, 1228960
    s_mul_i32 s24, s9, 7168
    s_add_u32 m0, s24, 57344
    s_nop 0
    buffer_load_dwordx4 v0, s[20:23], s28 offen lds
    s_add_u32 m0, s24, 58368
    s_nop 0
    buffer_load_dwordx4 v1, s[20:23], s28 offen lds
    s_add_u32 m0, s24, 59392
    s_nop 0
    buffer_load_dwordx4 v2, s[20:23], s28 offen lds
    s_add_u32 m0, s24, 60416
    s_nop 0
    buffer_load_dwordx4 v3, s[20:23], s28 offen lds
    s_add_u32 m0, s24, 61440
    s_nop 0
    buffer_load_dwordx4 v4, s[20:23], s28 offen lds
    s_add_u32 m0, s24, 62464
    s_nop 0
    buffer_load_dwordx4 v5, s[20:23], s28 offen lds
    s_add_u32 m0, s24, 63488
    s_nop 0
    buffer_load_dwordx4 v6, s[20:23], s28 offen lds
    v_add_u32 v21, 86016, v16
    ds_read_b64_tr_b16 v[72:73], v21 offset:0
    ds_read_b64_tr_b16 v[74:75], v21 offset:640
    ds_read_b64_tr_b16 v[76:77], v21 offset:8
    ds_read_b64_tr_b16 v[78:79], v21 offset:648
    ds_read_b64_tr_b16 v[80:81], v21 offset:16
    ds_read_b64_tr_b16 v[82:83], v21 offset:656
    ds_read_b64_tr_b16 v[84:85], v21 offset:24
    ds_read_b64_tr_b16 v[86:87], v21 offset:664
    ds_read_b64_tr_b16 v[88:89], v21 offset:32
    ds_read_b64_tr_b16 v[90:91], v21 offset:672
    s_waitcnt lgkmcnt(0)
    v_mfma_f32_16x16x32_bf16 v[32:35], v[72:75], a[60:63], v[32:35]
    ds_read_b64_tr_b16 v[92:93], v21 offset:5120
    v_mfma_f32_16x16x32_bf16 v[36:39], v[72:75], a[140:143], v[36:39]
    ds_read_b64_tr_b16 v[94:95], v21 offset:5760
    v_mfma_f32_16x16x32_bf16 v[40:43], v[76:79], a[60:63], v[40:43]
    ds_read_b64_tr_b16 v[96:97], v21 offset:5128
    v_mfma_f32_16x16x32_bf16 v[44:47], v[76:79], a[140:143], v[44:47]
    ds_read_b64_tr_b16 v[98:99], v21 offset:5768
    v_mfma_f32_16x16x32_bf16 v[48:51], v[80:83], a[60:63], v[48:51]
    ds_read_b64_tr_b16 v[100:101], v21 offset:5136
    v_mfma_f32_16x16x32_bf16 v[52:55], v[80:83], a[140:143], v[52:55]
    ds_read_b64_tr_b16 v[102:103], v21 offset:5776
    v_mfma_f32_16x16x32_bf16 v[56:59], v[84:87], a[60:63], v[56:59]
    ds_read_b64_tr_b16 v[104:105], v21 offset:5144
    v_mfma_f32_16x16x32_bf16 v[60:63], v[84:87], a[140:143], v[60:63]
    ds_read_b64_tr_b16 v[106:107], v21 offset:5784
    v_mfma_f32_16x16x32_bf16 v[64:67], v[88:91], a[60:63], v[64:67]
    ds_read_b64_tr_b16 v[108:109], v21 offset:5152
    v_mfma_f32_16x16x32_bf16 v[68:71], v[88:91], a[140:143], v[68:71]
    ds_read_b64_tr_b16 v[110:111], v21 offset:5792
    s_waitcnt lgkmcnt(0)
    v_mfma_f32_16x16x32_bf16 v[32:35], v[92:95], a[64:67], v[32:35]
    ds_read_b64_tr_b16 v[72:73], v21 offset:10240
    v_mfma_f32_16x16x32_bf16 v[36:39], v[92:95], a[144:147], v[36:39]
    ds_read_b64_tr_b16 v[74:75], v21 offset:10880
    v_mfma_f32_16x16x32_bf16 v[40:43], v[96:99], a[64:67], v[40:43]
    ds_read_b64_tr_b16 v[76:77], v21 offset:10248
    v_mfma_f32_16x16x32_bf16 v[44:47], v[96:99], a[144:147], v[44:47]
    ds_read_b64_tr_b16 v[78:79], v21 offset:10888
    v_mfma_f32_16x16x32_bf16 v[48:51], v[100:103], a[64:67], v[48:51]
    ds_read_b64_tr_b16 v[80:81], v21 offset:10256
    v_mfma_f32_16x16x32_bf16 v[52:55], v[100:103], a[144:147], v[52:55]
    ds_read_b64_tr_b16 v[82:83], v21 offset:10896
    v_mfma_f32_16x16x32_bf16 v[56:59], v[104:107], a[64:67], v[56:59]
    ds_read_b64_tr_b16 v[84:85], v21 offset:10264
    v_mfma_f32_16x16x32_bf16 v[60:63], v[104:107], a[144:147], v[60:63]
    ds_read_b64_tr_b16 v[86:87], v21 offset:10904
    v_mfma_f32_16x16x32_bf16 v[64:67], v[108:111], a[64:67], v[64:67]
    ds_read_b64_tr_b16 v[88:89], v21 offset:10272
    v_mfma_f32_16x16x32_bf16 v[68:71], v[108:111], a[144:147], v[68:71]
    ds_read_b64_tr_b16 v[90:91], v21 offset:10912
    s_waitcnt lgkmcnt(0)
    v_mfma_f32_16x16x32_bf16 v[32:35], v[72:75], a[68:71], v[32:35]
    ds_read_b64_tr_b16 v[92:93], v21 offset:15360
    v_mfma_f32_16x16x32_bf16 v[36:39], v[72:75], a[148:151], v[36:39]
    ds_read_b64_tr_b16 v[94:95], v21 offset:16000
    v_mfma_f32_16x16x32_bf16 v[40:43], v[76:79], a[68:71], v[40:43]
    ds_read_b64_tr_b16 v[96:97], v21 offset:15368
    v_mfma_f32_16x16x32_bf16 v[44:47], v[76:79], a[148:151], v[44:47]
    ds_read_b64_tr_b16 v[98:99], v21 offset:16008
    v_mfma_f32_16x16x32_bf16 v[48:51], v[80:83], a[68:71], v[48:51]
    ds_read_b64_tr_b16 v[100:101], v21 offset:15376
    v_mfma_f32_16x16x32_bf16 v[52:55], v[80:83], a[148:151], v[52:55]
    ds_read_b64_tr_b16 v[102:103], v21 offset:16016
    v_mfma_f32_16x16x32_bf16 v[56:59], v[84:87], a[68:71], v[56:59]
    ds_read_b64_tr_b16 v[104:105], v21 offset:15384
    v_mfma_f32_16x16x32_bf16 v[60:63], v[84:87], a[148:151], v[60:63]
    ds_read_b64_tr_b16 v[106:107], v21 offset:16024
    v_mfma_f32_16x16x32_bf16 v[64:67], v[88:91], a[68:71], v[64:67]
    ds_read_b64_tr_b16 v[108:109], v21 offset:15392
    v_mfma_f32_16x16x32_bf16 v[68:71], v[88:91], a[148:151], v[68:71]
    ds_read_b64_tr_b16 v[110:111], v21 offset:16032
    s_waitcnt lgkmcnt(0)
    v_mfma_f32_16x16x32_bf16 v[32:35], v[92:95], a[72:75], v[32:35]
    ds_read_b64_tr_b16 v[72:73], v21 offset:20480
    v_mfma_f32_16x16x32_bf16 v[36:39], v[92:95], a[152:155], v[36:39]
    ds_read_b64_tr_b16 v[74:75], v21 offset:21120
    v_mfma_f32_16x16x32_bf16 v[40:43], v[96:99], a[72:75], v[40:43]
    ds_read_b64_tr_b16 v[76:77], v21 offset:20488
    v_mfma_f32_16x16x32_bf16 v[44:47], v[96:99], a[152:155], v[44:47]
    ds_read_b64_tr_b16 v[78:79], v21 offset:21128
    v_mfma_f32_16x16x32_bf16 v[48:51], v[100:103], a[72:75], v[48:51]
    ds_read_b64_tr_b16 v[80:81], v21 offset:20496
    v_mfma_f32_16x16x32_bf16 v[52:55], v[100:103], a[152:155], v[52:55]
    ds_read_b64_tr_b16 v[82:83], v21 offset:21136
    v_mfma_f32_16x16x32_bf16 v[56:59], v[104:107], a[72:75], v[56:59]
    ds_read_b64_tr_b16 v[84:85], v21 offset:20504
    v_mfma_f32_16x16x32_bf16 v[60:63], v[104:107], a[152:155], v[60:63]
    ds_read_b64_tr_b16 v[86:87], v21 offset:21144
    v_mfma_f32_16x16x32_bf16 v[64:67], v[108:111], a[72:75], v[64:67]
    ds_read_b64_tr_b16 v[88:89], v21 offset:20512
    v_mfma_f32_16x16x32_bf16 v[68:71], v[108:111], a[152:155], v[68:71]
    ds_read_b64_tr_b16 v[90:91], v21 offset:21152
    s_waitcnt lgkmcnt(0)
    v_mfma_f32_16x16x32_bf16 v[32:35], v[72:75], a[76:79], v[32:35]
    v_mfma_f32_16x16x32_bf16 v[36:39], v[72:75], a[156:159], v[36:39]
    v_mfma_f32_16x16x32_bf16 v[40:43], v[76:79], a[76:79], v[40:43]
    v_mfma_f32_16x16x32_bf16 v[44:47], v[76:79], a[156:159], v[44:47]
    v_mfma_f32_16x16x32_bf16 v[48:51], v[80:83], a[76:79], v[48:51]
    v_mfma_f32_16x16x32_bf16 v[52:55], v[80:83], a[156:159], v[52:55]
    v_mfma_f32_16x16x32_bf16 v[56:59], v[84:87], a[76:79], v[56:59]
    v_mfma_f32_16x16x32_bf16 v[60:63], v[84:87], a[156:159], v[60:63]
    v_mfma_f32_16x16x32_bf16 v[64:67], v[88:91], a[76:79], v[64:67]
    v_mfma_f32_16x16x32_bf16 v[68:71], v[88:91], a[156:159], v[68:71]
    s_nop 7
    v_add_u32 v21, 0, v19
    v_cndmask_b32 v21, v19, v21, s[40:41]
    ds_read_b64_tr_b16 v[112:113], v21 offset:0
    ds_read_b64_tr_b16 v[114:115], v21 offset:160
    ds_read_b64_tr_b16 v[116:117], v21 offset:320
    ds_read_b64_tr_b16 v[118:119], v21 offset:480
    ds_read_b64_tr_b16 v[120:121], v21 offset:640
    ds_read_b64_tr_b16 v[122:123], v21 offset:8
    ds_read_b64_tr_b16 v[124:125], v21 offset:168
    ds_read_b64_tr_b16 v[126:127], v21 offset:328
    ds_read_b64_tr_b16 v[128:129], v21 offset:488
    ds_read_b64_tr_b16 v[130:131], v21 offset:648
    s_waitcnt lgkmcnt(0)
    ds_read_b64_tr_b16 v[132:133], v21 offset:16
    ds_read_b64_tr_b16 v[134:135], v21 offset:176
    ds_read_b64_tr_b16 v[136:137], v21 offset:336
    ds_read_b64_tr_b16 v[138:139], v21 offset:496
    ds_read_b64_tr_b16 v[140:141], v21 offset:656
    ds_read_b64_tr_b16 v[142:143], v21 offset:24
    ds_read_b64_tr_b16 v[144:145], v21 offset:184
    ds_read_b64_tr_b16 v[146:147], v21 offset:344
    ds_read_b64_tr_b16 v[148:149], v21 offset:504
    ds_read_b64_tr_b16 v[150:151], v21 offset:664
    s_waitcnt lgkmcnt(0)
    ds_read_b64_tr_b16 v[152:153], v21 offset:32
    ds_read_b64_tr_b16 v[154:155], v21 offset:192
    ds_read_b64_tr_b16 v[156:157], v21 offset:352
    ds_read_b64_tr_b16 v[158:159], v21 offset:512
    ds_read_b64_tr_b16 v[160:161], v21 offset:672
    v_cvt_pk_bf16_f32 v234, v32, v33
    v_cvt_pk_bf16_f32 v235, v34, v35
    v_cvt_pk_bf16_f32 v236, v40, v41
    v_cvt_pk_bf16_f32 v237, v42, v43
    v_cvt_pk_bf16_f32 v238, v48, v49
    v_cvt_pk_bf16_f32 v239, v50, v51
    v_cvt_pk_bf16_f32 v240, v56, v57
    v_cvt_pk_bf16_f32 v241, v58, v59
    v_cvt_pk_bf16_f32 v242, v64, v65
    v_cvt_pk_bf16_f32 v243, v66, v67
    v_cvt_pk_bf16_f32 v244, v36, v37
    v_cvt_pk_bf16_f32 v245, v38, v39
    v_cvt_pk_bf16_f32 v246, v44, v45
    v_cvt_pk_bf16_f32 v247, v46, v47
    v_cvt_pk_bf16_f32 v248, v52, v53
    v_cvt_pk_bf16_f32 v249, v54, v55
    v_cvt_pk_bf16_f32 v250, v60, v61
    v_cvt_pk_bf16_f32 v251, v62, v63
    v_cvt_pk_bf16_f32 v252, v68, v69
    v_cvt_pk_bf16_f32 v253, v70, v71
    s_waitcnt lgkmcnt(0)
    s_nop 1
    v_mfma_f32_16x16x32_bf16 v[72:75], v[112:115], v[234:237], 0
    v_mfma_f32_16x16x32_bf16 v[92:95], v[112:115], v[244:247], 0
    v_mfma_f32_16x16x32_bf16 v[76:79], v[122:125], v[234:237], 0
    v_mfma_f32_16x16x32_bf16 v[96:99], v[122:125], v[244:247], 0
    v_mfma_f32_16x16x32_bf16 v[80:83], v[132:135], v[234:237], 0
    v_mfma_f32_16x16x32_bf16 v[100:103], v[132:135], v[244:247], 0
    v_mfma_f32_16x16x32_bf16 v[84:87], v[142:145], v[234:237], 0
    v_mfma_f32_16x16x32_bf16 v[104:107], v[142:145], v[244:247], 0
    v_mfma_f32_16x16x32_bf16 v[88:91], v[152:155], v[234:237], 0
    v_mfma_f32_16x16x32_bf16 v[108:111], v[152:155], v[244:247], 0
    v_mfma_f32_16x16x32_bf16 v[72:75], v[116:119], v[238:241], v[72:75]
    v_mfma_f32_16x16x32_bf16 v[92:95], v[116:119], v[248:251], v[92:95]
    v_mfma_f32_16x16x32_bf16 v[76:79], v[126:129], v[238:241], v[76:79]
    v_mfma_f32_16x16x32_bf16 v[96:99], v[126:129], v[248:251], v[96:99]
    v_mfma_f32_16x16x32_bf16 v[80:83], v[136:139], v[238:241], v[80:83]
    v_mfma_f32_16x16x32_bf16 v[100:103], v[136:139], v[248:251], v[100:103]
    v_mfma_f32_16x16x32_bf16 v[84:87], v[146:149], v[238:241], v[84:87]
    v_mfma_f32_16x16x32_bf16 v[104:107], v[146:149], v[248:251], v[104:107]
    v_mfma_f32_16x16x32_bf16 v[88:91], v[156:159], v[238:241], v[88:91]
    v_mfma_f32_16x16x32_bf16 v[108:111], v[156:159], v[248:251], v[108:111]
    v_mfma_f32_16x16x16_bf16 v[72:75], v[120:121], v[242:243], v[72:75]
    v_mfma_f32_16x16x16_bf16 v[92:95], v[120:121], v[252:253], v[92:95]
    v_mfma_f32_16x16x16_bf16 v[76:79], v[130:131], v[242:243], v[76:79]
    v_mfma_f32_16x16x16_bf16 v[96:99], v[130:131], v[252:253], v[96:99]
    v_mfma_f32_16x16x16_bf16 v[80:83], v[140:141], v[242:243], v[80:83]
    v_mfma_f32_16x16x16_bf16 v[100:103], v[140:141], v[252:253], v[100:103]
    v_mfma_f32_16x16x16_bf16 v[84:87], v[150:151], v[242:243], v[84:87]
    v_mfma_f32_16x16x16_bf16 v[104:107], v[150:151], v[252:253], v[104:107]
    v_mfma_f32_16x16x16_bf16 v[88:91], v[160:161], v[242:243], v[88:91]
    v_mfma_f32_16x16x16_bf16 v[108:111], v[160:161], v[252:253], v[108:111]
    s_mov_b32 s24, 0x3fb8aa3b
    s_nop 7
    v_cvt_pk_bf16_f32 v8, v72, v73
    v_lshlrev_b32 v72, 16, v8
    v_and_b32 v73, 0xffff0000, v8
    v_cvt_pk_bf16_f32 v8, v74, v75
    v_lshlrev_b32 v74, 16, v8
    v_and_b32 v75, 0xffff0000, v8
    v_cvt_pk_bf16_f32 v8, v76, v77
    v_lshlrev_b32 v76, 16, v8
    v_and_b32 v77, 0xffff0000, v8
    v_cvt_pk_bf16_f32 v8, v78, v79
    v_lshlrev_b32 v78, 16, v8
    v_and_b32 v79, 0xffff0000, v8
    v_cvt_pk_bf16_f32 v8, v80, v81
    v_lshlrev_b32 v80, 16, v8
    v_and_b32 v81, 0xffff0000, v8
    v_cvt_pk_bf16_f32 v8, v82, v83
    v_lshlrev_b32 v82, 16, v8
    v_and_b32 v83, 0xffff0000, v8
    v_cvt_pk_bf16_f32 v8, v84, v85
    v_lshlrev_b32 v84, 16, v8
    v_and_b32 v85, 0xffff0000, v8
    v_cvt_pk_bf16_f32 v8, v86, v87
    v_lshlrev_b32 v86, 16, v8
    v_and_b32 v87, 0xffff0000, v8
    v_cvt_pk_bf16_f32 v8, v88, v89
    v_lshlrev_b32 v88, 16, v8
    v_and_b32 v89, 0xffff0000, v8
    v_cvt_pk_bf16_f32 v8, v90, v91
    v_lshlrev_b32 v90, 16, v8
    v_and_b32 v91, 0xffff0000, v8
    v_max3_f32 v8, v72, v73, v74
    v_max3_f32 v8, v8, v75, v76
    v_max3_f32 v8, v8, v77, v78
    v_max3_f32 v8, v8, v79, v80
    v_max3_f32 v8, v8, v81, v82
    v_max3_f32 v8, v8, v83, v84
    v_max3_f32 v8, v8, v85, v86
    v_max3_f32 v8, v8, v87, v88
    v_max3_f32 v8, v8, v89, v90
    v_max_f32 v8, v8, v91
    v_min3_f32 v9, v72, v73, v74
    v_min3_f32 v9, v9, v75, v76
    v_min3_f32 v9, v9, v77, v78
    v_min3_f32 v9, v9, v79, v80
    v_min3_f32 v9, v9, v81, v82
    v_min3_f32 v9, v9, v83, v84
    v_min3_f32 v9, v9, v85, v86
    v_min3_f32 v9, v9, v87, v88
    v_min3_f32 v9, v9, v89, v90
    v_min_f32 v9, v9, v91
    v_mul_f32 v8, s24, v8
    v_mul_f32 v9, s24, v9
    v_fma_f32 v32, -v72, s24, v9
    v_fma_f32 v72, v72, s24, -v8
    v_fma_f32 v33, -v73, s24, v9
    v_fma_f32 v73, v73, s24, -v8
    v_fma_f32 v34, -v74, s24, v9
    v_fma_f32 v74, v74, s24, -v8
    v_fma_f32 v35, -v75, s24, v9
    v_fma_f32 v75, v75, s24, -v8
    v_fma_f32 v36, -v76, s24, v9
    v_fma_f32 v76, v76, s24, -v8
    v_fma_f32 v37, -v77, s24, v9
    v_fma_f32 v77, v77, s24, -v8
    v_fma_f32 v38, -v78, s24, v9
    v_fma_f32 v78, v78, s24, -v8
    v_fma_f32 v39, -v79, s24, v9
    v_fma_f32 v79, v79, s24, -v8
    v_fma_f32 v40, -v80, s24, v9
    v_fma_f32 v80, v80, s24, -v8
    v_fma_f32 v41, -v81, s24, v9
    v_fma_f32 v81, v81, s24, -v8
    v_fma_f32 v42, -v82, s24, v9
    v_fma_f32 v82, v82, s24, -v8
    v_fma_f32 v43, -v83, s24, v9
    v_fma_f32 v83, v83, s24, -v8
    v_fma_f32 v44, -v84, s24, v9
    v_fma_f32 v84, v84, s24, -v8
    v_fma_f32 v45, -v85, s24, v9
    v_fma_f32 v85, v85, s24, -v8
    v_fma_f32 v46, -v86, s24, v9
    v_fma_f32 v86, v86, s24, -v8
    v_fma_f32 v47, -v87, s24, v9
    v_fma_f32 v87, v87, s24, -v8
    v_fma_f32 v48, -v88, s24, v9
    v_fma_f32 v88, v88, s24, -v8
    v_fma_f32 v49, -v89, s24, v9
    v_fma_f32 v89, v89, s24, -v8
    v_fma_f32 v50, -v90, s24, v9
    v_fma_f32 v90, v90, s24, -v8
    v_fma_f32 v51, -v91, s24, v9
    v_fma_f32 v91, v91, s24, -v8
    v_exp_f32 v32, v32
    v_exp_f32 v72, v72
    v_exp_f32 v33, v33
    v_exp_f32 v73, v73
    v_exp_f32 v34, v34
    v_exp_f32 v74, v74
    v_exp_f32 v35, v35
    v_exp_f32 v75, v75
    v_exp_f32 v36, v36
    v_exp_f32 v76, v76
    v_exp_f32 v37, v37
    v_exp_f32 v77, v77
    v_exp_f32 v38, v38
    v_exp_f32 v78, v78
    v_exp_f32 v39, v39
    v_exp_f32 v79, v79
    v_exp_f32 v40, v40
    v_exp_f32 v80, v80
    v_exp_f32 v41, v41
    v_exp_f32 v81, v81
    v_exp_f32 v42, v42
    v_exp_f32 v82, v82
    v_exp_f32 v43, v43
    v_exp_f32 v83, v83
    v_exp_f32 v44, v44
    v_exp_f32 v84, v84
    v_exp_f32 v45, v45
    v_exp_f32 v85, v85
    v_exp_f32 v46, v46
    v_exp_f32 v86, v86
    v_exp_f32 v47, v47
    v_exp_f32 v87, v87
    v_exp_f32 v48, v48
    v_exp_f32 v88, v88
    v_exp_f32 v49, v49
    v_exp_f32 v89, v89
    v_exp_f32 v50, v50
    v_exp_f32 v90, v90
    v_exp_f32 v51, v51
    v_exp_f32 v91, v91
    v_add_f32 v9, v32, v33
    v_add_f32 v9, v9, v34
    v_add_f32 v9, v9, v35
    v_add_f32 v9, v9, v36
    v_add_f32 v9, v9, v37
    v_add_f32 v9, v9, v38
    v_add_f32 v9, v9, v39
    v_add_f32 v9, v9, v40
    v_add_f32 v9, v9, v41
    v_add_f32 v9, v9, v42
    v_add_f32 v9, v9, v43
    v_add_f32 v9, v9, v44
    v_add_f32 v9, v9, v45
    v_add_f32 v9, v9, v46
    v_add_f32 v9, v9, v47
    v_add_f32 v9, v9, v48
    v_add_f32 v9, v9, v49
    v_add_f32 v9, v9, v50
    v_add_f32 v9, v9, v51
    v_add_f32 v8, v72, v73
    v_add_f32 v8, v8, v74
    v_add_f32 v8, v8, v75
    v_add_f32 v8, v8, v76
    v_add_f32 v8, v8, v77
    v_add_f32 v8, v8, v78
    v_add_f32 v8, v8, v79
    v_add_f32 v8, v8, v80
    v_add_f32 v8, v8, v81
    v_add_f32 v8, v8, v82
    v_add_f32 v8, v8, v83
    v_add_f32 v8, v8, v84
    v_add_f32 v8, v8, v85
    v_add_f32 v8, v8, v86
    v_add_f32 v8, v8, v87
    v_add_f32 v8, v8, v88
    v_add_f32 v8, v8, v89
    v_add_f32 v8, v8, v90
    v_add_f32 v8, v8, v91
    v_rcp_f32 v8, v8
    v_rcp_f32 v9, v9
    s_nop 0
    v_mul_f32 v72, v72, v8
    v_mul_f32 v32, v32, v9
    v_mul_f32 v73, v73, v8
    v_mul_f32 v33, v33, v9
    v_mul_f32 v74, v74, v8
    v_mul_f32 v34, v34, v9
    v_mul_f32 v75, v75, v8
    v_mul_f32 v35, v35, v9
    v_mul_f32 v76, v76, v8
    v_mul_f32 v36, v36, v9
    v_mul_f32 v77, v77, v8
    v_mul_f32 v37, v37, v9
    v_mul_f32 v78, v78, v8
    v_mul_f32 v38, v38, v9
    v_mul_f32 v79, v79, v8
    v_mul_f32 v39, v39, v9
    v_mul_f32 v80, v80, v8
    v_mul_f32 v40, v40, v9
    v_mul_f32 v81, v81, v8
    v_mul_f32 v41, v41, v9
    v_mul_f32 v82, v82, v8
    v_mul_f32 v42, v42, v9
    v_mul_f32 v83, v83, v8
    v_mul_f32 v43, v43, v9
    v_mul_f32 v84, v84, v8
    v_mul_f32 v44, v44, v9
    v_mul_f32 v85, v85, v8
    v_mul_f32 v45, v45, v9
    v_mul_f32 v86, v86, v8
    v_mul_f32 v46, v46, v9
    v_mul_f32 v87, v87, v8
    v_mul_f32 v47, v47, v9
    v_mul_f32 v88, v88, v8
    v_mul_f32 v48, v48, v9
    v_mul_f32 v89, v89, v8
    v_mul_f32 v49, v49, v9
    v_mul_f32 v90, v90, v8
    v_mul_f32 v50, v50, v9
    v_mul_f32 v91, v91, v8
    v_mul_f32 v51, v51, v9
    v_cvt_pk_bf16_f32 v162, v72, v73
    v_cvt_pk_bf16_f32 v172, v32, v33
    v_cvt_pk_bf16_f32 v163, v74, v75
    v_cvt_pk_bf16_f32 v173, v34, v35
    v_cvt_pk_bf16_f32 v164, v76, v77
    v_cvt_pk_bf16_f32 v174, v36, v37
    v_cvt_pk_bf16_f32 v165, v78, v79
    v_cvt_pk_bf16_f32 v175, v38, v39
    v_cvt_pk_bf16_f32 v166, v80, v81
    v_cvt_pk_bf16_f32 v176, v40, v41
    v_cvt_pk_bf16_f32 v167, v82, v83
    v_cvt_pk_bf16_f32 v177, v42, v43
    v_cvt_pk_bf16_f32 v168, v84, v85
    v_cvt_pk_bf16_f32 v178, v44, v45
    v_cvt_pk_bf16_f32 v169, v86, v87
    v_cvt_pk_bf16_f32 v179, v46, v47
    v_cvt_pk_bf16_f32 v170, v88, v89
    v_cvt_pk_bf16_f32 v180, v48, v49
    v_cvt_pk_bf16_f32 v171, v90, v91
    v_cvt_pk_bf16_f32 v181, v50, v51
    v_cvt_pk_bf16_f32 v8, v92, v93
    v_lshlrev_b32 v92, 16, v8
    v_and_b32 v93, 0xffff0000, v8
    v_cvt_pk_bf16_f32 v8, v94, v95
    v_lshlrev_b32 v94, 16, v8
    v_and_b32 v95, 0xffff0000, v8
    v_cvt_pk_bf16_f32 v8, v96, v97
    v_lshlrev_b32 v96, 16, v8
    v_and_b32 v97, 0xffff0000, v8
    v_cvt_pk_bf16_f32 v8, v98, v99
    v_lshlrev_b32 v98, 16, v8
    v_and_b32 v99, 0xffff0000, v8
    v_cvt_pk_bf16_f32 v8, v100, v101
    v_lshlrev_b32 v100, 16, v8
    v_and_b32 v101, 0xffff0000, v8
    v_cvt_pk_bf16_f32 v8, v102, v103
    v_lshlrev_b32 v102, 16, v8
    v_and_b32 v103, 0xffff0000, v8
    v_cvt_pk_bf16_f32 v8, v104, v105
    v_lshlrev_b32 v104, 16, v8
    v_and_b32 v105, 0xffff0000, v8
    v_cvt_pk_bf16_f32 v8, v106, v107
    v_lshlrev_b32 v106, 16, v8
    v_and_b32 v107, 0xffff0000, v8
    v_cvt_pk_bf16_f32 v8, v108, v109
    v_lshlrev_b32 v108, 16, v8
    v_and_b32 v109, 0xffff0000, v8
    v_cvt_pk_bf16_f32 v8, v110, v111
    v_lshlrev_b32 v110, 16, v8
    v_and_b32 v111, 0xffff0000, v8
    v_max3_f32 v8, v92, v93, v94
    v_max3_f32 v8, v8, v95, v96
    v_max3_f32 v8, v8, v97, v98
    v_max3_f32 v8, v8, v99, v100
    v_max3_f32 v8, v8, v101, v102
    v_max3_f32 v8, v8, v103, v104
    v_max3_f32 v8, v8, v105, v106
    v_max3_f32 v8, v8, v107, v108
    v_max3_f32 v8, v8, v109, v110
    v_max_f32 v8, v8, v111
    v_min3_f32 v9, v92, v93, v94
    v_min3_f32 v9, v9, v95, v96
    v_min3_f32 v9, v9, v97, v98
    v_min3_f32 v9, v9, v99, v100
    v_min3_f32 v9, v9, v101, v102
    v_min3_f32 v9, v9, v103, v104
    v_min3_f32 v9, v9, v105, v106
    v_min3_f32 v9, v9, v107, v108
    v_min3_f32 v9, v9, v109, v110
    v_min_f32 v9, v9, v111
    v_mul_f32 v8, s24, v8
    v_mul_f32 v9, s24, v9
    v_fma_f32 v32, -v92, s24, v9
    v_fma_f32 v92, v92, s24, -v8
    v_fma_f32 v33, -v93, s24, v9
    v_fma_f32 v93, v93, s24, -v8
    v_fma_f32 v34, -v94, s24, v9
    v_fma_f32 v94, v94, s24, -v8
    v_fma_f32 v35, -v95, s24, v9
    v_fma_f32 v95, v95, s24, -v8
    v_fma_f32 v36, -v96, s24, v9
    v_fma_f32 v96, v96, s24, -v8
    v_fma_f32 v37, -v97, s24, v9
    v_fma_f32 v97, v97, s24, -v8
    v_fma_f32 v38, -v98, s24, v9
    v_fma_f32 v98, v98, s24, -v8
    v_fma_f32 v39, -v99, s24, v9
    v_fma_f32 v99, v99, s24, -v8
    v_fma_f32 v40, -v100, s24, v9
    v_fma_f32 v100, v100, s24, -v8
    v_fma_f32 v41, -v101, s24, v9
    v_fma_f32 v101, v101, s24, -v8
    v_fma_f32 v42, -v102, s24, v9
    v_fma_f32 v102, v102, s24, -v8
    v_fma_f32 v43, -v103, s24, v9
    v_fma_f32 v103, v103, s24, -v8
    v_fma_f32 v44, -v104, s24, v9
    v_fma_f32 v104, v104, s24, -v8
    v_fma_f32 v45, -v105, s24, v9
    v_fma_f32 v105, v105, s24, -v8
    v_fma_f32 v46, -v106, s24, v9
    v_fma_f32 v106, v106, s24, -v8
    v_fma_f32 v47, -v107, s24, v9
    v_fma_f32 v107, v107, s24, -v8
    v_fma_f32 v48, -v108, s24, v9
    v_fma_f32 v108, v108, s24, -v8
    v_fma_f32 v49, -v109, s24, v9
    v_fma_f32 v109, v109, s24, -v8
    v_fma_f32 v50, -v110, s24, v9
    v_fma_f32 v110, v110, s24, -v8
    v_fma_f32 v51, -v111, s24, v9
    v_fma_f32 v111, v111, s24, -v8
    v_exp_f32 v32, v32
    v_exp_f32 v92, v92
    v_exp_f32 v33, v33
    v_exp_f32 v93, v93
    v_exp_f32 v34, v34
    v_exp_f32 v94, v94
    v_exp_f32 v35, v35
    v_exp_f32 v95, v95
    v_exp_f32 v36, v36
    v_exp_f32 v96, v96
    v_exp_f32 v37, v37
    v_exp_f32 v97, v97
    v_exp_f32 v38, v38
    v_exp_f32 v98, v98
    v_exp_f32 v39, v39
    v_exp_f32 v99, v99
    v_exp_f32 v40, v40
    v_exp_f32 v100, v100
    v_exp_f32 v41, v41
    v_exp_f32 v101, v101
    v_exp_f32 v42, v42
    v_exp_f32 v102, v102
    v_exp_f32 v43, v43
    v_exp_f32 v103, v103
    v_exp_f32 v44, v44
    v_exp_f32 v104, v104
    v_exp_f32 v45, v45
    v_exp_f32 v105, v105
    v_exp_f32 v46, v46
    v_exp_f32 v106, v106
    v_exp_f32 v47, v47
    v_exp_f32 v107, v107
    v_exp_f32 v48, v48
    v_exp_f32 v108, v108
    v_exp_f32 v49, v49
    v_exp_f32 v109, v109
    v_exp_f32 v50, v50
    v_exp_f32 v110, v110
    v_exp_f32 v51, v51
    v_exp_f32 v111, v111
    v_add_f32 v9, v32, v33
    v_add_f32 v9, v9, v34
    v_add_f32 v9, v9, v35
    v_add_f32 v9, v9, v36
    v_add_f32 v9, v9, v37
    v_add_f32 v9, v9, v38
    v_add_f32 v9, v9, v39
    v_add_f32 v9, v9, v40
    v_add_f32 v9, v9, v41
    v_add_f32 v9, v9, v42
    v_add_f32 v9, v9, v43
    v_add_f32 v9, v9, v44
    v_add_f32 v9, v9, v45
    v_add_f32 v9, v9, v46
    v_add_f32 v9, v9, v47
    v_add_f32 v9, v9, v48
    v_add_f32 v9, v9, v49
    v_add_f32 v9, v9, v50
    v_add_f32 v9, v9, v51
    v_add_f32 v8, v92, v93
    v_add_f32 v8, v8, v94
    v_add_f32 v8, v8, v95
    v_add_f32 v8, v8, v96
    v_add_f32 v8, v8, v97
    v_add_f32 v8, v8, v98
    v_add_f32 v8, v8, v99
    v_add_f32 v8, v8, v100
    v_add_f32 v8, v8, v101
    v_add_f32 v8, v8, v102
    v_add_f32 v8, v8, v103
    v_add_f32 v8, v8, v104
    v_add_f32 v8, v8, v105
    v_add_f32 v8, v8, v106
    v_add_f32 v8, v8, v107
    v_add_f32 v8, v8, v108
    v_add_f32 v8, v8, v109
    v_add_f32 v8, v8, v110
    v_add_f32 v8, v8, v111
    v_rcp_f32 v8, v8
    v_rcp_f32 v9, v9
    s_nop 0
    v_mul_f32 v92, v92, v8
    v_mul_f32 v32, v32, v9
    v_mul_f32 v93, v93, v8
    v_mul_f32 v33, v33, v9
    v_mul_f32 v94, v94, v8
    v_mul_f32 v34, v34, v9
    v_mul_f32 v95, v95, v8
    v_mul_f32 v35, v35, v9
    v_mul_f32 v96, v96, v8
    v_mul_f32 v36, v36, v9
    v_mul_f32 v97, v97, v8
    v_mul_f32 v37, v37, v9
    v_mul_f32 v98, v98, v8
    v_mul_f32 v38, v38, v9
    v_mul_f32 v99, v99, v8
    v_mul_f32 v39, v39, v9
    v_mul_f32 v100, v100, v8
    v_mul_f32 v40, v40, v9
    v_mul_f32 v101, v101, v8
    v_mul_f32 v41, v41, v9
    v_mul_f32 v102, v102, v8
    v_mul_f32 v42, v42, v9
    v_mul_f32 v103, v103, v8
    v_mul_f32 v43, v43, v9
    v_mul_f32 v104, v104, v8
    v_mul_f32 v44, v44, v9
    v_mul_f32 v105, v105, v8
    v_mul_f32 v45, v45, v9
    v_mul_f32 v106, v106, v8
    v_mul_f32 v46, v46, v9
    v_mul_f32 v107, v107, v8
    v_mul_f32 v47, v47, v9
    v_mul_f32 v108, v108, v8
    v_mul_f32 v48, v48, v9
    v_mul_f32 v109, v109, v8
    v_mul_f32 v49, v49, v9
    v_mul_f32 v110, v110, v8
    v_mul_f32 v50, v50, v9
    v_mul_f32 v111, v111, v8
    v_mul_f32 v51, v51, v9
    v_cvt_pk_bf16_f32 v182, v92, v93
    v_cvt_pk_bf16_f32 v192, v32, v33
    v_cvt_pk_bf16_f32 v183, v94, v95
    v_cvt_pk_bf16_f32 v193, v34, v35
    v_cvt_pk_bf16_f32 v184, v96, v97
    v_cvt_pk_bf16_f32 v194, v36, v37
    v_cvt_pk_bf16_f32 v185, v98, v99
    v_cvt_pk_bf16_f32 v195, v38, v39
    v_cvt_pk_bf16_f32 v186, v100, v101
    v_cvt_pk_bf16_f32 v196, v40, v41
    v_cvt_pk_bf16_f32 v187, v102, v103
    v_cvt_pk_bf16_f32 v197, v42, v43
    v_cvt_pk_bf16_f32 v188, v104, v105
    v_cvt_pk_bf16_f32 v198, v44, v45
    v_cvt_pk_bf16_f32 v189, v106, v107
    v_cvt_pk_bf16_f32 v199, v46, v47
    v_cvt_pk_bf16_f32 v190, v108, v109
    v_cvt_pk_bf16_f32 v200, v48, v49
    v_cvt_pk_bf16_f32 v191, v110, v111
    v_cvt_pk_bf16_f32 v201, v50, v51
    v_accvgpr_write_b32 a160, v162
    v_accvgpr_write_b32 a161, v163
    v_accvgpr_write_b32 a162, v164
    v_accvgpr_write_b32 a163, v165
    v_accvgpr_write_b32 a164, v166
    v_accvgpr_write_b32 a165, v167
    v_accvgpr_write_b32 a166, v168
    v_accvgpr_write_b32 a167, v169
    v_accvgpr_write_b32 a168, v170
    v_accvgpr_write_b32 a169, v171
    v_accvgpr_write_b32 a170, v172
    v_accvgpr_write_b32 a171, v173
    v_accvgpr_write_b32 a172, v174
    v_accvgpr_write_b32 a173, v175
    v_accvgpr_write_b32 a174, v176
    v_accvgpr_write_b32 a175, v177
    v_accvgpr_write_b32 a176, v178
    v_accvgpr_write_b32 a177, v179
    v_accvgpr_write_b32 a178, v180
    v_accvgpr_write_b32 a179, v181
    v_accvgpr_write_b32 a180, v182
    v_accvgpr_write_b32 a181, v183
    v_accvgpr_write_b32 a182, v184
    v_accvgpr_write_b32 a183, v185
    v_accvgpr_write_b32 a184, v186
    v_accvgpr_write_b32 a185, v187
    v_accvgpr_write_b32 a186, v188
    v_accvgpr_write_b32 a187, v189
    v_accvgpr_write_b32 a188, v190
    v_accvgpr_write_b32 a189, v191
    v_accvgpr_write_b32 a190, v192
    v_accvgpr_write_b32 a191, v193
    v_accvgpr_write_b32 a192, v194
    v_accvgpr_write_b32 a193, v195
    v_accvgpr_write_b32 a194, v196
    v_accvgpr_write_b32 a195, v197
    v_accvgpr_write_b32 a196, v198
    v_accvgpr_write_b32 a197, v199
    v_accvgpr_write_b32 a198, v200
    v_accvgpr_write_b32 a199, v201
    s_waitcnt vmcnt(14)
    s_barrier
    s_add_u32 s28, s33, 1843360
    s_mul_i32 s24, s9, 7168
    s_add_u32 m0, s24, 86016
    s_nop 0
    buffer_load_dwordx4 v0, s[20:23], s28 offen lds
    s_add_u32 m0, s24, 87040
    s_nop 0
    buffer_load_dwordx4 v1, s[20:23], s28 offen lds
    s_add_u32 m0, s24, 88064
    s_nop 0
    buffer_load_dwordx4 v2, s[20:23], s28 offen lds
    s_add_u32 m0, s24, 89088
    s_nop 0
    buffer_load_dwordx4 v3, s[20:23], s28 offen lds
    s_add_u32 m0, s24, 90112
    s_nop 0
    buffer_load_dwordx4 v4, s[20:23], s28 offen lds
    s_add_u32 m0, s24, 91136
    s_nop 0
    buffer_load_dwordx4 v5, s[20:23], s28 offen lds
    s_add_u32 m0, s24, 92160
    s_nop 0
    buffer_load_dwordx4 v6, s[20:23], s28 offen lds
    v_add_u32 v21, 0, v16
    ds_read_b64_tr_b16 v[72:73], v21 offset:0
    ds_read_b64_tr_b16 v[74:75], v21 offset:640
    ds_read_b64_tr_b16 v[76:77], v21 offset:8
    ds_read_b64_tr_b16 v[78:79], v21 offset:648
    ds_read_b64_tr_b16 v[80:81], v21 offset:16
    ds_read_b64_tr_b16 v[82:83], v21 offset:656
    ds_read_b64_tr_b16 v[84:85], v21 offset:24
    ds_read_b64_tr_b16 v[86:87], v21 offset:664
    ds_read_b64_tr_b16 v[88:89], v21 offset:32
    ds_read_b64_tr_b16 v[90:91], v21 offset:672
    s_waitcnt lgkmcnt(0)
    v_mfma_f32_16x16x32_bf16 v[32:35], v[72:75], a[0:3], 0
    ds_read_b64_tr_b16 v[92:93], v21 offset:5120
    v_mfma_f32_16x16x32_bf16 v[36:39], v[72:75], a[80:83], 0
    ds_read_b64_tr_b16 v[94:95], v21 offset:5760
    v_mfma_f32_16x16x32_bf16 v[40:43], v[76:79], a[0:3], 0
    ds_read_b64_tr_b16 v[96:97], v21 offset:5128
    v_mfma_f32_16x16x32_bf16 v[44:47], v[76:79], a[80:83], 0
    ds_read_b64_tr_b16 v[98:99], v21 offset:5768
    v_mfma_f32_16x16x32_bf16 v[48:51], v[80:83], a[0:3], 0
    ds_read_b64_tr_b16 v[100:101], v21 offset:5136
    v_mfma_f32_16x16x32_bf16 v[52:55], v[80:83], a[80:83], 0
    ds_read_b64_tr_b16 v[102:103], v21 offset:5776
    v_mfma_f32_16x16x32_bf16 v[56:59], v[84:87], a[0:3], 0
    ds_read_b64_tr_b16 v[104:105], v21 offset:5144
    v_mfma_f32_16x16x32_bf16 v[60:63], v[84:87], a[80:83], 0
    ds_read_b64_tr_b16 v[106:107], v21 offset:5784
    v_mfma_f32_16x16x32_bf16 v[64:67], v[88:91], a[0:3], 0
    ds_read_b64_tr_b16 v[108:109], v21 offset:5152
    v_mfma_f32_16x16x32_bf16 v[68:71], v[88:91], a[80:83], 0
    ds_read_b64_tr_b16 v[110:111], v21 offset:5792
    s_waitcnt lgkmcnt(0)
    v_mfma_f32_16x16x32_bf16 v[32:35], v[92:95], a[4:7], v[32:35]
    ds_read_b64_tr_b16 v[72:73], v21 offset:10240
    v_mfma_f32_16x16x32_bf16 v[36:39], v[92:95], a[84:87], v[36:39]
    ds_read_b64_tr_b16 v[74:75], v21 offset:10880
    v_mfma_f32_16x16x32_bf16 v[40:43], v[96:99], a[4:7], v[40:43]
    ds_read_b64_tr_b16 v[76:77], v21 offset:10248
    v_mfma_f32_16x16x32_bf16 v[44:47], v[96:99], a[84:87], v[44:47]
    ds_read_b64_tr_b16 v[78:79], v21 offset:10888
    v_mfma_f32_16x16x32_bf16 v[48:51], v[100:103], a[4:7], v[48:51]
    ds_read_b64_tr_b16 v[80:81], v21 offset:10256
    v_mfma_f32_16x16x32_bf16 v[52:55], v[100:103], a[84:87], v[52:55]
    ds_read_b64_tr_b16 v[82:83], v21 offset:10896
    v_mfma_f32_16x16x32_bf16 v[56:59], v[104:107], a[4:7], v[56:59]
    ds_read_b64_tr_b16 v[84:85], v21 offset:10264
    v_mfma_f32_16x16x32_bf16 v[60:63], v[104:107], a[84:87], v[60:63]
    ds_read_b64_tr_b16 v[86:87], v21 offset:10904
    v_mfma_f32_16x16x32_bf16 v[64:67], v[108:111], a[4:7], v[64:67]
    ds_read_b64_tr_b16 v[88:89], v21 offset:10272
    v_mfma_f32_16x16x32_bf16 v[68:71], v[108:111], a[84:87], v[68:71]
    ds_read_b64_tr_b16 v[90:91], v21 offset:10912
    s_waitcnt lgkmcnt(0)
    v_mfma_f32_16x16x32_bf16 v[32:35], v[72:75], a[8:11], v[32:35]
    ds_read_b64_tr_b16 v[92:93], v21 offset:15360
    v_mfma_f32_16x16x32_bf16 v[36:39], v[72:75], a[88:91], v[36:39]
    ds_read_b64_tr_b16 v[94:95], v21 offset:16000
    v_mfma_f32_16x16x32_bf16 v[40:43], v[76:79], a[8:11], v[40:43]
    ds_read_b64_tr_b16 v[96:97], v21 offset:15368
    v_mfma_f32_16x16x32_bf16 v[44:47], v[76:79], a[88:91], v[44:47]
    ds_read_b64_tr_b16 v[98:99], v21 offset:16008
    v_mfma_f32_16x16x32_bf16 v[48:51], v[80:83], a[8:11], v[48:51]
    ds_read_b64_tr_b16 v[100:101], v21 offset:15376
    v_mfma_f32_16x16x32_bf16 v[52:55], v[80:83], a[88:91], v[52:55]
    ds_read_b64_tr_b16 v[102:103], v21 offset:16016
    v_mfma_f32_16x16x32_bf16 v[56:59], v[84:87], a[8:11], v[56:59]
    ds_read_b64_tr_b16 v[104:105], v21 offset:15384
    v_mfma_f32_16x16x32_bf16 v[60:63], v[84:87], a[88:91], v[60:63]
    ds_read_b64_tr_b16 v[106:107], v21 offset:16024
    v_mfma_f32_16x16x32_bf16 v[64:67], v[88:91], a[8:11], v[64:67]
    ds_read_b64_tr_b16 v[108:109], v21 offset:15392
    v_mfma_f32_16x16x32_bf16 v[68:71], v[88:91], a[88:91], v[68:71]
    ds_read_b64_tr_b16 v[110:111], v21 offset:16032
    s_waitcnt lgkmcnt(0)
    v_mfma_f32_16x16x32_bf16 v[32:35], v[92:95], a[12:15], v[32:35]
    ds_read_b64_tr_b16 v[72:73], v21 offset:20480
    v_mfma_f32_16x16x32_bf16 v[36:39], v[92:95], a[92:95], v[36:39]
    ds_read_b64_tr_b16 v[74:75], v21 offset:21120
    v_mfma_f32_16x16x32_bf16 v[40:43], v[96:99], a[12:15], v[40:43]
    ds_read_b64_tr_b16 v[76:77], v21 offset:20488
    v_mfma_f32_16x16x32_bf16 v[44:47], v[96:99], a[92:95], v[44:47]
    ds_read_b64_tr_b16 v[78:79], v21 offset:21128
    v_mfma_f32_16x16x32_bf16 v[48:51], v[100:103], a[12:15], v[48:51]
    ds_read_b64_tr_b16 v[80:81], v21 offset:20496
    v_mfma_f32_16x16x32_bf16 v[52:55], v[100:103], a[92:95], v[52:55]
    ds_read_b64_tr_b16 v[82:83], v21 offset:21136
    v_mfma_f32_16x16x32_bf16 v[56:59], v[104:107], a[12:15], v[56:59]
    ds_read_b64_tr_b16 v[84:85], v21 offset:20504
    v_mfma_f32_16x16x32_bf16 v[60:63], v[104:107], a[92:95], v[60:63]
    ds_read_b64_tr_b16 v[86:87], v21 offset:21144
    v_mfma_f32_16x16x32_bf16 v[64:67], v[108:111], a[12:15], v[64:67]
    ds_read_b64_tr_b16 v[88:89], v21 offset:20512
    v_mfma_f32_16x16x32_bf16 v[68:71], v[108:111], a[92:95], v[68:71]
    ds_read_b64_tr_b16 v[90:91], v21 offset:21152
    s_waitcnt lgkmcnt(0)
    v_mfma_f32_16x16x32_bf16 v[32:35], v[72:75], a[16:19], v[32:35]
    v_mfma_f32_16x16x32_bf16 v[36:39], v[72:75], a[96:99], v[36:39]
    v_mfma_f32_16x16x32_bf16 v[40:43], v[76:79], a[16:19], v[40:43]
    v_mfma_f32_16x16x32_bf16 v[44:47], v[76:79], a[96:99], v[44:47]
    v_mfma_f32_16x16x32_bf16 v[48:51], v[80:83], a[16:19], v[48:51]
    v_mfma_f32_16x16x32_bf16 v[52:55], v[80:83], a[96:99], v[52:55]
    v_mfma_f32_16x16x32_bf16 v[56:59], v[84:87], a[16:19], v[56:59]
    v_mfma_f32_16x16x32_bf16 v[60:63], v[84:87], a[96:99], v[60:63]
    v_mfma_f32_16x16x32_bf16 v[64:67], v[88:91], a[16:19], v[64:67]
    v_mfma_f32_16x16x32_bf16 v[68:71], v[88:91], a[96:99], v[68:71]
    s_waitcnt vmcnt(14)
    s_barrier
    v_add_u32 v21, 28672, v16
    ds_read_b64_tr_b16 v[72:73], v21 offset:0
    ds_read_b64_tr_b16 v[74:75], v21 offset:640
    ds_read_b64_tr_b16 v[76:77], v21 offset:8
    ds_read_b64_tr_b16 v[78:79], v21 offset:648
    ds_read_b64_tr_b16 v[80:81], v21 offset:16
    ds_read_b64_tr_b16 v[82:83], v21 offset:656
    ds_read_b64_tr_b16 v[84:85], v21 offset:24
    ds_read_b64_tr_b16 v[86:87], v21 offset:664
    ds_read_b64_tr_b16 v[88:89], v21 offset:32
    ds_read_b64_tr_b16 v[90:91], v21 offset:672
    s_waitcnt lgkmcnt(0)
    v_mfma_f32_16x16x32_bf16 v[32:35], v[72:75], a[20:23], v[32:35]
    ds_read_b64_tr_b16 v[92:93], v21 offset:5120
    v_mfma_f32_16x16x32_bf16 v[36:39], v[72:75], a[100:103], v[36:39]
    ds_read_b64_tr_b16 v[94:95], v21 offset:5760
    v_mfma_f32_16x16x32_bf16 v[40:43], v[76:79], a[20:23], v[40:43]
    ds_read_b64_tr_b16 v[96:97], v21 offset:5128
    v_mfma_f32_16x16x32_bf16 v[44:47], v[76:79], a[100:103], v[44:47]
    ds_read_b64_tr_b16 v[98:99], v21 offset:5768
    v_mfma_f32_16x16x32_bf16 v[48:51], v[80:83], a[20:23], v[48:51]
    ds_read_b64_tr_b16 v[100:101], v21 offset:5136
    v_mfma_f32_16x16x32_bf16 v[52:55], v[80:83], a[100:103], v[52:55]
    ds_read_b64_tr_b16 v[102:103], v21 offset:5776
    v_mfma_f32_16x16x32_bf16 v[56:59], v[84:87], a[20:23], v[56:59]
    ds_read_b64_tr_b16 v[104:105], v21 offset:5144
    v_mfma_f32_16x16x32_bf16 v[60:63], v[84:87], a[100:103], v[60:63]
    ds_read_b64_tr_b16 v[106:107], v21 offset:5784
    v_mfma_f32_16x16x32_bf16 v[64:67], v[88:91], a[20:23], v[64:67]
    ds_read_b64_tr_b16 v[108:109], v21 offset:5152
    v_mfma_f32_16x16x32_bf16 v[68:71], v[88:91], a[100:103], v[68:71]
    ds_read_b64_tr_b16 v[110:111], v21 offset:5792
    s_waitcnt lgkmcnt(0)
    v_mfma_f32_16x16x32_bf16 v[32:35], v[92:95], a[24:27], v[32:35]
    ds_read_b64_tr_b16 v[72:73], v21 offset:10240
    v_mfma_f32_16x16x32_bf16 v[36:39], v[92:95], a[104:107], v[36:39]
    ds_read_b64_tr_b16 v[74:75], v21 offset:10880
    v_mfma_f32_16x16x32_bf16 v[40:43], v[96:99], a[24:27], v[40:43]
    ds_read_b64_tr_b16 v[76:77], v21 offset:10248
    v_mfma_f32_16x16x32_bf16 v[44:47], v[96:99], a[104:107], v[44:47]
    ds_read_b64_tr_b16 v[78:79], v21 offset:10888
    v_mfma_f32_16x16x32_bf16 v[48:51], v[100:103], a[24:27], v[48:51]
    ds_read_b64_tr_b16 v[80:81], v21 offset:10256
    v_mfma_f32_16x16x32_bf16 v[52:55], v[100:103], a[104:107], v[52:55]
    ds_read_b64_tr_b16 v[82:83], v21 offset:10896
    v_mfma_f32_16x16x32_bf16 v[56:59], v[104:107], a[24:27], v[56:59]
    ds_read_b64_tr_b16 v[84:85], v21 offset:10264
    v_mfma_f32_16x16x32_bf16 v[60:63], v[104:107], a[104:107], v[60:63]
    ds_read_b64_tr_b16 v[86:87], v21 offset:10904
    v_mfma_f32_16x16x32_bf16 v[64:67], v[108:111], a[24:27], v[64:67]
    ds_read_b64_tr_b16 v[88:89], v21 offset:10272
    v_mfma_f32_16x16x32_bf16 v[68:71], v[108:111], a[104:107], v[68:71]
    ds_read_b64_tr_b16 v[90:91], v21 offset:10912
    s_waitcnt lgkmcnt(0)
    v_mfma_f32_16x16x32_bf16 v[32:35], v[72:75], a[28:31], v[32:35]
    ds_read_b64_tr_b16 v[92:93], v21 offset:15360
    v_mfma_f32_16x16x32_bf16 v[36:39], v[72:75], a[108:111], v[36:39]
    ds_read_b64_tr_b16 v[94:95], v21 offset:16000
    v_mfma_f32_16x16x32_bf16 v[40:43], v[76:79], a[28:31], v[40:43]
    ds_read_b64_tr_b16 v[96:97], v21 offset:15368
    v_mfma_f32_16x16x32_bf16 v[44:47], v[76:79], a[108:111], v[44:47]
    ds_read_b64_tr_b16 v[98:99], v21 offset:16008
    v_mfma_f32_16x16x32_bf16 v[48:51], v[80:83], a[28:31], v[48:51]
    ds_read_b64_tr_b16 v[100:101], v21 offset:15376
    v_mfma_f32_16x16x32_bf16 v[52:55], v[80:83], a[108:111], v[52:55]
    ds_read_b64_tr_b16 v[102:103], v21 offset:16016
    v_mfma_f32_16x16x32_bf16 v[56:59], v[84:87], a[28:31], v[56:59]
    ds_read_b64_tr_b16 v[104:105], v21 offset:15384
    v_mfma_f32_16x16x32_bf16 v[60:63], v[84:87], a[108:111], v[60:63]
    ds_read_b64_tr_b16 v[106:107], v21 offset:16024
    v_mfma_f32_16x16x32_bf16 v[64:67], v[88:91], a[28:31], v[64:67]
    ds_read_b64_tr_b16 v[108:109], v21 offset:15392
    v_mfma_f32_16x16x32_bf16 v[68:71], v[88:91], a[108:111], v[68:71]
    ds_read_b64_tr_b16 v[110:111], v21 offset:16032
    s_waitcnt lgkmcnt(0)
    v_mfma_f32_16x16x32_bf16 v[32:35], v[92:95], a[32:35], v[32:35]
    ds_read_b64_tr_b16 v[72:73], v21 offset:20480
    v_mfma_f32_16x16x32_bf16 v[36:39], v[92:95], a[112:115], v[36:39]
    ds_read_b64_tr_b16 v[74:75], v21 offset:21120
    v_mfma_f32_16x16x32_bf16 v[40:43], v[96:99], a[32:35], v[40:43]
    ds_read_b64_tr_b16 v[76:77], v21 offset:20488
    v_mfma_f32_16x16x32_bf16 v[44:47], v[96:99], a[112:115], v[44:47]
    ds_read_b64_tr_b16 v[78:79], v21 offset:21128
    v_mfma_f32_16x16x32_bf16 v[48:51], v[100:103], a[32:35], v[48:51]
    ds_read_b64_tr_b16 v[80:81], v21 offset:20496
    v_mfma_f32_16x16x32_bf16 v[52:55], v[100:103], a[112:115], v[52:55]
    ds_read_b64_tr_b16 v[82:83], v21 offset:21136
    v_mfma_f32_16x16x32_bf16 v[56:59], v[104:107], a[32:35], v[56:59]
    ds_read_b64_tr_b16 v[84:85], v21 offset:20504
    v_mfma_f32_16x16x32_bf16 v[60:63], v[104:107], a[112:115], v[60:63]
    ds_read_b64_tr_b16 v[86:87], v21 offset:21144
    v_mfma_f32_16x16x32_bf16 v[64:67], v[108:111], a[32:35], v[64:67]
    ds_read_b64_tr_b16 v[88:89], v21 offset:20512
    v_mfma_f32_16x16x32_bf16 v[68:71], v[108:111], a[112:115], v[68:71]
    ds_read_b64_tr_b16 v[90:91], v21 offset:21152
    s_waitcnt lgkmcnt(0)
    v_mfma_f32_16x16x32_bf16 v[32:35], v[72:75], a[36:39], v[32:35]
    v_mfma_f32_16x16x32_bf16 v[36:39], v[72:75], a[116:119], v[36:39]
    v_mfma_f32_16x16x32_bf16 v[40:43], v[76:79], a[36:39], v[40:43]
    v_mfma_f32_16x16x32_bf16 v[44:47], v[76:79], a[116:119], v[44:47]
    v_mfma_f32_16x16x32_bf16 v[48:51], v[80:83], a[36:39], v[48:51]
    v_mfma_f32_16x16x32_bf16 v[52:55], v[80:83], a[116:119], v[52:55]
    v_mfma_f32_16x16x32_bf16 v[56:59], v[84:87], a[36:39], v[56:59]
    v_mfma_f32_16x16x32_bf16 v[60:63], v[84:87], a[116:119], v[60:63]
    v_mfma_f32_16x16x32_bf16 v[64:67], v[88:91], a[36:39], v[64:67]
    v_mfma_f32_16x16x32_bf16 v[68:71], v[88:91], a[116:119], v[68:71]
    s_waitcnt vmcnt(7)
    s_barrier
    v_add_u32 v21, 57344, v16
    ds_read_b64_tr_b16 v[72:73], v21 offset:0
    ds_read_b64_tr_b16 v[74:75], v21 offset:640
    ds_read_b64_tr_b16 v[76:77], v21 offset:8
    ds_read_b64_tr_b16 v[78:79], v21 offset:648
    ds_read_b64_tr_b16 v[80:81], v21 offset:16
    ds_read_b64_tr_b16 v[82:83], v21 offset:656
    ds_read_b64_tr_b16 v[84:85], v21 offset:24
    ds_read_b64_tr_b16 v[86:87], v21 offset:664
    ds_read_b64_tr_b16 v[88:89], v21 offset:32
    ds_read_b64_tr_b16 v[90:91], v21 offset:672
    s_waitcnt lgkmcnt(0)
    v_mfma_f32_16x16x32_bf16 v[32:35], v[72:75], a[40:43], v[32:35]
    ds_read_b64_tr_b16 v[92:93], v21 offset:5120
    v_mfma_f32_16x16x32_bf16 v[36:39], v[72:75], a[120:123], v[36:39]
    ds_read_b64_tr_b16 v[94:95], v21 offset:5760
    v_mfma_f32_16x16x32_bf16 v[40:43], v[76:79], a[40:43], v[40:43]
    ds_read_b64_tr_b16 v[96:97], v21 offset:5128
    v_mfma_f32_16x16x32_bf16 v[44:47], v[76:79], a[120:123], v[44:47]
    ds_read_b64_tr_b16 v[98:99], v21 offset:5768
    v_mfma_f32_16x16x32_bf16 v[48:51], v[80:83], a[40:43], v[48:51]
    ds_read_b64_tr_b16 v[100:101], v21 offset:5136
    v_mfma_f32_16x16x32_bf16 v[52:55], v[80:83], a[120:123], v[52:55]
    ds_read_b64_tr_b16 v[102:103], v21 offset:5776
    v_mfma_f32_16x16x32_bf16 v[56:59], v[84:87], a[40:43], v[56:59]
    ds_read_b64_tr_b16 v[104:105], v21 offset:5144
    v_mfma_f32_16x16x32_bf16 v[60:63], v[84:87], a[120:123], v[60:63]
    ds_read_b64_tr_b16 v[106:107], v21 offset:5784
    v_mfma_f32_16x16x32_bf16 v[64:67], v[88:91], a[40:43], v[64:67]
    ds_read_b64_tr_b16 v[108:109], v21 offset:5152
    v_mfma_f32_16x16x32_bf16 v[68:71], v[88:91], a[120:123], v[68:71]
    ds_read_b64_tr_b16 v[110:111], v21 offset:5792
    s_waitcnt lgkmcnt(0)
    v_mfma_f32_16x16x32_bf16 v[32:35], v[92:95], a[44:47], v[32:35]
    ds_read_b64_tr_b16 v[72:73], v21 offset:10240
    v_mfma_f32_16x16x32_bf16 v[36:39], v[92:95], a[124:127], v[36:39]
    ds_read_b64_tr_b16 v[74:75], v21 offset:10880
    v_mfma_f32_16x16x32_bf16 v[40:43], v[96:99], a[44:47], v[40:43]
    ds_read_b64_tr_b16 v[76:77], v21 offset:10248
    v_mfma_f32_16x16x32_bf16 v[44:47], v[96:99], a[124:127], v[44:47]
    ds_read_b64_tr_b16 v[78:79], v21 offset:10888
    v_mfma_f32_16x16x32_bf16 v[48:51], v[100:103], a[44:47], v[48:51]
    ds_read_b64_tr_b16 v[80:81], v21 offset:10256
    v_mfma_f32_16x16x32_bf16 v[52:55], v[100:103], a[124:127], v[52:55]
    ds_read_b64_tr_b16 v[82:83], v21 offset:10896
    v_mfma_f32_16x16x32_bf16 v[56:59], v[104:107], a[44:47], v[56:59]
    ds_read_b64_tr_b16 v[84:85], v21 offset:10264
    v_mfma_f32_16x16x32_bf16 v[60:63], v[104:107], a[124:127], v[60:63]
    ds_read_b64_tr_b16 v[86:87], v21 offset:10904
    v_mfma_f32_16x16x32_bf16 v[64:67], v[108:111], a[44:47], v[64:67]
    ds_read_b64_tr_b16 v[88:89], v21 offset:10272
    v_mfma_f32_16x16x32_bf16 v[68:71], v[108:111], a[124:127], v[68:71]
    ds_read_b64_tr_b16 v[90:91], v21 offset:10912
    s_waitcnt lgkmcnt(0)
    v_mfma_f32_16x16x32_bf16 v[32:35], v[72:75], a[48:51], v[32:35]
    ds_read_b64_tr_b16 v[92:93], v21 offset:15360
    v_mfma_f32_16x16x32_bf16 v[36:39], v[72:75], a[128:131], v[36:39]
    ds_read_b64_tr_b16 v[94:95], v21 offset:16000
    v_mfma_f32_16x16x32_bf16 v[40:43], v[76:79], a[48:51], v[40:43]
    ds_read_b64_tr_b16 v[96:97], v21 offset:15368
    v_mfma_f32_16x16x32_bf16 v[44:47], v[76:79], a[128:131], v[44:47]
    ds_read_b64_tr_b16 v[98:99], v21 offset:16008
    v_mfma_f32_16x16x32_bf16 v[48:51], v[80:83], a[48:51], v[48:51]
    ds_read_b64_tr_b16 v[100:101], v21 offset:15376
    v_mfma_f32_16x16x32_bf16 v[52:55], v[80:83], a[128:131], v[52:55]
    ds_read_b64_tr_b16 v[102:103], v21 offset:16016
    v_mfma_f32_16x16x32_bf16 v[56:59], v[84:87], a[48:51], v[56:59]
    ds_read_b64_tr_b16 v[104:105], v21 offset:15384
    v_mfma_f32_16x16x32_bf16 v[60:63], v[84:87], a[128:131], v[60:63]
    ds_read_b64_tr_b16 v[106:107], v21 offset:16024
    v_mfma_f32_16x16x32_bf16 v[64:67], v[88:91], a[48:51], v[64:67]
    ds_read_b64_tr_b16 v[108:109], v21 offset:15392
    v_mfma_f32_16x16x32_bf16 v[68:71], v[88:91], a[128:131], v[68:71]
    ds_read_b64_tr_b16 v[110:111], v21 offset:16032
    s_waitcnt lgkmcnt(0)
    v_mfma_f32_16x16x32_bf16 v[32:35], v[92:95], a[52:55], v[32:35]
    ds_read_b64_tr_b16 v[72:73], v21 offset:20480
    v_mfma_f32_16x16x32_bf16 v[36:39], v[92:95], a[132:135], v[36:39]
    ds_read_b64_tr_b16 v[74:75], v21 offset:21120
    v_mfma_f32_16x16x32_bf16 v[40:43], v[96:99], a[52:55], v[40:43]
    ds_read_b64_tr_b16 v[76:77], v21 offset:20488
    v_mfma_f32_16x16x32_bf16 v[44:47], v[96:99], a[132:135], v[44:47]
    ds_read_b64_tr_b16 v[78:79], v21 offset:21128
    v_mfma_f32_16x16x32_bf16 v[48:51], v[100:103], a[52:55], v[48:51]
    ds_read_b64_tr_b16 v[80:81], v21 offset:20496
    v_mfma_f32_16x16x32_bf16 v[52:55], v[100:103], a[132:135], v[52:55]
    ds_read_b64_tr_b16 v[82:83], v21 offset:21136
    v_mfma_f32_16x16x32_bf16 v[56:59], v[104:107], a[52:55], v[56:59]
    ds_read_b64_tr_b16 v[84:85], v21 offset:20504
    v_mfma_f32_16x16x32_bf16 v[60:63], v[104:107], a[132:135], v[60:63]
    ds_read_b64_tr_b16 v[86:87], v21 offset:21144
    v_mfma_f32_16x16x32_bf16 v[64:67], v[108:111], a[52:55], v[64:67]
    ds_read_b64_tr_b16 v[88:89], v21 offset:20512
    v_mfma_f32_16x16x32_bf16 v[68:71], v[108:111], a[132:135], v[68:71]
    ds_read_b64_tr_b16 v[90:91], v21 offset:21152
    s_waitcnt lgkmcnt(0)
    v_mfma_f32_16x16x32_bf16 v[32:35], v[72:75], a[56:59], v[32:35]
    v_mfma_f32_16x16x32_bf16 v[36:39], v[72:75], a[136:139], v[36:39]
    v_mfma_f32_16x16x32_bf16 v[40:43], v[76:79], a[56:59], v[40:43]
    v_mfma_f32_16x16x32_bf16 v[44:47], v[76:79], a[136:139], v[44:47]
    v_mfma_f32_16x16x32_bf16 v[48:51], v[80:83], a[56:59], v[48:51]
    v_mfma_f32_16x16x32_bf16 v[52:55], v[80:83], a[136:139], v[52:55]
    v_mfma_f32_16x16x32_bf16 v[56:59], v[84:87], a[56:59], v[56:59]
    v_mfma_f32_16x16x32_bf16 v[60:63], v[84:87], a[136:139], v[60:63]
    v_mfma_f32_16x16x32_bf16 v[64:67], v[88:91], a[56:59], v[64:67]
    v_mfma_f32_16x16x32_bf16 v[68:71], v[88:91], a[136:139], v[68:71]
    s_waitcnt vmcnt(0)
    s_barrier
    v_add_u32 v21, 86016, v16
    ds_read_b64_tr_b16 v[72:73], v21 offset:0
    ds_read_b64_tr_b16 v[74:75], v21 offset:640
    ds_read_b64_tr_b16 v[76:77], v21 offset:8
    ds_read_b64_tr_b16 v[78:79], v21 offset:648
    ds_read_b64_tr_b16 v[80:81], v21 offset:16
    ds_read_b64_tr_b16 v[82:83], v21 offset:656
    ds_read_b64_tr_b16 v[84:85], v21 offset:24
    ds_read_b64_tr_b16 v[86:87], v21 offset:664
    ds_read_b64_tr_b16 v[88:89], v21 offset:32
    ds_read_b64_tr_b16 v[90:91], v21 offset:672
    s_waitcnt lgkmcnt(0)
    v_mfma_f32_16x16x32_bf16 v[32:35], v[72:75], a[60:63], v[32:35]
    ds_read_b64_tr_b16 v[92:93], v21 offset:5120
    v_mfma_f32_16x16x32_bf16 v[36:39], v[72:75], a[140:143], v[36:39]
    ds_read_b64_tr_b16 v[94:95], v21 offset:5760
    v_mfma_f32_16x16x32_bf16 v[40:43], v[76:79], a[60:63], v[40:43]
    ds_read_b64_tr_b16 v[96:97], v21 offset:5128
    v_mfma_f32_16x16x32_bf16 v[44:47], v[76:79], a[140:143], v[44:47]
    ds_read_b64_tr_b16 v[98:99], v21 offset:5768
    v_mfma_f32_16x16x32_bf16 v[48:51], v[80:83], a[60:63], v[48:51]
    ds_read_b64_tr_b16 v[100:101], v21 offset:5136
    v_mfma_f32_16x16x32_bf16 v[52:55], v[80:83], a[140:143], v[52:55]
    ds_read_b64_tr_b16 v[102:103], v21 offset:5776
    v_mfma_f32_16x16x32_bf16 v[56:59], v[84:87], a[60:63], v[56:59]
    ds_read_b64_tr_b16 v[104:105], v21 offset:5144
    v_mfma_f32_16x16x32_bf16 v[60:63], v[84:87], a[140:143], v[60:63]
    ds_read_b64_tr_b16 v[106:107], v21 offset:5784
    v_mfma_f32_16x16x32_bf16 v[64:67], v[88:91], a[60:63], v[64:67]
    ds_read_b64_tr_b16 v[108:109], v21 offset:5152
    v_mfma_f32_16x16x32_bf16 v[68:71], v[88:91], a[140:143], v[68:71]
    ds_read_b64_tr_b16 v[110:111], v21 offset:5792
    s_waitcnt lgkmcnt(0)
    v_mfma_f32_16x16x32_bf16 v[32:35], v[92:95], a[64:67], v[32:35]
    ds_read_b64_tr_b16 v[72:73], v21 offset:10240
    v_mfma_f32_16x16x32_bf16 v[36:39], v[92:95], a[144:147], v[36:39]
    ds_read_b64_tr_b16 v[74:75], v21 offset:10880
    v_mfma_f32_16x16x32_bf16 v[40:43], v[96:99], a[64:67], v[40:43]
    ds_read_b64_tr_b16 v[76:77], v21 offset:10248
    v_mfma_f32_16x16x32_bf16 v[44:47], v[96:99], a[144:147], v[44:47]
    ds_read_b64_tr_b16 v[78:79], v21 offset:10888
    v_mfma_f32_16x16x32_bf16 v[48:51], v[100:103], a[64:67], v[48:51]
    ds_read_b64_tr_b16 v[80:81], v21 offset:10256
    v_mfma_f32_16x16x32_bf16 v[52:55], v[100:103], a[144:147], v[52:55]
    ds_read_b64_tr_b16 v[82:83], v21 offset:10896
    v_mfma_f32_16x16x32_bf16 v[56:59], v[104:107], a[64:67], v[56:59]
    ds_read_b64_tr_b16 v[84:85], v21 offset:10264
    v_mfma_f32_16x16x32_bf16 v[60:63], v[104:107], a[144:147], v[60:63]
    ds_read_b64_tr_b16 v[86:87], v21 offset:10904
    v_mfma_f32_16x16x32_bf16 v[64:67], v[108:111], a[64:67], v[64:67]
    ds_read_b64_tr_b16 v[88:89], v21 offset:10272
    v_mfma_f32_16x16x32_bf16 v[68:71], v[108:111], a[144:147], v[68:71]
    ds_read_b64_tr_b16 v[90:91], v21 offset:10912
    s_waitcnt lgkmcnt(0)
    v_mfma_f32_16x16x32_bf16 v[32:35], v[72:75], a[68:71], v[32:35]
    ds_read_b64_tr_b16 v[92:93], v21 offset:15360
    v_mfma_f32_16x16x32_bf16 v[36:39], v[72:75], a[148:151], v[36:39]
    ds_read_b64_tr_b16 v[94:95], v21 offset:16000
    v_mfma_f32_16x16x32_bf16 v[40:43], v[76:79], a[68:71], v[40:43]
    ds_read_b64_tr_b16 v[96:97], v21 offset:15368
    v_mfma_f32_16x16x32_bf16 v[44:47], v[76:79], a[148:151], v[44:47]
    ds_read_b64_tr_b16 v[98:99], v21 offset:16008
    v_mfma_f32_16x16x32_bf16 v[48:51], v[80:83], a[68:71], v[48:51]
    ds_read_b64_tr_b16 v[100:101], v21 offset:15376
    v_mfma_f32_16x16x32_bf16 v[52:55], v[80:83], a[148:151], v[52:55]
    ds_read_b64_tr_b16 v[102:103], v21 offset:16016
    v_mfma_f32_16x16x32_bf16 v[56:59], v[84:87], a[68:71], v[56:59]
    ds_read_b64_tr_b16 v[104:105], v21 offset:15384
    v_mfma_f32_16x16x32_bf16 v[60:63], v[84:87], a[148:151], v[60:63]
    ds_read_b64_tr_b16 v[106:107], v21 offset:16024
    v_mfma_f32_16x16x32_bf16 v[64:67], v[88:91], a[68:71], v[64:67]
    ds_read_b64_tr_b16 v[108:109], v21 offset:15392
    v_mfma_f32_16x16x32_bf16 v[68:71], v[88:91], a[148:151], v[68:71]
    ds_read_b64_tr_b16 v[110:111], v21 offset:16032
    s_waitcnt lgkmcnt(0)
    v_mfma_f32_16x16x32_bf16 v[32:35], v[92:95], a[72:75], v[32:35]
    ds_read_b64_tr_b16 v[72:73], v21 offset:20480
    v_mfma_f32_16x16x32_bf16 v[36:39], v[92:95], a[152:155], v[36:39]
    ds_read_b64_tr_b16 v[74:75], v21 offset:21120
    v_mfma_f32_16x16x32_bf16 v[40:43], v[96:99], a[72:75], v[40:43]
    ds_read_b64_tr_b16 v[76:77], v21 offset:20488
    v_mfma_f32_16x16x32_bf16 v[44:47], v[96:99], a[152:155], v[44:47]
    ds_read_b64_tr_b16 v[78:79], v21 offset:21128
    v_mfma_f32_16x16x32_bf16 v[48:51], v[100:103], a[72:75], v[48:51]
    ds_read_b64_tr_b16 v[80:81], v21 offset:20496
    v_mfma_f32_16x16x32_bf16 v[52:55], v[100:103], a[152:155], v[52:55]
    ds_read_b64_tr_b16 v[82:83], v21 offset:21136
    v_mfma_f32_16x16x32_bf16 v[56:59], v[104:107], a[72:75], v[56:59]
    ds_read_b64_tr_b16 v[84:85], v21 offset:20504
    v_mfma_f32_16x16x32_bf16 v[60:63], v[104:107], a[152:155], v[60:63]
    ds_read_b64_tr_b16 v[86:87], v21 offset:21144
    v_mfma_f32_16x16x32_bf16 v[64:67], v[108:111], a[72:75], v[64:67]
    ds_read_b64_tr_b16 v[88:89], v21 offset:20512
    v_mfma_f32_16x16x32_bf16 v[68:71], v[108:111], a[152:155], v[68:71]
    ds_read_b64_tr_b16 v[90:91], v21 offset:21152
    s_waitcnt lgkmcnt(0)
    v_mfma_f32_16x16x32_bf16 v[32:35], v[72:75], a[76:79], v[32:35]
    v_mfma_f32_16x16x32_bf16 v[36:39], v[72:75], a[156:159], v[36:39]
    v_mfma_f32_16x16x32_bf16 v[40:43], v[76:79], a[76:79], v[40:43]
    v_mfma_f32_16x16x32_bf16 v[44:47], v[76:79], a[156:159], v[44:47]
    v_mfma_f32_16x16x32_bf16 v[48:51], v[80:83], a[76:79], v[48:51]
    v_mfma_f32_16x16x32_bf16 v[52:55], v[80:83], a[156:159], v[52:55]
    v_mfma_f32_16x16x32_bf16 v[56:59], v[84:87], a[76:79], v[56:59]
    v_mfma_f32_16x16x32_bf16 v[60:63], v[84:87], a[156:159], v[60:63]
    v_mfma_f32_16x16x32_bf16 v[64:67], v[88:91], a[76:79], v[64:67]
    v_mfma_f32_16x16x32_bf16 v[68:71], v[88:91], a[156:159], v[68:71]
    s_nop 7
    v_add_u32 v21, 3200, v19
    v_cndmask_b32 v21, v19, v21, s[40:41]
    ds_read_b64_tr_b16 v[112:113], v21 offset:0
    ds_read_b64_tr_b16 v[114:115], v21 offset:160
    ds_read_b64_tr_b16 v[116:117], v21 offset:320
    ds_read_b64_tr_b16 v[118:119], v21 offset:480
    ds_read_b64_tr_b16 v[120:121], v21 offset:640
    ds_read_b64_tr_b16 v[122:123], v21 offset:8
    ds_read_b64_tr_b16 v[124:125], v21 offset:168
    ds_read_b64_tr_b16 v[126:127], v21 offset:328
    ds_read_b64_tr_b16 v[128:129], v21 offset:488
    ds_read_b64_tr_b16 v[130:131], v21 offset:648
    s_waitcnt lgkmcnt(0)
    ds_read_b64_tr_b16 v[132:133], v21 offset:16
    ds_read_b64_tr_b16 v[134:135], v21 offset:176
    ds_read_b64_tr_b16 v[136:137], v21 offset:336
    ds_read_b64_tr_b16 v[138:139], v21 offset:496
    ds_read_b64_tr_b16 v[140:141], v21 offset:656
    ds_read_b64_tr_b16 v[142:143], v21 offset:24
    ds_read_b64_tr_b16 v[144:145], v21 offset:184
    ds_read_b64_tr_b16 v[146:147], v21 offset:344
    ds_read_b64_tr_b16 v[148:149], v21 offset:504
    ds_read_b64_tr_b16 v[150:151], v21 offset:664
    s_waitcnt lgkmcnt(0)
    ds_read_b64_tr_b16 v[152:153], v21 offset:32
    ds_read_b64_tr_b16 v[154:155], v21 offset:192
    ds_read_b64_tr_b16 v[156:157], v21 offset:352
    ds_read_b64_tr_b16 v[158:159], v21 offset:512
    ds_read_b64_tr_b16 v[160:161], v21 offset:672
    v_cvt_pk_bf16_f32 v234, v32, v33
    v_cvt_pk_bf16_f32 v235, v34, v35
    v_cvt_pk_bf16_f32 v236, v40, v41
    v_cvt_pk_bf16_f32 v237, v42, v43
    v_cvt_pk_bf16_f32 v238, v48, v49
    v_cvt_pk_bf16_f32 v239, v50, v51
    v_cvt_pk_bf16_f32 v240, v56, v57
    v_cvt_pk_bf16_f32 v241, v58, v59
    v_cvt_pk_bf16_f32 v242, v64, v65
    v_cvt_pk_bf16_f32 v243, v66, v67
    v_cvt_pk_bf16_f32 v244, v36, v37
    v_cvt_pk_bf16_f32 v245, v38, v39
    v_cvt_pk_bf16_f32 v246, v44, v45
    v_cvt_pk_bf16_f32 v247, v46, v47
    v_cvt_pk_bf16_f32 v248, v52, v53
    v_cvt_pk_bf16_f32 v249, v54, v55
    v_cvt_pk_bf16_f32 v250, v60, v61
    v_cvt_pk_bf16_f32 v251, v62, v63
    v_cvt_pk_bf16_f32 v252, v68, v69
    v_cvt_pk_bf16_f32 v253, v70, v71
    s_waitcnt lgkmcnt(0)
    s_nop 1
    v_mfma_f32_16x16x32_bf16 v[72:75], v[112:115], v[234:237], 0
    v_mfma_f32_16x16x32_bf16 v[92:95], v[112:115], v[244:247], 0
    v_mfma_f32_16x16x32_bf16 v[76:79], v[122:125], v[234:237], 0
    v_mfma_f32_16x16x32_bf16 v[96:99], v[122:125], v[244:247], 0
    v_mfma_f32_16x16x32_bf16 v[80:83], v[132:135], v[234:237], 0
    v_mfma_f32_16x16x32_bf16 v[100:103], v[132:135], v[244:247], 0
    v_mfma_f32_16x16x32_bf16 v[84:87], v[142:145], v[234:237], 0
    v_mfma_f32_16x16x32_bf16 v[104:107], v[142:145], v[244:247], 0
    v_mfma_f32_16x16x32_bf16 v[88:91], v[152:155], v[234:237], 0
    v_mfma_f32_16x16x32_bf16 v[108:111], v[152:155], v[244:247], 0
    v_mfma_f32_16x16x32_bf16 v[72:75], v[116:119], v[238:241], v[72:75]
    v_mfma_f32_16x16x32_bf16 v[92:95], v[116:119], v[248:251], v[92:95]
    v_mfma_f32_16x16x32_bf16 v[76:79], v[126:129], v[238:241], v[76:79]
    v_mfma_f32_16x16x32_bf16 v[96:99], v[126:129], v[248:251], v[96:99]
    v_mfma_f32_16x16x32_bf16 v[80:83], v[136:139], v[238:241], v[80:83]
    v_mfma_f32_16x16x32_bf16 v[100:103], v[136:139], v[248:251], v[100:103]
    v_mfma_f32_16x16x32_bf16 v[84:87], v[146:149], v[238:241], v[84:87]
    v_mfma_f32_16x16x32_bf16 v[104:107], v[146:149], v[248:251], v[104:107]
    v_mfma_f32_16x16x32_bf16 v[88:91], v[156:159], v[238:241], v[88:91]
    v_mfma_f32_16x16x32_bf16 v[108:111], v[156:159], v[248:251], v[108:111]
    v_mfma_f32_16x16x16_bf16 v[72:75], v[120:121], v[242:243], v[72:75]
    v_mfma_f32_16x16x16_bf16 v[92:95], v[120:121], v[252:253], v[92:95]
    v_mfma_f32_16x16x16_bf16 v[76:79], v[130:131], v[242:243], v[76:79]
    v_mfma_f32_16x16x16_bf16 v[96:99], v[130:131], v[252:253], v[96:99]
    v_mfma_f32_16x16x16_bf16 v[80:83], v[140:141], v[242:243], v[80:83]
    v_mfma_f32_16x16x16_bf16 v[100:103], v[140:141], v[252:253], v[100:103]
    v_mfma_f32_16x16x16_bf16 v[84:87], v[150:151], v[242:243], v[84:87]
    v_mfma_f32_16x16x16_bf16 v[104:107], v[150:151], v[252:253], v[104:107]
    v_mfma_f32_16x16x16_bf16 v[88:91], v[160:161], v[242:243], v[88:91]
    v_mfma_f32_16x16x16_bf16 v[108:111], v[160:161], v[252:253], v[108:111]
    s_mov_b32 s24, 0x3fb8aa3b
    s_nop 7
    v_cvt_pk_bf16_f32 v8, v72, v73
    v_lshlrev_b32 v72, 16, v8
    v_and_b32 v73, 0xffff0000, v8
    v_cvt_pk_bf16_f32 v8, v74, v75
    v_lshlrev_b32 v74, 16, v8
    v_and_b32 v75, 0xffff0000, v8
    v_cvt_pk_bf16_f32 v8, v76, v77
    v_lshlrev_b32 v76, 16, v8
    v_and_b32 v77, 0xffff0000, v8
    v_cvt_pk_bf16_f32 v8, v78, v79
    v_lshlrev_b32 v78, 16, v8
    v_and_b32 v79, 0xffff0000, v8
    v_cvt_pk_bf16_f32 v8, v80, v81
    v_lshlrev_b32 v80, 16, v8
    v_and_b32 v81, 0xffff0000, v8
    v_cvt_pk_bf16_f32 v8, v82, v83
    v_lshlrev_b32 v82, 16, v8
    v_and_b32 v83, 0xffff0000, v8
    v_cvt_pk_bf16_f32 v8, v84, v85
    v_lshlrev_b32 v84, 16, v8
    v_and_b32 v85, 0xffff0000, v8
    v_cvt_pk_bf16_f32 v8, v86, v87
    v_lshlrev_b32 v86, 16, v8
    v_and_b32 v87, 0xffff0000, v8
    v_cvt_pk_bf16_f32 v8, v88, v89
    v_lshlrev_b32 v88, 16, v8
    v_and_b32 v89, 0xffff0000, v8
    v_cvt_pk_bf16_f32 v8, v90, v91
    v_lshlrev_b32 v90, 16, v8
    v_and_b32 v91, 0xffff0000, v8
    v_max3_f32 v8, v72, v73, v74
    v_max3_f32 v8, v8, v75, v76
    v_max3_f32 v8, v8, v77, v78
    v_max3_f32 v8, v8, v79, v80
    v_max3_f32 v8, v8, v81, v82
    v_max3_f32 v8, v8, v83, v84
    v_max3_f32 v8, v8, v85, v86
    v_max3_f32 v8, v8, v87, v88
    v_max3_f32 v8, v8, v89, v90
    v_max_f32 v8, v8, v91
    v_min3_f32 v9, v72, v73, v74
    v_min3_f32 v9, v9, v75, v76
    v_min3_f32 v9, v9, v77, v78
    v_min3_f32 v9, v9, v79, v80
    v_min3_f32 v9, v9, v81, v82
    v_min3_f32 v9, v9, v83, v84
    v_min3_f32 v9, v9, v85, v86
    v_min3_f32 v9, v9, v87, v88
    v_min3_f32 v9, v9, v89, v90
    v_min_f32 v9, v9, v91
    v_mul_f32 v8, s24, v8
    v_mul_f32 v9, s24, v9
    v_fma_f32 v32, -v72, s24, v9
    v_fma_f32 v72, v72, s24, -v8
    v_fma_f32 v33, -v73, s24, v9
    v_fma_f32 v73, v73, s24, -v8
    v_fma_f32 v34, -v74, s24, v9
    v_fma_f32 v74, v74, s24, -v8
    v_fma_f32 v35, -v75, s24, v9
    v_fma_f32 v75, v75, s24, -v8
    v_fma_f32 v36, -v76, s24, v9
    v_fma_f32 v76, v76, s24, -v8
    v_fma_f32 v37, -v77, s24, v9
    v_fma_f32 v77, v77, s24, -v8
    v_fma_f32 v38, -v78, s24, v9
    v_fma_f32 v78, v78, s24, -v8
    v_fma_f32 v39, -v79, s24, v9
    v_fma_f32 v79, v79, s24, -v8
    v_fma_f32 v40, -v80, s24, v9
    v_fma_f32 v80, v80, s24, -v8
    v_fma_f32 v41, -v81, s24, v9
    v_fma_f32 v81, v81, s24, -v8
    v_fma_f32 v42, -v82, s24, v9
    v_fma_f32 v82, v82, s24, -v8
    v_fma_f32 v43, -v83, s24, v9
    v_fma_f32 v83, v83, s24, -v8
    v_fma_f32 v44, -v84, s24, v9
    v_fma_f32 v84, v84, s24, -v8
    v_fma_f32 v45, -v85, s24, v9
    v_fma_f32 v85, v85, s24, -v8
    v_fma_f32 v46, -v86, s24, v9
    v_fma_f32 v86, v86, s24, -v8
    v_fma_f32 v47, -v87, s24, v9
    v_fma_f32 v87, v87, s24, -v8
    v_fma_f32 v48, -v88, s24, v9
    v_fma_f32 v88, v88, s24, -v8
    v_fma_f32 v49, -v89, s24, v9
    v_fma_f32 v89, v89, s24, -v8
    v_fma_f32 v50, -v90, s24, v9
    v_fma_f32 v90, v90, s24, -v8
    v_fma_f32 v51, -v91, s24, v9
    v_fma_f32 v91, v91, s24, -v8
    v_exp_f32 v32, v32
    v_exp_f32 v72, v72
    v_exp_f32 v33, v33
    v_exp_f32 v73, v73
    v_exp_f32 v34, v34
    v_exp_f32 v74, v74
    v_exp_f32 v35, v35
    v_exp_f32 v75, v75
    v_exp_f32 v36, v36
    v_exp_f32 v76, v76
    v_exp_f32 v37, v37
    v_exp_f32 v77, v77
    v_exp_f32 v38, v38
    v_exp_f32 v78, v78
    v_exp_f32 v39, v39
    v_exp_f32 v79, v79
    v_exp_f32 v40, v40
    v_exp_f32 v80, v80
    v_exp_f32 v41, v41
    v_exp_f32 v81, v81
    v_exp_f32 v42, v42
    v_exp_f32 v82, v82
    v_exp_f32 v43, v43
    v_exp_f32 v83, v83
    v_exp_f32 v44, v44
    v_exp_f32 v84, v84
    v_exp_f32 v45, v45
    v_exp_f32 v85, v85
    v_exp_f32 v46, v46
    v_exp_f32 v86, v86
    v_exp_f32 v47, v47
    v_exp_f32 v87, v87
    v_exp_f32 v48, v48
    v_exp_f32 v88, v88
    v_exp_f32 v49, v49
    v_exp_f32 v89, v89
    v_exp_f32 v50, v50
    v_exp_f32 v90, v90
    v_exp_f32 v51, v51
    v_exp_f32 v91, v91
    v_add_f32 v9, v32, v33
    v_add_f32 v9, v9, v34
    v_add_f32 v9, v9, v35
    v_add_f32 v9, v9, v36
    v_add_f32 v9, v9, v37
    v_add_f32 v9, v9, v38
    v_add_f32 v9, v9, v39
    v_add_f32 v9, v9, v40
    v_add_f32 v9, v9, v41
    v_add_f32 v9, v9, v42
    v_add_f32 v9, v9, v43
    v_add_f32 v9, v9, v44
    v_add_f32 v9, v9, v45
    v_add_f32 v9, v9, v46
    v_add_f32 v9, v9, v47
    v_add_f32 v9, v9, v48
    v_add_f32 v9, v9, v49
    v_add_f32 v9, v9, v50
    v_add_f32 v9, v9, v51
    v_add_f32 v8, v72, v73
    v_add_f32 v8, v8, v74
    v_add_f32 v8, v8, v75
    v_add_f32 v8, v8, v76
    v_add_f32 v8, v8, v77
    v_add_f32 v8, v8, v78
    v_add_f32 v8, v8, v79
    v_add_f32 v8, v8, v80
    v_add_f32 v8, v8, v81
    v_add_f32 v8, v8, v82
    v_add_f32 v8, v8, v83
    v_add_f32 v8, v8, v84
    v_add_f32 v8, v8, v85
    v_add_f32 v8, v8, v86
    v_add_f32 v8, v8, v87
    v_add_f32 v8, v8, v88
    v_add_f32 v8, v8, v89
    v_add_f32 v8, v8, v90
    v_add_f32 v8, v8, v91
    v_rcp_f32 v8, v8
    v_rcp_f32 v9, v9
    s_nop 0
    v_mul_f32 v72, v72, v8
    v_mul_f32 v32, v32, v9
    v_mul_f32 v73, v73, v8
    v_mul_f32 v33, v33, v9
    v_mul_f32 v74, v74, v8
    v_mul_f32 v34, v34, v9
    v_mul_f32 v75, v75, v8
    v_mul_f32 v35, v35, v9
    v_mul_f32 v76, v76, v8
    v_mul_f32 v36, v36, v9
    v_mul_f32 v77, v77, v8
    v_mul_f32 v37, v37, v9
    v_mul_f32 v78, v78, v8
    v_mul_f32 v38, v38, v9
    v_mul_f32 v79, v79, v8
    v_mul_f32 v39, v39, v9
    v_mul_f32 v80, v80, v8
    v_mul_f32 v40, v40, v9
    v_mul_f32 v81, v81, v8
    v_mul_f32 v41, v41, v9
    v_mul_f32 v82, v82, v8
    v_mul_f32 v42, v42, v9
    v_mul_f32 v83, v83, v8
    v_mul_f32 v43, v43, v9
    v_mul_f32 v84, v84, v8
    v_mul_f32 v44, v44, v9
    v_mul_f32 v85, v85, v8
    v_mul_f32 v45, v45, v9
    v_mul_f32 v86, v86, v8
    v_mul_f32 v46, v46, v9
    v_mul_f32 v87, v87, v8
    v_mul_f32 v47, v47, v9
    v_mul_f32 v88, v88, v8
    v_mul_f32 v48, v48, v9
    v_mul_f32 v89, v89, v8
    v_mul_f32 v49, v49, v9
    v_mul_f32 v90, v90, v8
    v_mul_f32 v50, v50, v9
    v_mul_f32 v91, v91, v8
    v_mul_f32 v51, v51, v9
    v_cvt_pk_bf16_f32 v162, v72, v73
    v_cvt_pk_bf16_f32 v172, v32, v33
    v_cvt_pk_bf16_f32 v163, v74, v75
    v_cvt_pk_bf16_f32 v173, v34, v35
    v_cvt_pk_bf16_f32 v164, v76, v77
    v_cvt_pk_bf16_f32 v174, v36, v37
    v_cvt_pk_bf16_f32 v165, v78, v79
    v_cvt_pk_bf16_f32 v175, v38, v39
    v_cvt_pk_bf16_f32 v166, v80, v81
    v_cvt_pk_bf16_f32 v176, v40, v41
    v_cvt_pk_bf16_f32 v167, v82, v83
    v_cvt_pk_bf16_f32 v177, v42, v43
    v_cvt_pk_bf16_f32 v168, v84, v85
    v_cvt_pk_bf16_f32 v178, v44, v45
    v_cvt_pk_bf16_f32 v169, v86, v87
    v_cvt_pk_bf16_f32 v179, v46, v47
    v_cvt_pk_bf16_f32 v170, v88, v89
    v_cvt_pk_bf16_f32 v180, v48, v49
    v_cvt_pk_bf16_f32 v171, v90, v91
    v_cvt_pk_bf16_f32 v181, v50, v51
    v_cvt_pk_bf16_f32 v8, v92, v93
    v_lshlrev_b32 v92, 16, v8
    v_and_b32 v93, 0xffff0000, v8
    v_cvt_pk_bf16_f32 v8, v94, v95
    v_lshlrev_b32 v94, 16, v8
    v_and_b32 v95, 0xffff0000, v8
    v_cvt_pk_bf16_f32 v8, v96, v97
    v_lshlrev_b32 v96, 16, v8
    v_and_b32 v97, 0xffff0000, v8
    v_cvt_pk_bf16_f32 v8, v98, v99
    v_lshlrev_b32 v98, 16, v8
    v_and_b32 v99, 0xffff0000, v8
    v_cvt_pk_bf16_f32 v8, v100, v101
    v_lshlrev_b32 v100, 16, v8
    v_and_b32 v101, 0xffff0000, v8
    v_cvt_pk_bf16_f32 v8, v102, v103
    v_lshlrev_b32 v102, 16, v8
    v_and_b32 v103, 0xffff0000, v8
    v_cvt_pk_bf16_f32 v8, v104, v105
    v_lshlrev_b32 v104, 16, v8
    v_and_b32 v105, 0xffff0000, v8
    v_cvt_pk_bf16_f32 v8, v106, v107
    v_lshlrev_b32 v106, 16, v8
    v_and_b32 v107, 0xffff0000, v8
    v_cvt_pk_bf16_f32 v8, v108, v109
    v_lshlrev_b32 v108, 16, v8
    v_and_b32 v109, 0xffff0000, v8
    v_cvt_pk_bf16_f32 v8, v110, v111
    v_lshlrev_b32 v110, 16, v8
    v_and_b32 v111, 0xffff0000, v8
    v_max3_f32 v8, v92, v93, v94
    v_max3_f32 v8, v8, v95, v96
    v_max3_f32 v8, v8, v97, v98
    v_max3_f32 v8, v8, v99, v100
    v_max3_f32 v8, v8, v101, v102
    v_max3_f32 v8, v8, v103, v104
    v_max3_f32 v8, v8, v105, v106
    v_max3_f32 v8, v8, v107, v108
    v_max3_f32 v8, v8, v109, v110
    v_max_f32 v8, v8, v111
    v_min3_f32 v9, v92, v93, v94
    v_min3_f32 v9, v9, v95, v96
    v_min3_f32 v9, v9, v97, v98
    v_min3_f32 v9, v9, v99, v100
    v_min3_f32 v9, v9, v101, v102
    v_min3_f32 v9, v9, v103, v104
    v_min3_f32 v9, v9, v105, v106
    v_min3_f32 v9, v9, v107, v108
    v_min3_f32 v9, v9, v109, v110
    v_min_f32 v9, v9, v111
    v_mul_f32 v8, s24, v8
    v_mul_f32 v9, s24, v9
    v_fma_f32 v32, -v92, s24, v9
    v_fma_f32 v92, v92, s24, -v8
    v_fma_f32 v33, -v93, s24, v9
    v_fma_f32 v93, v93, s24, -v8
    v_fma_f32 v34, -v94, s24, v9
    v_fma_f32 v94, v94, s24, -v8
    v_fma_f32 v35, -v95, s24, v9
    v_fma_f32 v95, v95, s24, -v8
    v_fma_f32 v36, -v96, s24, v9
    v_fma_f32 v96, v96, s24, -v8
    v_fma_f32 v37, -v97, s24, v9
    v_fma_f32 v97, v97, s24, -v8
    v_fma_f32 v38, -v98, s24, v9
    v_fma_f32 v98, v98, s24, -v8
    v_fma_f32 v39, -v99, s24, v9
    v_fma_f32 v99, v99, s24, -v8
    v_fma_f32 v40, -v100, s24, v9
    v_fma_f32 v100, v100, s24, -v8
    v_fma_f32 v41, -v101, s24, v9
    v_fma_f32 v101, v101, s24, -v8
    v_fma_f32 v42, -v102, s24, v9
    v_fma_f32 v102, v102, s24, -v8
    v_fma_f32 v43, -v103, s24, v9
    v_fma_f32 v103, v103, s24, -v8
    v_fma_f32 v44, -v104, s24, v9
    v_fma_f32 v104, v104, s24, -v8
    v_fma_f32 v45, -v105, s24, v9
    v_fma_f32 v105, v105, s24, -v8
    v_fma_f32 v46, -v106, s24, v9
    v_fma_f32 v106, v106, s24, -v8
    v_fma_f32 v47, -v107, s24, v9
    v_fma_f32 v107, v107, s24, -v8
    v_fma_f32 v48, -v108, s24, v9
    v_fma_f32 v108, v108, s24, -v8
    v_fma_f32 v49, -v109, s24, v9
    v_fma_f32 v109, v109, s24, -v8
    v_fma_f32 v50, -v110, s24, v9
    v_fma_f32 v110, v110, s24, -v8
    v_fma_f32 v51, -v111, s24, v9
    v_fma_f32 v111, v111, s24, -v8
    v_exp_f32 v32, v32
    v_exp_f32 v92, v92
    v_exp_f32 v33, v33
    v_exp_f32 v93, v93
    v_exp_f32 v34, v34
    v_exp_f32 v94, v94
    v_exp_f32 v35, v35
    v_exp_f32 v95, v95
    v_exp_f32 v36, v36
    v_exp_f32 v96, v96
    v_exp_f32 v37, v37
    v_exp_f32 v97, v97
    v_exp_f32 v38, v38
    v_exp_f32 v98, v98
    v_exp_f32 v39, v39
    v_exp_f32 v99, v99
    v_exp_f32 v40, v40
    v_exp_f32 v100, v100
    v_exp_f32 v41, v41
    v_exp_f32 v101, v101
    v_exp_f32 v42, v42
    v_exp_f32 v102, v102
    v_exp_f32 v43, v43
    v_exp_f32 v103, v103
    v_exp_f32 v44, v44
    v_exp_f32 v104, v104
    v_exp_f32 v45, v45
    v_exp_f32 v105, v105
    v_exp_f32 v46, v46
    v_exp_f32 v106, v106
    v_exp_f32 v47, v47
    v_exp_f32 v107, v107
    v_exp_f32 v48, v48
    v_exp_f32 v108, v108
    v_exp_f32 v49, v49
    v_exp_f32 v109, v109
    v_exp_f32 v50, v50
    v_exp_f32 v110, v110
    v_exp_f32 v51, v51
    v_exp_f32 v111, v111
    v_add_f32 v9, v32, v33
    v_add_f32 v9, v9, v34
    v_add_f32 v9, v9, v35
    v_add_f32 v9, v9, v36
    v_add_f32 v9, v9, v37
    v_add_f32 v9, v9, v38
    v_add_f32 v9, v9, v39
    v_add_f32 v9, v9, v40
    v_add_f32 v9, v9, v41
    v_add_f32 v9, v9, v42
    v_add_f32 v9, v9, v43
    v_add_f32 v9, v9, v44
    v_add_f32 v9, v9, v45
    v_add_f32 v9, v9, v46
    v_add_f32 v9, v9, v47
    v_add_f32 v9, v9, v48
    v_add_f32 v9, v9, v49
    v_add_f32 v9, v9, v50
    v_add_f32 v9, v9, v51
    v_add_f32 v8, v92, v93
    v_add_f32 v8, v8, v94
    v_add_f32 v8, v8, v95
    v_add_f32 v8, v8, v96
    v_add_f32 v8, v8, v97
    v_add_f32 v8, v8, v98
    v_add_f32 v8, v8, v99
    v_add_f32 v8, v8, v100
    v_add_f32 v8, v8, v101
    v_add_f32 v8, v8, v102
    v_add_f32 v8, v8, v103
    v_add_f32 v8, v8, v104
    v_add_f32 v8, v8, v105
    v_add_f32 v8, v8, v106
    v_add_f32 v8, v8, v107
    v_add_f32 v8, v8, v108
    v_add_f32 v8, v8, v109
    v_add_f32 v8, v8, v110
    v_add_f32 v8, v8, v111
    v_rcp_f32 v8, v8
    v_rcp_f32 v9, v9
    s_nop 0
    v_mul_f32 v92, v92, v8
    v_mul_f32 v32, v32, v9
    v_mul_f32 v93, v93, v8
    v_mul_f32 v33, v33, v9
    v_mul_f32 v94, v94, v8
    v_mul_f32 v34, v34, v9
    v_mul_f32 v95, v95, v8
    v_mul_f32 v35, v35, v9
    v_mul_f32 v96, v96, v8
    v_mul_f32 v36, v36, v9
    v_mul_f32 v97, v97, v8
    v_mul_f32 v37, v37, v9
    v_mul_f32 v98, v98, v8
    v_mul_f32 v38, v38, v9
    v_mul_f32 v99, v99, v8
    v_mul_f32 v39, v39, v9
    v_mul_f32 v100, v100, v8
    v_mul_f32 v40, v40, v9
    v_mul_f32 v101, v101, v8
    v_mul_f32 v41, v41, v9
    v_mul_f32 v102, v102, v8
    v_mul_f32 v42, v42, v9
    v_mul_f32 v103, v103, v8
    v_mul_f32 v43, v43, v9
    v_mul_f32 v104, v104, v8
    v_mul_f32 v44, v44, v9
    v_mul_f32 v105, v105, v8
    v_mul_f32 v45, v45, v9
    v_mul_f32 v106, v106, v8
    v_mul_f32 v46, v46, v9
    v_mul_f32 v107, v107, v8
    v_mul_f32 v47, v47, v9
    v_mul_f32 v108, v108, v8
    v_mul_f32 v48, v48, v9
    v_mul_f32 v109, v109, v8
    v_mul_f32 v49, v49, v9
    v_mul_f32 v110, v110, v8
    v_mul_f32 v50, v50, v9
    v_mul_f32 v111, v111, v8
    v_mul_f32 v51, v51, v9
    v_cvt_pk_bf16_f32 v182, v92, v93
    v_cvt_pk_bf16_f32 v192, v32, v33
    v_cvt_pk_bf16_f32 v183, v94, v95
    v_cvt_pk_bf16_f32 v193, v34, v35
    v_cvt_pk_bf16_f32 v184, v96, v97
    v_cvt_pk_bf16_f32 v194, v36, v37
    v_cvt_pk_bf16_f32 v185, v98, v99
    v_cvt_pk_bf16_f32 v195, v38, v39
    v_cvt_pk_bf16_f32 v186, v100, v101
    v_cvt_pk_bf16_f32 v196, v40, v41
    v_cvt_pk_bf16_f32 v187, v102, v103
    v_cvt_pk_bf16_f32 v197, v42, v43
    v_cvt_pk_bf16_f32 v188, v104, v105
    v_cvt_pk_bf16_f32 v198, v44, v45
    v_cvt_pk_bf16_f32 v189, v106, v107
    v_cvt_pk_bf16_f32 v199, v46, v47
    v_cvt_pk_bf16_f32 v190, v108, v109
    v_cvt_pk_bf16_f32 v200, v48, v49
    v_cvt_pk_bf16_f32 v191, v110, v111
    v_cvt_pk_bf16_f32 v201, v50, v51
    v_accvgpr_write_b32 a200, v162
    v_accvgpr_write_b32 a201, v163
    v_accvgpr_write_b32 a202, v164
    v_accvgpr_write_b32 a203, v165
    v_accvgpr_write_b32 a204, v166
    v_accvgpr_write_b32 a205, v167
    v_accvgpr_write_b32 a206, v168
    v_accvgpr_write_b32 a207, v169
    v_accvgpr_write_b32 a208, v170
    v_accvgpr_write_b32 a209, v171
    v_accvgpr_write_b32 a210, v172
    v_accvgpr_write_b32 a211, v173
    v_accvgpr_write_b32 a212, v174
    v_accvgpr_write_b32 a213, v175
    v_accvgpr_write_b32 a214, v176
    v_accvgpr_write_b32 a215, v177
    v_accvgpr_write_b32 a216, v178
    v_accvgpr_write_b32 a217, v179
    v_accvgpr_write_b32 a218, v180
    v_accvgpr_write_b32 a219, v181
    v_accvgpr_write_b32 a220, v182
    v_accvgpr_write_b32 a221, v183
    v_accvgpr_write_b32 a222, v184
    v_accvgpr_write_b32 a223, v185
    v_accvgpr_write_b32 a224, v186
    v_accvgpr_write_b32 a225, v187
    v_accvgpr_write_b32 a226, v188
    v_accvgpr_write_b32 a227, v189
    v_accvgpr_write_b32 a228, v190
    v_accvgpr_write_b32 a229, v191
    v_accvgpr_write_b32 a230, v192
    v_accvgpr_write_b32 a231, v193
    v_accvgpr_write_b32 a232, v194
    v_accvgpr_write_b32 a233, v195
    v_accvgpr_write_b32 a234, v196
    v_accvgpr_write_b32 a235, v197
    v_accvgpr_write_b32 a236, v198
    v_accvgpr_write_b32 a237, v199
    v_accvgpr_write_b32 a238, v200
    v_accvgpr_write_b32 a239, v201
    s_barrier
    s_mul_i32 s24, s9, 448
    s_add_u32 s24, s24, 0
    v_add_u32 v8, s24, v31
    v_mul_u32_u24 v9, 0xcccd, v8
    v_lshrrev_b32 v9, 19, v9
    v_mul_u32_u24 v10, 10, v9
    v_sub_u32 v10, v8, v10
    v_lshlrev_b32 v10, 4, v10
    s_movk_i32 s25, 1280
    v_mad_u32_u24 v10, v9, s25, v10
    v_cmp_gt_u32 vcc, 1600, v8
    v_mov_b32 v9, 0x40000000
    v_cndmask_b32 v0, v9, v10, vcc
    s_mul_i32 s24, s9, 448
    s_add_u32 s24, s24, 64
    v_add_u32 v8, s24, v31
    v_mul_u32_u24 v9, 0xcccd, v8
    v_lshrrev_b32 v9, 19, v9
    v_mul_u32_u24 v10, 10, v9
    v_sub_u32 v10, v8, v10
    v_lshlrev_b32 v10, 4, v10
    s_movk_i32 s25, 1280
    v_mad_u32_u24 v10, v9, s25, v10
    v_cmp_gt_u32 vcc, 1600, v8
    v_mov_b32 v9, 0x40000000
    v_cndmask_b32 v1, v9, v10, vcc
    s_mul_i32 s24, s9, 448
    s_add_u32 s24, s24, 128
    v_add_u32 v8, s24, v31
    v_mul_u32_u24 v9, 0xcccd, v8
    v_lshrrev_b32 v9, 19, v9
    v_mul_u32_u24 v10, 10, v9
    v_sub_u32 v10, v8, v10
    v_lshlrev_b32 v10, 4, v10
    s_movk_i32 s25, 1280
    v_mad_u32_u24 v10, v9, s25, v10
    v_cmp_gt_u32 vcc, 1600, v8
    v_mov_b32 v9, 0x40000000
    v_cndmask_b32 v2, v9, v10, vcc
    s_mul_i32 s24, s9, 448
    s_add_u32 s24, s24, 192
    v_add_u32 v8, s24, v31
    v_mul_u32_u24 v9, 0xcccd, v8
    v_lshrrev_b32 v9, 19, v9
    v_mul_u32_u24 v10, 10, v9
    v_sub_u32 v10, v8, v10
    v_lshlrev_b32 v10, 4, v10
    s_movk_i32 s25, 1280
    v_mad_u32_u24 v10, v9, s25, v10
    v_cmp_gt_u32 vcc, 1600, v8
    v_mov_b32 v9, 0x40000000
    v_cndmask_b32 v3, v9, v10, vcc
    s_mul_i32 s24, s9, 448
    s_add_u32 s24, s24, 256
    v_add_u32 v8, s24, v31
    v_mul_u32_u24 v9, 0xcccd, v8
    v_lshrrev_b32 v9, 19, v9
    v_mul_u32_u24 v10, 10, v9
    v_sub_u32 v10, v8, v10
    v_lshlrev_b32 v10, 4, v10
    s_movk_i32 s25, 1280
    v_mad_u32_u24 v10, v9, s25, v10
    v_cmp_gt_u32 vcc, 1600, v8
    v_mov_b32 v9, 0x40000000
    v_cndmask_b32 v4, v9, v10, vcc
    s_mul_i32 s24, s9, 448
    s_add_u32 s24, s24, 320
    v_add_u32 v8, s24, v31
    v_mul_u32_u24 v9, 0xcccd, v8
    v_lshrrev_b32 v9, 19, v9
    v_mul_u32_u24 v10, 10, v9
    v_sub_u32 v10, v8, v10
    v_lshlrev_b32 v10, 4, v10
    s_movk_i32 s25, 1280
    v_mad_u32_u24 v10, v9, s25, v10
    v_cmp_gt_u32 vcc, 1600, v8
    v_mov_b32 v9, 0x40000000
    v_cndmask_b32 v5, v9, v10, vcc
    s_mul_i32 s24, s9, 448
    s_add_u32 s24, s24, 384
    v_add_u32 v8, s24, v31
    v_mul_u32_u24 v9, 0xcccd, v8
    v_lshrrev_b32 v9, 19, v9
    v_mul_u32_u24 v10, 10, v9
    v_sub_u32 v10, v8, v10
    v_lshlrev_b32 v10, 4, v10
    s_movk_i32 s25, 1280
    v_mad_u32_u24 v10, v9, s25, v10
    v_cmp_gt_u32 vcc, 1600, v8
    v_mov_b32 v9, 0x40000000
    v_cndmask_b32 v6, v9, v10, vcc
    s_mov_b32 s20, s54
    s_mov_b32 s21, s55
    s_mov_b32 s22, 0xc8000
    s_mov_b32 s23, 0x20000
    s_add_u32 s28, s33, 0
    s_mul_i32 s24, s9, 7168
    s_add_u32 m0, s24, 0
    s_nop 0
    buffer_load_dwordx4 v0, s[20:23], s28 offen lds
    s_add_u32 m0, s24, 1024
    s_nop 0
    buffer_load_dwordx4 v1, s[20:23], s28 offen lds
    s_add_u32 m0, s24, 2048
    s_nop 0
    buffer_load_dwordx4 v2, s[20:23], s28 offen lds
    s_add_u32 m0, s24, 3072
    s_nop 0
    buffer_load_dwordx4 v3, s[20:23], s28 offen lds
    s_add_u32 m0, s24, 4096
    s_nop 0
    buffer_load_dwordx4 v4, s[20:23], s28 offen lds
    s_add_u32 m0, s24, 5120
    s_nop 0
    buffer_load_dwordx4 v5, s[20:23], s28 offen lds
    s_add_u32 m0, s24, 6144
    s_nop 0
    buffer_load_dwordx4 v6, s[20:23], s28 offen lds
    s_add_u32 s28, s33, 204800
    s_mul_i32 s24, s9, 7168
    s_add_u32 m0, s24, 28672
    s_nop 0
    buffer_load_dwordx4 v0, s[20:23], s28 offen lds
    s_add_u32 m0, s24, 29696
    s_nop 0
    buffer_load_dwordx4 v1, s[20:23], s28 offen lds
    s_add_u32 m0, s24, 30720
    s_nop 0
    buffer_load_dwordx4 v2, s[20:23], s28 offen lds
    s_add_u32 m0, s24, 31744
    s_nop 0
    buffer_load_dwordx4 v3, s[20:23], s28 offen lds
    s_add_u32 m0, s24, 32768
    s_nop 0
    buffer_load_dwordx4 v4, s[20:23], s28 offen lds
    s_add_u32 m0, s24, 33792
    s_nop 0
    buffer_load_dwordx4 v5, s[20:23], s28 offen lds
    s_add_u32 m0, s24, 34816
    s_nop 0
    buffer_load_dwordx4 v6, s[20:23], s28 offen lds
    s_add_u32 s28, s33, 409600
    s_mul_i32 s24, s9, 7168
    s_add_u32 m0, s24, 57344
    s_nop 0
    buffer_load_dwordx4 v0, s[20:23], s28 offen lds
    s_add_u32 m0, s24, 58368
    s_nop 0
    buffer_load_dwordx4 v1, s[20:23], s28 offen lds
    s_add_u32 m0, s24, 59392
    s_nop 0
    buffer_load_dwordx4 v2, s[20:23], s28 offen lds
    s_add_u32 m0, s24, 60416
    s_nop 0
    buffer_load_dwordx4 v3, s[20:23], s28 offen lds
    s_add_u32 m0, s24, 61440
    s_nop 0
    buffer_load_dwordx4 v4, s[20:23], s28 offen lds
    s_add_u32 m0, s24, 62464
    s_nop 0
    buffer_load_dwordx4 v5, s[20:23], s28 offen lds
    s_add_u32 m0, s24, 63488
    s_nop 0
    buffer_load_dwordx4 v6, s[20:23], s28 offen lds
    s_add_u32 s28, s33, 614400
    s_mul_i32 s24, s9, 7168
    s_add_u32 m0, s24, 86016
    s_nop 0
    buffer_load_dwordx4 v0, s[20:23], s28 offen lds
    s_add_u32 m0, s24, 87040
    s_nop 0
    buffer_load_dwordx4 v1, s[20:23], s28 offen lds
    s_add_u32 m0, s24, 88064
    s_nop 0
    buffer_load_dwordx4 v2, s[20:23], s28 offen lds
    s_add_u32 m0, s24, 89088
    s_nop 0
    buffer_load_dwordx4 v3, s[20:23], s28 offen lds
    s_add_u32 m0, s24, 90112
    s_nop 0
    buffer_load_dwordx4 v4, s[20:23], s28 offen lds
    s_add_u32 m0, s24, 91136
    s_nop 0
    buffer_load_dwordx4 v5, s[20:23], s28 offen lds
    s_add_u32 m0, s24, 92160
    s_nop 0
    buffer_load_dwordx4 v6, s[20:23], s28 offen lds
    v_mov_b32 v17, 64
    s_mov_b32 s26, 200000
wa_23:
    buffer_load_dword v16, v17, s[12:15], 0 offen sc1
    s_waitcnt vmcnt(0)
    v_readfirstlane_b32 s24, v16
    s_sub_u32 s26, s26, 1
    s_cbranch_scc1 L_fail2
    s_cmp_lt_u32 s24, 256
    s_cbranch_scc1 wa_23
    s_cmp_ge_u32 s30, 32
    s_cbranch_scc1 L_anored
    v_lshrrev_b32 v10, 2, v31
    v_lshlrev_b32 v10, 2, v10
    s_lshr_b32 s24, s30, 3
    v_add_u32 v10, s24, v10
    v_mov_b32 v11, v27
    v_mul_u32_u24 v12, 0x5556, v10
    v_lshrrev_b32 v12, 18, v12
    v_mul_u32_u24 v13, 12, v12
    v_sub_u32 v13, v10, v13
    v_lshlrev_b32 v12, 9, v12
    v_lshl_add_u32 v12, v13, 4, v12
    v_lshl_add_u32 v12, v11, 2, v12
    v_add_u32 v12, 3162432, v12
    s_mov_b32 s26, 400000
aw_24:
    buffer_load_dword v13, v12, s[16:19], 0 offen sc1
    s_waitcnt vmcnt(0)
    v_cmp_gt_u32 vcc, 1, v13
    s_cbranch_vccz ad_25
    s_sub_u32 s26, s26, 1
    s_cbranch_scc1 L_fail2
    s_sleep 24
    s_branch aw_24
ad_25:
    s_mul_i32 s24, s30, 6144
    s_lshl_b32 s25, s9, 2
    s_add_u32 s24, s24, s25
    s_add_u32 s24, s24, 100663296
    v_mov_b32 v8, v26
    v_add_u32 v9, 4096, v8
    buffer_load_dword v72, v8, s[16:19], s24 offen offset:0 sc1
    buffer_load_dword v73, v8, s[16:19], s24 offen offset:1024 sc1
    buffer_load_dword v74, v8, s[16:19], s24 offen offset:2048 sc1
    buffer_load_dword v75, v8, s[16:19], s24 offen offset:3072 sc1
    buffer_load_dword v76, v9, s[16:19], s24 offen offset:0 sc1
    buffer_load_dword v77, v9, s[16:19], s24 offen offset:1024 sc1
    s_add_u32 s24, s24, 196608
    buffer_load_dword v78, v8, s[16:19], s24 offen offset:0 sc1
    buffer_load_dword v79, v8, s[16:19], s24 offen offset:1024 sc1
    buffer_load_dword v80, v8, s[16:19], s24 offen offset:2048 sc1
    buffer_load_dword v81, v8, s[16:19], s24 offen offset:3072 sc1
    buffer_load_dword v82, v9, s[16:19], s24 offen offset:0 sc1
    buffer_load_dword v83, v9, s[16:19], s24 offen offset:1024 sc1
    s_add_u32 s24, s24, 196608
    buffer_load_dword v84, v8, s[16:19], s24 offen offset:0 sc1
    buffer_load_dword v85, v8, s[16:19], s24 offen offset:1024 sc1
    buffer_load_dword v86, v8, s[16:19], s24 offen offset:2048 sc1
    buffer_load_dword v87, v8, s[16:19], s24 offen offset:3072 sc1
    buffer_load_dword v88, v9, s[16:19], s24 offen offset:0 sc1
    buffer_load_dword v89, v9, s[16:19], s24 offen offset:1024 sc1
    s_add_u32 s24, s24, 196608
    buffer_load_dword v90, v8, s[16:19], s24 offen offset:0 sc1
    buffer_load_dword v91, v8, s[16:19], s24 offen offset:1024 sc1
    buffer_load_dword v92, v8, s[16:19], s24 offen offset:2048 sc1
    buffer_load_dword v93, v8, s[16:19], s24 offen offset:3072 sc1
    buffer_load_dword v94, v9, s[16:19], s24 offen offset:0 sc1
    buffer_load_dword v95, v9, s[16:19], s24 offen offset:1024 sc1
    s_add_u32 s24, s24, 196608
    buffer_load_dword v96, v8, s[16:19], s24 offen offset:0 sc1
    buffer_load_dword v97, v8, s[16:19], s24 offen offset:1024 sc1
    buffer_load_dword v98, v8, s[16:19], s24 offen offset:2048 sc1
    buffer_load_dword v99, v8, s[16:19], s24 offen offset:3072 sc1
    buffer_load_dword v100, v9, s[16:19], s24 offen offset:0 sc1
    buffer_load_dword v101, v9, s[16:19], s24 offen offset:1024 sc1
    s_add_u32 s24, s24, 196608
    buffer_load_dword v102, v8, s[16:19], s24 offen offset:0 sc1
    buffer_load_dword v103, v8, s[16:19], s24 offen offset:1024 sc1
    buffer_load_dword v104, v8, s[16:19], s24 offen offset:2048 sc1
    buffer_load_dword v105, v8, s[16:19], s24 offen offset:3072 sc1
    buffer_load_dword v106, v9, s[16:19], s24 offen offset:0 sc1
    buffer_load_dword v107, v9, s[16:19], s24 offen offset:1024 sc1
    s_add_u32 s24, s24, 196608
    buffer_load_dword v108, v8, s[16:19], s24 offen offset:0 sc1
    buffer_load_dword v109, v8, s[16:19], s24 offen offset:1024 sc1
    buffer_load_dword v110, v8, s[16:19], s24 offen offset:2048 sc1
    buffer_load_dword v111, v8, s[16:19], s24 offen offset:3072 sc1
    buffer_load_dword v112, v9, s[16:19], s24 offen offset:0 sc1
    buffer_load_dword v113, v9, s[16:19], s24 offen offset:1024 sc1
    s_add_u32 s24, s24, 196608
    buffer_load_dword v114, v8, s[16:19], s24 offen offset:0 sc1
    buffer_load_dword v115, v8, s[16:19], s24 offen offset:1024 sc1
    buffer_load_dword v116, v8, s[16:19], s24 offen offset:2048 sc1
    buffer_load_dword v117, v8, s[16:19], s24 offen offset:3072 sc1
    buffer_load_dword v118, v9, s[16:19], s24 offen offset:0 sc1
    buffer_load_dword v119, v9, s[16:19], s24 offen offset:1024 sc1
    s_add_u32 s24, s24, 196608
    s_waitcnt vmcnt(0)
    v_mov_b32 v32, v72
    v_add_f32 v32, v32, v78
    v_add_f32 v32, v32, v84
    v_add_f32 v32, v32, v90
    v_add_f32 v32, v32, v96
    v_add_f32 v32, v32, v102
    v_add_f32 v32, v32, v108
    v_add_f32 v32, v32, v114
    v_mov_b32 v33, v73
    v_add_f32 v33, v33, v79
    v_add_f32 v33, v33, v85
    v_add_f32 v33, v33, v91
    v_add_f32 v33, v33, v97
    v_add_f32 v33, v33, v103
    v_add_f32 v33, v33, v109
    v_add_f32 v33, v33, v115
    v_mov_b32 v34, v74
    v_add_f32 v34, v34, v80
    v_add_f32 v34, v34, v86
    v_add_f32 v34, v34, v92
    v_add_f32 v34, v34, v98
    v_add_f32 v34, v34, v104
    v_add_f32 v34, v34, v110
    v_add_f32 v34, v34, v116
    v_mov_b32 v35, v75
    v_add_f32 v35, v35, v81
    v_add_f32 v35, v35, v87
    v_add_f32 v35, v35, v93
    v_add_f32 v35, v35, v99
    v_add_f32 v35, v35, v105
    v_add_f32 v35, v35, v111
    v_add_f32 v35, v35, v117
    v_mov_b32 v36, v76
    v_add_f32 v36, v36, v82
    v_add_f32 v36, v36, v88
    v_add_f32 v36, v36, v94
    v_add_f32 v36, v36, v100
    v_add_f32 v36, v36, v106
    v_add_f32 v36, v36, v112
    v_add_f32 v36, v36, v118
    v_mov_b32 v37, v77
    v_add_f32 v37, v37, v83
    v_add_f32 v37, v37, v89
    v_add_f32 v37, v37, v95
    v_add_f32 v37, v37, v101
    v_add_f32 v37, v37, v107
    v_add_f32 v37, v37, v113
    v_add_f32 v37, v37, v119
    buffer_load_dword v72, v8, s[16:19], s24 offen offset:0 sc1
    buffer_load_dword v73, v8, s[16:19], s24 offen offset:1024 sc1
    buffer_load_dword v74, v8, s[16:19], s24 offen offset:2048 sc1
    buffer_load_dword v75, v8, s[16:19], s24 offen offset:3072 sc1
    buffer_load_dword v76, v9, s[16:19], s24 offen offset:0 sc1
    buffer_load_dword v77, v9, s[16:19], s24 offen offset:1024 sc1
    s_add_u32 s24, s24, 196608
    buffer_load_dword v78, v8, s[16:19], s24 offen offset:0 sc1
    buffer_load_dword v79, v8, s[16:19], s24 offen offset:1024 sc1
    buffer_load_dword v80, v8, s[16:19], s24 offen offset:2048 sc1
    buffer_load_dword v81, v8, s[16:19], s24 offen offset:3072 sc1
    buffer_load_dword v82, v9, s[16:19], s24 offen offset:0 sc1
    buffer_load_dword v83, v9, s[16:19], s24 offen offset:1024 sc1
    s_add_u32 s24, s24, 196608
    buffer_load_dword v84, v8, s[16:19], s24 offen offset:0 sc1
    buffer_load_dword v85, v8, s[16:19], s24 offen offset:1024 sc1
    buffer_load_dword v86, v8, s[16:19], s24 offen offset:2048 sc1
    buffer_load_dword v87, v8, s[16:19], s24 offen offset:3072 sc1
    buffer_load_dword v88, v9, s[16:19], s24 offen offset:0 sc1
    buffer_load_dword v89, v9, s[16:19], s24 offen offset:1024 sc1
    s_add_u32 s24, s24, 196608
    buffer_load_dword v90, v8, s[16:19], s24 offen offset:0 sc1
    buffer_load_dword v91, v8, s[16:19], s24 offen offset:1024 sc1
    buffer_load_dword v92, v8, s[16:19], s24 offen offset:2048 sc1
    buffer_load_dword v93, v8, s[16:19], s24 offen offset:3072 sc1
    buffer_load_dword v94, v9, s[16:19], s24 offen offset:0 sc1
    buffer_load_dword v95, v9, s[16:19], s24 offen offset:1024 sc1
    s_add_u32 s24, s24, 196608
    buffer_load_dword v96, v8, s[16:19], s24 offen offset:0 sc1
    buffer_load_dword v97, v8, s[16:19], s24 offen offset:1024 sc1
    buffer_load_dword v98, v8, s[16:19], s24 offen offset:2048 sc1
    buffer_load_dword v99, v8, s[16:19], s24 offen offset:3072 sc1
    buffer_load_dword v100, v9, s[16:19], s24 offen offset:0 sc1
    buffer_load_dword v101, v9, s[16:19], s24 offen offset:1024 sc1
    s_add_u32 s24, s24, 196608
    buffer_load_dword v102, v8, s[16:19], s24 offen offset:0 sc1
    buffer_load_dword v103, v8, s[16:19], s24 offen offset:1024 sc1
    buffer_load_dword v104, v8, s[16:19], s24 offen offset:2048 sc1
    buffer_load_dword v105, v8, s[16:19], s24 offen offset:3072 sc1
    buffer_load_dword v106, v9, s[16:19], s24 offen offset:0 sc1
    buffer_load_dword v107, v9, s[16:19], s24 offen offset:1024 sc1
    s_add_u32 s24, s24, 196608
    buffer_load_dword v108, v8, s[16:19], s24 offen offset:0 sc1
    buffer_load_dword v109, v8, s[16:19], s24 offen offset:1024 sc1
    buffer_load_dword v110, v8, s[16:19], s24 offen offset:2048 sc1
    buffer_load_dword v111, v8, s[16:19], s24 offen offset:3072 sc1
    buffer_load_dword v112, v9, s[16:19], s24 offen offset:0 sc1
    buffer_load_dword v113, v9, s[16:19], s24 offen offset:1024 sc1
    s_add_u32 s24, s24, 196608
    buffer_load_dword v114, v8, s[16:19], s24 offen offset:0 sc1
    buffer_load_dword v115, v8, s[16:19], s24 offen offset:1024 sc1
    buffer_load_dword v116, v8, s[16:19], s24 offen offset:2048 sc1
    buffer_load_dword v117, v8, s[16:19], s24 offen offset:3072 sc1
    buffer_load_dword v118, v9, s[16:19], s24 offen offset:0 sc1
    buffer_load_dword v119, v9, s[16:19], s24 offen offset:1024 sc1
    s_add_u32 s24, s24, 196608
    s_waitcnt vmcnt(0)
    v_add_f32 v32, v32, v72
    v_add_f32 v32, v32, v78
    v_add_f32 v32, v32, v84
    v_add_f32 v32, v32, v90
    v_add_f32 v32, v32, v96
    v_add_f32 v32, v32, v102
    v_add_f32 v32, v32, v108
    v_add_f32 v32, v32, v114
    v_add_f32 v33, v33, v73
    v_add_f32 v33, v33, v79
    v_add_f32 v33, v33, v85
    v_add_f32 v33, v33, v91
    v_add_f32 v33, v33, v97
    v_add_f32 v33, v33, v103
    v_add_f32 v33, v33, v109
    v_add_f32 v33, v33, v115
    v_add_f32 v34, v34, v74
    v_add_f32 v34, v34, v80
    v_add_f32 v34, v34, v86
    v_add_f32 v34, v34, v92
    v_add_f32 v34, v34, v98
    v_add_f32 v34, v34, v104
    v_add_f32 v34, v34, v110
    v_add_f32 v34, v34, v116
    v_add_f32 v35, v35, v75
    v_add_f32 v35, v35, v81
    v_add_f32 v35, v35, v87
    v_add_f32 v35, v35, v93
    v_add_f32 v35, v35, v99
    v_add_f32 v35, v35, v105
    v_add_f32 v35, v35, v111
    v_add_f32 v35, v35, v117
    v_add_f32 v36, v36, v76
    v_add_f32 v36, v36, v82
    v_add_f32 v36, v36, v88
    v_add_f32 v36, v36, v94
    v_add_f32 v36, v36, v100
    v_add_f32 v36, v36, v106
    v_add_f32 v36, v36, v112
    v_add_f32 v36, v36, v118
    v_add_f32 v37, v37, v77
    v_add_f32 v37, v37, v83
    v_add_f32 v37, v37, v89
    v_add_f32 v37, v37, v95
    v_add_f32 v37, v37, v101
    v_add_f32 v37, v37, v107
    v_add_f32 v37, v37, v113
    v_add_f32 v37, v37, v119
    s_and_b32 s24, s30, 3
    v_lshlrev_b32 v8, 2, v29
    v_add_u32 v8, s9, v8
    v_mul_u32_u24 v8, 48, v8
    v_lshl_add_u32 v9, v30, 1, v8
    v_lshl_add_u32 v10, v27, 1, v8
    v_add_u32 v10, 32, v10
    v_add_u32 v11, 40, v8
    v_mov_b32 v12, 0x40000000
    v_cmp_eq_u32 vcc, s24, v28
    s_lshl_b32 s25, s24, 2
    s_add_u32 s25, s25, 4
    s_and_b32 s25, s25, 15
    v_cndmask_b32 v10, v12, v10, vcc
    v_cmp_eq_u32 vcc, s25, v30
    s_mul_i32 s24, s30, 1920
    s_add_u32 s24, s24, 104857600
    v_cndmask_b32 v10, v10, v11, vcc
    v_cvt_pk_bf16_f32 v32, v32, v32
    buffer_store_short v32, v9, s[16:19], s24 offen offset:0 sc1
    v_cvt_pk_bf16_f32 v33, v33, v33
    buffer_store_short v33, v10, s[16:19], s24 offen offset:0 sc1
    v_cvt_pk_bf16_f32 v34, v34, v34
    buffer_store_short v34, v9, s[16:19], s24 offen offset:768 sc1
    v_cvt_pk_bf16_f32 v35, v35, v35
    buffer_store_short v35, v10, s[16:19], s24 offen offset:768 sc1
    v_cvt_pk_bf16_f32 v36, v36, v36
    s_mov_b64 exec, 0xffffffff
    buffer_store_short v36, v9, s[16:19], s24 offen offset:1536 sc1
    v_cvt_pk_bf16_f32 v37, v37, v37
    buffer_store_short v37, v10, s[16:19], s24 offen offset:1536 sc1
    s_mov_b64 exec, -1
    v_mov_b32 v8, 2
    s_waitcnt vmcnt(0)
    s_mov_b64 exec, 1
    buffer_store_dword v8, v25, s[16:19], s11 offen sc1
    s_mov_b64 exec, -1
L_anored:
    v_lshrrev_b32 v10, 2, v31
    v_and_b32 v10, 7, v10
    s_lshl_b32 s24, s32, 3
    v_add_u32 v10, s24, v10
    v_mov_b32 v11, v27
    v_mul_u32_u24 v12, 0x5556, v10
    v_lshrrev_b32 v12, 18, v12
    v_mul_u32_u24 v13, 12, v12
    v_sub_u32 v13, v10, v13
    v_lshlrev_b32 v12, 9, v12
    v_lshl_add_u32 v12, v13, 4, v12
    v_lshl_add_u32 v12, v11, 2, v12
    v_add_u32 v12, 3162432, v12
    s_mov_b32 s26, 400000
aw_26:
    buffer_load_dword v13, v12, s[16:19], 0 offen sc1
    s_waitcnt vmcnt(0)
    v_cmp_gt_u32 vcc, 2, v13
    s_cbranch_vccz ad_27
    s_sub_u32 s26, s26, 1
    s_cbranch_scc1 L_fail2
    s_sleep 24
    s_branch aw_26
ad_27:
    s_mul_i32 s24, s32, 15360
    s_lshl_b32 s25, s9, 12
    s_add_u32 s24, s24, s25
    s_add_u32 s24, s24, 104857600
    s_add_u32 m0, s25, 114688
    s_nop 0
    buffer_load_dwordx4 v26, s[16:19], s24 offen offset:0 sc1 lds
    buffer_load_dwordx4 v26, s[16:19], s24 offen offset:1024 sc1 lds
    buffer_load_dwordx4 v26, s[16:19], s24 offen offset:2048 sc1 lds
    buffer_load_dwordx4 v26, s[16:19], s24 offen offset:3072 sc1 lds
    s_waitcnt vmcnt(0)
    s_barrier
    v_add_u32 v21, 0, v20
    v_cndmask_b32 v21, v20, v21, s[40:41]
    ds_read_b64_tr_b16 v[84:85], v21 offset:0
    ds_read_b64_tr_b16 v[86:87], v21 offset:192
    ds_read_b64_tr_b16 v[88:89], v21 offset:384
    ds_read_b64_tr_b16 v[90:91], v21 offset:576
    ds_read_b64_tr_b16 v[92:93], v21 offset:768
    ds_read_b64_tr_b16 v[94:95], v21 offset:960
    ds_read_b64_tr_b16 v[96:97], v21 offset:1152
    ds_read_b64_tr_b16 v[98:99], v21 offset:1344
    ds_read_b64_tr_b16 v[100:101], v21 offset:1536
    ds_read_b64_tr_b16 v[102:103], v21 offset:1728
    s_waitcnt lgkmcnt(0)
    v_mfma_f32_16x16x32_bf16 v[32:35], v[84:87], a[160:163], 0
    v_mfma_f32_16x16x32_bf16 v[56:59], v[84:87], a[180:183], 0
    v_mfma_f32_16x16x32_bf16 v[32:35], v[88:91], a[164:167], v[32:35]
    v_mfma_f32_16x16x32_bf16 v[56:59], v[88:91], a[184:187], v[56:59]
    v_mfma_f32_16x16x32_bf16 v[32:35], v[92:95], a[168:171], v[32:35]
    v_mfma_f32_16x16x32_bf16 v[56:59], v[92:95], a[188:191], v[56:59]
    v_mfma_f32_16x16x32_bf16 v[32:35], v[96:99], a[172:175], v[32:35]
    v_mfma_f32_16x16x32_bf16 v[56:59], v[96:99], a[192:195], v[56:59]
    v_mfma_f32_16x16x32_bf16 v[32:35], v[100:103], a[176:179], v[32:35]
    v_mfma_f32_16x16x32_bf16 v[56:59], v[100:103], a[196:199], v[56:59]
    ds_read_b64_tr_b16 v[84:85], v21 offset:8
    ds_read_b64_tr_b16 v[86:87], v21 offset:200
    ds_read_b64_tr_b16 v[88:89], v21 offset:392
    ds_read_b64_tr_b16 v[90:91], v21 offset:584
    ds_read_b64_tr_b16 v[92:93], v21 offset:776
    ds_read_b64_tr_b16 v[94:95], v21 offset:968
    ds_read_b64_tr_b16 v[96:97], v21 offset:1160
    ds_read_b64_tr_b16 v[98:99], v21 offset:1352
    ds_read_b64_tr_b16 v[100:101], v21 offset:1544
    ds_read_b64_tr_b16 v[102:103], v21 offset:1736
    s_waitcnt lgkmcnt(0)
    v_mfma_f32_16x16x32_bf16 v[36:39], v[84:87], a[160:163], 0
    v_mfma_f32_16x16x32_bf16 v[60:63], v[84:87], a[180:183], 0
    v_mfma_f32_16x16x32_bf16 v[36:39], v[88:91], a[164:167], v[36:39]
    v_mfma_f32_16x16x32_bf16 v[60:63], v[88:91], a[184:187], v[60:63]
    v_mfma_f32_16x16x32_bf16 v[36:39], v[92:95], a[168:171], v[36:39]
    v_mfma_f32_16x16x32_bf16 v[60:63], v[92:95], a[188:191], v[60:63]
    v_mfma_f32_16x16x32_bf16 v[36:39], v[96:99], a[172:175], v[36:39]
    v_mfma_f32_16x16x32_bf16 v[60:63], v[96:99], a[192:195], v[60:63]
    v_mfma_f32_16x16x32_bf16 v[36:39], v[100:103], a[176:179], v[36:39]
    v_mfma_f32_16x16x32_bf16 v[60:63], v[100:103], a[196:199], v[60:63]
    ds_read_b64_tr_b16 v[84:85], v21 offset:16
    ds_read_b64_tr_b16 v[86:87], v21 offset:208
    ds_read_b64_tr_b16 v[88:89], v21 offset:400
    ds_read_b64_tr_b16 v[90:91], v21 offset:592
    ds_read_b64_tr_b16 v[92:93], v21 offset:784
    ds_read_b64_tr_b16 v[94:95], v21 offset:976
    ds_read_b64_tr_b16 v[96:97], v21 offset:1168
    ds_read_b64_tr_b16 v[98:99], v21 offset:1360
    ds_read_b64_tr_b16 v[100:101], v21 offset:1552
    ds_read_b64_tr_b16 v[102:103], v21 offset:1744
    s_waitcnt lgkmcnt(0)
    v_mfma_f32_16x16x32_bf16 v[40:43], v[84:87], a[160:163], 0
    v_mfma_f32_16x16x32_bf16 v[64:67], v[84:87], a[180:183], 0
    v_mfma_f32_16x16x32_bf16 v[40:43], v[88:91], a[164:167], v[40:43]
    v_mfma_f32_16x16x32_bf16 v[64:67], v[88:91], a[184:187], v[64:67]
    v_mfma_f32_16x16x32_bf16 v[40:43], v[92:95], a[168:171], v[40:43]
    v_mfma_f32_16x16x32_bf16 v[64:67], v[92:95], a[188:191], v[64:67]
    v_mfma_f32_16x16x32_bf16 v[40:43], v[96:99], a[172:175], v[40:43]
    v_mfma_f32_16x16x32_bf16 v[64:67], v[96:99], a[192:195], v[64:67]
    v_mfma_f32_16x16x32_bf16 v[40:43], v[100:103], a[176:179], v[40:43]
    v_mfma_f32_16x16x32_bf16 v[64:67], v[100:103], a[196:199], v[64:67]
    ds_read_b64_tr_b16 v[84:85], v21 offset:24
    ds_read_b64_tr_b16 v[86:87], v21 offset:216
    ds_read_b64_tr_b16 v[88:89], v21 offset:408
    ds_read_b64_tr_b16 v[90:91], v21 offset:600
    ds_read_b64_tr_b16 v[92:93], v21 offset:792
    ds_read_b64_tr_b16 v[94:95], v21 offset:984
    ds_read_b64_tr_b16 v[96:97], v21 offset:1176
    ds_read_b64_tr_b16 v[98:99], v21 offset:1368
    ds_read_b64_tr_b16 v[100:101], v21 offset:1560
    ds_read_b64_tr_b16 v[102:103], v21 offset:1752
    s_waitcnt lgkmcnt(0)
    v_mfma_f32_16x16x32_bf16 v[44:47], v[84:87], a[160:163], 0
    v_mfma_f32_16x16x32_bf16 v[68:71], v[84:87], a[180:183], 0
    v_mfma_f32_16x16x32_bf16 v[44:47], v[88:91], a[164:167], v[44:47]
    v_mfma_f32_16x16x32_bf16 v[68:71], v[88:91], a[184:187], v[68:71]
    v_mfma_f32_16x16x32_bf16 v[44:47], v[92:95], a[168:171], v[44:47]
    v_mfma_f32_16x16x32_bf16 v[68:71], v[92:95], a[188:191], v[68:71]
    v_mfma_f32_16x16x32_bf16 v[44:47], v[96:99], a[172:175], v[44:47]
    v_mfma_f32_16x16x32_bf16 v[68:71], v[96:99], a[192:195], v[68:71]
    v_mfma_f32_16x16x32_bf16 v[44:47], v[100:103], a[176:179], v[44:47]
    v_mfma_f32_16x16x32_bf16 v[68:71], v[100:103], a[196:199], v[68:71]
    ds_read_b64_tr_b16 v[84:85], v21 offset:32
    ds_read_b64_tr_b16 v[86:87], v21 offset:224
    ds_read_b64_tr_b16 v[88:89], v21 offset:416
    ds_read_b64_tr_b16 v[90:91], v21 offset:608
    ds_read_b64_tr_b16 v[92:93], v21 offset:800
    ds_read_b64_tr_b16 v[94:95], v21 offset:992
    ds_read_b64_tr_b16 v[96:97], v21 offset:1184
    ds_read_b64_tr_b16 v[98:99], v21 offset:1376
    ds_read_b64_tr_b16 v[100:101], v21 offset:1568
    ds_read_b64_tr_b16 v[102:103], v21 offset:1760
    s_waitcnt lgkmcnt(0)
    v_mfma_f32_16x16x32_bf16 v[48:51], v[84:87], a[160:163], 0
    v_mfma_f32_16x16x32_bf16 v[72:75], v[84:87], a[180:183], 0
    v_mfma_f32_16x16x32_bf16 v[48:51], v[88:91], a[164:167], v[48:51]
    v_mfma_f32_16x16x32_bf16 v[72:75], v[88:91], a[184:187], v[72:75]
    v_mfma_f32_16x16x32_bf16 v[48:51], v[92:95], a[168:171], v[48:51]
    v_mfma_f32_16x16x32_bf16 v[72:75], v[92:95], a[188:191], v[72:75]
    v_mfma_f32_16x16x32_bf16 v[48:51], v[96:99], a[172:175], v[48:51]
    v_mfma_f32_16x16x32_bf16 v[72:75], v[96:99], a[192:195], v[72:75]
    v_mfma_f32_16x16x32_bf16 v[48:51], v[100:103], a[176:179], v[48:51]
    v_mfma_f32_16x16x32_bf16 v[72:75], v[100:103], a[196:199], v[72:75]
    ds_read_b64_tr_b16 v[84:85], v21 offset:40
    ds_read_b64_tr_b16 v[86:87], v21 offset:232
    ds_read_b64_tr_b16 v[88:89], v21 offset:424
    ds_read_b64_tr_b16 v[90:91], v21 offset:616
    ds_read_b64_tr_b16 v[92:93], v21 offset:808
    ds_read_b64_tr_b16 v[94:95], v21 offset:1000
    ds_read_b64_tr_b16 v[96:97], v21 offset:1192
    ds_read_b64_tr_b16 v[98:99], v21 offset:1384
    ds_read_b64_tr_b16 v[100:101], v21 offset:1576
    ds_read_b64_tr_b16 v[102:103], v21 offset:1768
    s_waitcnt lgkmcnt(0)
    v_mfma_f32_16x16x32_bf16 v[52:55], v[84:87], a[160:163], 0
    v_mfma_f32_16x16x32_bf16 v[76:79], v[84:87], a[180:183], 0
    v_mfma_f32_16x16x32_bf16 v[52:55], v[88:91], a[164:167], v[52:55]
    v_mfma_f32_16x16x32_bf16 v[76:79], v[88:91], a[184:187], v[76:79]
    v_mfma_f32_16x16x32_bf16 v[52:55], v[92:95], a[168:171], v[52:55]
    v_mfma_f32_16x16x32_bf16 v[76:79], v[92:95], a[188:191], v[76:79]
    v_mfma_f32_16x16x32_bf16 v[52:55], v[96:99], a[172:175], v[52:55]
    v_mfma_f32_16x16x32_bf16 v[76:79], v[96:99], a[192:195], v[76:79]
    v_mfma_f32_16x16x32_bf16 v[52:55], v[100:103], a[176:179], v[52:55]
    v_mfma_f32_16x16x32_bf16 v[76:79], v[100:103], a[196:199], v[76:79]
    s_nop 7
    v_add_f32 v8, 0x358637bd, v52
    v_rcp_f32 v8, v8
    s_nop 0
    v_mul_f32 v32, v32, v8
    v_mul_f32 v33, v33, v8
    v_mul_f32 v34, v34, v8
    v_mul_f32 v35, v35, v8
    v_mul_f32 v36, v36, v8
    v_mul_f32 v37, v37, v8
    v_mul_f32 v38, v38, v8
    v_mul_f32 v39, v39, v8
    v_mul_f32 v40, v40, v8
    v_mul_f32 v41, v41, v8
    v_mul_f32 v42, v42, v8
    v_mul_f32 v43, v43, v8
    v_mul_f32 v44, v44, v8
    v_mul_f32 v45, v45, v8
    v_mul_f32 v46, v46, v8
    v_mul_f32 v47, v47, v8
    v_mul_f32 v48, v48, v8
    v_mul_f32 v49, v49, v8
    v_mul_f32 v50, v50, v8
    v_mul_f32 v51, v51, v8
    v_cvt_pk_bf16_f32 v120, v32, v33
    v_cvt_pk_bf16_f32 v121, v34, v35
    v_cvt_pk_bf16_f32 v122, v36, v37
    v_cvt_pk_bf16_f32 v123, v38, v39
    v_cvt_pk_bf16_f32 v124, v40, v41
    v_cvt_pk_bf16_f32 v125, v42, v43
    v_cvt_pk_bf16_f32 v126, v44, v45
    v_cvt_pk_bf16_f32 v127, v46, v47
    v_cvt_pk_bf16_f32 v136, v48, v49
    v_cvt_pk_bf16_f32 v137, v50, v51
    v_add_f32 v8, 0x358637bd, v76
    v_rcp_f32 v8, v8
    s_nop 0
    v_mul_f32 v56, v56, v8
    v_mul_f32 v57, v57, v8
    v_mul_f32 v58, v58, v8
    v_mul_f32 v59, v59, v8
    v_mul_f32 v60, v60, v8
    v_mul_f32 v61, v61, v8
    v_mul_f32 v62, v62, v8
    v_mul_f32 v63, v63, v8
    v_mul_f32 v64, v64, v8
    v_mul_f32 v65, v65, v8
    v_mul_f32 v66, v66, v8
    v_mul_f32 v67, v67, v8
    v_mul_f32 v68, v68, v8
    v_mul_f32 v69, v69, v8
    v_mul_f32 v70, v70, v8
    v_mul_f32 v71, v71, v8
    v_mul_f32 v72, v72, v8
    v_mul_f32 v73, v73, v8
    v_mul_f32 v74, v74, v8
    v_mul_f32 v75, v75, v8
    v_cvt_pk_bf16_f32 v140, v56, v57
    v_cvt_pk_bf16_f32 v141, v58, v59
    v_cvt_pk_bf16_f32 v142, v60, v61
    v_cvt_pk_bf16_f32 v143, v62, v63
    v_cvt_pk_bf16_f32 v144, v64, v65
    v_cvt_pk_bf16_f32 v145, v66, v67
    v_cvt_pk_bf16_f32 v146, v68, v69
    v_cvt_pk_bf16_f32 v147, v70, v71
    v_cvt_pk_bf16_f32 v156, v72, v73
    v_cvt_pk_bf16_f32 v157, v74, v75
    v_add_u32 v21, 7680, v20
    v_cndmask_b32 v21, v20, v21, s[40:41]
    ds_read_b64_tr_b16 v[84:85], v21 offset:0
    ds_read_b64_tr_b16 v[86:87], v21 offset:192
    ds_read_b64_tr_b16 v[88:89], v21 offset:384
    ds_read_b64_tr_b16 v[90:91], v21 offset:576
    ds_read_b64_tr_b16 v[92:93], v21 offset:768
    ds_read_b64_tr_b16 v[94:95], v21 offset:960
    ds_read_b64_tr_b16 v[96:97], v21 offset:1152
    ds_read_b64_tr_b16 v[98:99], v21 offset:1344
    ds_read_b64_tr_b16 v[100:101], v21 offset:1536
    ds_read_b64_tr_b16 v[102:103], v21 offset:1728
    s_waitcnt lgkmcnt(0)
    v_mfma_f32_16x16x32_bf16 v[32:35], v[84:87], a[200:203], 0
    v_mfma_f32_16x16x32_bf16 v[56:59], v[84:87], a[220:223], 0
    v_mfma_f32_16x16x32_bf16 v[32:35], v[88:91], a[204:207], v[32:35]
    v_mfma_f32_16x16x32_bf16 v[56:59], v[88:91], a[224:227], v[56:59]
    v_mfma_f32_16x16x32_bf16 v[32:35], v[92:95], a[208:211], v[32:35]
    v_mfma_f32_16x16x32_bf16 v[56:59], v[92:95], a[228:231], v[56:59]
    v_mfma_f32_16x16x32_bf16 v[32:35], v[96:99], a[212:215], v[32:35]
    v_mfma_f32_16x16x32_bf16 v[56:59], v[96:99], a[232:235], v[56:59]
    v_mfma_f32_16x16x32_bf16 v[32:35], v[100:103], a[216:219], v[32:35]
    v_mfma_f32_16x16x32_bf16 v[56:59], v[100:103], a[236:239], v[56:59]
    ds_read_b64_tr_b16 v[84:85], v21 offset:8
    ds_read_b64_tr_b16 v[86:87], v21 offset:200
    ds_read_b64_tr_b16 v[88:89], v21 offset:392
    ds_read_b64_tr_b16 v[90:91], v21 offset:584
    ds_read_b64_tr_b16 v[92:93], v21 offset:776
    ds_read_b64_tr_b16 v[94:95], v21 offset:968
    ds_read_b64_tr_b16 v[96:97], v21 offset:1160
    ds_read_b64_tr_b16 v[98:99], v21 offset:1352
    ds_read_b64_tr_b16 v[100:101], v21 offset:1544
    ds_read_b64_tr_b16 v[102:103], v21 offset:1736
    s_waitcnt lgkmcnt(0)
    v_mfma_f32_16x16x32_bf16 v[36:39], v[84:87], a[200:203], 0
    v_mfma_f32_16x16x32_bf16 v[60:63], v[84:87], a[220:223], 0
    v_mfma_f32_16x16x32_bf16 v[36:39], v[88:91], a[204:207], v[36:39]
    v_mfma_f32_16x16x32_bf16 v[60:63], v[88:91], a[224:227], v[60:63]
    v_mfma_f32_16x16x32_bf16 v[36:39], v[92:95], a[208:211], v[36:39]
    v_mfma_f32_16x16x32_bf16 v[60:63], v[92:95], a[228:231], v[60:63]
    v_mfma_f32_16x16x32_bf16 v[36:39], v[96:99], a[212:215], v[36:39]
    v_mfma_f32_16x16x32_bf16 v[60:63], v[96:99], a[232:235], v[60:63]
    v_mfma_f32_16x16x32_bf16 v[36:39], v[100:103], a[216:219], v[36:39]
    v_mfma_f32_16x16x32_bf16 v[60:63], v[100:103], a[236:239], v[60:63]
    ds_read_b64_tr_b16 v[84:85], v21 offset:16
    ds_read_b64_tr_b16 v[86:87], v21 offset:208
    ds_read_b64_tr_b16 v[88:89], v21 offset:400
    ds_read_b64_tr_b16 v[90:91], v21 offset:592
    ds_read_b64_tr_b16 v[92:93], v21 offset:784
    ds_read_b64_tr_b16 v[94:95], v21 offset:976
    ds_read_b64_tr_b16 v[96:97], v21 offset:1168
    ds_read_b64_tr_b16 v[98:99], v21 offset:1360
    ds_read_b64_tr_b16 v[100:101], v21 offset:1552
    ds_read_b64_tr_b16 v[102:103], v21 offset:1744
    s_waitcnt lgkmcnt(0)
    v_mfma_f32_16x16x32_bf16 v[40:43], v[84:87], a[200:203], 0
    v_mfma_f32_16x16x32_bf16 v[64:67], v[84:87], a[220:223], 0
    v_mfma_f32_16x16x32_bf16 v[40:43], v[88:91], a[204:207], v[40:43]
    v_mfma_f32_16x16x32_bf16 v[64:67], v[88:91], a[224:227], v[64:67]
    v_mfma_f32_16x16x32_bf16 v[40:43], v[92:95], a[208:211], v[40:43]
    v_mfma_f32_16x16x32_bf16 v[64:67], v[92:95], a[228:231], v[64:67]
    v_mfma_f32_16x16x32_bf16 v[40:43], v[96:99], a[212:215], v[40:43]
    v_mfma_f32_16x16x32_bf16 v[64:67], v[96:99], a[232:235], v[64:67]
    v_mfma_f32_16x16x32_bf16 v[40:43], v[100:103], a[216:219], v[40:43]
    v_mfma_f32_16x16x32_bf16 v[64:67], v[100:103], a[236:239], v[64:67]
    ds_read_b64_tr_b16 v[84:85], v21 offset:24
    ds_read_b64_tr_b16 v[86:87], v21 offset:216
    ds_read_b64_tr_b16 v[88:89], v21 offset:408
    ds_read_b64_tr_b16 v[90:91], v21 offset:600
    ds_read_b64_tr_b16 v[92:93], v21 offset:792
    ds_read_b64_tr_b16 v[94:95], v21 offset:984
    ds_read_b64_tr_b16 v[96:97], v21 offset:1176
    ds_read_b64_tr_b16 v[98:99], v21 offset:1368
    ds_read_b64_tr_b16 v[100:101], v21 offset:1560
    ds_read_b64_tr_b16 v[102:103], v21 offset:1752
    s_waitcnt lgkmcnt(0)
    v_mfma_f32_16x16x32_bf16 v[44:47], v[84:87], a[200:203], 0
    v_mfma_f32_16x16x32_bf16 v[68:71], v[84:87], a[220:223], 0
    v_mfma_f32_16x16x32_bf16 v[44:47], v[88:91], a[204:207], v[44:47]
    v_mfma_f32_16x16x32_bf16 v[68:71], v[88:91], a[224:227], v[68:71]
    v_mfma_f32_16x16x32_bf16 v[44:47], v[92:95], a[208:211], v[44:47]
    v_mfma_f32_16x16x32_bf16 v[68:71], v[92:95], a[228:231], v[68:71]
    v_mfma_f32_16x16x32_bf16 v[44:47], v[96:99], a[212:215], v[44:47]
    v_mfma_f32_16x16x32_bf16 v[68:71], v[96:99], a[232:235], v[68:71]
    v_mfma_f32_16x16x32_bf16 v[44:47], v[100:103], a[216:219], v[44:47]
    v_mfma_f32_16x16x32_bf16 v[68:71], v[100:103], a[236:239], v[68:71]
    ds_read_b64_tr_b16 v[84:85], v21 offset:32
    ds_read_b64_tr_b16 v[86:87], v21 offset:224
    ds_read_b64_tr_b16 v[88:89], v21 offset:416
    ds_read_b64_tr_b16 v[90:91], v21 offset:608
    ds_read_b64_tr_b16 v[92:93], v21 offset:800
    ds_read_b64_tr_b16 v[94:95], v21 offset:992
    ds_read_b64_tr_b16 v[96:97], v21 offset:1184
    ds_read_b64_tr_b16 v[98:99], v21 offset:1376
    ds_read_b64_tr_b16 v[100:101], v21 offset:1568
    ds_read_b64_tr_b16 v[102:103], v21 offset:1760
    s_waitcnt lgkmcnt(0)
    v_mfma_f32_16x16x32_bf16 v[48:51], v[84:87], a[200:203], 0
    v_mfma_f32_16x16x32_bf16 v[72:75], v[84:87], a[220:223], 0
    v_mfma_f32_16x16x32_bf16 v[48:51], v[88:91], a[204:207], v[48:51]
    v_mfma_f32_16x16x32_bf16 v[72:75], v[88:91], a[224:227], v[72:75]
    v_mfma_f32_16x16x32_bf16 v[48:51], v[92:95], a[208:211], v[48:51]
    v_mfma_f32_16x16x32_bf16 v[72:75], v[92:95], a[228:231], v[72:75]
    v_mfma_f32_16x16x32_bf16 v[48:51], v[96:99], a[212:215], v[48:51]
    v_mfma_f32_16x16x32_bf16 v[72:75], v[96:99], a[232:235], v[72:75]
    v_mfma_f32_16x16x32_bf16 v[48:51], v[100:103], a[216:219], v[48:51]
    v_mfma_f32_16x16x32_bf16 v[72:75], v[100:103], a[236:239], v[72:75]
    ds_read_b64_tr_b16 v[84:85], v21 offset:40
    ds_read_b64_tr_b16 v[86:87], v21 offset:232
    ds_read_b64_tr_b16 v[88:89], v21 offset:424
    ds_read_b64_tr_b16 v[90:91], v21 offset:616
    ds_read_b64_tr_b16 v[92:93], v21 offset:808
    ds_read_b64_tr_b16 v[94:95], v21 offset:1000
    ds_read_b64_tr_b16 v[96:97], v21 offset:1192
    ds_read_b64_tr_b16 v[98:99], v21 offset:1384
    ds_read_b64_tr_b16 v[100:101], v21 offset:1576
    ds_read_b64_tr_b16 v[102:103], v21 offset:1768
    s_waitcnt lgkmcnt(0)
    v_mfma_f32_16x16x32_bf16 v[52:55], v[84:87], a[200:203], 0
    v_mfma_f32_16x16x32_bf16 v[76:79], v[84:87], a[220:223], 0
    v_mfma_f32_16x16x32_bf16 v[52:55], v[88:91], a[204:207], v[52:55]
    v_mfma_f32_16x16x32_bf16 v[76:79], v[88:91], a[224:227], v[76:79]
    v_mfma_f32_16x16x32_bf16 v[52:55], v[92:95], a[208:211], v[52:55]
    v_mfma_f32_16x16x32_bf16 v[76:79], v[92:95], a[228:231], v[76:79]
    v_mfma_f32_16x16x32_bf16 v[52:55], v[96:99], a[212:215], v[52:55]
    v_mfma_f32_16x16x32_bf16 v[76:79], v[96:99], a[232:235], v[76:79]
    v_mfma_f32_16x16x32_bf16 v[52:55], v[100:103], a[216:219], v[52:55]
    v_mfma_f32_16x16x32_bf16 v[76:79], v[100:103], a[236:239], v[76:79]
    s_nop 7
    v_add_f32 v8, 0x358637bd, v52
    v_rcp_f32 v8, v8
    s_nop 0
    v_mul_f32 v32, v32, v8
    v_mul_f32 v33, v33, v8
    v_mul_f32 v34, v34, v8
    v_mul_f32 v35, v35, v8
    v_mul_f32 v36, v36, v8
    v_mul_f32 v37, v37, v8
    v_mul_f32 v38, v38, v8
    v_mul_f32 v39, v39, v8
    v_mul_f32 v40, v40, v8
    v_mul_f32 v41, v41, v8
    v_mul_f32 v42, v42, v8
    v_mul_f32 v43, v43, v8
    v_mul_f32 v44, v44, v8
    v_mul_f32 v45, v45, v8
    v_mul_f32 v46, v46, v8
    v_mul_f32 v47, v47, v8
    v_mul_f32 v48, v48, v8
    v_mul_f32 v49, v49, v8
    v_mul_f32 v50, v50, v8
    v_mul_f32 v51, v51, v8
    v_cvt_pk_bf16_f32 v128, v32, v33
    v_cvt_pk_bf16_f32 v129, v34, v35
    v_cvt_pk_bf16_f32 v130, v36, v37
    v_cvt_pk_bf16_f32 v131, v38, v39
    v_cvt_pk_bf16_f32 v132, v40, v41
    v_cvt_pk_bf16_f32 v133, v42, v43
    v_cvt_pk_bf16_f32 v134, v44, v45
    v_cvt_pk_bf16_f32 v135, v46, v47
    v_cvt_pk_bf16_f32 v138, v48, v49
    v_cvt_pk_bf16_f32 v139, v50, v51
    v_add_f32 v8, 0x358637bd, v76
    v_rcp_f32 v8, v8
    s_nop 0
    v_mul_f32 v56, v56, v8
    v_mul_f32 v57, v57, v8
    v_mul_f32 v58, v58, v8
    v_mul_f32 v59, v59, v8
    v_mul_f32 v60, v60, v8
    v_mul_f32 v61, v61, v8
    v_mul_f32 v62, v62, v8
    v_mul_f32 v63, v63, v8
    v_mul_f32 v64, v64, v8
    v_mul_f32 v65, v65, v8
    v_mul_f32 v66, v66, v8
    v_mul_f32 v67, v67, v8
    v_mul_f32 v68, v68, v8
    v_mul_f32 v69, v69, v8
    v_mul_f32 v70, v70, v8
    v_mul_f32 v71, v71, v8
    v_mul_f32 v72, v72, v8
    v_mul_f32 v73, v73, v8
    v_mul_f32 v74, v74, v8
    v_mul_f32 v75, v75, v8
    v_cvt_pk_bf16_f32 v148, v56, v57
    v_cvt_pk_bf16_f32 v149, v58, v59
    v_cvt_pk_bf16_f32 v150, v60, v61
    v_cvt_pk_bf16_f32 v151, v62, v63
    v_cvt_pk_bf16_f32 v152, v64, v65
    v_cvt_pk_bf16_f32 v153, v66, v67
    v_cvt_pk_bf16_f32 v154, v68, v69
    v_cvt_pk_bf16_f32 v155, v70, v71
    v_cvt_pk_bf16_f32 v158, v72, v73
    v_cvt_pk_bf16_f32 v159, v74, v75
    s_lshl_b32 s24, s31, 2
    s_add_u32 s24, s24, s9
    s_mul_i32 s35, s24, 40960
    s_add_u32 s35, s35, 105906176
    s_mul_i32 s24, s32, 5120
    s_add_u32 s24, s24, s35
    buffer_store_dwordx4 v[120:123], v26, s[16:19], s24 offen offset:0 sc1
    buffer_store_dwordx4 v[124:127], v26, s[16:19], s24 offen offset:1024 sc1
    buffer_store_dwordx4 v[128:131], v26, s[16:19], s24 offen offset:2048 sc1
    buffer_store_dwordx4 v[132:135], v26, s[16:19], s24 offen offset:3072 sc1
    s_add_u32 s24, s24, 4096
    buffer_store_dwordx4 v[136:139], v26, s[16:19], s24 offen offset:0 sc1
    s_add_u32 s24, s24, 16384
    buffer_store_dwordx4 v[140:143], v26, s[16:19], s24 offen offset:0 sc1
    buffer_store_dwordx4 v[144:147], v26, s[16:19], s24 offen offset:1024 sc1
    buffer_store_dwordx4 v[148:151], v26, s[16:19], s24 offen offset:2048 sc1
    buffer_store_dwordx4 v[152:155], v26, s[16:19], s24 offen offset:3072 sc1
    s_add_u32 s24, s24, 4096
    buffer_store_dwordx4 v[156:159], v26, s[16:19], s24 offen offset:0 sc1
    s_add_u32 s24, s24, 16384
    v_mov_b32 v8, 3
    s_waitcnt vmcnt(0)
    s_mov_b64 exec, 1
    buffer_store_dword v8, v25, s[16:19], s11 offen sc1
    s_mov_b64 exec, -1
    s_lshl_b32 s24, s31, 2
    v_add_u32 v10, s24, v27
    v_mov_b32 v11, s9
    v_mul_u32_u24 v12, 0x5556, v10
    v_lshrrev_b32 v12, 18, v12
    v_mul_u32_u24 v13, 12, v12
    v_sub_u32 v13, v10, v13
    v_lshlrev_b32 v12, 9, v12
    v_lshl_add_u32 v12, v13, 4, v12
    v_lshl_add_u32 v12, v11, 2, v12
    v_add_u32 v12, 3162432, v12
    s_mov_b32 s26, 400000
aw_28:
    buffer_load_dword v13, v12, s[16:19], 0 offen sc1
    s_waitcnt vmcnt(0)
    v_cmp_gt_u32 vcc, 3, v13
    s_cbranch_vccz ad_29
    s_sub_u32 s26, s26, 1
    s_cbranch_scc1 L_fail2
    s_sleep 24
    s_branch aw_28
ad_29:
    s_mov_b32 s24, s35
    buffer_load_dwordx4 a[0:3], v26, s[16:19], s24 offen offset:0 sc1
    buffer_load_dwordx4 a[4:7], v26, s[16:19], s24 offen offset:1024 sc1
    buffer_load_dwordx4 a[8:11], v26, s[16:19], s24 offen offset:2048 sc1
    buffer_load_dwordx4 a[12:15], v26, s[16:19], s24 offen offset:3072 sc1
    s_add_u32 s24, s24, 4096
    buffer_load_dwordx4 a[16:19], v26, s[16:19], s24 offen offset:0 sc1
    buffer_load_dwordx4 a[20:23], v26, s[16:19], s24 offen offset:1024 sc1
    buffer_load_dwordx4 a[24:27], v26, s[16:19], s24 offen offset:2048 sc1
    buffer_load_dwordx4 a[28:31], v26, s[16:19], s24 offen offset:3072 sc1
    s_add_u32 s24, s24, 4096
    buffer_load_dwordx4 a[32:35], v26, s[16:19], s24 offen offset:0 sc1
    buffer_load_dwordx4 a[36:39], v26, s[16:19], s24 offen offset:1024 sc1
    buffer_load_dwordx4 a[40:43], v26, s[16:19], s24 offen offset:2048 sc1
    buffer_load_dwordx4 a[44:47], v26, s[16:19], s24 offen offset:3072 sc1
    s_add_u32 s24, s24, 4096
    buffer_load_dwordx4 a[48:51], v26, s[16:19], s24 offen offset:0 sc1
    buffer_load_dwordx4 a[52:55], v26, s[16:19], s24 offen offset:1024 sc1
    buffer_load_dwordx4 a[56:59], v26, s[16:19], s24 offen offset:2048 sc1
    buffer_load_dwordx4 a[60:63], v26, s[16:19], s24 offen offset:3072 sc1
    s_add_u32 s24, s24, 4096
    buffer_load_dwordx4 a[64:67], v26, s[16:19], s24 offen offset:0 sc1
    buffer_load_dwordx4 a[68:71], v26, s[16:19], s24 offen offset:1024 sc1
    buffer_load_dwordx4 a[72:75], v26, s[16:19], s24 offen offset:2048 sc1
    buffer_load_dwordx4 a[76:79], v26, s[16:19], s24 offen offset:3072 sc1
    s_add_u32 s24, s24, 4096
    buffer_load_dwordx4 a[80:83], v26, s[16:19], s24 offen offset:0 sc1
    buffer_load_dwordx4 a[84:87], v26, s[16:19], s24 offen offset:1024 sc1
    buffer_load_dwordx4 a[88:91], v26, s[16:19], s24 offen offset:2048 sc1
    buffer_load_dwordx4 a[92:95], v26, s[16:19], s24 offen offset:3072 sc1
    s_add_u32 s24, s24, 4096
    buffer_load_dwordx4 a[96:99], v26, s[16:19], s24 offen offset:0 sc1
    buffer_load_dwordx4 a[100:103], v26, s[16:19], s24 offen offset:1024 sc1
    buffer_load_dwordx4 a[104:107], v26, s[16:19], s24 offen offset:2048 sc1
    buffer_load_dwordx4 a[108:111], v26, s[16:19], s24 offen offset:3072 sc1
    s_add_u32 s24, s24, 4096
    buffer_load_dwordx4 a[112:115], v26, s[16:19], s24 offen offset:0 sc1
    buffer_load_dwordx4 a[116:119], v26, s[16:19], s24 offen offset:1024 sc1
    buffer_load_dwordx4 a[120:123], v26, s[16:19], s24 offen offset:2048 sc1
    buffer_load_dwordx4 a[124:127], v26, s[16:19], s24 offen offset:3072 sc1
    s_add_u32 s24, s24, 4096
    buffer_load_dwordx4 a[128:131], v26, s[16:19], s24 offen offset:0 sc1
    buffer_load_dwordx4 a[132:135], v26, s[16:19], s24 offen offset:1024 sc1
    buffer_load_dwordx4 a[136:139], v26, s[16:19], s24 offen offset:2048 sc1
    buffer_load_dwordx4 a[140:143], v26, s[16:19], s24 offen offset:3072 sc1
    s_add_u32 s24, s24, 4096
    buffer_load_dwordx4 a[144:147], v26, s[16:19], s24 offen offset:0 sc1
    buffer_load_dwordx4 a[148:151], v26, s[16:19], s24 offen offset:1024 sc1
    buffer_load_dwordx4 a[152:155], v26, s[16:19], s24 offen offset:2048 sc1
    buffer_load_dwordx4 a[156:159], v26, s[16:19], s24 offen offset:3072 sc1
    s_mov_b32 s44, s70
    s_mov_b32 s45, s71
    s_mov_b32 s46, 5242880
    v_mul_u32_u24 v23, 2560, v30
    v_lshl_add_u32 v23, v29, 3, v23
    s_mul_i32 s36, s34, 2560
    s_add_u32 s36, s36, s33
    s_add_u32 s37, s36, 40960
    s_waitcnt vmcnt(0)
    s_barrier
    v_add_u32 v21, 0, v18
    ds_read_b64_tr_b16 v[72:73], v21 offset:0
    ds_read_b64_tr_b16 v[74:75], v21 offset:640
    ds_read_b64_tr_b16 v[76:77], v21 offset:32
    ds_read_b64_tr_b16 v[78:79], v21 offset:672
    ds_read_b64_tr_b16 v[80:81], v21 offset:64
    ds_read_b64_tr_b16 v[82:83], v21 offset:704
    ds_read_b64_tr_b16 v[84:85], v21 offset:96
    ds_read_b64_tr_b16 v[86:87], v21 offset:736
    ds_read_b64_tr_b16 v[88:89], v21 offset:128
    ds_read_b64_tr_b16 v[90:91], v21 offset:768
    s_waitcnt lgkmcnt(0)
    v_mfma_f32_16x16x32_bf16 v[32:35], v[72:75], a[0:3], 0
    ds_read_b64_tr_b16 v[92:93], v21 offset:1280
    v_mfma_f32_16x16x32_bf16 v[36:39], v[72:75], a[80:83], 0
    ds_read_b64_tr_b16 v[94:95], v21 offset:1920
    v_mfma_f32_16x16x32_bf16 v[40:43], v[76:79], a[0:3], 0
    ds_read_b64_tr_b16 v[96:97], v21 offset:1312
    v_mfma_f32_16x16x32_bf16 v[44:47], v[76:79], a[80:83], 0
    ds_read_b64_tr_b16 v[98:99], v21 offset:1952
    v_mfma_f32_16x16x32_bf16 v[48:51], v[80:83], a[0:3], 0
    ds_read_b64_tr_b16 v[100:101], v21 offset:1344
    v_mfma_f32_16x16x32_bf16 v[52:55], v[80:83], a[80:83], 0
    ds_read_b64_tr_b16 v[102:103], v21 offset:1984
    v_mfma_f32_16x16x32_bf16 v[56:59], v[84:87], a[0:3], 0
    ds_read_b64_tr_b16 v[104:105], v21 offset:1376
    v_mfma_f32_16x16x32_bf16 v[60:63], v[84:87], a[80:83], 0
    ds_read_b64_tr_b16 v[106:107], v21 offset:2016
    v_mfma_f32_16x16x32_bf16 v[64:67], v[88:91], a[0:3], 0
    ds_read_b64_tr_b16 v[108:109], v21 offset:1408
    v_mfma_f32_16x16x32_bf16 v[68:71], v[88:91], a[80:83], 0
    ds_read_b64_tr_b16 v[110:111], v21 offset:2048
    s_waitcnt lgkmcnt(0)
    v_mfma_f32_16x16x32_bf16 v[32:35], v[92:95], a[4:7], v[32:35]
    ds_read_b64_tr_b16 v[72:73], v21 offset:12800
    v_mfma_f32_16x16x32_bf16 v[36:39], v[92:95], a[84:87], v[36:39]
    ds_read_b64_tr_b16 v[74:75], v21 offset:13440
    v_mfma_f32_16x16x32_bf16 v[40:43], v[96:99], a[4:7], v[40:43]
    ds_read_b64_tr_b16 v[76:77], v21 offset:12832
    v_mfma_f32_16x16x32_bf16 v[44:47], v[96:99], a[84:87], v[44:47]
    ds_read_b64_tr_b16 v[78:79], v21 offset:13472
    v_mfma_f32_16x16x32_bf16 v[48:51], v[100:103], a[4:7], v[48:51]
    ds_read_b64_tr_b16 v[80:81], v21 offset:12864
    v_mfma_f32_16x16x32_bf16 v[52:55], v[100:103], a[84:87], v[52:55]
    ds_read_b64_tr_b16 v[82:83], v21 offset:13504
    v_mfma_f32_16x16x32_bf16 v[56:59], v[104:107], a[4:7], v[56:59]
    ds_read_b64_tr_b16 v[84:85], v21 offset:12896
    v_mfma_f32_16x16x32_bf16 v[60:63], v[104:107], a[84:87], v[60:63]
    ds_read_b64_tr_b16 v[86:87], v21 offset:13536
    v_mfma_f32_16x16x32_bf16 v[64:67], v[108:111], a[4:7], v[64:67]
    ds_read_b64_tr_b16 v[88:89], v21 offset:12928
    v_mfma_f32_16x16x32_bf16 v[68:71], v[108:111], a[84:87], v[68:71]
    ds_read_b64_tr_b16 v[90:91], v21 offset:13568
    s_waitcnt lgkmcnt(0)
    v_mfma_f32_16x16x32_bf16 v[32:35], v[72:75], a[8:11], v[32:35]
    ds_read_b64_tr_b16 v[92:93], v21 offset:14080
    v_mfma_f32_16x16x32_bf16 v[36:39], v[72:75], a[88:91], v[36:39]
    ds_read_b64_tr_b16 v[94:95], v21 offset:14720
    v_mfma_f32_16x16x32_bf16 v[40:43], v[76:79], a[8:11], v[40:43]
    ds_read_b64_tr_b16 v[96:97], v21 offset:14112
    v_mfma_f32_16x16x32_bf16 v[44:47], v[76:79], a[88:91], v[44:47]
    ds_read_b64_tr_b16 v[98:99], v21 offset:14752
    v_mfma_f32_16x16x32_bf16 v[48:51], v[80:83], a[8:11], v[48:51]
    ds_read_b64_tr_b16 v[100:101], v21 offset:14144
    v_mfma_f32_16x16x32_bf16 v[52:55], v[80:83], a[88:91], v[52:55]
    ds_read_b64_tr_b16 v[102:103], v21 offset:14784
    v_mfma_f32_16x16x32_bf16 v[56:59], v[84:87], a[8:11], v[56:59]
    ds_read_b64_tr_b16 v[104:105], v21 offset:14176
    v_mfma_f32_16x16x32_bf16 v[60:63], v[84:87], a[88:91], v[60:63]
    ds_read_b64_tr_b16 v[106:107], v21 offset:14816
    v_mfma_f32_16x16x32_bf16 v[64:67], v[88:91], a[8:11], v[64:67]
    ds_read_b64_tr_b16 v[108:109], v21 offset:14208
    v_mfma_f32_16x16x32_bf16 v[68:71], v[88:91], a[88:91], v[68:71]
    ds_read_b64_tr_b16 v[110:111], v21 offset:14848
    s_waitcnt lgkmcnt(0)
    v_mfma_f32_16x16x32_bf16 v[32:35], v[92:95], a[12:15], v[32:35]
    ds_read_b64_tr_b16 v[72:73], v21 offset:2560
    v_mfma_f32_16x16x32_bf16 v[36:39], v[92:95], a[92:95], v[36:39]
    ds_read_b64_tr_b16 v[74:75], v21 offset:15360
    v_mfma_f32_16x16x32_bf16 v[40:43], v[96:99], a[12:15], v[40:43]
    ds_read_b64_tr_b16 v[76:77], v21 offset:2592
    v_mfma_f32_16x16x32_bf16 v[44:47], v[96:99], a[92:95], v[44:47]
    ds_read_b64_tr_b16 v[78:79], v21 offset:15392
    v_mfma_f32_16x16x32_bf16 v[48:51], v[100:103], a[12:15], v[48:51]
    ds_read_b64_tr_b16 v[80:81], v21 offset:2624
    v_mfma_f32_16x16x32_bf16 v[52:55], v[100:103], a[92:95], v[52:55]
    ds_read_b64_tr_b16 v[82:83], v21 offset:15424
    v_mfma_f32_16x16x32_bf16 v[56:59], v[104:107], a[12:15], v[56:59]
    ds_read_b64_tr_b16 v[84:85], v21 offset:2656
    v_mfma_f32_16x16x32_bf16 v[60:63], v[104:107], a[92:95], v[60:63]
    ds_read_b64_tr_b16 v[86:87], v21 offset:15456
    v_mfma_f32_16x16x32_bf16 v[64:67], v[108:111], a[12:15], v[64:67]
    ds_read_b64_tr_b16 v[88:89], v21 offset:2688
    v_mfma_f32_16x16x32_bf16 v[68:71], v[108:111], a[92:95], v[68:71]
    ds_read_b64_tr_b16 v[90:91], v21 offset:15488
    s_waitcnt lgkmcnt(0)
    v_mfma_f32_16x16x32_bf16 v[32:35], v[72:75], a[16:19], v[32:35]
    v_mfma_f32_16x16x32_bf16 v[36:39], v[72:75], a[96:99], v[36:39]
    v_mfma_f32_16x16x32_bf16 v[40:43], v[76:79], a[16:19], v[40:43]
    v_mfma_f32_16x16x32_bf16 v[44:47], v[76:79], a[96:99], v[44:47]
    v_mfma_f32_16x16x32_bf16 v[48:51], v[80:83], a[16:19], v[48:51]
    v_mfma_f32_16x16x32_bf16 v[52:55], v[80:83], a[96:99], v[52:55]
    v_mfma_f32_16x16x32_bf16 v[56:59], v[84:87], a[16:19], v[56:59]
    v_mfma_f32_16x16x32_bf16 v[60:63], v[84:87], a[96:99], v[60:63]
    v_mfma_f32_16x16x32_bf16 v[64:67], v[88:91], a[16:19], v[64:67]
    v_mfma_f32_16x16x32_bf16 v[68:71], v[88:91], a[96:99], v[68:71]
    s_barrier
    s_add_u32 s28, s33, 160
    s_mul_i32 s24, s9, 7168
    s_add_u32 m0, s24, 0
    s_nop 0
    buffer_load_dwordx4 v0, s[20:23], s28 offen lds
    s_add_u32 m0, s24, 1024
    s_nop 0
    buffer_load_dwordx4 v1, s[20:23], s28 offen lds
    s_add_u32 m0, s24, 2048
    s_nop 0
    buffer_load_dwordx4 v2, s[20:23], s28 offen lds
    s_add_u32 m0, s24, 3072
    s_nop 0
    buffer_load_dwordx4 v3, s[20:23], s28 offen lds
    s_add_u32 m0, s24, 4096
    s_nop 0
    buffer_load_dwordx4 v4, s[20:23], s28 offen lds
    s_add_u32 m0, s24, 5120
    s_nop 0
    buffer_load_dwordx4 v5, s[20:23], s28 offen lds
    s_add_u32 m0, s24, 6144
    s_nop 0
    buffer_load_dwordx4 v6, s[20:23], s28 offen lds
    v_add_u32 v21, 28672, v18
    ds_read_b64_tr_b16 v[72:73], v21 offset:0
    ds_read_b64_tr_b16 v[74:75], v21 offset:640
    ds_read_b64_tr_b16 v[76:77], v21 offset:32
    ds_read_b64_tr_b16 v[78:79], v21 offset:672
    ds_read_b64_tr_b16 v[80:81], v21 offset:64
    ds_read_b64_tr_b16 v[82:83], v21 offset:704
    ds_read_b64_tr_b16 v[84:85], v21 offset:96
    ds_read_b64_tr_b16 v[86:87], v21 offset:736
    ds_read_b64_tr_b16 v[88:89], v21 offset:128
    ds_read_b64_tr_b16 v[90:91], v21 offset:768
    s_waitcnt lgkmcnt(0)
    v_mfma_f32_16x16x32_bf16 v[32:35], v[72:75], a[20:23], v[32:35]
    ds_read_b64_tr_b16 v[92:93], v21 offset:1280
    v_mfma_f32_16x16x32_bf16 v[36:39], v[72:75], a[100:103], v[36:39]
    ds_read_b64_tr_b16 v[94:95], v21 offset:1920
    v_mfma_f32_16x16x32_bf16 v[40:43], v[76:79], a[20:23], v[40:43]
    ds_read_b64_tr_b16 v[96:97], v21 offset:1312
    v_mfma_f32_16x16x32_bf16 v[44:47], v[76:79], a[100:103], v[44:47]
    ds_read_b64_tr_b16 v[98:99], v21 offset:1952
    v_mfma_f32_16x16x32_bf16 v[48:51], v[80:83], a[20:23], v[48:51]
    ds_read_b64_tr_b16 v[100:101], v21 offset:1344
    v_mfma_f32_16x16x32_bf16 v[52:55], v[80:83], a[100:103], v[52:55]
    ds_read_b64_tr_b16 v[102:103], v21 offset:1984
    v_mfma_f32_16x16x32_bf16 v[56:59], v[84:87], a[20:23], v[56:59]
    ds_read_b64_tr_b16 v[104:105], v21 offset:1376
    v_mfma_f32_16x16x32_bf16 v[60:63], v[84:87], a[100:103], v[60:63]
    ds_read_b64_tr_b16 v[106:107], v21 offset:2016
    v_mfma_f32_16x16x32_bf16 v[64:67], v[88:91], a[20:23], v[64:67]
    ds_read_b64_tr_b16 v[108:109], v21 offset:1408
    v_mfma_f32_16x16x32_bf16 v[68:71], v[88:91], a[100:103], v[68:71]
    ds_read_b64_tr_b16 v[110:111], v21 offset:2048
    s_waitcnt lgkmcnt(0)
    v_mfma_f32_16x16x32_bf16 v[32:35], v[92:95], a[24:27], v[32:35]
    ds_read_b64_tr_b16 v[72:73], v21 offset:12800
    v_mfma_f32_16x16x32_bf16 v[36:39], v[92:95], a[104:107], v[36:39]
    ds_read_b64_tr_b16 v[74:75], v21 offset:13440
    v_mfma_f32_16x16x32_bf16 v[40:43], v[96:99], a[24:27], v[40:43]
    ds_read_b64_tr_b16 v[76:77], v21 offset:12832
    v_mfma_f32_16x16x32_bf16 v[44:47], v[96:99], a[104:107], v[44:47]
    ds_read_b64_tr_b16 v[78:79], v21 offset:13472
    v_mfma_f32_16x16x32_bf16 v[48:51], v[100:103], a[24:27], v[48:51]
    ds_read_b64_tr_b16 v[80:81], v21 offset:12864
    v_mfma_f32_16x16x32_bf16 v[52:55], v[100:103], a[104:107], v[52:55]
    ds_read_b64_tr_b16 v[82:83], v21 offset:13504
    v_mfma_f32_16x16x32_bf16 v[56:59], v[104:107], a[24:27], v[56:59]
    ds_read_b64_tr_b16 v[84:85], v21 offset:12896
    v_mfma_f32_16x16x32_bf16 v[60:63], v[104:107], a[104:107], v[60:63]
    ds_read_b64_tr_b16 v[86:87], v21 offset:13536
    v_mfma_f32_16x16x32_bf16 v[64:67], v[108:111], a[24:27], v[64:67]
    ds_read_b64_tr_b16 v[88:89], v21 offset:12928
    v_mfma_f32_16x16x32_bf16 v[68:71], v[108:111], a[104:107], v[68:71]
    ds_read_b64_tr_b16 v[90:91], v21 offset:13568
    s_waitcnt lgkmcnt(0)
    v_mfma_f32_16x16x32_bf16 v[32:35], v[72:75], a[28:31], v[32:35]
    ds_read_b64_tr_b16 v[92:93], v21 offset:14080
    v_mfma_f32_16x16x32_bf16 v[36:39], v[72:75], a[108:111], v[36:39]
    ds_read_b64_tr_b16 v[94:95], v21 offset:14720
    v_mfma_f32_16x16x32_bf16 v[40:43], v[76:79], a[28:31], v[40:43]
    ds_read_b64_tr_b16 v[96:97], v21 offset:14112
    v_mfma_f32_16x16x32_bf16 v[44:47], v[76:79], a[108:111], v[44:47]
    ds_read_b64_tr_b16 v[98:99], v21 offset:14752
    v_mfma_f32_16x16x32_bf16 v[48:51], v[80:83], a[28:31], v[48:51]
    ds_read_b64_tr_b16 v[100:101], v21 offset:14144
    v_mfma_f32_16x16x32_bf16 v[52:55], v[80:83], a[108:111], v[52:55]
    ds_read_b64_tr_b16 v[102:103], v21 offset:14784
    v_mfma_f32_16x16x32_bf16 v[56:59], v[84:87], a[28:31], v[56:59]
    ds_read_b64_tr_b16 v[104:105], v21 offset:14176
    v_mfma_f32_16x16x32_bf16 v[60:63], v[84:87], a[108:111], v[60:63]
    ds_read_b64_tr_b16 v[106:107], v21 offset:14816
    v_mfma_f32_16x16x32_bf16 v[64:67], v[88:91], a[28:31], v[64:67]
    ds_read_b64_tr_b16 v[108:109], v21 offset:14208
    v_mfma_f32_16x16x32_bf16 v[68:71], v[88:91], a[108:111], v[68:71]
    ds_read_b64_tr_b16 v[110:111], v21 offset:14848
    s_waitcnt lgkmcnt(0)
    v_mfma_f32_16x16x32_bf16 v[32:35], v[92:95], a[32:35], v[32:35]
    ds_read_b64_tr_b16 v[72:73], v21 offset:2560
    v_mfma_f32_16x16x32_bf16 v[36:39], v[92:95], a[112:115], v[36:39]
    ds_read_b64_tr_b16 v[74:75], v21 offset:15360
    v_mfma_f32_16x16x32_bf16 v[40:43], v[96:99], a[32:35], v[40:43]
    ds_read_b64_tr_b16 v[76:77], v21 offset:2592
    v_mfma_f32_16x16x32_bf16 v[44:47], v[96:99], a[112:115], v[44:47]
    ds_read_b64_tr_b16 v[78:79], v21 offset:15392
    v_mfma_f32_16x16x32_bf16 v[48:51], v[100:103], a[32:35], v[48:51]
    ds_read_b64_tr_b16 v[80:81], v21 offset:2624
    v_mfma_f32_16x16x32_bf16 v[52:55], v[100:103], a[112:115], v[52:55]
    ds_read_b64_tr_b16 v[82:83], v21 offset:15424
    v_mfma_f32_16x16x32_bf16 v[56:59], v[104:107], a[32:35], v[56:59]
    ds_read_b64_tr_b16 v[84:85], v21 offset:2656
    v_mfma_f32_16x16x32_bf16 v[60:63], v[104:107], a[112:115], v[60:63]
    ds_read_b64_tr_b16 v[86:87], v21 offset:15456
    v_mfma_f32_16x16x32_bf16 v[64:67], v[108:111], a[32:35], v[64:67]
    ds_read_b64_tr_b16 v[88:89], v21 offset:2688
    v_mfma_f32_16x16x32_bf16 v[68:71], v[108:111], a[112:115], v[68:71]
    ds_read_b64_tr_b16 v[90:91], v21 offset:15488
    s_waitcnt lgkmcnt(0)
    v_mfma_f32_16x16x32_bf16 v[32:35], v[72:75], a[36:39], v[32:35]
    v_mfma_f32_16x16x32_bf16 v[36:39], v[72:75], a[116:119], v[36:39]
    v_mfma_f32_16x16x32_bf16 v[40:43], v[76:79], a[36:39], v[40:43]
    v_mfma_f32_16x16x32_bf16 v[44:47], v[76:79], a[116:119], v[44:47]
    v_mfma_f32_16x16x32_bf16 v[48:51], v[80:83], a[36:39], v[48:51]
    v_mfma_f32_16x16x32_bf16 v[52:55], v[80:83], a[116:119], v[52:55]
    v_mfma_f32_16x16x32_bf16 v[56:59], v[84:87], a[36:39], v[56:59]
    v_mfma_f32_16x16x32_bf16 v[60:63], v[84:87], a[116:119], v[60:63]
    v_mfma_f32_16x16x32_bf16 v[64:67], v[88:91], a[36:39], v[64:67]
    v_mfma_f32_16x16x32_bf16 v[68:71], v[88:91], a[116:119], v[68:71]
    s_barrier
    s_add_u32 s28, s33, 204960
    s_mul_i32 s24, s9, 7168
    s_add_u32 m0, s24, 28672
    s_nop 0
    buffer_load_dwordx4 v0, s[20:23], s28 offen lds
    s_add_u32 m0, s24, 29696
    s_nop 0
    buffer_load_dwordx4 v1, s[20:23], s28 offen lds
    s_add_u32 m0, s24, 30720
    s_nop 0
    buffer_load_dwordx4 v2, s[20:23], s28 offen lds
    s_add_u32 m0, s24, 31744
    s_nop 0
    buffer_load_dwordx4 v3, s[20:23], s28 offen lds
    s_add_u32 m0, s24, 32768
    s_nop 0
    buffer_load_dwordx4 v4, s[20:23], s28 offen lds
    s_add_u32 m0, s24, 33792
    s_nop 0
    buffer_load_dwordx4 v5, s[20:23], s28 offen lds
    s_add_u32 m0, s24, 34816
    s_nop 0
    buffer_load_dwordx4 v6, s[20:23], s28 offen lds
    v_add_u32 v21, 57344, v18
    ds_read_b64_tr_b16 v[72:73], v21 offset:0
    ds_read_b64_tr_b16 v[74:75], v21 offset:640
    ds_read_b64_tr_b16 v[76:77], v21 offset:32
    ds_read_b64_tr_b16 v[78:79], v21 offset:672
    ds_read_b64_tr_b16 v[80:81], v21 offset:64
    ds_read_b64_tr_b16 v[82:83], v21 offset:704
    ds_read_b64_tr_b16 v[84:85], v21 offset:96
    ds_read_b64_tr_b16 v[86:87], v21 offset:736
    ds_read_b64_tr_b16 v[88:89], v21 offset:128
    ds_read_b64_tr_b16 v[90:91], v21 offset:768
    s_waitcnt lgkmcnt(0)
    v_mfma_f32_16x16x32_bf16 v[32:35], v[72:75], a[40:43], v[32:35]
    ds_read_b64_tr_b16 v[92:93], v21 offset:1280
    v_mfma_f32_16x16x32_bf16 v[36:39], v[72:75], a[120:123], v[36:39]
    ds_read_b64_tr_b16 v[94:95], v21 offset:1920
    v_mfma_f32_16x16x32_bf16 v[40:43], v[76:79], a[40:43], v[40:43]
    ds_read_b64_tr_b16 v[96:97], v21 offset:1312
    v_mfma_f32_16x16x32_bf16 v[44:47], v[76:79], a[120:123], v[44:47]
    ds_read_b64_tr_b16 v[98:99], v21 offset:1952
    v_mfma_f32_16x16x32_bf16 v[48:51], v[80:83], a[40:43], v[48:51]
    ds_read_b64_tr_b16 v[100:101], v21 offset:1344
    v_mfma_f32_16x16x32_bf16 v[52:55], v[80:83], a[120:123], v[52:55]
    ds_read_b64_tr_b16 v[102:103], v21 offset:1984
    v_mfma_f32_16x16x32_bf16 v[56:59], v[84:87], a[40:43], v[56:59]
    ds_read_b64_tr_b16 v[104:105], v21 offset:1376
    v_mfma_f32_16x16x32_bf16 v[60:63], v[84:87], a[120:123], v[60:63]
    ds_read_b64_tr_b16 v[106:107], v21 offset:2016
    v_mfma_f32_16x16x32_bf16 v[64:67], v[88:91], a[40:43], v[64:67]
    ds_read_b64_tr_b16 v[108:109], v21 offset:1408
    v_mfma_f32_16x16x32_bf16 v[68:71], v[88:91], a[120:123], v[68:71]
    ds_read_b64_tr_b16 v[110:111], v21 offset:2048
    s_waitcnt lgkmcnt(0)
    v_mfma_f32_16x16x32_bf16 v[32:35], v[92:95], a[44:47], v[32:35]
    ds_read_b64_tr_b16 v[72:73], v21 offset:12800
    v_mfma_f32_16x16x32_bf16 v[36:39], v[92:95], a[124:127], v[36:39]
    ds_read_b64_tr_b16 v[74:75], v21 offset:13440
    v_mfma_f32_16x16x32_bf16 v[40:43], v[96:99], a[44:47], v[40:43]
    ds_read_b64_tr_b16 v[76:77], v21 offset:12832
    v_mfma_f32_16x16x32_bf16 v[44:47], v[96:99], a[124:127], v[44:47]
    ds_read_b64_tr_b16 v[78:79], v21 offset:13472
    v_mfma_f32_16x16x32_bf16 v[48:51], v[100:103], a[44:47], v[48:51]
    ds_read_b64_tr_b16 v[80:81], v21 offset:12864
    v_mfma_f32_16x16x32_bf16 v[52:55], v[100:103], a[124:127], v[52:55]
    ds_read_b64_tr_b16 v[82:83], v21 offset:13504
    v_mfma_f32_16x16x32_bf16 v[56:59], v[104:107], a[44:47], v[56:59]
    ds_read_b64_tr_b16 v[84:85], v21 offset:12896
    v_mfma_f32_16x16x32_bf16 v[60:63], v[104:107], a[124:127], v[60:63]
    ds_read_b64_tr_b16 v[86:87], v21 offset:13536
    v_mfma_f32_16x16x32_bf16 v[64:67], v[108:111], a[44:47], v[64:67]
    ds_read_b64_tr_b16 v[88:89], v21 offset:12928
    v_mfma_f32_16x16x32_bf16 v[68:71], v[108:111], a[124:127], v[68:71]
    ds_read_b64_tr_b16 v[90:91], v21 offset:13568
    s_waitcnt lgkmcnt(0)
    v_mfma_f32_16x16x32_bf16 v[32:35], v[72:75], a[48:51], v[32:35]
    ds_read_b64_tr_b16 v[92:93], v21 offset:14080
    v_mfma_f32_16x16x32_bf16 v[36:39], v[72:75], a[128:131], v[36:39]
    ds_read_b64_tr_b16 v[94:95], v21 offset:14720
    v_mfma_f32_16x16x32_bf16 v[40:43], v[76:79], a[48:51], v[40:43]
    ds_read_b64_tr_b16 v[96:97], v21 offset:14112
    v_mfma_f32_16x16x32_bf16 v[44:47], v[76:79], a[128:131], v[44:47]
    ds_read_b64_tr_b16 v[98:99], v21 offset:14752
    v_mfma_f32_16x16x32_bf16 v[48:51], v[80:83], a[48:51], v[48:51]
    ds_read_b64_tr_b16 v[100:101], v21 offset:14144
    v_mfma_f32_16x16x32_bf16 v[52:55], v[80:83], a[128:131], v[52:55]
    ds_read_b64_tr_b16 v[102:103], v21 offset:14784
    v_mfma_f32_16x16x32_bf16 v[56:59], v[84:87], a[48:51], v[56:59]
    ds_read_b64_tr_b16 v[104:105], v21 offset:14176
    v_mfma_f32_16x16x32_bf16 v[60:63], v[84:87], a[128:131], v[60:63]
    ds_read_b64_tr_b16 v[106:107], v21 offset:14816
    v_mfma_f32_16x16x32_bf16 v[64:67], v[88:91], a[48:51], v[64:67]
    ds_read_b64_tr_b16 v[108:109], v21 offset:14208
    v_mfma_f32_16x16x32_bf16 v[68:71], v[88:91], a[128:131], v[68:71]
    ds_read_b64_tr_b16 v[110:111], v21 offset:14848
    s_waitcnt lgkmcnt(0)
    v_mfma_f32_16x16x32_bf16 v[32:35], v[92:95], a[52:55], v[32:35]
    ds_read_b64_tr_b16 v[72:73], v21 offset:2560
    v_mfma_f32_16x16x32_bf16 v[36:39], v[92:95], a[132:135], v[36:39]
    ds_read_b64_tr_b16 v[74:75], v21 offset:15360
    v_mfma_f32_16x16x32_bf16 v[40:43], v[96:99], a[52:55], v[40:43]
    ds_read_b64_tr_b16 v[76:77], v21 offset:2592
    v_mfma_f32_16x16x32_bf16 v[44:47], v[96:99], a[132:135], v[44:47]
    ds_read_b64_tr_b16 v[78:79], v21 offset:15392
    v_mfma_f32_16x16x32_bf16 v[48:51], v[100:103], a[52:55], v[48:51]
    ds_read_b64_tr_b16 v[80:81], v21 offset:2624
    v_mfma_f32_16x16x32_bf16 v[52:55], v[100:103], a[132:135], v[52:55]
    ds_read_b64_tr_b16 v[82:83], v21 offset:15424
    v_mfma_f32_16x16x32_bf16 v[56:59], v[104:107], a[52:55], v[56:59]
    ds_read_b64_tr_b16 v[84:85], v21 offset:2656
    v_mfma_f32_16x16x32_bf16 v[60:63], v[104:107], a[132:135], v[60:63]
    ds_read_b64_tr_b16 v[86:87], v21 offset:15456
    v_mfma_f32_16x16x32_bf16 v[64:67], v[108:111], a[52:55], v[64:67]
    ds_read_b64_tr_b16 v[88:89], v21 offset:2688
    v_mfma_f32_16x16x32_bf16 v[68:71], v[108:111], a[132:135], v[68:71]
    ds_read_b64_tr_b16 v[90:91], v21 offset:15488
    s_waitcnt lgkmcnt(0)
    v_mfma_f32_16x16x32_bf16 v[32:35], v[72:75], a[56:59], v[32:35]
    v_mfma_f32_16x16x32_bf16 v[36:39], v[72:75], a[136:139], v[36:39]
    v_mfma_f32_16x16x32_bf16 v[40:43], v[76:79], a[56:59], v[40:43]
    v_mfma_f32_16x16x32_bf16 v[44:47], v[76:79], a[136:139], v[44:47]
    v_mfma_f32_16x16x32_bf16 v[48:51], v[80:83], a[56:59], v[48:51]
    v_mfma_f32_16x16x32_bf16 v[52:55], v[80:83], a[136:139], v[52:55]
    v_mfma_f32_16x16x32_bf16 v[56:59], v[84:87], a[56:59], v[56:59]
    v_mfma_f32_16x16x32_bf16 v[60:63], v[84:87], a[136:139], v[60:63]
    v_mfma_f32_16x16x32_bf16 v[64:67], v[88:91], a[56:59], v[64:67]
    v_mfma_f32_16x16x32_bf16 v[68:71], v[88:91], a[136:139], v[68:71]
    s_barrier
    s_add_u32 s28, s33, 409760
    s_mul_i32 s24, s9, 7168
    s_add_u32 m0, s24, 57344
    s_nop 0
    buffer_load_dwordx4 v0, s[20:23], s28 offen lds
    s_add_u32 m0, s24, 58368
    s_nop 0
    buffer_load_dwordx4 v1, s[20:23], s28 offen lds
    s_add_u32 m0, s24, 59392
    s_nop 0
    buffer_load_dwordx4 v2, s[20:23], s28 offen lds
    s_add_u32 m0, s24, 60416
    s_nop 0
    buffer_load_dwordx4 v3, s[20:23], s28 offen lds
    s_add_u32 m0, s24, 61440
    s_nop 0
    buffer_load_dwordx4 v4, s[20:23], s28 offen lds
    s_add_u32 m0, s24, 62464
    s_nop 0
    buffer_load_dwordx4 v5, s[20:23], s28 offen lds
    s_add_u32 m0, s24, 63488
    s_nop 0
    buffer_load_dwordx4 v6, s[20:23], s28 offen lds
    v_add_u32 v21, 86016, v18
    ds_read_b64_tr_b16 v[72:73], v21 offset:0
    ds_read_b64_tr_b16 v[74:75], v21 offset:640
    ds_read_b64_tr_b16 v[76:77], v21 offset:32
    ds_read_b64_tr_b16 v[78:79], v21 offset:672
    ds_read_b64_tr_b16 v[80:81], v21 offset:64
    ds_read_b64_tr_b16 v[82:83], v21 offset:704
    ds_read_b64_tr_b16 v[84:85], v21 offset:96
    ds_read_b64_tr_b16 v[86:87], v21 offset:736
    ds_read_b64_tr_b16 v[88:89], v21 offset:128
    ds_read_b64_tr_b16 v[90:91], v21 offset:768
    s_waitcnt lgkmcnt(0)
    v_mfma_f32_16x16x32_bf16 v[32:35], v[72:75], a[60:63], v[32:35]
    ds_read_b64_tr_b16 v[92:93], v21 offset:1280
    v_mfma_f32_16x16x32_bf16 v[36:39], v[72:75], a[140:143], v[36:39]
    ds_read_b64_tr_b16 v[94:95], v21 offset:1920
    v_mfma_f32_16x16x32_bf16 v[40:43], v[76:79], a[60:63], v[40:43]
    ds_read_b64_tr_b16 v[96:97], v21 offset:1312
    v_mfma_f32_16x16x32_bf16 v[44:47], v[76:79], a[140:143], v[44:47]
    ds_read_b64_tr_b16 v[98:99], v21 offset:1952
    v_mfma_f32_16x16x32_bf16 v[48:51], v[80:83], a[60:63], v[48:51]
    ds_read_b64_tr_b16 v[100:101], v21 offset:1344
    v_mfma_f32_16x16x32_bf16 v[52:55], v[80:83], a[140:143], v[52:55]
    ds_read_b64_tr_b16 v[102:103], v21 offset:1984
    v_mfma_f32_16x16x32_bf16 v[56:59], v[84:87], a[60:63], v[56:59]
    ds_read_b64_tr_b16 v[104:105], v21 offset:1376
    v_mfma_f32_16x16x32_bf16 v[60:63], v[84:87], a[140:143], v[60:63]
    ds_read_b64_tr_b16 v[106:107], v21 offset:2016
    v_mfma_f32_16x16x32_bf16 v[64:67], v[88:91], a[60:63], v[64:67]
    ds_read_b64_tr_b16 v[108:109], v21 offset:1408
    v_mfma_f32_16x16x32_bf16 v[68:71], v[88:91], a[140:143], v[68:71]
    ds_read_b64_tr_b16 v[110:111], v21 offset:2048
    s_waitcnt lgkmcnt(0)
    v_mfma_f32_16x16x32_bf16 v[32:35], v[92:95], a[64:67], v[32:35]
    ds_read_b64_tr_b16 v[72:73], v21 offset:12800
    v_mfma_f32_16x16x32_bf16 v[36:39], v[92:95], a[144:147], v[36:39]
    ds_read_b64_tr_b16 v[74:75], v21 offset:13440
    v_mfma_f32_16x16x32_bf16 v[40:43], v[96:99], a[64:67], v[40:43]
    ds_read_b64_tr_b16 v[76:77], v21 offset:12832
    v_mfma_f32_16x16x32_bf16 v[44:47], v[96:99], a[144:147], v[44:47]
    ds_read_b64_tr_b16 v[78:79], v21 offset:13472
    v_mfma_f32_16x16x32_bf16 v[48:51], v[100:103], a[64:67], v[48:51]
    ds_read_b64_tr_b16 v[80:81], v21 offset:12864
    v_mfma_f32_16x16x32_bf16 v[52:55], v[100:103], a[144:147], v[52:55]
    ds_read_b64_tr_b16 v[82:83], v21 offset:13504
    v_mfma_f32_16x16x32_bf16 v[56:59], v[104:107], a[64:67], v[56:59]
    ds_read_b64_tr_b16 v[84:85], v21 offset:12896
    v_mfma_f32_16x16x32_bf16 v[60:63], v[104:107], a[144:147], v[60:63]
    ds_read_b64_tr_b16 v[86:87], v21 offset:13536
    v_mfma_f32_16x16x32_bf16 v[64:67], v[108:111], a[64:67], v[64:67]
    ds_read_b64_tr_b16 v[88:89], v21 offset:12928
    v_mfma_f32_16x16x32_bf16 v[68:71], v[108:111], a[144:147], v[68:71]
    ds_read_b64_tr_b16 v[90:91], v21 offset:13568
    s_waitcnt lgkmcnt(0)
    v_mfma_f32_16x16x32_bf16 v[32:35], v[72:75], a[68:71], v[32:35]
    ds_read_b64_tr_b16 v[92:93], v21 offset:14080
    v_mfma_f32_16x16x32_bf16 v[36:39], v[72:75], a[148:151], v[36:39]
    ds_read_b64_tr_b16 v[94:95], v21 offset:14720
    v_mfma_f32_16x16x32_bf16 v[40:43], v[76:79], a[68:71], v[40:43]
    ds_read_b64_tr_b16 v[96:97], v21 offset:14112
    v_mfma_f32_16x16x32_bf16 v[44:47], v[76:79], a[148:151], v[44:47]
    ds_read_b64_tr_b16 v[98:99], v21 offset:14752
    v_mfma_f32_16x16x32_bf16 v[48:51], v[80:83], a[68:71], v[48:51]
    ds_read_b64_tr_b16 v[100:101], v21 offset:14144
    v_mfma_f32_16x16x32_bf16 v[52:55], v[80:83], a[148:151], v[52:55]
    ds_read_b64_tr_b16 v[102:103], v21 offset:14784
    v_mfma_f32_16x16x32_bf16 v[56:59], v[84:87], a[68:71], v[56:59]
    ds_read_b64_tr_b16 v[104:105], v21 offset:14176
    v_mfma_f32_16x16x32_bf16 v[60:63], v[84:87], a[148:151], v[60:63]
    ds_read_b64_tr_b16 v[106:107], v21 offset:14816
    v_mfma_f32_16x16x32_bf16 v[64:67], v[88:91], a[68:71], v[64:67]
    ds_read_b64_tr_b16 v[108:109], v21 offset:14208
    v_mfma_f32_16x16x32_bf16 v[68:71], v[88:91], a[148:151], v[68:71]
    ds_read_b64_tr_b16 v[110:111], v21 offset:14848
    s_waitcnt lgkmcnt(0)
    v_mfma_f32_16x16x32_bf16 v[32:35], v[92:95], a[72:75], v[32:35]
    ds_read_b64_tr_b16 v[72:73], v21 offset:2560
    v_mfma_f32_16x16x32_bf16 v[36:39], v[92:95], a[152:155], v[36:39]
    ds_read_b64_tr_b16 v[74:75], v21 offset:15360
    v_mfma_f32_16x16x32_bf16 v[40:43], v[96:99], a[72:75], v[40:43]
    ds_read_b64_tr_b16 v[76:77], v21 offset:2592
    v_mfma_f32_16x16x32_bf16 v[44:47], v[96:99], a[152:155], v[44:47]
    ds_read_b64_tr_b16 v[78:79], v21 offset:15392
    v_mfma_f32_16x16x32_bf16 v[48:51], v[100:103], a[72:75], v[48:51]
    ds_read_b64_tr_b16 v[80:81], v21 offset:2624
    v_mfma_f32_16x16x32_bf16 v[52:55], v[100:103], a[152:155], v[52:55]
    ds_read_b64_tr_b16 v[82:83], v21 offset:15424
    v_mfma_f32_16x16x32_bf16 v[56:59], v[104:107], a[72:75], v[56:59]
    ds_read_b64_tr_b16 v[84:85], v21 offset:2656
    v_mfma_f32_16x16x32_bf16 v[60:63], v[104:107], a[152:155], v[60:63]
    ds_read_b64_tr_b16 v[86:87], v21 offset:15456
    v_mfma_f32_16x16x32_bf16 v[64:67], v[108:111], a[72:75], v[64:67]
    ds_read_b64_tr_b16 v[88:89], v21 offset:2688
    v_mfma_f32_16x16x32_bf16 v[68:71], v[108:111], a[152:155], v[68:71]
    ds_read_b64_tr_b16 v[90:91], v21 offset:15488
    s_waitcnt lgkmcnt(0)
    v_mfma_f32_16x16x32_bf16 v[32:35], v[72:75], a[76:79], v[32:35]
    v_mfma_f32_16x16x32_bf16 v[36:39], v[72:75], a[156:159], v[36:39]
    v_mfma_f32_16x16x32_bf16 v[40:43], v[76:79], a[76:79], v[40:43]
    v_mfma_f32_16x16x32_bf16 v[44:47], v[76:79], a[156:159], v[44:47]
    v_mfma_f32_16x16x32_bf16 v[48:51], v[80:83], a[76:79], v[48:51]
    v_mfma_f32_16x16x32_bf16 v[52:55], v[80:83], a[156:159], v[52:55]
    v_mfma_f32_16x16x32_bf16 v[56:59], v[84:87], a[76:79], v[56:59]
    v_mfma_f32_16x16x32_bf16 v[60:63], v[84:87], a[156:159], v[60:63]
    v_mfma_f32_16x16x32_bf16 v[64:67], v[88:91], a[76:79], v[64:67]
    v_mfma_f32_16x16x32_bf16 v[68:71], v[88:91], a[156:159], v[68:71]
    s_nop 7
    v_cvt_pk_bf16_f32 v32, v32, v33
    v_cvt_pk_bf16_f32 v33, v34, v35
    buffer_store_dwordx2 v[32:33], v23, s[44:47], s36 offen offset:0 sc1
    v_cvt_pk_bf16_f32 v40, v40, v41
    v_cvt_pk_bf16_f32 v41, v42, v43
    buffer_store_dwordx2 v[40:41], v23, s[44:47], s36 offen offset:32 sc1
    v_cvt_pk_bf16_f32 v48, v48, v49
    v_cvt_pk_bf16_f32 v49, v50, v51
    buffer_store_dwordx2 v[48:49], v23, s[44:47], s36 offen offset:64 sc1
    v_cvt_pk_bf16_f32 v56, v56, v57
    v_cvt_pk_bf16_f32 v57, v58, v59
    buffer_store_dwordx2 v[56:57], v23, s[44:47], s36 offen offset:96 sc1
    v_cvt_pk_bf16_f32 v64, v64, v65
    v_cvt_pk_bf16_f32 v65, v66, v67
    buffer_store_dwordx2 v[64:65], v23, s[44:47], s36 offen offset:128 sc1
    v_cvt_pk_bf16_f32 v36, v36, v37
    v_cvt_pk_bf16_f32 v37, v38, v39
    buffer_store_dwordx2 v[36:37], v23, s[44:47], s37 offen offset:0 sc1
    v_cvt_pk_bf16_f32 v44, v44, v45
    v_cvt_pk_bf16_f32 v45, v46, v47
    buffer_store_dwordx2 v[44:45], v23, s[44:47], s37 offen offset:32 sc1
    v_cvt_pk_bf16_f32 v52, v52, v53
    v_cvt_pk_bf16_f32 v53, v54, v55
    buffer_store_dwordx2 v[52:53], v23, s[44:47], s37 offen offset:64 sc1
    v_cvt_pk_bf16_f32 v60, v60, v61
    v_cvt_pk_bf16_f32 v61, v62, v63
    buffer_store_dwordx2 v[60:61], v23, s[44:47], s37 offen offset:96 sc1
    v_cvt_pk_bf16_f32 v68, v68, v69
    v_cvt_pk_bf16_f32 v69, v70, v71
    buffer_store_dwordx2 v[68:69], v23, s[44:47], s37 offen offset:128 sc1
    s_waitcnt vmcnt(24)
    s_barrier
    s_add_u32 s28, s33, 614560
    s_mul_i32 s24, s9, 7168
    s_add_u32 m0, s24, 86016
    s_nop 0
    buffer_load_dwordx4 v0, s[20:23], s28 offen lds
    s_add_u32 m0, s24, 87040
    s_nop 0
    buffer_load_dwordx4 v1, s[20:23], s28 offen lds
    s_add_u32 m0, s24, 88064
    s_nop 0
    buffer_load_dwordx4 v2, s[20:23], s28 offen lds
    s_add_u32 m0, s24, 89088
    s_nop 0
    buffer_load_dwordx4 v3, s[20:23], s28 offen lds
    s_add_u32 m0, s24, 90112
    s_nop 0
    buffer_load_dwordx4 v4, s[20:23], s28 offen lds
    s_add_u32 m0, s24, 91136
    s_nop 0
    buffer_load_dwordx4 v5, s[20:23], s28 offen lds
    s_add_u32 m0, s24, 92160
    s_nop 0
    buffer_load_dwordx4 v6, s[20:23], s28 offen lds
    v_add_u32 v21, 0, v18
    ds_read_b64_tr_b16 v[72:73], v21 offset:0
    ds_read_b64_tr_b16 v[74:75], v21 offset:640
    ds_read_b64_tr_b16 v[76:77], v21 offset:32
    ds_read_b64_tr_b16 v[78:79], v21 offset:672
    ds_read_b64_tr_b16 v[80:81], v21 offset:64
    ds_read_b64_tr_b16 v[82:83], v21 offset:704
    ds_read_b64_tr_b16 v[84:85], v21 offset:96
    ds_read_b64_tr_b16 v[86:87], v21 offset:736
    ds_read_b64_tr_b16 v[88:89], v21 offset:128
    ds_read_b64_tr_b16 v[90:91], v21 offset:768
    s_waitcnt lgkmcnt(0)
    v_mfma_f32_16x16x32_bf16 v[32:35], v[72:75], a[0:3], 0
    ds_read_b64_tr_b16 v[92:93], v21 offset:1280
    v_mfma_f32_16x16x32_bf16 v[36:39], v[72:75], a[80:83], 0
    ds_read_b64_tr_b16 v[94:95], v21 offset:1920
    v_mfma_f32_16x16x32_bf16 v[40:43], v[76:79], a[0:3], 0
    ds_read_b64_tr_b16 v[96:97], v21 offset:1312
    v_mfma_f32_16x16x32_bf16 v[44:47], v[76:79], a[80:83], 0
    ds_read_b64_tr_b16 v[98:99], v21 offset:1952
    v_mfma_f32_16x16x32_bf16 v[48:51], v[80:83], a[0:3], 0
    ds_read_b64_tr_b16 v[100:101], v21 offset:1344
    v_mfma_f32_16x16x32_bf16 v[52:55], v[80:83], a[80:83], 0
    ds_read_b64_tr_b16 v[102:103], v21 offset:1984
    v_mfma_f32_16x16x32_bf16 v[56:59], v[84:87], a[0:3], 0
    ds_read_b64_tr_b16 v[104:105], v21 offset:1376
    v_mfma_f32_16x16x32_bf16 v[60:63], v[84:87], a[80:83], 0
    ds_read_b64_tr_b16 v[106:107], v21 offset:2016
    v_mfma_f32_16x16x32_bf16 v[64:67], v[88:91], a[0:3], 0
    ds_read_b64_tr_b16 v[108:109], v21 offset:1408
    v_mfma_f32_16x16x32_bf16 v[68:71], v[88:91], a[80:83], 0
    ds_read_b64_tr_b16 v[110:111], v21 offset:2048
    s_waitcnt lgkmcnt(0)
    v_mfma_f32_16x16x32_bf16 v[32:35], v[92:95], a[4:7], v[32:35]
    ds_read_b64_tr_b16 v[72:73], v21 offset:12800
    v_mfma_f32_16x16x32_bf16 v[36:39], v[92:95], a[84:87], v[36:39]
    ds_read_b64_tr_b16 v[74:75], v21 offset:13440
    v_mfma_f32_16x16x32_bf16 v[40:43], v[96:99], a[4:7], v[40:43]
    ds_read_b64_tr_b16 v[76:77], v21 offset:12832
    v_mfma_f32_16x16x32_bf16 v[44:47], v[96:99], a[84:87], v[44:47]
    ds_read_b64_tr_b16 v[78:79], v21 offset:13472
    v_mfma_f32_16x16x32_bf16 v[48:51], v[100:103], a[4:7], v[48:51]
    ds_read_b64_tr_b16 v[80:81], v21 offset:12864
    v_mfma_f32_16x16x32_bf16 v[52:55], v[100:103], a[84:87], v[52:55]
    ds_read_b64_tr_b16 v[82:83], v21 offset:13504
    v_mfma_f32_16x16x32_bf16 v[56:59], v[104:107], a[4:7], v[56:59]
    ds_read_b64_tr_b16 v[84:85], v21 offset:12896
    v_mfma_f32_16x16x32_bf16 v[60:63], v[104:107], a[84:87], v[60:63]
    ds_read_b64_tr_b16 v[86:87], v21 offset:13536
    v_mfma_f32_16x16x32_bf16 v[64:67], v[108:111], a[4:7], v[64:67]
    ds_read_b64_tr_b16 v[88:89], v21 offset:12928
    v_mfma_f32_16x16x32_bf16 v[68:71], v[108:111], a[84:87], v[68:71]
    ds_read_b64_tr_b16 v[90:91], v21 offset:13568
    s_waitcnt lgkmcnt(0)
    v_mfma_f32_16x16x32_bf16 v[32:35], v[72:75], a[8:11], v[32:35]
    ds_read_b64_tr_b16 v[92:93], v21 offset:14080
    v_mfma_f32_16x16x32_bf16 v[36:39], v[72:75], a[88:91], v[36:39]
    ds_read_b64_tr_b16 v[94:95], v21 offset:14720
    v_mfma_f32_16x16x32_bf16 v[40:43], v[76:79], a[8:11], v[40:43]
    ds_read_b64_tr_b16 v[96:97], v21 offset:14112
    v_mfma_f32_16x16x32_bf16 v[44:47], v[76:79], a[88:91], v[44:47]
    ds_read_b64_tr_b16 v[98:99], v21 offset:14752
    v_mfma_f32_16x16x32_bf16 v[48:51], v[80:83], a[8:11], v[48:51]
    ds_read_b64_tr_b16 v[100:101], v21 offset:14144
    v_mfma_f32_16x16x32_bf16 v[52:55], v[80:83], a[88:91], v[52:55]
    ds_read_b64_tr_b16 v[102:103], v21 offset:14784
    v_mfma_f32_16x16x32_bf16 v[56:59], v[84:87], a[8:11], v[56:59]
    ds_read_b64_tr_b16 v[104:105], v21 offset:14176
    v_mfma_f32_16x16x32_bf16 v[60:63], v[84:87], a[88:91], v[60:63]
    ds_read_b64_tr_b16 v[106:107], v21 offset:14816
    v_mfma_f32_16x16x32_bf16 v[64:67], v[88:91], a[8:11], v[64:67]
    ds_read_b64_tr_b16 v[108:109], v21 offset:14208
    v_mfma_f32_16x16x32_bf16 v[68:71], v[88:91], a[88:91], v[68:71]
    ds_read_b64_tr_b16 v[110:111], v21 offset:14848
    s_waitcnt lgkmcnt(0)
    v_mfma_f32_16x16x32_bf16 v[32:35], v[92:95], a[12:15], v[32:35]
    ds_read_b64_tr_b16 v[72:73], v21 offset:2560
    v_mfma_f32_16x16x32_bf16 v[36:39], v[92:95], a[92:95], v[36:39]
    ds_read_b64_tr_b16 v[74:75], v21 offset:15360
    v_mfma_f32_16x16x32_bf16 v[40:43], v[96:99], a[12:15], v[40:43]
    ds_read_b64_tr_b16 v[76:77], v21 offset:2592
    v_mfma_f32_16x16x32_bf16 v[44:47], v[96:99], a[92:95], v[44:47]
    ds_read_b64_tr_b16 v[78:79], v21 offset:15392
    v_mfma_f32_16x16x32_bf16 v[48:51], v[100:103], a[12:15], v[48:51]
    ds_read_b64_tr_b16 v[80:81], v21 offset:2624
    v_mfma_f32_16x16x32_bf16 v[52:55], v[100:103], a[92:95], v[52:55]
    ds_read_b64_tr_b16 v[82:83], v21 offset:15424
    v_mfma_f32_16x16x32_bf16 v[56:59], v[104:107], a[12:15], v[56:59]
    ds_read_b64_tr_b16 v[84:85], v21 offset:2656
    v_mfma_f32_16x16x32_bf16 v[60:63], v[104:107], a[92:95], v[60:63]
    ds_read_b64_tr_b16 v[86:87], v21 offset:15456
    v_mfma_f32_16x16x32_bf16 v[64:67], v[108:111], a[12:15], v[64:67]
    ds_read_b64_tr_b16 v[88:89], v21 offset:2688
    v_mfma_f32_16x16x32_bf16 v[68:71], v[108:111], a[92:95], v[68:71]
    ds_read_b64_tr_b16 v[90:91], v21 offset:15488
    s_waitcnt lgkmcnt(0)
    v_mfma_f32_16x16x32_bf16 v[32:35], v[72:75], a[16:19], v[32:35]
    v_mfma_f32_16x16x32_bf16 v[36:39], v[72:75], a[96:99], v[36:39]
    v_mfma_f32_16x16x32_bf16 v[40:43], v[76:79], a[16:19], v[40:43]
    v_mfma_f32_16x16x32_bf16 v[44:47], v[76:79], a[96:99], v[44:47]
    v_mfma_f32_16x16x32_bf16 v[48:51], v[80:83], a[16:19], v[48:51]
    v_mfma_f32_16x16x32_bf16 v[52:55], v[80:83], a[96:99], v[52:55]
    v_mfma_f32_16x16x32_bf16 v[56:59], v[84:87], a[16:19], v[56:59]
    v_mfma_f32_16x16x32_bf16 v[60:63], v[84:87], a[96:99], v[60:63]
    v_mfma_f32_16x16x32_bf16 v[64:67], v[88:91], a[16:19], v[64:67]
    v_mfma_f32_16x16x32_bf16 v[68:71], v[88:91], a[96:99], v[68:71]
    s_waitcnt vmcnt(24)
    s_barrier
    v_add_u32 v21, 28672, v18
    ds_read_b64_tr_b16 v[72:73], v21 offset:0
    ds_read_b64_tr_b16 v[74:75], v21 offset:640
    ds_read_b64_tr_b16 v[76:77], v21 offset:32
    ds_read_b64_tr_b16 v[78:79], v21 offset:672
    ds_read_b64_tr_b16 v[80:81], v21 offset:64
    ds_read_b64_tr_b16 v[82:83], v21 offset:704
    ds_read_b64_tr_b16 v[84:85], v21 offset:96
    ds_read_b64_tr_b16 v[86:87], v21 offset:736
    ds_read_b64_tr_b16 v[88:89], v21 offset:128
    ds_read_b64_tr_b16 v[90:91], v21 offset:768
    s_waitcnt lgkmcnt(0)
    v_mfma_f32_16x16x32_bf16 v[32:35], v[72:75], a[20:23], v[32:35]
    ds_read_b64_tr_b16 v[92:93], v21 offset:1280
    v_mfma_f32_16x16x32_bf16 v[36:39], v[72:75], a[100:103], v[36:39]
    ds_read_b64_tr_b16 v[94:95], v21 offset:1920
    v_mfma_f32_16x16x32_bf16 v[40:43], v[76:79], a[20:23], v[40:43]
    ds_read_b64_tr_b16 v[96:97], v21 offset:1312
    v_mfma_f32_16x16x32_bf16 v[44:47], v[76:79], a[100:103], v[44:47]
    ds_read_b64_tr_b16 v[98:99], v21 offset:1952
    v_mfma_f32_16x16x32_bf16 v[48:51], v[80:83], a[20:23], v[48:51]
    ds_read_b64_tr_b16 v[100:101], v21 offset:1344
    v_mfma_f32_16x16x32_bf16 v[52:55], v[80:83], a[100:103], v[52:55]
    ds_read_b64_tr_b16 v[102:103], v21 offset:1984
    v_mfma_f32_16x16x32_bf16 v[56:59], v[84:87], a[20:23], v[56:59]
    ds_read_b64_tr_b16 v[104:105], v21 offset:1376
    v_mfma_f32_16x16x32_bf16 v[60:63], v[84:87], a[100:103], v[60:63]
    ds_read_b64_tr_b16 v[106:107], v21 offset:2016
    v_mfma_f32_16x16x32_bf16 v[64:67], v[88:91], a[20:23], v[64:67]
    ds_read_b64_tr_b16 v[108:109], v21 offset:1408
    v_mfma_f32_16x16x32_bf16 v[68:71], v[88:91], a[100:103], v[68:71]
    ds_read_b64_tr_b16 v[110:111], v21 offset:2048
    s_waitcnt lgkmcnt(0)
    v_mfma_f32_16x16x32_bf16 v[32:35], v[92:95], a[24:27], v[32:35]
    ds_read_b64_tr_b16 v[72:73], v21 offset:12800
    v_mfma_f32_16x16x32_bf16 v[36:39], v[92:95], a[104:107], v[36:39]
    ds_read_b64_tr_b16 v[74:75], v21 offset:13440
    v_mfma_f32_16x16x32_bf16 v[40:43], v[96:99], a[24:27], v[40:43]
    ds_read_b64_tr_b16 v[76:77], v21 offset:12832
    v_mfma_f32_16x16x32_bf16 v[44:47], v[96:99], a[104:107], v[44:47]
    ds_read_b64_tr_b16 v[78:79], v21 offset:13472
    v_mfma_f32_16x16x32_bf16 v[48:51], v[100:103], a[24:27], v[48:51]
    ds_read_b64_tr_b16 v[80:81], v21 offset:12864
    v_mfma_f32_16x16x32_bf16 v[52:55], v[100:103], a[104:107], v[52:55]
    ds_read_b64_tr_b16 v[82:83], v21 offset:13504
    v_mfma_f32_16x16x32_bf16 v[56:59], v[104:107], a[24:27], v[56:59]
    ds_read_b64_tr_b16 v[84:85], v21 offset:12896
    v_mfma_f32_16x16x32_bf16 v[60:63], v[104:107], a[104:107], v[60:63]
    ds_read_b64_tr_b16 v[86:87], v21 offset:13536
    v_mfma_f32_16x16x32_bf16 v[64:67], v[108:111], a[24:27], v[64:67]
    ds_read_b64_tr_b16 v[88:89], v21 offset:12928
    v_mfma_f32_16x16x32_bf16 v[68:71], v[108:111], a[104:107], v[68:71]
    ds_read_b64_tr_b16 v[90:91], v21 offset:13568
    s_waitcnt lgkmcnt(0)
    v_mfma_f32_16x16x32_bf16 v[32:35], v[72:75], a[28:31], v[32:35]
    ds_read_b64_tr_b16 v[92:93], v21 offset:14080
    v_mfma_f32_16x16x32_bf16 v[36:39], v[72:75], a[108:111], v[36:39]
    ds_read_b64_tr_b16 v[94:95], v21 offset:14720
    v_mfma_f32_16x16x32_bf16 v[40:43], v[76:79], a[28:31], v[40:43]
    ds_read_b64_tr_b16 v[96:97], v21 offset:14112
    v_mfma_f32_16x16x32_bf16 v[44:47], v[76:79], a[108:111], v[44:47]
    ds_read_b64_tr_b16 v[98:99], v21 offset:14752
    v_mfma_f32_16x16x32_bf16 v[48:51], v[80:83], a[28:31], v[48:51]
    ds_read_b64_tr_b16 v[100:101], v21 offset:14144
    v_mfma_f32_16x16x32_bf16 v[52:55], v[80:83], a[108:111], v[52:55]
    ds_read_b64_tr_b16 v[102:103], v21 offset:14784
    v_mfma_f32_16x16x32_bf16 v[56:59], v[84:87], a[28:31], v[56:59]
    ds_read_b64_tr_b16 v[104:105], v21 offset:14176
    v_mfma_f32_16x16x32_bf16 v[60:63], v[84:87], a[108:111], v[60:63]
    ds_read_b64_tr_b16 v[106:107], v21 offset:14816
    v_mfma_f32_16x16x32_bf16 v[64:67], v[88:91], a[28:31], v[64:67]
    ds_read_b64_tr_b16 v[108:109], v21 offset:14208
    v_mfma_f32_16x16x32_bf16 v[68:71], v[88:91], a[108:111], v[68:71]
    ds_read_b64_tr_b16 v[110:111], v21 offset:14848
    s_waitcnt lgkmcnt(0)
    v_mfma_f32_16x16x32_bf16 v[32:35], v[92:95], a[32:35], v[32:35]
    ds_read_b64_tr_b16 v[72:73], v21 offset:2560
    v_mfma_f32_16x16x32_bf16 v[36:39], v[92:95], a[112:115], v[36:39]
    ds_read_b64_tr_b16 v[74:75], v21 offset:15360
    v_mfma_f32_16x16x32_bf16 v[40:43], v[96:99], a[32:35], v[40:43]
    ds_read_b64_tr_b16 v[76:77], v21 offset:2592
    v_mfma_f32_16x16x32_bf16 v[44:47], v[96:99], a[112:115], v[44:47]
    ds_read_b64_tr_b16 v[78:79], v21 offset:15392
    v_mfma_f32_16x16x32_bf16 v[48:51], v[100:103], a[32:35], v[48:51]
    ds_read_b64_tr_b16 v[80:81], v21 offset:2624
    v_mfma_f32_16x16x32_bf16 v[52:55], v[100:103], a[112:115], v[52:55]
    ds_read_b64_tr_b16 v[82:83], v21 offset:15424
    v_mfma_f32_16x16x32_bf16 v[56:59], v[104:107], a[32:35], v[56:59]
    ds_read_b64_tr_b16 v[84:85], v21 offset:2656
    v_mfma_f32_16x16x32_bf16 v[60:63], v[104:107], a[112:115], v[60:63]
    ds_read_b64_tr_b16 v[86:87], v21 offset:15456
    v_mfma_f32_16x16x32_bf16 v[64:67], v[108:111], a[32:35], v[64:67]
    ds_read_b64_tr_b16 v[88:89], v21 offset:2688
    v_mfma_f32_16x16x32_bf16 v[68:71], v[108:111], a[112:115], v[68:71]
    ds_read_b64_tr_b16 v[90:91], v21 offset:15488
    s_waitcnt lgkmcnt(0)
    v_mfma_f32_16x16x32_bf16 v[32:35], v[72:75], a[36:39], v[32:35]
    v_mfma_f32_16x16x32_bf16 v[36:39], v[72:75], a[116:119], v[36:39]
    v_mfma_f32_16x16x32_bf16 v[40:43], v[76:79], a[36:39], v[40:43]
    v_mfma_f32_16x16x32_bf16 v[44:47], v[76:79], a[116:119], v[44:47]
    v_mfma_f32_16x16x32_bf16 v[48:51], v[80:83], a[36:39], v[48:51]
    v_mfma_f32_16x16x32_bf16 v[52:55], v[80:83], a[116:119], v[52:55]
    v_mfma_f32_16x16x32_bf16 v[56:59], v[84:87], a[36:39], v[56:59]
    v_mfma_f32_16x16x32_bf16 v[60:63], v[84:87], a[116:119], v[60:63]
    v_mfma_f32_16x16x32_bf16 v[64:67], v[88:91], a[36:39], v[64:67]
    v_mfma_f32_16x16x32_bf16 v[68:71], v[88:91], a[116:119], v[68:71]
    s_waitcnt vmcnt(17)
    s_barrier
    v_add_u32 v21, 57344, v18
    ds_read_b64_tr_b16 v[72:73], v21 offset:0
    ds_read_b64_tr_b16 v[74:75], v21 offset:640
    ds_read_b64_tr_b16 v[76:77], v21 offset:32
    ds_read_b64_tr_b16 v[78:79], v21 offset:672
    ds_read_b64_tr_b16 v[80:81], v21 offset:64
    ds_read_b64_tr_b16 v[82:83], v21 offset:704
    ds_read_b64_tr_b16 v[84:85], v21 offset:96
    ds_read_b64_tr_b16 v[86:87], v21 offset:736
    ds_read_b64_tr_b16 v[88:89], v21 offset:128
    ds_read_b64_tr_b16 v[90:91], v21 offset:768
    s_waitcnt lgkmcnt(0)
    v_mfma_f32_16x16x32_bf16 v[32:35], v[72:75], a[40:43], v[32:35]
    ds_read_b64_tr_b16 v[92:93], v21 offset:1280
    v_mfma_f32_16x16x32_bf16 v[36:39], v[72:75], a[120:123], v[36:39]
    ds_read_b64_tr_b16 v[94:95], v21 offset:1920
    v_mfma_f32_16x16x32_bf16 v[40:43], v[76:79], a[40:43], v[40:43]
    ds_read_b64_tr_b16 v[96:97], v21 offset:1312
    v_mfma_f32_16x16x32_bf16 v[44:47], v[76:79], a[120:123], v[44:47]
    ds_read_b64_tr_b16 v[98:99], v21 offset:1952
    v_mfma_f32_16x16x32_bf16 v[48:51], v[80:83], a[40:43], v[48:51]
    ds_read_b64_tr_b16 v[100:101], v21 offset:1344
    v_mfma_f32_16x16x32_bf16 v[52:55], v[80:83], a[120:123], v[52:55]
    ds_read_b64_tr_b16 v[102:103], v21 offset:1984
    v_mfma_f32_16x16x32_bf16 v[56:59], v[84:87], a[40:43], v[56:59]
    ds_read_b64_tr_b16 v[104:105], v21 offset:1376
    v_mfma_f32_16x16x32_bf16 v[60:63], v[84:87], a[120:123], v[60:63]
    ds_read_b64_tr_b16 v[106:107], v21 offset:2016
    v_mfma_f32_16x16x32_bf16 v[64:67], v[88:91], a[40:43], v[64:67]
    ds_read_b64_tr_b16 v[108:109], v21 offset:1408
    v_mfma_f32_16x16x32_bf16 v[68:71], v[88:91], a[120:123], v[68:71]
    ds_read_b64_tr_b16 v[110:111], v21 offset:2048
    s_waitcnt lgkmcnt(0)
    v_mfma_f32_16x16x32_bf16 v[32:35], v[92:95], a[44:47], v[32:35]
    ds_read_b64_tr_b16 v[72:73], v21 offset:12800
    v_mfma_f32_16x16x32_bf16 v[36:39], v[92:95], a[124:127], v[36:39]
    ds_read_b64_tr_b16 v[74:75], v21 offset:13440
    v_mfma_f32_16x16x32_bf16 v[40:43], v[96:99], a[44:47], v[40:43]
    ds_read_b64_tr_b16 v[76:77], v21 offset:12832
    v_mfma_f32_16x16x32_bf16 v[44:47], v[96:99], a[124:127], v[44:47]
    ds_read_b64_tr_b16 v[78:79], v21 offset:13472
    v_mfma_f32_16x16x32_bf16 v[48:51], v[100:103], a[44:47], v[48:51]
    ds_read_b64_tr_b16 v[80:81], v21 offset:12864
    v_mfma_f32_16x16x32_bf16 v[52:55], v[100:103], a[124:127], v[52:55]
    ds_read_b64_tr_b16 v[82:83], v21 offset:13504
    v_mfma_f32_16x16x32_bf16 v[56:59], v[104:107], a[44:47], v[56:59]
    ds_read_b64_tr_b16 v[84:85], v21 offset:12896
    v_mfma_f32_16x16x32_bf16 v[60:63], v[104:107], a[124:127], v[60:63]
    ds_read_b64_tr_b16 v[86:87], v21 offset:13536
    v_mfma_f32_16x16x32_bf16 v[64:67], v[108:111], a[44:47], v[64:67]
    ds_read_b64_tr_b16 v[88:89], v21 offset:12928
    v_mfma_f32_16x16x32_bf16 v[68:71], v[108:111], a[124:127], v[68:71]
    ds_read_b64_tr_b16 v[90:91], v21 offset:13568
    s_waitcnt lgkmcnt(0)
    v_mfma_f32_16x16x32_bf16 v[32:35], v[72:75], a[48:51], v[32:35]
    ds_read_b64_tr_b16 v[92:93], v21 offset:14080
    v_mfma_f32_16x16x32_bf16 v[36:39], v[72:75], a[128:131], v[36:39]
    ds_read_b64_tr_b16 v[94:95], v21 offset:14720
    v_mfma_f32_16x16x32_bf16 v[40:43], v[76:79], a[48:51], v[40:43]
    ds_read_b64_tr_b16 v[96:97], v21 offset:14112
    v_mfma_f32_16x16x32_bf16 v[44:47], v[76:79], a[128:131], v[44:47]
    ds_read_b64_tr_b16 v[98:99], v21 offset:14752
    v_mfma_f32_16x16x32_bf16 v[48:51], v[80:83], a[48:51], v[48:51]
    ds_read_b64_tr_b16 v[100:101], v21 offset:14144
    v_mfma_f32_16x16x32_bf16 v[52:55], v[80:83], a[128:131], v[52:55]
    ds_read_b64_tr_b16 v[102:103], v21 offset:14784
    v_mfma_f32_16x16x32_bf16 v[56:59], v[84:87], a[48:51], v[56:59]
    ds_read_b64_tr_b16 v[104:105], v21 offset:14176
    v_mfma_f32_16x16x32_bf16 v[60:63], v[84:87], a[128:131], v[60:63]
    ds_read_b64_tr_b16 v[106:107], v21 offset:14816
    v_mfma_f32_16x16x32_bf16 v[64:67], v[88:91], a[48:51], v[64:67]
    ds_read_b64_tr_b16 v[108:109], v21 offset:14208
    v_mfma_f32_16x16x32_bf16 v[68:71], v[88:91], a[128:131], v[68:71]
    ds_read_b64_tr_b16 v[110:111], v21 offset:14848
    s_waitcnt lgkmcnt(0)
    v_mfma_f32_16x16x32_bf16 v[32:35], v[92:95], a[52:55], v[32:35]
    ds_read_b64_tr_b16 v[72:73], v21 offset:2560
    v_mfma_f32_16x16x32_bf16 v[36:39], v[92:95], a[132:135], v[36:39]
    ds_read_b64_tr_b16 v[74:75], v21 offset:15360
    v_mfma_f32_16x16x32_bf16 v[40:43], v[96:99], a[52:55], v[40:43]
    ds_read_b64_tr_b16 v[76:77], v21 offset:2592
    v_mfma_f32_16x16x32_bf16 v[44:47], v[96:99], a[132:135], v[44:47]
    ds_read_b64_tr_b16 v[78:79], v21 offset:15392
    v_mfma_f32_16x16x32_bf16 v[48:51], v[100:103], a[52:55], v[48:51]
    ds_read_b64_tr_b16 v[80:81], v21 offset:2624
    v_mfma_f32_16x16x32_bf16 v[52:55], v[100:103], a[132:135], v[52:55]
    ds_read_b64_tr_b16 v[82:83], v21 offset:15424
    v_mfma_f32_16x16x32_bf16 v[56:59], v[104:107], a[52:55], v[56:59]
    ds_read_b64_tr_b16 v[84:85], v21 offset:2656
    v_mfma_f32_16x16x32_bf16 v[60:63], v[104:107], a[132:135], v[60:63]
    ds_read_b64_tr_b16 v[86:87], v21 offset:15456
    v_mfma_f32_16x16x32_bf16 v[64:67], v[108:111], a[52:55], v[64:67]
    ds_read_b64_tr_b16 v[88:89], v21 offset:2688
    v_mfma_f32_16x16x32_bf16 v[68:71], v[108:111], a[132:135], v[68:71]
    ds_read_b64_tr_b16 v[90:91], v21 offset:15488
    s_waitcnt lgkmcnt(0)
    v_mfma_f32_16x16x32_bf16 v[32:35], v[72:75], a[56:59], v[32:35]
    v_mfma_f32_16x16x32_bf16 v[36:39], v[72:75], a[136:139], v[36:39]
    v_mfma_f32_16x16x32_bf16 v[40:43], v[76:79], a[56:59], v[40:43]
    v_mfma_f32_16x16x32_bf16 v[44:47], v[76:79], a[136:139], v[44:47]
    v_mfma_f32_16x16x32_bf16 v[48:51], v[80:83], a[56:59], v[48:51]
    v_mfma_f32_16x16x32_bf16 v[52:55], v[80:83], a[136:139], v[52:55]
    v_mfma_f32_16x16x32_bf16 v[56:59], v[84:87], a[56:59], v[56:59]
    v_mfma_f32_16x16x32_bf16 v[60:63], v[84:87], a[136:139], v[60:63]
    v_mfma_f32_16x16x32_bf16 v[64:67], v[88:91], a[56:59], v[64:67]
    v_mfma_f32_16x16x32_bf16 v[68:71], v[88:91], a[136:139], v[68:71]
    s_waitcnt vmcnt(0)
    s_barrier
    v_add_u32 v21, 86016, v18
    ds_read_b64_tr_b16 v[72:73], v21 offset:0
    ds_read_b64_tr_b16 v[74:75], v21 offset:640
    ds_read_b64_tr_b16 v[76:77], v21 offset:32
    ds_read_b64_tr_b16 v[78:79], v21 offset:672
    ds_read_b64_tr_b16 v[80:81], v21 offset:64
    ds_read_b64_tr_b16 v[82:83], v21 offset:704
    ds_read_b64_tr_b16 v[84:85], v21 offset:96
    ds_read_b64_tr_b16 v[86:87], v21 offset:736
    ds_read_b64_tr_b16 v[88:89], v21 offset:128
    ds_read_b64_tr_b16 v[90:91], v21 offset:768
    s_waitcnt lgkmcnt(0)
    v_mfma_f32_16x16x32_bf16 v[32:35], v[72:75], a[60:63], v[32:35]
    ds_read_b64_tr_b16 v[92:93], v21 offset:1280
    v_mfma_f32_16x16x32_bf16 v[36:39], v[72:75], a[140:143], v[36:39]
    ds_read_b64_tr_b16 v[94:95], v21 offset:1920
    v_mfma_f32_16x16x32_bf16 v[40:43], v[76:79], a[60:63], v[40:43]
    ds_read_b64_tr_b16 v[96:97], v21 offset:1312
    v_mfma_f32_16x16x32_bf16 v[44:47], v[76:79], a[140:143], v[44:47]
    ds_read_b64_tr_b16 v[98:99], v21 offset:1952
    v_mfma_f32_16x16x32_bf16 v[48:51], v[80:83], a[60:63], v[48:51]
    ds_read_b64_tr_b16 v[100:101], v21 offset:1344
    v_mfma_f32_16x16x32_bf16 v[52:55], v[80:83], a[140:143], v[52:55]
    ds_read_b64_tr_b16 v[102:103], v21 offset:1984
    v_mfma_f32_16x16x32_bf16 v[56:59], v[84:87], a[60:63], v[56:59]
    ds_read_b64_tr_b16 v[104:105], v21 offset:1376
    v_mfma_f32_16x16x32_bf16 v[60:63], v[84:87], a[140:143], v[60:63]
    ds_read_b64_tr_b16 v[106:107], v21 offset:2016
    v_mfma_f32_16x16x32_bf16 v[64:67], v[88:91], a[60:63], v[64:67]
    ds_read_b64_tr_b16 v[108:109], v21 offset:1408
    v_mfma_f32_16x16x32_bf16 v[68:71], v[88:91], a[140:143], v[68:71]
    ds_read_b64_tr_b16 v[110:111], v21 offset:2048
    s_waitcnt lgkmcnt(0)
    v_mfma_f32_16x16x32_bf16 v[32:35], v[92:95], a[64:67], v[32:35]
    ds_read_b64_tr_b16 v[72:73], v21 offset:12800
    v_mfma_f32_16x16x32_bf16 v[36:39], v[92:95], a[144:147], v[36:39]
    ds_read_b64_tr_b16 v[74:75], v21 offset:13440
    v_mfma_f32_16x16x32_bf16 v[40:43], v[96:99], a[64:67], v[40:43]
    ds_read_b64_tr_b16 v[76:77], v21 offset:12832
    v_mfma_f32_16x16x32_bf16 v[44:47], v[96:99], a[144:147], v[44:47]
    ds_read_b64_tr_b16 v[78:79], v21 offset:13472
    v_mfma_f32_16x16x32_bf16 v[48:51], v[100:103], a[64:67], v[48:51]
    ds_read_b64_tr_b16 v[80:81], v21 offset:12864
    v_mfma_f32_16x16x32_bf16 v[52:55], v[100:103], a[144:147], v[52:55]
    ds_read_b64_tr_b16 v[82:83], v21 offset:13504
    v_mfma_f32_16x16x32_bf16 v[56:59], v[104:107], a[64:67], v[56:59]
    ds_read_b64_tr_b16 v[84:85], v21 offset:12896
    v_mfma_f32_16x16x32_bf16 v[60:63], v[104:107], a[144:147], v[60:63]
    ds_read_b64_tr_b16 v[86:87], v21 offset:13536
    v_mfma_f32_16x16x32_bf16 v[64:67], v[108:111], a[64:67], v[64:67]
    ds_read_b64_tr_b16 v[88:89], v21 offset:12928
    v_mfma_f32_16x16x32_bf16 v[68:71], v[108:111], a[144:147], v[68:71]
    ds_read_b64_tr_b16 v[90:91], v21 offset:13568
    s_waitcnt lgkmcnt(0)
    v_mfma_f32_16x16x32_bf16 v[32:35], v[72:75], a[68:71], v[32:35]
    ds_read_b64_tr_b16 v[92:93], v21 offset:14080
    v_mfma_f32_16x16x32_bf16 v[36:39], v[72:75], a[148:151], v[36:39]
    ds_read_b64_tr_b16 v[94:95], v21 offset:14720
    v_mfma_f32_16x16x32_bf16 v[40:43], v[76:79], a[68:71], v[40:43]
    ds_read_b64_tr_b16 v[96:97], v21 offset:14112
    v_mfma_f32_16x16x32_bf16 v[44:47], v[76:79], a[148:151], v[44:47]
    ds_read_b64_tr_b16 v[98:99], v21 offset:14752
    v_mfma_f32_16x16x32_bf16 v[48:51], v[80:83], a[68:71], v[48:51]
    ds_read_b64_tr_b16 v[100:101], v21 offset:14144
    v_mfma_f32_16x16x32_bf16 v[52:55], v[80:83], a[148:151], v[52:55]
    ds_read_b64_tr_b16 v[102:103], v21 offset:14784
    v_mfma_f32_16x16x32_bf16 v[56:59], v[84:87], a[68:71], v[56:59]
    ds_read_b64_tr_b16 v[104:105], v21 offset:14176
    v_mfma_f32_16x16x32_bf16 v[60:63], v[84:87], a[148:151], v[60:63]
    ds_read_b64_tr_b16 v[106:107], v21 offset:14816
    v_mfma_f32_16x16x32_bf16 v[64:67], v[88:91], a[68:71], v[64:67]
    ds_read_b64_tr_b16 v[108:109], v21 offset:14208
    v_mfma_f32_16x16x32_bf16 v[68:71], v[88:91], a[148:151], v[68:71]
    ds_read_b64_tr_b16 v[110:111], v21 offset:14848
    s_waitcnt lgkmcnt(0)
    v_mfma_f32_16x16x32_bf16 v[32:35], v[92:95], a[72:75], v[32:35]
    ds_read_b64_tr_b16 v[72:73], v21 offset:2560
    v_mfma_f32_16x16x32_bf16 v[36:39], v[92:95], a[152:155], v[36:39]
    ds_read_b64_tr_b16 v[74:75], v21 offset:15360
    v_mfma_f32_16x16x32_bf16 v[40:43], v[96:99], a[72:75], v[40:43]
    ds_read_b64_tr_b16 v[76:77], v21 offset:2592
    v_mfma_f32_16x16x32_bf16 v[44:47], v[96:99], a[152:155], v[44:47]
    ds_read_b64_tr_b16 v[78:79], v21 offset:15392
    v_mfma_f32_16x16x32_bf16 v[48:51], v[100:103], a[72:75], v[48:51]
    ds_read_b64_tr_b16 v[80:81], v21 offset:2624
    v_mfma_f32_16x16x32_bf16 v[52:55], v[100:103], a[152:155], v[52:55]
    ds_read_b64_tr_b16 v[82:83], v21 offset:15424
    v_mfma_f32_16x16x32_bf16 v[56:59], v[104:107], a[72:75], v[56:59]
    ds_read_b64_tr_b16 v[84:85], v21 offset:2656
    v_mfma_f32_16x16x32_bf16 v[60:63], v[104:107], a[152:155], v[60:63]
    ds_read_b64_tr_b16 v[86:87], v21 offset:15456
    v_mfma_f32_16x16x32_bf16 v[64:67], v[108:111], a[72:75], v[64:67]
    ds_read_b64_tr_b16 v[88:89], v21 offset:2688
    v_mfma_f32_16x16x32_bf16 v[68:71], v[108:111], a[152:155], v[68:71]
    ds_read_b64_tr_b16 v[90:91], v21 offset:15488
    s_waitcnt lgkmcnt(0)
    v_mfma_f32_16x16x32_bf16 v[32:35], v[72:75], a[76:79], v[32:35]
    v_mfma_f32_16x16x32_bf16 v[36:39], v[72:75], a[156:159], v[36:39]
    v_mfma_f32_16x16x32_bf16 v[40:43], v[76:79], a[76:79], v[40:43]
    v_mfma_f32_16x16x32_bf16 v[44:47], v[76:79], a[156:159], v[44:47]
    v_mfma_f32_16x16x32_bf16 v[48:51], v[80:83], a[76:79], v[48:51]
    v_mfma_f32_16x16x32_bf16 v[52:55], v[80:83], a[156:159], v[52:55]
    v_mfma_f32_16x16x32_bf16 v[56:59], v[84:87], a[76:79], v[56:59]
    v_mfma_f32_16x16x32_bf16 v[60:63], v[84:87], a[156:159], v[60:63]
    v_mfma_f32_16x16x32_bf16 v[64:67], v[88:91], a[76:79], v[64:67]
    v_mfma_f32_16x16x32_bf16 v[68:71], v[88:91], a[156:159], v[68:71]
    s_nop 7
    v_cvt_pk_bf16_f32 v32, v32, v33
    v_cvt_pk_bf16_f32 v33, v34, v35
    buffer_store_dwordx2 v[32:33], v23, s[44:47], s36 offen offset:160 sc1
    v_cvt_pk_bf16_f32 v40, v40, v41
    v_cvt_pk_bf16_f32 v41, v42, v43
    buffer_store_dwordx2 v[40:41], v23, s[44:47], s36 offen offset:192 sc1
    v_cvt_pk_bf16_f32 v48, v48, v49
    v_cvt_pk_bf16_f32 v49, v50, v51
    buffer_store_dwordx2 v[48:49], v23, s[44:47], s36 offen offset:224 sc1
    v_cvt_pk_bf16_f32 v56, v56, v57
    v_cvt_pk_bf16_f32 v57, v58, v59
    buffer_store_dwordx2 v[56:57], v23, s[44:47], s36 offen offset:256 sc1
    v_cvt_pk_bf16_f32 v64, v64, v65
    v_cvt_pk_bf16_f32 v65, v66, v67
    buffer_store_dwordx2 v[64:65], v23, s[44:47], s36 offen offset:288 sc1
    v_cvt_pk_bf16_f32 v36, v36, v37
    v_cvt_pk_bf16_f32 v37, v38, v39
    buffer_store_dwordx2 v[36:37], v23, s[44:47], s37 offen offset:160 sc1
    v_cvt_pk_bf16_f32 v44, v44, v45
    v_cvt_pk_bf16_f32 v45, v46, v47
    buffer_store_dwordx2 v[44:45], v23, s[44:47], s37 offen offset:192 sc1
    v_cvt_pk_bf16_f32 v52, v52, v53
    v_cvt_pk_bf16_f32 v53, v54, v55
    buffer_store_dwordx2 v[52:53], v23, s[44:47], s37 offen offset:224 sc1
    v_cvt_pk_bf16_f32 v60, v60, v61
    v_cvt_pk_bf16_f32 v61, v62, v63
    buffer_store_dwordx2 v[60:61], v23, s[44:47], s37 offen offset:256 sc1
    v_cvt_pk_bf16_f32 v68, v68, v69
    v_cvt_pk_bf16_f32 v69, v70, v71
    buffer_store_dwordx2 v[68:69], v23, s[44:47], s37 offen offset:288 sc1
    s_endpgm
L_fail2:
    s_waitcnt vmcnt(0)
    v_mov_b32 v4, 68
    v_mov_b32 v3, 1
    s_mov_b64 exec, 1
    buffer_atomic_add v3, v4, s[12:15], 0 offen
    s_waitcnt vmcnt(0)
L_end2:
    s_endpgm
L_codeend:

.section .rodata,"a"
.p2align 6
.amdhsa_kernel concat_heads__linear_kernel_hedgehog__memory_aug_recurrent_mem_tr__prompt_kernel
  .amdhsa_next_free_vgpr 512
  .amdhsa_next_free_sgpr 102
  .amdhsa_accum_offset 256
  .amdhsa_group_segment_fixed_size 0
  .amdhsa_kernarg_size 112
  .amdhsa_user_sgpr_count 2
  .amdhsa_user_sgpr_kernarg_segment_ptr 1
  .amdhsa_system_sgpr_workgroup_id_x 1
  .amdhsa_float_denorm_mode_32 3
.end_amdhsa_kernel
```
